```python
import torch

def _softmax(x, axis=-1):
    return torch.softmax(x, dim=axis)

def _gelu(x):
    return torch.nn.functional.gelu(x, approximate='tanh')

def _silu(x):
    return torch.nn.functional.silu(x)

def _sigmoid(x):
    return torch.sigmoid(x)

def _layernorm(x, axis=-1, eps=1e-05):
    m = x.mean(dim=axis, keepdim=True)
    v = x.var(dim=axis, keepdim=True, unbiased=False)
    return (x - m) / torch.sqrt(v + eps)

def _scatter_add(tgt, idx, src, axis=0):
    return tgt.clone().index_add_(axis, idx, src)

def _segment_sum(src, seg, n):
    out = torch.zeros((n,) + src.shape[1:], dtype=src.dtype)
    return out.index_add_(0, seg, src)

def _pad(x, pw):
    flat = tuple((v for pair in reversed(pw) for v in pair))
    return torch.nn.functional.pad(x, flat)
kernel_name = 'parallel_sum__compressed_kv_cla__mixer_gmlp__prompt'

def setup_inputs():

    _w = lambda a: (lambda t: t.to(torch.bfloat16) if t.is_floating_point() else t)(torch.as_tensor(a))

    def _A_setup():
        B, H, Sq, Sk, D, M = (1, 32, 2048, 2048, 128, 576)
        Dc = 4 * D
        return {'x': _w((lambda *s: torch.randn(*s, dtype=torch.bfloat16) * 0.05)(B, Sq, M)), 'c_kv': _w((lambda *s: torch.randn(*s, dtype=torch.bfloat16) * 1.6)(B, Sk, Dc)), 'w_q': _w((lambda *s: torch.randn(*s, dtype=torch.bfloat16) * 1.6)(M, H, D) * M ** (-0.5)), 'w_uk': _w((lambda *s: torch.randn(*s, dtype=torch.bfloat16) * 1.6)(Dc, H, D) * Dc ** (-0.5)), 'w_uv': _w((lambda *s: torch.randn(*s, dtype=torch.bfloat16) * 1.6)(Dc, H, D) * Dc ** (-0.5)), 'w_o': _w((lambda *s: torch.randn(*s, dtype=torch.bfloat16) * 1.6)(H, D, M) * (H * D) ** (-0.5))}
    _A_in = _A_setup()

    def _B_setup():
        B, S, D, F = (1, 2048, 576, 4608)
        Fh = F // 2
        return {'x': _w((lambda *s: torch.randn(*s, dtype=torch.bfloat16) * 0.05)(B, S, D)), 'w_in': _w((lambda *s: torch.randn(*s, dtype=torch.bfloat16) * 0.4)(D, 2 * Fh)), 'w_sp': _w(0.01 * (lambda *s: torch.randn(*s, dtype=torch.bfloat16) * 0.4)(S, S)), 'b_sp': _w(1.0 + 0.01 * (lambda *s: torch.randn(*s, dtype=torch.bfloat16) * 0.05)(S)), 'w_out': _w((lambda *s: torch.randn(*s, dtype=torch.bfloat16) * 0.05)(Fh, D))}
    _B_in = _B_setup()
    return {'A_x': _A_in['x'], 'A_c_kv': _A_in['c_kv'], 'A_w_q': _A_in['w_q'], 'A_w_uk': _A_in['w_uk'], 'A_w_uv': _A_in['w_uv'], 'A_w_o': _A_in['w_o'], 'B_x': _B_in['x'], 'B_w_in': _B_in['w_in'], 'B_w_sp': _B_in['w_sp'], 'B_b_sp': _B_in['b_sp'], 'B_w_out': _B_in['w_out']}

def reference(A_x, A_c_kv, A_w_q, A_w_uk, A_w_uv, A_w_o, B_x, B_w_in, B_w_sp, B_b_sp, B_w_out):

    def _A_ref(x, c_kv, w_q, w_uk, w_uv, w_o):
        B, Sq, M = (x.shape[0], x.shape[1], x.shape[2])
        Sk = c_kv.shape[1]
        H, D = (w_q.shape[1], w_q.shape[2])
        q = torch.einsum('bqm,mhd->bhqd', x, w_q)
        k = torch.einsum('bkc,chd->bhkd', c_kv, w_uk)
        v = torch.einsum('bkc,chd->bhkd', c_kv, w_uv)
        scores = torch.einsum('bhqd,bhkd->bhqk', q, k) * D ** (-0.5)
        off = Sk - Sq
        qi = torch.arange(Sq)[:, None]
        kj = torch.arange(Sk)[None, :]
        cmask = kj <= qi + off
        scores = torch.where(cmask[None, None], scores, -1000000000.0)
        p = _softmax(scores, axis=-1)
        ctx = torch.einsum('bhqk,bhkd->bhqd', p, v)
        return torch.einsum('bhqd,hdm->bqm', ctx, w_o)

    def _B_ref(x, w_in, w_sp, b_sp, w_out):
        B, S, D = x.shape
        F = w_in.shape[-1]
        Fh = F // 2
        z = _gelu(torch.einsum('bsd,df->bsf', x, w_in))
        z1 = z[..., :Fh].clone()
        z2 = _layernorm(z[..., Fh:], axis=-1)
        g = torch.einsum('ts,bsf->btf', w_sp, z2) + b_sp[None, :, None]
        return torch.einsum('bsf,fd->bsd', z1 * g, w_out)
    x = A_x
    xn = _layernorm(x, axis=-1)
    return x + _A_ref(xn, A_c_kv, A_w_q, A_w_uk, A_w_uv, A_w_o) + _B_ref(xn, B_w_in, B_w_sp, B_b_sp, B_w_out)
```

```asm
; @launch grid=(256,1,1) block=(256,1,1) lds=163840
.amdgcn_target "amdgcn-amd-amdhsa--gfx950"
.macro N a,b,c
v_and_b32 v[\a:\a+0],\b,v[\c:\c+0]
.endm
.macro SL a,b,c
v_lshlrev_b32 v[\a:\a+0],\b,v[\c:\c+0]
.endm
.macro L a,b,c
buffer_load_dwordx4 v[\a:\a+0],s[\b:\b+3],s[\c:\c+0] offen lds
.endm
.macro L1 a,b,c,o
buffer_load_dwordx4 v[\a:\a+0],s[\b:\b+3],s[\c:\c+0] offen offset:\o lds
.endm
.macro L2 a,b,c,d
buffer_load_dwordx4 v[\a:\a+3],v[\b:\b+0],s[\c:\c+3],s[\d:\d+0] offen
.endm
.macro L3 a,b,c,d,o
buffer_load_dwordx4 v[\a:\a+3],v[\b:\b+0],s[\c:\c+3],s[\d:\d+0] offen offset:\o
.endm
.macro V a,b
v_mov_b32 v[\a:\a+0],\b
.endm
.macro K a,b,c,d
v_cndmask_b32 v[\a:\a+0],v[\b:\b+0],\c,\d
.endm
.macro AW a,b
v_accvgpr_write_b32 a[\a:\a+0],v[\b:\b+0]
.endm
.macro A a,b,c
v_add_f32 v[\a:\a+0],v[\b:\b+0],v[\c:\c+0]
.endm
.macro V1 a,b
v_mov_b32 v[\a:\a+0],v[\b:\b+0]
.endm
.macro U a,b,c
v_mul_f32 v[\a:\a+0],\b,v[\c:\c+0]
.endm
.macro F a,b,c,d
v_fma_f32 v[\a:\a+0],\b,v[\c:\c+0],v[\d:\d+0]
.endm
.macro C a,b,c
v_cvt_pk_bf16_f32 v[\a:\a+0],v[\b:\b+0],v[\c:\c+0]
.endm
.macro A1 a,b,c
v_add_f32 v[\a:\a+0],\b,v[\c:\c+0]
.endm
.macro RC a,b
v_rcp_f32 v[\a:\a+0],v[\b:\b+0]
.endm
.macro U1 a,b,c
v_mul_f32 v[\a:\a+0],v[\b:\b+0],v[\c:\c+0]
.endm
.macro B a,b,c
v_sub_f32 v[\a:\a+0],\b,v[\c:\c+0]
.endm
.macro F1 a,b,c,d
v_fma_f32 v[\a:\a+0],v[\b:\b+0],v[\c:\c+0],v[\d:\d+0]
.endm
.macro S a,b,c,d
buffer_store_dwordx4 v[\a:\a+3],v[\b:\b+0],s[\c:\c+3],s[\d:\d+0] offen sc1
.endm
.macro T a,b,o
ds_read_b64_tr_b16 a[\a:\a+1],v[\b:\b+0] offset:\o
.endm
.macro R a,b,o
ds_read_b128 a[\a:\a+3],v[\b:\b+0] offset:\o
.endm
.macro M a,b,c,d
v_mfma_f32_16x16x32_bf16 v[\a:\a+3],a[\b:\b+3],a[\c:\c+3],\d
.endm
.macro M1 a,b,c,d
v_mfma_f32_16x16x32_bf16 a[\a:\a+3],a[\b:\b+3],a[\c:\c+3],\d
.endm
.macro M2 a,b,c,d
v_mfma_f32_16x16x32_bf16 v[\a:\a+3],a[\b:\b+3],a[\c:\c+3],v[\d:\d+3]
.endm
.macro M3 a,b,c,d
v_mfma_f32_16x16x32_bf16 a[\a:\a+3],a[\b:\b+3],a[\c:\c+3],a[\d:\d+3]
.endm
.macro L4 a,b,c,d
buffer_load_dwordx4 a[\a:\a+3],v[\b:\b+0],s[\c:\c+3],s[\d:\d+0] offen sc1
.endm
.macro L5 a,b,c,d,o
buffer_load_dwordx4 a[\a:\a+3],v[\b:\b+0],s[\c:\c+3],s[\d:\d+0] offen offset:\o sc1
.endm
.macro AR a,b
v_accvgpr_read_b32 v[\a:\a+0],a[\b:\b+0]
.endm
.macro S1 a,b,c,d,o
buffer_store_dwordx4 v[\a:\a+3],v[\b:\b+0],s[\c:\c+3],s[\d:\d+0] offen offset:\o sc1
.endm
.macro L6 a,b,c
buffer_load_dwordx4 v[\a:\a+0],s[\b:\b+3],s[\c:\c+0] offen sc1 lds
.endm
.macro L7 a,b,c,o
buffer_load_dwordx4 v[\a:\a+0],s[\b:\b+3],s[\c:\c+0] offen offset:\o sc1 lds
.endm
.macro PM a,b,c
v_pk_mul_f32 v[\a:\a+1],v[\b:\b+1],v[\c:\c+1]
.endm
.macro M4 a,b,c,d
v_mfma_f32_16x16x32_bf16 v[\a:\a+3],a[\b:\b+3],v[\c:\c+3],\d
.endm
.macro M5 a,b,c,d
v_mfma_f32_16x16x32_bf16 v[\a:\a+3],a[\b:\b+3],v[\c:\c+3],v[\d:\d+3]
.endm
.macro K1 a,b,c,d
v_cndmask_b32 v[\a:\a+0],v[\b:\b+0],v[\c:\c+0],s[\d:\d+1]
.endm
.macro B1 a,b,c
v_sub_f32 v[\a:\a+0],v[\b:\b+0],v[\c:\c+0]
.endm
.macro E a,b
v_exp_f32 v[\a:\a+0],v[\b:\b+0]
.endm
.macro M6 a,b,c,d
v_mfma_f32_16x16x32_bf16 a[\a:\a+3],a[\b:\b+3],v[\c:\c+3],\d
.endm
.macro M7 a,b,c,d
v_mfma_f32_16x16x32_bf16 a[\a:\a+3],a[\b:\b+3],v[\c:\c+3],a[\d:\d+3]
.endm
.macro E1 a,b
v_exp_f32 v[\a:\a+0],\b
.endm
.macro PF a,b,c,d
v_pk_fma_f32 v[\a:\a+1],v[\b:\b+1],v[\c:\c+1],v[\d:\d+1]
.endm
.macro PA a,b,c
v_pk_add_f32 v[\a:\a+1],v[\b:\b+1],v[\c:\c+1]
.endm
.macro R1 a,b,o
ds_read_b128 v[\a:\a+3],v[\b:\b+0] offset:\o
.endm
.macro N1 a,b,c
v_and_b32 v[\a:\a+0],s[\b:\b+0],v[\c:\c+0]
.endm
.macro F2 a,b,c,d
v_fma_f32 v[\a:\a+0],v[\b:\b+0],s[\c:\c+0],v[\d:\d+0]
.endm
.macro L8 a,b,c,d
buffer_load_dwordx4 v[\a:\a+3],v[\b:\b+0],s[\c:\c+3],s[\d:\d+0] offen sc1
.endm
.text
.globl parallel_sum__compressed_kv_cla__mixer_gmlp__prompt_kernel
.p2align 8
.type parallel_sum__compressed_kv_cla__mixer_gmlp__prompt_kernel,@function
parallel_sum__compressed_kv_cla__mixer_gmlp__prompt_kernel:
s_cmp_ge_u32 s2,256
s_cbranch_scc0 l12_go
s_endpgm
l12_go:
s_load_dwordx4 s[4:7],s[0:1],0
s_load_dwordx4 s[48:51],s[0:1],24
N 1,63,0
v_lshrrev_b32 v2,6,v0
SL 26,7,1
v_readfirstlane_b32 s30,v2
s_getpc_b64 s[96:97]
l12_pc:
s_and_b32 s97,s97,0xffff
s_mov_b32 s99,0x00020000
s_lshl_b32 s39,s30,11
s_add_u32 s98,s39,2048
buffer_load_dword a210,v26,s[96:99],s39 offen
s_load_dwordx4 s[92:95],s[0:1],96
s_load_dwordx2 s[16:17],s[0:1],16
s_load_dwordx2 s[18:19],s[0:1],56
v_lshrrev_b32 v60,5,v1
s_and_b32 s39,s30,1
s_lshl_b32 s39,s39,3
v_lshl_add_u32 v61,v60,1,s39
N 62,31,1
v_xor_b32 v61,v61,v62
s_mul_i32 s39,s30,65536
v_lshl_add_u32 v61,v61,4,s39
v_mul_u32_u24 v60,8192,v60
v_add_u32 v2,v60,v61
v_xor_b32 v3,64,v2
v_add_u32 v4,30720,v2
v_add_u32 v3,15360,v3
v_add_u32 v5,30720,v3
v_lshrrev_b32 v60,3,v1
v_lshrrev_b32 v61,4,v1
N 62,7,1
v_xor_b32 v61,v61,v62
s_mul_i32 s39,s30,65536
v_lshl_add_u32 v61,v61,4,s39
v_mul_u32_u24 v60,1024,v60
v_add_u32 v14,v60,v61
v_xor_b32 v15,64,v14
v_add_u32 v16,14336,v14
v_add_u32 v15,7168,v15
v_add_u32 v17,14336,v15
s_and_b32 s39,s2,7
s_lshl_b32 s39,s39,1
s_bfe_u32 s11,s2,0x10003
s_add_u32 s11,s11,s39
s_lshr_b32 s10,s2,5
s_add_u32 s10,s10,5
s_and_b32 s10,s10,7
s_bfe_u32 s39,s2,0x20003
s_add_u32 s39,s39,s10
s_and_b32 s39,s39,3
s_lshl_b32 s31,s11,9
s_lshl_b32 s40,s39,19
s_add_u32 s31,s31,s40
s_lshl_b32 s32,s10,18
s_lshl_b32 s40,s39,7
s_add_u32 s32,s32,s40
s_add_u32 s33,s32,32768
s_lshl_b32 s34,s30,12
s_lshl_b32 s35,s30,13
s_mov_b32 s46,2097152
s_mov_b32 s47,0x00020000
s_bitcmp1_b32 s2,4
s_waitcnt lgkmcnt(0)
s_cselect_b32 s48,s50,s48
s_cselect_b32 s49,s51,s49
s_and_b32 s49,s49,0xffff
s_mov_b32 s50,4194304
s_mov_b32 s51,0x00020000
s_mov_b32 s44,s6
s_and_b32 s45,s7,0xffff
s_add_u32 m0,s34,0
s_nop 0
L 2,48,31
L1 3,48,31,1024
L1 4,48,31,2048
L1 5,48,31,3072
s_add_u32 s31,s31,262144
s_and_b32 s31,s31,0xffdfffff
s_add_u32 m0,s35,65536
s_nop 0
L 14,44,32
L1 15,44,32,1024
L1 16,44,32,2048
L1 17,44,32,3072
s_add_u32 s32,s32,128
s_and_b32 s32,s32,0xfffffdff
s_add_u32 m0,s35,69632
s_nop 0
L 14,44,33
L1 15,44,33,1024
L1 16,44,33,2048
L1 17,44,33,3072
s_add_u32 s33,s33,128
s_and_b32 s33,s33,0xfffffdff
N 42,7,1
v_lshrrev_b32 v43,3,v1
v_mul_u32_u24 v40,1152,v42
v_lshl_add_u32 v40,v43,4,v40
s_cmp_eq_u32 s30,0
s_cselect_b32 s40,0,1073741824
v_add_u32 v41,s40,v40
s_mul_i32 s39,s2,9216
s_lshl_b32 s38,s30,7
s_add_u32 s38,s38,s39
s_mov_b32 s52,s4
s_and_b32 s53,s5,0xffff
s_mov_b32 s54,2359296
s_mov_b32 s55,0x00020000
L2 48,40,52,38
L3 52,40,52,38,512
L3 56,41,52,38,1024
s_add_u32 m0,s34,16384
s_nop 0
L 2,48,31
L1 3,48,31,1024
L1 4,48,31,2048
L1 5,48,31,3072
s_add_u32 s31,s31,262144
s_and_b32 s31,s31,0xffdfffff
s_lshr_b32 s39,s2,3
s_lshl_b32 s39,s39,2
s_add_u32 s39,s39,s30
s_mul_i32 s39,s39,2048
s_add_u32 s39,s39,8192
s_add_u32 s38,s39,2048
s_min_u32 s98,s38,code_end-l12_pc
buffer_load_dword a211,v26,s[96:99],s39 offen
s_mov_b32 s88,s96
s_mov_b32 s89,s97
s_mov_b32 s91,s99
s_and_b32 s36,s30,1
s_lshr_b32 s37,s30,1
s_lshl_b32 s36,s36,3
s_lshl_b32 s37,s37,3
v_lshrrev_b32 v60,4,v1
v_bfe_u32 v61,v1,2,2
v_lshl_add_u32 v61,v60,3,v61
N 63,3,61
v_bfe_u32 v60,v61,3,1
v_lshl_add_u32 v63,v60,2,v63
v_mul_u32_u24 v61,512,v61
N 62,3,1
v_lshl_add_u32 v61,v62,3,v61
s_lshl_b32 s39,s36,5
s_add_u32 s39,s39,0
v_lshl_add_u32 v61,v63,5,v61
v_add_u32 v6,s39,v61
v_xor_b32 v7,32,v6
v_xor_b32 v8,64,v6
v_xor_b32 v9,96,v6
v_xor_b32 v10,128,v6
v_xor_b32 v11,160,v6
v_xor_b32 v12,192,v6
v_xor_b32 v13,224,v6
N 60,15,1
v_lshrrev_b32 v61,1,v60
v_lshrrev_b32 v62,4,v1
v_xor_b32 v61,v61,v62
SL 61,4,61
v_lshl_add_u32 v60,v60,7,v61
s_lshl_b32 s39,s37,11
s_add_u32 s39,s39,65536
v_add_u32 v18,s39,v60
v_xor_b32 v60,64,v60
v_add_u32 v19,s39,v60
v_add_u32 v20,0x10000,v18
v_add_u32 v21,0x10000,v19
s_mov_b32 s8,s94
s_mov_b32 s9,s95
s_and_b32 s93,s93,0xffff
s_mov_b32 s94,256
s_mov_b32 s95,0x00020000
s_add_u32 s12,s8,4194304
s_addc_u32 s13,s9,0
s_and_b32 s13,s13,0xffff
s_mov_b32 s14,33554432
s_mov_b32 s15,0x00020000
s_add_u32 s96,s8,4194304
s_addc_u32 s97,s9,0
s_and_b32 s97,s97,0xffff
s_mov_b32 s98,33554432
s_mov_b32 s99,0x00020000
s_add_u32 s20,s8,0
s_addc_u32 s21,s9,0
s_and_b32 s21,s21,0xffff
s_mov_b32 s22,2359296
s_mov_b32 s23,0x00020000
s_add_u32 s24,s8,48234496
s_addc_u32 s25,s9,0
s_and_b32 s25,s25,0xffff
s_mov_b32 s26,26214400
s_mov_b32 s27,0x00020000
SL 27,4,1
V 28,1
V 29,1073741824
v_cmp_eq_u32 vcc,0,v0
s_lshl_b32 s3,s2,2
s_add_u32 s3,s3,s30
K 29,29,0,vcc
s_lshl_b32 s38,s11,1
s_lshr_b32 s39,s36,3
s_add_u32 s38,s38,s39
s_lshl_b32 s38,s38,20
s_lshl_b32 s39,s10,17
s_add_u32 s38,s38,s39
s_lshl_b32 s39,s37,13
s_add_u32 s38,s38,s39
V 24,1073741824
V 25,1073741824
V 30,1073741824
V 31,1073741824
s_cmp_lt_u32 s2,96
s_cbranch_scc1 l12_gsetup
s_lshr_b32 s39,s2,3
s_sub_u32 s39,s39,12
s_lshr_b32 s28,s39,2
s_sub_u32 s28,7,s28
s_and_b32 s39,s39,3
s_and_b32 s29,s2,7
s_lshl_b32 s29,s29,2
s_add_u32 s29,s29,s39
s_and_b32 s17,s17,0xffff
s_mov_b32 s18,4718592
s_mov_b32 s19,0x00020000
s_lshl_b32 s43,s30,11
s_mov_b32 s42,0
v_lshrrev_b32 v60,4,v1
s_and_b32 s39,s30,1
s_lshl_b32 s39,s39,3
v_lshl_add_u32 v61,v60,1,s39
N 62,15,1
v_xor_b32 v61,v61,v62
s_mul_i32 s39,s30,65536
v_lshl_add_u32 v61,v61,4,s39
v_mul_u32_u24 v60,8192,v60
v_add_u32 v22,v60,v61
v_add_u32 v23,31744,v22
v_lshrrev_b32 v60,4,v1
v_bfe_u32 v61,v1,2,2
v_lshl_add_u32 v61,v60,3,v61
N 63,3,61
v_bfe_u32 v60,v61,3,1
v_lshl_add_u32 v63,v60,2,v63
v_mul_u32_u24 v61,256,v61
N 62,3,1
v_lshl_add_u32 v61,v62,3,v61
s_lshl_b32 s39,s42,5
s_add_u32 s39,s39,98304
v_lshl_add_u32 v61,v63,5,v61
v_add_u32 v32,s39,v61
v_xor_b32 v33,32,v32
v_xor_b32 v34,64,v32
v_xor_b32 v35,96,v32
v_xor_b32 v36,128,v32
v_xor_b32 v37,160,v32
v_xor_b32 v38,192,v32
v_xor_b32 v39,224,v32
AW 196,32
AW 197,33
AW 198,34
AW 199,35
AW 200,36
AW 201,37
AW 202,38
AW 203,39
s_lshl_b32 s41,s29,8
s_mov_b32 s42,0
s_lshl_b32 s39,s28,3
s_add_u32 s39,s39,s30
s_lshl_b32 s39,s39,11
v_add_u32 v30,s39,v27
s_lshl_b32 s39,s28,3
s_add_u32 s39,s39,7
s_sub_u32 s39,s39,s30
s_lshl_b32 s39,s39,11
v_add_u32 v31,s39,v27
s_branch l12_ln
l12_gsetup:
s_and_b32 s28,s2,1
s_lshl_b32 s28,s28,2
s_bfe_u32 s39,s2,0x20003
s_add_u32 s28,s28,s39
s_bfe_u32 s29,s2,0x20001
s_mul_i32 s29,s29,3
s_lshr_b32 s39,s2,5
s_add_u32 s29,s29,s39
s_mov_b32 s16,s18
s_and_b32 s17,s19,0xffff
s_mov_b32 s18,5308416
s_mov_b32 s19,0x00020000
s_and_b32 s42,s30,1
s_mul_i32 s42,s42,6
s_mul_i32 s39,s30,4096
SL 60,4,1
v_add_u32 v22,s39,v60
s_lshl_b32 s39,s37,10
s_add_u32 s39,s39,98304
v_bfe_u32 v61,v1,3,1
SL 61,10,61
v_bfe_u32 v62,v1,2,1
v_lshl_add_u32 v61,v62,7,v61
N 62,3,1
v_lshl_add_u32 v61,v62,4,v61
v_lshrrev_b32 v62,4,v1
v_lshl_add_u32 v61,v62,8,v61
v_add_u32 v32,s39,v61
s_mul_i32 s39,s30,192
v_add_u32 v60,s39,v1
v_mul_u32_u24 v61,2731,v60
v_lshrrev_b32 v61,16,v61
v_mul_u32_u24 v62,24,v61
v_sub_u32 v62,v60,v62
v_bfe_u32 v63,v61,1,1
v_bfe_u32 v23,v61,3,1
v_lshl_add_u32 v63,v23,1,v63
SL 63,1,63
v_xor_b32 v62,v62,v63
v_mul_u32_u24 v61,9216,v61
v_lshl_add_u32 v23,v62,4,v61
v_add_u32 v60,64,v60
v_mul_u32_u24 v61,2731,v60
v_lshrrev_b32 v61,16,v61
v_mul_u32_u24 v62,24,v61
v_sub_u32 v62,v60,v62
v_bfe_u32 v63,v61,1,1
v_bfe_u32 v24,v61,3,1
v_lshl_add_u32 v63,v24,1,v63
SL 63,1,63
v_xor_b32 v62,v62,v63
v_mul_u32_u24 v61,9216,v61
v_lshl_add_u32 v24,v62,4,v61
v_subrev_u32 v24,1024,v24
v_add_u32 v60,64,v60
v_mul_u32_u24 v61,2731,v60
v_lshrrev_b32 v61,16,v61
v_mul_u32_u24 v62,24,v61
v_sub_u32 v62,v60,v62
v_bfe_u32 v63,v61,1,1
v_bfe_u32 v25,v61,3,1
v_lshl_add_u32 v63,v25,1,v63
SL 63,1,63
v_xor_b32 v62,v62,v63
v_mul_u32_u24 v61,9216,v61
v_lshl_add_u32 v25,v62,4,v61
v_subrev_u32 v25,2048,v25
v_lshrrev_b32 v60,4,v1
v_bfe_u32 v61,v1,2,2
v_lshl_add_u32 v61,v60,3,v61
v_bfe_u32 v63,v61,1,1
v_bfe_u32 v60,v61,3,1
v_lshl_add_u32 v63,v60,1,v63
v_mul_u32_u24 v61,384,v61
N 62,3,1
v_lshl_add_u32 v61,v62,3,v61
s_add_u32 s39,s42,0
v_xor_b32 v62,s39,v63
v_lshl_add_u32 v33,v62,5,v61
s_add_u32 s39,s42,1
v_xor_b32 v62,s39,v63
v_lshl_add_u32 v34,v62,5,v61
s_add_u32 s39,s42,2
v_xor_b32 v62,s39,v63
v_lshl_add_u32 v35,v62,5,v61
s_add_u32 s39,s42,3
v_xor_b32 v62,s39,v63
v_lshl_add_u32 v36,v62,5,v61
s_add_u32 s39,s42,4
v_xor_b32 v62,s39,v63
v_lshl_add_u32 v37,v62,5,v61
s_add_u32 s39,s42,5
v_xor_b32 v62,s39,v63
v_lshl_add_u32 v38,v62,5,v61
AW 196,32
AW 197,33
AW 198,34
AW 199,35
AW 200,36
AW 201,37
AW 202,38
s_lshl_b32 s41,s28,14
s_mul_i32 s42,s29,384
s_add_u32 s42,s42,4608
s_lshl_b32 s43,s30,12
l12_ln:
v_lshrrev_b32 v44,2,v43
SL 44,17,44
N 45,3,43
v_lshl_add_u32 v44,v45,8,v44
v_lshl_add_u32 v44,v42,4,v44
v_add_u32 v45,s40,v44
SL 46,3,42
v_add_u32 v46,163584,v46
s_lshl_b32 s39,s30,6
v_add_u32 v47,s39,v46
s_mov_b32 s39,0x3f803f80
V 60,0
V 61,0
V 62,0
V 63,0
s_waitcnt vmcnt(5)
s_add_u32 m0,s34,32768
s_nop 0
L 2,48,31
L1 3,48,31,1024
L1 4,48,31,2048
L1 5,48,31,3072
s_add_u32 s31,s31,262144
s_and_b32 s31,s31,0xffdfffff
s_add_u32 m0,s35,98304
s_nop 0
L 14,44,32
L1 15,44,32,1024
L1 16,44,32,2048
L1 17,44,32,3072
s_add_u32 s32,s32,128
s_and_b32 s32,s32,0xfffffdff
s_add_u32 m0,s35,102400
s_nop 0
L 14,44,33
L1 15,44,33,1024
L1 16,44,33,2048
L1 17,44,33,3072
s_add_u32 s33,s33,128
s_and_b32 s33,s33,0xfffffdff
v_dot2_f32_bf16 v60,v48,s39,v60
v_dot2_f32_bf16 v62,v48,v48,v62
v_dot2_f32_bf16 v61,v49,s39,v61
v_dot2_f32_bf16 v63,v49,v49,v63
v_dot2_f32_bf16 v60,v50,s39,v60
v_dot2_f32_bf16 v62,v50,v50,v62
v_dot2_f32_bf16 v61,v51,s39,v61
v_dot2_f32_bf16 v63,v51,v51,v63
v_dot2_f32_bf16 v60,v52,s39,v60
v_dot2_f32_bf16 v62,v52,v52,v62
v_dot2_f32_bf16 v61,v53,s39,v61
v_dot2_f32_bf16 v63,v53,v53,v63
v_dot2_f32_bf16 v60,v54,s39,v60
v_dot2_f32_bf16 v62,v54,v54,v62
v_dot2_f32_bf16 v61,v55,s39,v61
v_dot2_f32_bf16 v63,v55,v55,v63
v_dot2_f32_bf16 v60,v56,s39,v60
v_dot2_f32_bf16 v62,v56,v56,v62
v_dot2_f32_bf16 v61,v57,s39,v61
v_dot2_f32_bf16 v63,v57,v57,v63
v_dot2_f32_bf16 v60,v58,s39,v60
v_dot2_f32_bf16 v62,v58,v58,v62
v_dot2_f32_bf16 v61,v59,s39,v61
v_dot2_f32_bf16 v63,v59,v59,v63
s_nop 2
A 60,60,61
A 61,62,63
s_nop 1
v_add_f32_dpp v60,v60,v60 row_ror:8 row_mask:0xf bank_mask:0xf
v_add_f32_dpp v61,v61,v61 row_ror:8 row_mask:0xf bank_mask:0xf
V1 62,60
s_nop 1
v_permlane16_swap_b32 v62,v60
s_nop 1
A 60,60,62
V1 62,60
s_nop 1
v_permlane32_swap_b32 v62,v60
s_nop 1
A 60,60,62
V1 62,61
s_nop 1
v_permlane16_swap_b32 v62,v61
s_nop 1
A 61,61,62
V1 62,61
s_nop 1
v_permlane32_swap_b32 v62,v61
s_nop 1
A 61,61,62
ds_write_b64 v47,v[60:61]
s_waitcnt lgkmcnt(0)
s_barrier
ds_read_b64 v[64:65],v46 offset:0
ds_read_b64 v[66:67],v46 offset:64
ds_read_b64 v[68:69],v46 offset:128
ds_read_b64 v[70:71],v46 offset:192
s_lshr_b32 s39,s2,1
s_lshl_b32 s39,s39,10
s_and_b32 s40,s2,1
s_lshl_b32 s40,s40,7
s_add_u32 s39,s39,s40
s_lshl_b32 s40,s30,18
s_add_u32 s39,s39,s40
s_waitcnt lgkmcnt(0)
A 64,64,66
A 65,65,67
A 64,64,68
A 65,65,69
A 64,64,70
A 65,65,71
s_add_u32 m0,s34,49152
s_nop 0
L 2,48,31
L1 3,48,31,1024
L1 4,48,31,2048
L1 5,48,31,3072
s_add_u32 s31,s31,262144
s_and_b32 s31,s31,0xffdfffff
U 64,0.001736111111111111,64
U 65,0.001736111111111111,65
F 65,-v64,64,65
v_max_f32 v65,0,v65
C 65,65,65
N 65,0xffff0000,65
A1 65,0x3727c5ac,65
C 65,65,65
N 65,0xffff0000,65
v_sqrt_f32 v65,v65
s_nop 0
C 65,65,65
N 65,0xffff0000,65
RC 66,65
C 64,64,64
N 64,0xffff0000,64
s_nop 0
U1 67,64,66
B 67,0,67
SL 60,16,48
N 61,0xffff0000,48
F1 60,60,66,67
F1 61,61,66,67
C 48,60,61
SL 60,16,49
N 61,0xffff0000,49
F1 60,60,66,67
F1 61,61,66,67
C 49,60,61
SL 60,16,50
N 61,0xffff0000,50
F1 60,60,66,67
F1 61,61,66,67
C 50,60,61
SL 60,16,51
N 61,0xffff0000,51
F1 60,60,66,67
F1 61,61,66,67
C 51,60,61
S 48,44,20,39
s_add_u32 s39,s39,1048576
SL 60,16,52
N 61,0xffff0000,52
F1 60,60,66,67
F1 61,61,66,67
C 52,60,61
SL 60,16,53
N 61,0xffff0000,53
F1 60,60,66,67
F1 61,61,66,67
C 53,60,61
SL 60,16,54
N 61,0xffff0000,54
F1 60,60,66,67
F1 61,61,66,67
C 54,60,61
SL 60,16,55
N 61,0xffff0000,55
F1 60,60,66,67
F1 61,61,66,67
C 55,60,61
S 52,44,20,39
s_add_u32 s39,s39,1048576
SL 60,16,56
N 61,0xffff0000,56
F1 60,60,66,67
F1 61,61,66,67
C 56,60,61
SL 60,16,57
N 61,0xffff0000,57
F1 60,60,66,67
F1 61,61,66,67
C 57,60,61
SL 60,16,58
N 61,0xffff0000,58
F1 60,60,66,67
F1 61,61,66,67
C 58,60,61
SL 60,16,59
N 61,0xffff0000,59
F1 60,60,66,67
F1 61,61,66,67
C 59,60,61
S 56,45,20,39
s_add_u32 s52,s8,48168960
s_addc_u32 s53,s9,0
s_and_b32 s53,s53,0xffff
s_mov_b32 s54,65536
s_mov_b32 s55,0x00020000
v_mov_b32_e64 v60,0
s_lshl_b32 s39,s2,8
buffer_store_dword v60,v29,s[52:55],s39 offen sc1
s_barrier
T 0,6,0
R 64,18,0
T 2,6,2048
T 4,7,0
R 68,18,2048
T 6,7,2048
T 8,8,0
R 72,18,4096
T 10,8,2048
T 12,9,0
R 76,18,6144
T 14,9,2048
T 16,10,0
R 80,18,8192
T 18,10,2048
T 20,11,0
R 84,18,10240
T 22,11,2048
T 24,12,0
R 88,18,12288
T 26,12,2048
T 28,13,0
R 92,18,14336
T 30,13,2048
s_bitcmp1_b32 s2,4
s_cbranch_scc1 l12_v
s_waitcnt lgkmcnt(0)
s_waitcnt vmcnt(21)
s_barrier
M 128,0,64,0
s_add_u32 m0,s34,0
T 32,6,16384
R 96,19,0
M 144,0,68,0
L 2,48,31
M 160,0,72,0
T 34,6,18432
M 176,0,76,0
M 192,0,80,0
T 36,7,16384
L1 3,48,31,1024
M 208,0,84,0
M 224,0,88,0
R 100,19,2048
M 240,0,92,0
L1 4,48,31,2048
M 32,4,64,0
T 38,7,18432
M 48,4,68,0
M 64,4,72,0
T 40,8,16384
L1 5,48,31,3072
M 80,4,76,0
R 104,19,4096
M 96,4,80,0
M 112,4,84,0
s_add_u32 s31,s31,262144
T 42,8,18432
M1 224,4,88,0
M1 240,4,92,0
T 44,9,16384
M 132,8,64,0
s_and_b32 s31,s31,0xffdfffff
M 148,8,68,0
R 108,19,6144
M 164,8,72,0
M 180,8,76,0
s_add_u32 m0,s35,131072
T 46,9,18432
M 196,8,80,0
M 212,8,84,0
T 48,10,16384
L 14,44,32
M 228,8,88,0
R 112,19,8192
M 244,8,92,0
M 36,12,64,0
T 50,10,18432
L1 15,44,32,1024
M 52,12,68,0
M 68,12,72,0
T 52,11,16384
M 84,12,76,0
L1 16,44,32,2048
M 100,12,80,0
R 116,19,10240
M 116,12,84,0
M1 228,12,88,0
T 54,11,18432
L1 17,44,32,3072
M1 244,12,92,0
M 136,16,64,0
T 56,12,16384
M 152,16,68,0
s_add_u32 s32,s32,128
R 120,19,12288
M 168,16,72,0
M 184,16,76,0
T 58,12,18432
M 200,16,80,0
s_and_b32 s32,s32,0xfffffdff
M 216,16,84,0
T 60,13,16384
M 232,16,88,0
M 248,16,92,0
s_add_u32 m0,s35,135168
R 124,19,14336
M 40,20,64,0
M 56,20,68,0
T 62,13,18432
L 14,44,33
M 72,20,72,0
M 88,20,76,0
M 104,20,80,0
L1 15,44,33,1024
M 120,20,84,0
M1 232,20,88,0
M1 248,20,92,0
L1 16,44,33,2048
M 140,24,64,0
M 156,24,68,0
M 172,24,72,0
L1 17,44,33,3072
M 188,24,76,0
M 204,24,80,0
M 220,24,84,0
s_add_u32 s33,s33,128
M 236,24,88,0
M 252,24,92,0
M 44,28,64,0
s_and_b32 s33,s33,0xfffffdff
M 60,28,68,0
M 76,28,72,0
M 92,28,76,0
M 108,28,80,0
M 124,28,84,0
M1 236,28,88,0
s_waitcnt vmcnt(20) lgkmcnt(0)
M1 252,28,92,0
s_barrier
M2 128,32,96,128
s_add_u32 m0,s34,16384
T 0,6,32768
R 64,18,32768
M2 144,32,100,144
L 2,48,31
M2 160,32,104,160
T 2,6,34816
M2 176,32,108,176
M2 192,32,112,192
T 4,7,32768
L1 3,48,31,1024
M2 208,32,116,208
M2 224,32,120,224
R 68,18,34816
M2 240,32,124,240
L1 4,48,31,2048
M2 32,36,96,32
T 6,7,34816
M2 48,36,100,48
M2 64,36,104,64
T 8,8,32768
L1 5,48,31,3072
M2 80,36,108,80
R 72,18,36864
M2 96,36,112,96
M2 112,36,116,112
s_add_u32 s31,s31,262144
T 10,8,34816
M3 224,36,120,224
M3 240,36,124,240
T 12,9,32768
M2 132,40,96,132
s_and_b32 s31,s31,0xffdfffff
M2 148,40,100,148
R 76,18,38912
M2 164,40,104,164
M2 180,40,108,180
s_add_u32 m0,s35,65536
T 14,9,34816
M2 196,40,112,196
M2 212,40,116,212
T 16,10,32768
L 14,44,32
M2 228,40,120,228
R 80,18,40960
M2 244,40,124,244
M2 36,44,96,36
T 18,10,34816
L1 15,44,32,1024
M2 52,44,100,52
M2 68,44,104,68
T 20,11,32768
M2 84,44,108,84
L1 16,44,32,2048
M2 100,44,112,100
R 84,18,43008
M2 116,44,116,116
M3 228,44,120,228
T 22,11,34816
L1 17,44,32,3072
M3 244,44,124,244
M2 136,48,96,136
T 24,12,32768
M2 152,48,100,152
s_add_u32 s32,s32,128
R 88,18,45056
M2 168,48,104,168
M2 184,48,108,184
T 26,12,34816
M2 200,48,112,200
s_or_b32 s32,s32,0x200
M2 216,48,116,216
T 28,13,32768
M2 232,48,120,232
M2 248,48,124,248
s_add_u32 m0,s35,69632
R 92,18,47104
M2 40,52,96,40
M2 56,52,100,56
T 30,13,34816
L 14,44,33
M2 72,52,104,72
M2 88,52,108,88
M2 104,52,112,104
L1 15,44,33,1024
M2 120,52,116,120
M3 232,52,120,232
M3 248,52,124,248
L1 16,44,33,2048
M2 140,56,96,140
M2 156,56,100,156
M2 172,56,104,172
L1 17,44,33,3072
M2 188,56,108,188
M2 204,56,112,204
M2 220,56,116,220
s_add_u32 s33,s33,128
M2 236,56,120,236
M2 252,56,124,252
M2 44,60,96,44
s_or_b32 s33,s33,0x200
M2 60,60,100,60
M2 76,60,104,76
M2 92,60,108,92
M2 108,60,112,108
M2 124,60,116,124
M3 236,60,120,236
s_waitcnt vmcnt(24) lgkmcnt(0)
M3 252,60,124,252
s_barrier
M2 128,0,64,128
s_add_u32 m0,s34,32768
T 32,6,49152
R 96,19,32768
M2 144,0,68,144
M2 160,0,72,160
T 34,6,51200
M2 176,0,76,176
M2 192,0,80,192
L 2,48,31
T 36,7,49152
M2 208,0,84,208
M2 224,0,88,224
R 100,19,34816
M2 240,0,92,240
M2 32,4,64,32
T 38,7,51200
M2 48,4,68,48
L1 3,48,31,1024
M2 64,4,72,64
T 40,8,49152
M2 80,4,76,80
R 104,19,36864
M2 96,4,80,96
M2 112,4,84,112
T 42,8,51200
M3 224,4,88,224
M3 240,4,92,240
L1 4,48,31,2048
T 44,9,49152
M2 132,8,64,132
M2 148,8,68,148
R 108,19,38912
M2 164,8,72,164
M2 180,8,76,180
T 46,9,51200
M2 196,8,80,196
L1 5,48,31,3072
M2 212,8,84,212
T 48,10,49152
M2 228,8,88,228
R 112,19,40960
M2 244,8,92,244
M2 36,12,64,36
T 50,10,51200
M2 52,12,68,52
M2 68,12,72,68
s_add_u32 s31,s31,262144
T 52,11,49152
M2 84,12,76,84
M2 100,12,80,100
R 116,19,43008
M2 116,12,84,116
M3 228,12,88,228
T 54,11,51200
M3 244,12,92,244
s_and_b32 s31,s31,0xffdfffff
M2 136,16,64,136
T 56,12,49152
M2 152,16,68,152
R 120,19,45056
M2 168,16,72,168
M2 184,16,76,184
T 58,12,51200
M2 200,16,80,200
M2 216,16,84,216
s_and_b32 s39,s2,0xe0
T 60,13,49152
M2 232,16,88,232
M2 248,16,92,248
R 124,19,47104
M2 40,20,64,40
M2 56,20,68,56
T 62,13,51200
M2 72,20,72,72
s_bfe_u32 s40,s2,0x20003
M2 88,20,76,88
M2 104,20,80,104
M2 120,20,84,120
M3 232,20,88,232
M3 248,20,92,248
M2 140,24,64,140
s_cmp_eq_u32 s40,0
s_cselect_b32 s39,s39,1073741824
M2 156,24,68,156
M2 172,24,72,172
M2 188,24,76,188
M2 204,24,80,204
M2 220,24,84,220
buffer_atomic_add v28,v29,s[92:95],s39 offen sc1
M2 236,24,88,236
M2 252,24,92,252
M2 44,28,64,44
M2 60,28,68,60
M2 76,28,72,76
M2 92,28,76,92
M2 108,28,80,108
M2 124,28,84,124
M3 236,28,88,236
s_waitcnt vmcnt(17) lgkmcnt(0)
M3 252,28,92,252
s_barrier
M2 128,32,96,128
s_add_u32 m0,s34,49152
T 0,6,0
R 64,20,0
M2 144,32,100,144
M2 160,32,104,160
L 2,48,31
T 2,6,2048
M2 176,32,108,176
M2 192,32,112,192
T 4,7,0
M2 208,32,116,208
L1 3,48,31,1024
M2 224,32,120,224
R 68,20,2048
M2 240,32,124,240
M2 32,36,96,32
T 6,7,2048
L1 4,48,31,2048
M2 48,36,100,48
M2 64,36,104,64
T 8,8,0
M2 80,36,108,80
L1 5,48,31,3072
R 72,20,4096
M2 96,36,112,96
M2 112,36,116,112
T 10,8,2048
M3 224,36,120,224
s_add_u32 s31,s31,262144
M3 240,36,124,240
T 12,9,0
M2 132,40,96,132
M2 148,40,100,148
s_or_b32 s31,s31,0x200000
R 76,20,6144
M2 164,40,104,164
M2 180,40,108,180
T 14,9,2048
M2 196,40,112,196
M2 212,40,116,212
s_add_u32 m0,s35,98304
T 16,10,0
M2 228,40,120,228
R 80,20,8192
M2 244,40,124,244
M2 36,44,96,36
L 14,44,32
T 18,10,2048
M2 52,44,100,52
M2 68,44,104,68
T 20,11,0
M2 84,44,108,84
L1 15,44,32,1024
M2 100,44,112,100
R 84,20,10240
M2 116,44,116,116
M3 228,44,120,228
T 22,11,2048
L1 16,44,32,2048
M3 244,44,124,244
M2 136,48,96,136
T 24,12,0
M2 152,48,100,152
L1 17,44,32,3072
R 88,20,12288
M2 168,48,104,168
M2 184,48,108,184
T 26,12,2048
M2 200,48,112,200
s_add_u32 s32,s32,128
M2 216,48,116,216
T 28,13,0
M2 232,48,120,232
M2 248,48,124,248
R 92,20,14336
M2 40,52,96,40
s_and_b32 s32,s32,0xfffffbff
M2 56,52,100,56
T 30,13,2048
M2 72,52,104,72
M2 88,52,108,88
s_or_b32 s32,s32,0x200
M2 104,52,112,104
M2 120,52,116,120
M3 232,52,120,232
s_and_b32 s39,s2,0xe0
M3 248,52,124,248
M2 140,56,96,140
M2 156,56,100,156
s_bfe_u32 s40,s2,0x20003
M2 172,56,104,172
M2 188,56,108,188
M2 204,56,112,204
s_cmp_eq_u32 s40,1
s_cselect_b32 s39,s39,1073741824
M2 220,56,116,220
M2 236,56,120,236
M2 252,56,124,252
buffer_atomic_add v28,v29,s[92:95],s39 offen sc1
M2 44,60,96,44
M2 60,60,100,60
M2 76,60,104,76
M2 92,60,108,92
M2 108,60,112,108
M2 124,60,116,124
M3 236,60,120,236
s_waitcnt vmcnt(22) lgkmcnt(0)
M3 252,60,124,252
s_barrier
M2 128,0,64,128
s_add_u32 m0,s35,102400
T 32,6,16384
R 96,21,0
M2 144,0,68,144
M2 160,0,72,160
L 14,44,33
T 34,6,18432
M2 176,0,76,176
M2 192,0,80,192
T 36,7,16384
M2 208,0,84,208
L1 15,44,33,1024
M2 224,0,88,224
R 100,21,2048
M2 240,0,92,240
M2 32,4,64,32
L1 16,44,33,2048
T 38,7,18432
M2 48,4,68,48
M2 64,4,72,64
T 40,8,16384
M2 80,4,76,80
L1 17,44,33,3072
R 104,21,4096
M2 96,4,80,96
M2 112,4,84,112
T 42,8,18432
M3 224,4,88,224
s_add_u32 s33,s33,128
M3 240,4,92,240
T 44,9,16384
M2 132,8,64,132
M2 148,8,68,148
s_and_b32 s33,s33,0xfffffbff
R 108,21,6144
M2 164,8,72,164
M2 180,8,76,180
T 46,9,18432
M2 196,8,80,196
s_or_b32 s33,s33,0x200
M2 212,8,84,212
T 48,10,16384
M2 228,8,88,228
R 112,21,8192
M2 244,8,92,244
s_add_u32 m0,s34,0
M2 36,12,64,36
T 50,10,18432
M2 52,12,68,52
M2 68,12,72,68
L 2,48,31
T 52,11,16384
M2 84,12,76,84
M2 100,12,80,100
R 116,21,10240
M2 116,12,84,116
L1 3,48,31,1024
M3 228,12,88,228
T 54,11,18432
M3 244,12,92,244
M2 136,16,64,136
T 56,12,16384
L1 4,48,31,2048
M2 152,16,68,152
R 120,21,12288
M2 168,16,72,168
M2 184,16,76,184
L1 5,48,31,3072
T 58,12,18432
M2 200,16,80,200
M2 216,16,84,216
T 60,13,16384
M2 232,16,88,232
s_add_u32 s31,s31,262144
M2 248,16,92,248
R 124,21,14336
M2 40,20,64,40
M2 56,20,68,56
s_and_b32 s31,s31,0xffbfffff
T 62,13,18432
M2 72,20,72,72
M2 88,20,76,88
M2 104,20,80,104
s_or_b32 s31,s31,0x200000
M2 120,20,84,120
M3 232,20,88,232
M3 248,20,92,248
s_and_b32 s39,s2,0xe0
M2 140,24,64,140
M2 156,24,68,156
M2 172,24,72,172
s_bfe_u32 s40,s2,0x20003
M2 188,24,76,188
M2 204,24,80,204
M2 220,24,84,220
s_cmp_eq_u32 s40,2
s_cselect_b32 s39,s39,1073741824
M2 236,24,88,236
M2 252,24,92,252
M2 44,28,64,44
buffer_atomic_add v28,v29,s[92:95],s39 offen sc1
M2 60,28,68,60
M2 76,28,72,76
M2 92,28,76,92
M2 108,28,80,108
M2 124,28,84,124
M3 236,28,88,236
s_waitcnt vmcnt(19) lgkmcnt(0)
M3 252,28,92,252
s_barrier
M2 128,32,96,128
s_add_u32 m0,s34,16384
T 0,6,32768
R 64,18,0
M2 144,32,100,144
M2 160,32,104,160
L 2,48,31
T 2,6,34816
M2 176,32,108,176
M2 192,32,112,192
T 4,7,32768
M2 208,32,116,208
L1 3,48,31,1024
M2 224,32,120,224
R 68,18,2048
M2 240,32,124,240
M2 32,36,96,32
L1 4,48,31,2048
T 6,7,34816
M2 48,36,100,48
M2 64,36,104,64
T 8,8,32768
M2 80,36,108,80
L1 5,48,31,3072
R 72,18,4096
M2 96,36,112,96
M2 112,36,116,112
T 10,8,34816
M3 224,36,120,224
s_add_u32 s31,s31,262144
M3 240,36,124,240
T 12,9,32768
M2 132,40,96,132
M2 148,40,100,148
s_and_b32 s31,s31,0xffbfffff
R 76,18,6144
M2 164,40,104,164
M2 180,40,108,180
T 14,9,34816
M2 196,40,112,196
s_or_b32 s31,s31,0x200000
M2 212,40,116,212
T 16,10,32768
M2 228,40,120,228
R 80,18,8192
M2 244,40,124,244
s_add_u32 m0,s35,131072
M2 36,44,96,36
T 18,10,34816
M2 52,44,100,52
M2 68,44,104,68
L 14,44,32
T 20,11,32768
M2 84,44,108,84
M2 100,44,112,100
R 84,18,10240
M2 116,44,116,116
L1 15,44,32,1024
M3 228,44,120,228
T 22,11,34816
M3 244,44,124,244
M2 136,48,96,136
T 24,12,32768
L1 16,44,32,2048
M2 152,48,100,152
R 88,18,12288
M2 168,48,104,168
M2 184,48,108,184
L1 17,44,32,3072
T 26,12,34816
M2 200,48,112,200
M2 216,48,116,216
T 28,13,32768
M2 232,48,120,232
s_add_u32 s32,s32,128
M2 248,48,124,248
R 92,18,14336
M2 40,52,96,40
M2 56,52,100,56
s_and_b32 s32,s32,0xfffffbff
T 30,13,34816
M2 72,52,104,72
M2 88,52,108,88
M2 104,52,112,104
s_or_b32 s32,s32,0x200
M2 120,52,116,120
M3 232,52,120,232
M3 248,52,124,248
s_and_b32 s39,s2,0xe0
M2 140,56,96,140
M2 156,56,100,156
M2 172,56,104,172
s_bfe_u32 s40,s2,0x20003
M2 188,56,108,188
M2 204,56,112,204
M2 220,56,116,220
s_cmp_eq_u32 s40,3
s_cselect_b32 s39,s39,1073741824
M2 236,56,120,236
M2 252,56,124,252
M2 44,60,96,44
buffer_atomic_add v28,v29,s[92:95],s39 offen sc1
M2 60,60,100,60
M2 76,60,104,76
M2 92,60,108,92
M2 108,60,112,108
M2 124,60,116,124
M3 236,60,120,236
s_waitcnt vmcnt(23) lgkmcnt(0)
M3 252,60,124,252
s_barrier
M2 128,0,64,128
s_add_u32 m0,s35,135168
T 32,6,49152
R 96,19,0
M2 144,0,68,144
M2 160,0,72,160
T 34,6,51200
L 14,44,33
M2 176,0,76,176
M2 192,0,80,192
T 36,7,49152
M2 208,0,84,208
M2 224,0,88,224
R 100,19,2048
L1 15,44,33,1024
M2 240,0,92,240
M2 32,4,64,32
T 38,7,51200
M2 48,4,68,48
M2 64,4,72,64
T 40,8,49152
L1 16,44,33,2048
M2 80,4,76,80
R 104,19,4096
M2 96,4,80,96
M2 112,4,84,112
T 42,8,51200
M3 224,4,88,224
L1 17,44,33,3072
M3 240,4,92,240
T 44,9,49152
M2 132,8,64,132
M2 148,8,68,148
s_add_u32 s33,s33,128
R 108,19,6144
M2 164,8,72,164
M2 180,8,76,180
T 46,9,51200
M2 196,8,80,196
M2 212,8,84,212
s_and_b32 s33,s33,0xfffffbff
T 48,10,49152
M2 228,8,88,228
R 112,19,8192
M2 244,8,92,244
M2 36,12,64,36
T 50,10,51200
M2 52,12,68,52
s_or_b32 s33,s33,0x200
M2 68,12,72,68
T 52,11,49152
M2 84,12,76,84
M2 100,12,80,100
R 116,19,10240
M2 116,12,84,116
s_add_u32 m0,s34,32768
M3 228,12,88,228
T 54,11,51200
M3 244,12,92,244
M2 136,16,64,136
T 56,12,49152
L 2,48,31
M2 152,16,68,152
R 120,19,12288
M2 168,16,72,168
M2 184,16,76,184
T 58,12,51200
M2 200,16,80,200
L1 3,48,31,1024
M2 216,16,84,216
T 60,13,49152
M2 232,16,88,232
M2 248,16,92,248
R 124,19,14336
M2 40,20,64,40
L1 4,48,31,2048
M2 56,20,68,56
T 62,13,51200
M2 72,20,72,72
M2 88,20,76,88
M2 104,20,80,104
L1 5,48,31,3072
M2 120,20,84,120
M3 232,20,88,232
M3 248,20,92,248
s_add_u32 s31,s31,262144
M2 140,24,64,140
M2 156,24,68,156
M2 172,24,72,172
M2 188,24,76,188
s_and_b32 s31,s31,0xffbfffff
M2 204,24,80,204
M2 220,24,84,220
M2 236,24,88,236
M2 252,24,92,252
s_or_b32 s31,s31,0x200000
M2 44,28,64,44
M2 60,28,68,60
M2 76,28,72,76
M2 92,28,76,92
M2 108,28,80,108
M2 124,28,84,124
M3 236,28,88,236
s_waitcnt vmcnt(18) lgkmcnt(0)
M3 252,28,92,252
s_barrier
M2 128,32,96,128
s_add_u32 m0,s34,49152
T 0,6,0
R 64,18,32768
M2 144,32,100,144
M2 160,32,104,160
T 2,6,2048
L 2,48,31
M2 176,32,108,176
M2 192,32,112,192
T 4,7,0
M2 208,32,116,208
M2 224,32,120,224
R 68,18,34816
L1 3,48,31,1024
M2 240,32,124,240
M2 32,36,96,32
T 6,7,2048
M2 48,36,100,48
M2 64,36,104,64
T 8,8,0
L1 4,48,31,2048
M2 80,36,108,80
R 72,18,36864
M2 96,36,112,96
M2 112,36,116,112
T 10,8,2048
M3 224,36,120,224
L1 5,48,31,3072
M3 240,36,124,240
T 12,9,0
M2 132,40,96,132
M2 148,40,100,148
s_add_u32 s31,s31,262144
R 76,18,38912
M2 164,40,104,164
M2 180,40,108,180
T 14,9,2048
M2 196,40,112,196
M2 212,40,116,212
s_and_b32 s31,s31,0xffbfffff
T 16,10,0
M2 228,40,120,228
R 80,18,40960
M2 244,40,124,244
M2 36,44,96,36
T 18,10,2048
M2 52,44,100,52
s_or_b32 s31,s31,0x200000
M2 68,44,104,68
T 20,11,0
M2 84,44,108,84
M2 100,44,112,100
R 84,18,43008
M2 116,44,116,116
s_add_u32 m0,s35,65536
M3 228,44,120,228
T 22,11,2048
M3 244,44,124,244
M2 136,48,96,136
T 24,12,0
L 14,44,32
M2 152,48,100,152
R 88,18,45056
M2 168,48,104,168
M2 184,48,108,184
T 26,12,2048
M2 200,48,112,200
L1 15,44,32,1024
M2 216,48,116,216
T 28,13,0
M2 232,48,120,232
M2 248,48,124,248
R 92,18,47104
M2 40,52,96,40
L1 16,44,32,2048
M2 56,52,100,56
T 30,13,2048
M2 72,52,104,72
M2 88,52,108,88
M2 104,52,112,104
L1 17,44,32,3072
M2 120,52,116,120
M3 232,52,120,232
M3 248,52,124,248
s_add_u32 s32,s32,128
M2 140,56,96,140
M2 156,56,100,156
M2 172,56,104,172
M2 188,56,108,188
s_and_b32 s32,s32,0xfffffbff
M2 204,56,112,204
M2 220,56,116,220
M2 236,56,120,236
M2 252,56,124,252
s_or_b32 s32,s32,0x200
M2 44,60,96,44
M2 60,60,100,60
M2 76,60,104,76
M2 92,60,108,92
M2 108,60,112,108
M2 124,60,116,124
M3 236,60,120,236
s_waitcnt vmcnt(21) lgkmcnt(0)
M3 252,60,124,252
s_barrier
M2 128,0,64,128
s_add_u32 m0,s35,69632
T 32,6,16384
R 96,19,32768
M2 144,0,68,144
M2 160,0,72,160
T 34,6,18432
L 14,44,33
M2 176,0,76,176
M2 192,0,80,192
T 36,7,16384
M2 208,0,84,208
M2 224,0,88,224
R 100,19,34816
L1 15,44,33,1024
M2 240,0,92,240
M2 32,4,64,32
T 38,7,18432
M2 48,4,68,48
M2 64,4,72,64
T 40,8,16384
L1 16,44,33,2048
M2 80,4,76,80
R 104,19,36864
M2 96,4,80,96
M2 112,4,84,112
T 42,8,18432
M3 224,4,88,224
L1 17,44,33,3072
M3 240,4,92,240
T 44,9,16384
M2 132,8,64,132
M2 148,8,68,148
s_add_u32 s33,s33,128
R 108,19,38912
M2 164,8,72,164
M2 180,8,76,180
T 46,9,18432
M2 196,8,80,196
M2 212,8,84,212
s_and_b32 s33,s33,0xfffffbff
T 48,10,16384
M2 228,8,88,228
R 112,19,40960
M2 244,8,92,244
M2 36,12,64,36
T 50,10,18432
M2 52,12,68,52
s_or_b32 s33,s33,0x200
M2 68,12,72,68
T 52,11,16384
M2 84,12,76,84
M2 100,12,80,100
R 116,19,43008
M2 116,12,84,116
s_add_u32 m0,s34,0
M3 228,12,88,228
T 54,11,18432
M3 244,12,92,244
M2 136,16,64,136
T 56,12,16384
L 2,48,31
M2 152,16,68,152
R 120,19,45056
M2 168,16,72,168
M2 184,16,76,184
T 58,12,18432
M2 200,16,80,200
L1 3,48,31,1024
M2 216,16,84,216
T 60,13,16384
M2 232,16,88,232
M2 248,16,92,248
R 124,19,47104
M2 40,20,64,40
L1 4,48,31,2048
M2 56,20,68,56
T 62,13,18432
M2 72,20,72,72
M2 88,20,76,88
M2 104,20,80,104
L1 5,48,31,3072
M2 120,20,84,120
M3 232,20,88,232
M3 248,20,92,248
s_add_u32 s31,s31,262144
M2 140,24,64,140
M2 156,24,68,156
M2 172,24,72,172
M2 188,24,76,188
s_and_b32 s31,s31,0xffbfffff
M2 204,24,80,204
M2 220,24,84,220
M2 236,24,88,236
M2 252,24,92,252
s_or_b32 s31,s31,0x200000
M2 44,28,64,44
M2 60,28,68,60
M2 76,28,72,76
M2 92,28,76,92
M2 108,28,80,108
M2 124,28,84,124
M3 236,28,88,236
s_waitcnt vmcnt(16) lgkmcnt(0)
M3 252,28,92,252
s_barrier
M2 128,32,96,128
s_add_u32 m0,s34,16384
T 0,6,32768
R 64,20,0
M2 144,32,100,144
M2 160,32,104,160
L 2,48,31
T 2,6,34816
M2 176,32,108,176
M2 192,32,112,192
T 4,7,32768
M2 208,32,116,208
L1 3,48,31,1024
M2 224,32,120,224
R 68,20,2048
M2 240,32,124,240
M2 32,36,96,32
T 6,7,34816
L1 4,48,31,2048
M2 48,36,100,48
M2 64,36,104,64
T 8,8,32768
M2 80,36,108,80
L1 5,48,31,3072
R 72,20,4096
M2 96,36,112,96
M2 112,36,116,112
T 10,8,34816
M3 224,36,120,224
s_add_u32 s31,s31,262144
M3 240,36,124,240
T 12,9,32768
M2 132,40,96,132
M2 148,40,100,148
s_and_b32 s31,s31,0xffbfffff
R 76,20,6144
M2 164,40,104,164
M2 180,40,108,180
T 14,9,34816
M2 196,40,112,196
M2 212,40,116,212
s_or_b32 s31,s31,0x200000
T 16,10,32768
M2 228,40,120,228
R 80,20,8192
M2 244,40,124,244
M2 36,44,96,36
s_add_u32 m0,s35,98304
T 18,10,34816
M2 52,44,100,52
M2 68,44,104,68
T 20,11,32768
M2 84,44,108,84
L 14,44,32
M2 100,44,112,100
R 84,20,10240
M2 116,44,116,116
M3 228,44,120,228
T 22,11,34816
L1 15,44,32,1024
M3 244,44,124,244
M2 136,48,96,136
T 24,12,32768
M2 152,48,100,152
L1 16,44,32,2048
R 88,20,12288
M2 168,48,104,168
M2 184,48,108,184
T 26,12,34816
M2 200,48,112,200
L1 17,44,32,3072
M2 216,48,116,216
T 28,13,32768
M2 232,48,120,232
M2 248,48,124,248
R 92,20,14336
M2 40,52,96,40
s_add_u32 s32,s32,128
M2 56,52,100,56
T 30,13,34816
M2 72,52,104,72
M2 88,52,108,88
s_and_b32 s32,s32,0xfffffbff
M2 104,52,112,104
M2 120,52,116,120
M3 232,52,120,232
s_or_b32 s32,s32,0x200
M3 248,52,124,248
M2 140,56,96,140
M2 156,56,100,156
s_cmp_eq_u32 s30,0
s_cselect_b32 s40,0,1073741824
M2 172,56,104,172
M2 188,56,108,188
M2 204,56,112,204
v_lshl_add_u32 v26,v1,5,s40
M2 220,56,116,220
M2 236,56,120,236
M2 252,56,124,252
buffer_load_dword v0,v26,s[92:95],0 offen sc1
M2 44,60,96,44
M2 60,60,100,60
M2 76,60,104,76
M2 92,60,108,92
M2 108,60,112,108
M2 124,60,116,124
M3 236,60,120,236
s_waitcnt vmcnt(21) lgkmcnt(0)
M3 252,60,124,252
s_barrier
M2 128,0,64,128
s_add_u32 m0,s35,102400
T 32,6,49152
R 96,21,0
M2 144,0,68,144
M2 160,0,72,160
T 34,6,51200
L 14,44,33
M2 176,0,76,176
M2 192,0,80,192
T 36,7,49152
M2 208,0,84,208
M2 224,0,88,224
R 100,21,2048
L1 15,44,33,1024
M2 240,0,92,240
M2 32,4,64,32
T 38,7,51200
M2 48,4,68,48
M2 64,4,72,64
T 40,8,49152
L1 16,44,33,2048
M2 80,4,76,80
R 104,21,4096
M2 96,4,80,96
M2 112,4,84,112
T 42,8,51200
M3 224,4,88,224
L1 17,44,33,3072
M3 240,4,92,240
T 44,9,49152
M2 132,8,64,132
M2 148,8,68,148
s_add_u32 s33,s33,128
R 108,21,6144
M2 164,8,72,164
M2 180,8,76,180
T 46,9,51200
M2 196,8,80,196
M2 212,8,84,212
s_and_b32 s33,s33,0xfffffbff
T 48,10,49152
M2 228,8,88,228
R 112,21,8192
M2 244,8,92,244
M2 36,12,64,36
T 50,10,51200
M2 52,12,68,52
s_or_b32 s33,s33,0x200
M2 68,12,72,68
T 52,11,49152
M2 84,12,76,84
M2 100,12,80,100
R 116,21,10240
M2 116,12,84,116
s_add_u32 m0,s34,32768
M3 228,12,88,228
T 54,11,51200
M3 244,12,92,244
M2 136,16,64,136
T 56,12,49152
L 2,48,31
M2 152,16,68,152
R 120,21,12288
M2 168,16,72,168
M2 184,16,76,184
T 58,12,51200
M2 200,16,80,200
L1 3,48,31,1024
M2 216,16,84,216
T 60,13,49152
M2 232,16,88,232
M2 248,16,92,248
R 124,21,14336
M2 40,20,64,40
L1 4,48,31,2048
M2 56,20,68,56
T 62,13,51200
M2 72,20,72,72
M2 88,20,76,88
M2 104,20,80,104
L1 5,48,31,3072
M2 120,20,84,120
M3 232,20,88,232
M3 248,20,92,248
s_add_u32 s31,s31,262144
M2 140,24,64,140
M2 156,24,68,156
M2 172,24,72,172
M2 188,24,76,188
s_and_b32 s31,s31,0xffbfffff
M2 204,24,80,204
M2 220,24,84,220
M2 236,24,88,236
M2 252,24,92,252
s_or_b32 s31,s31,0x200000
M2 44,28,64,44
M2 60,28,68,60
M2 76,28,72,76
M2 92,28,76,92
M2 108,28,80,108
M2 124,28,84,124
M3 236,28,88,236
s_waitcnt vmcnt(17) lgkmcnt(0)
M3 252,28,92,252
s_barrier
M2 128,32,96,128
s_add_u32 m0,s34,49152
T 0,6,0
R 64,18,0
M2 144,32,100,144
M2 160,32,104,160
T 2,6,2048
M2 176,32,108,176
M2 192,32,112,192
T 4,7,0
M2 208,32,116,208
M2 224,32,120,224
R 68,18,2048
L 2,48,31
M2 240,32,124,240
M2 32,36,96,32
T 6,7,2048
M2 48,36,100,48
M2 64,36,104,64
T 8,8,0
M2 80,36,108,80
R 72,18,4096
M2 96,36,112,96
M2 112,36,116,112
T 10,8,2048
M3 224,36,120,224
L1 3,48,31,1024
M3 240,36,124,240
T 12,9,0
M2 132,40,96,132
M2 148,40,100,148
R 76,18,6144
M2 164,40,104,164
M2 180,40,108,180
T 14,9,2048
M2 196,40,112,196
M2 212,40,116,212
T 16,10,0
M2 228,40,120,228
L1 4,48,31,2048
R 80,18,8192
M2 244,40,124,244
M2 36,44,96,36
T 18,10,2048
M2 52,44,100,52
M2 68,44,104,68
T 20,11,0
M2 84,44,108,84
M2 100,44,112,100
R 84,18,10240
M2 116,44,116,116
M3 228,44,120,228
T 22,11,2048
L1 5,48,31,3072
M3 244,44,124,244
M2 136,48,96,136
T 24,12,0
M2 152,48,100,152
R 88,18,12288
M2 168,48,104,168
M2 184,48,108,184
T 26,12,2048
M2 200,48,112,200
M2 216,48,116,216
T 28,13,0
M2 232,48,120,232
s_add_u32 s31,s31,262144
M2 248,48,124,248
R 92,18,14336
M2 40,52,96,40
M2 56,52,100,56
T 30,13,2048
M2 72,52,104,72
M2 88,52,108,88
M2 104,52,112,104
M2 120,52,116,120
M3 232,52,120,232
s_and_b32 s31,s31,0xffbfffff
M3 248,52,124,248
M2 140,56,96,140
M2 156,56,100,156
M2 172,56,104,172
M2 188,56,108,188
M2 204,56,112,204
M2 220,56,116,220
M2 236,56,120,236
s_or_b32 s31,s31,0x200000
M2 252,56,124,252
M2 44,60,96,44
M2 60,60,100,60
M2 76,60,104,76
M2 92,60,108,92
M2 108,60,112,108
M2 124,60,116,124
M3 236,60,120,236
M3 252,60,124,252
l12_s0:
s_cmp_lt_u32 s2,96
s_cbranch_scc1 l12_g0
s_waitcnt vmcnt(12)
s_cmp_lg_u32 s30,0
s_cbranch_scc1 spinret_lnatt0
v_cmp_le_u32 vcc,32,v0
s_nop 3
s_and_b32 s39,vcc_lo,0xff
s_cmp_lg_u32 s39,0xff
s_cbranch_scc1 spin_lnatt0
spinret_lnatt0:
s_add_u32 s92,s8,48168960
s_addc_u32 s93,s9,0
s_and_b32 s93,s93,0xffff
s_mov_b32 s94,65536
s_mov_b32 s95,0x00020000
V1 26,29
s_and_b32 s39,s29,3
s_add_u32 s39,s39,s28
s_cmp_ge_u32 s39,6
s_cselect_b32 s4,6,0
s_sub_u32 s39,s39,s4
s_mov_b32 s4,s41
s_mul_i32 s5,s39,786432
s_add_u32 s41,s41,s5
s_add_u32 s5,s4,4718592
s_mov_b32 s6,s42
s_mul_i32 s7,s39,393216
s_add_u32 s42,s42,s7
s_add_u32 s7,s6,2359296
s_waitcnt lgkmcnt(0)
s_barrier
s_sub_i32 s10,5,s28
M2 128,0,64,128
s_add_u32 m0,s43,131072
T 32,6,16384
R 96,19,0
M2 144,0,68,144
M2 160,0,72,160
T 34,6,18432
M2 176,0,76,176
L 22,16,41
M2 192,0,80,192
T 36,7,16384
M2 208,0,84,208
M2 224,0,88,224
R 100,19,2048
M2 240,0,92,240
M2 32,4,64,32
T 38,7,18432
L1 23,16,41,1024
M2 48,4,68,48
M2 64,4,72,64
T 40,8,16384
M2 80,4,76,80
R 104,19,4096
M2 96,4,80,96
s_add_u32 s41,s41,262144
s_cmp_eq_u32 s41,s5
s_cselect_b32 s41,s4,s41
M2 112,4,84,112
T 42,8,18432
M3 224,4,88,224
M3 240,4,92,240
T 44,9,16384
M2 132,8,64,132
M2 148,8,68,148
R 108,19,6144
L4 128,30,20,42
M2 164,8,72,164
M2 180,8,76,180
T 46,9,18432
M2 196,8,80,196
M2 212,8,84,212
T 48,10,16384
M2 228,8,88,228
L5 132,30,20,42,1024
R 112,19,8192
M2 244,8,92,244
M2 36,12,64,36
T 50,10,18432
M2 52,12,68,52
M2 68,12,72,68
T 52,11,16384
L4 136,31,20,42
M2 84,12,76,84
M2 100,12,80,100
R 116,19,10240
M2 116,12,84,116
M3 228,12,88,228
T 54,11,18432
M3 244,12,92,244
L5 140,31,20,42,1024
M2 136,16,64,136
T 56,12,16384
M2 152,16,68,152
R 120,19,12288
M2 168,16,72,168
M2 184,16,76,184
T 58,12,18432
M2 200,16,80,200
s_add_u32 s42,s42,131072
s_cmp_eq_u32 s42,s7
s_cselect_b32 s42,s6,s42
M2 216,16,84,216
T 60,13,16384
M2 232,16,88,232
M2 248,16,92,248
R 124,19,14336
M2 40,20,64,40
s_add_u32 m0,s43,139264
M2 56,20,68,56
T 62,13,18432
M2 72,20,72,72
M2 88,20,76,88
M2 104,20,80,104
M2 120,20,84,120
L 22,16,41
M3 232,20,88,232
M3 248,20,92,248
M2 140,24,64,140
M2 156,24,68,156
L1 23,16,41,1024
M2 172,24,72,172
M2 188,24,76,188
M2 204,24,80,204
M2 220,24,84,220
M2 236,24,88,236
s_add_u32 s41,s41,262144
s_cmp_eq_u32 s41,s5
s_cselect_b32 s41,s4,s41
M2 252,24,92,252
M2 44,28,64,44
M2 60,28,68,60
M2 76,28,72,76
M2 92,28,76,92
M2 108,28,80,108
M2 124,28,84,124
M3 236,28,88,236
s_waitcnt vmcnt(12) lgkmcnt(0)
M3 252,28,92,252
s_barrier
M2 128,32,96,128
T 0,6,32768
L4 144,30,20,42
M2 144,32,100,144
R 64,18,32768
M2 160,32,104,160
L5 148,30,20,42,1024
T 2,6,34816
M2 176,32,108,176
M2 192,32,112,192
T 4,7,32768
M2 208,32,116,208
L4 152,31,20,42
M2 224,32,120,224
R 68,18,34816
M2 240,32,124,240
M2 32,36,96,32
T 6,7,34816
M2 48,36,100,48
L5 156,31,20,42,1024
M2 64,36,104,64
T 8,8,32768
M2 80,36,108,80
R 72,18,36864
M2 96,36,112,96
s_add_u32 s42,s42,131072
s_cmp_eq_u32 s42,s7
s_cselect_b32 s42,s6,s42
M2 112,36,116,112
T 10,8,34816
M3 224,36,120,224
M3 240,36,124,240
s_add_u32 m0,s43,147456
T 12,9,32768
M2 132,40,96,132
M2 148,40,100,148
R 76,18,38912
M2 164,40,104,164
M2 180,40,108,180
L 22,16,41
T 14,9,34816
M2 196,40,112,196
M2 212,40,116,212
T 16,10,32768
M2 228,40,120,228
L1 23,16,41,1024
R 80,18,40960
M2 244,40,124,244
M2 36,44,96,36
T 18,10,34816
M2 52,44,100,52
s_add_u32 s41,s41,262144
s_cmp_eq_u32 s41,s5
s_cselect_b32 s41,s4,s41
M2 68,44,104,68
T 20,11,32768
M2 84,44,108,84
M2 100,44,112,100
R 84,18,43008
M2 116,44,116,116
L4 160,30,20,42
M3 228,44,120,228
T 22,11,34816
M3 244,44,124,244
M2 136,48,96,136
T 24,12,32768
L5 164,30,20,42,1024
M2 152,48,100,152
R 88,18,45056
M2 168,48,104,168
M2 184,48,108,184
T 26,12,34816
L4 168,31,20,42
M2 200,48,112,200
M2 216,48,116,216
T 28,13,32768
M2 232,48,120,232
M2 248,48,124,248
L5 172,31,20,42,1024
R 92,18,47104
M2 40,52,96,40
M2 56,52,100,56
T 30,13,34816
M2 72,52,104,72
s_add_u32 s42,s42,131072
s_cmp_eq_u32 s42,s7
s_cselect_b32 s42,s6,s42
M2 88,52,108,88
M2 104,52,112,104
M2 120,52,116,120
s_add_u32 m0,s43,155648
M3 232,52,120,232
M3 248,52,124,248
M2 140,56,96,140
M2 156,56,100,156
L 22,16,41
M2 172,56,104,172
M2 188,56,108,188
M2 204,56,112,204
L1 23,16,41,1024
M2 220,56,116,220
M2 236,56,120,236
M2 252,56,124,252
s_add_u32 s41,s41,262144
s_cmp_eq_u32 s41,s5
s_cselect_b32 s41,s4,s41
M2 44,60,96,44
M2 60,60,100,60
M2 76,60,104,76
M2 92,60,108,92
M2 108,60,112,108
M2 124,60,116,124
M3 236,60,120,236
s_waitcnt vmcnt(20) lgkmcnt(0)
M3 252,60,124,252
s_barrier
M2 128,0,64,128
T 32,6,49152
L4 176,30,20,42
M2 144,0,68,144
R 96,19,32768
AR 2,196
M2 160,0,72,160
T 34,6,51200
M2 176,0,76,176
M2 192,0,80,192
T 36,7,49152
M2 208,0,84,208
AR 3,197
M2 224,0,88,224
R 100,19,34816
M2 240,0,92,240
M2 32,4,64,32
T 38,7,51200
M2 48,4,68,48
M2 64,4,72,64
T 40,8,49152
M2 80,4,76,80
L5 180,30,20,42,1024
R 104,19,36864
M2 96,4,80,96
M2 112,4,84,112
T 42,8,51200
AR 4,198
M3 224,4,88,224
M3 240,4,92,240
T 44,9,49152
M2 132,8,64,132
M2 148,8,68,148
R 108,19,38912
M2 164,8,72,164
M2 180,8,76,180
T 46,9,51200
M2 196,8,80,196
AR 5,199
M2 212,8,84,212
T 48,10,49152
M2 228,8,88,228
R 112,19,40960
M2 244,8,92,244
L4 184,31,20,42
M2 36,12,64,36
T 50,10,51200
M2 52,12,68,52
M2 68,12,72,68
T 52,11,49152
M2 84,12,76,84
M2 100,12,80,100
R 116,19,43008
AR 14,200
M2 116,12,84,116
M3 228,12,88,228
T 54,11,51200
M3 244,12,92,244
M2 136,16,64,136
T 56,12,49152
M2 152,16,68,152
R 120,19,45056
M2 168,16,72,168
M2 184,16,76,184
L5 188,31,20,42,1024
T 58,12,51200
M2 200,16,80,200
AR 15,201
M2 216,16,84,216
T 60,13,49152
M2 232,16,88,232
M2 248,16,92,248
R 124,19,47104
M2 40,20,64,40
M2 56,20,68,56
T 62,13,51200
M2 72,20,72,72
M2 88,20,76,88
AR 16,202
M2 104,20,80,104
M2 120,20,84,120
M3 232,20,88,232
M3 248,20,92,248
s_add_u32 s42,s42,131072
s_cmp_eq_u32 s42,s7
s_cselect_b32 s42,s6,s42
M2 140,24,64,140
M2 156,24,68,156
M2 172,24,72,172
AR 17,203
M2 188,24,76,188
M2 204,24,80,204
M2 220,24,84,220
M2 236,24,88,236
M2 252,24,92,252
M2 44,28,64,44
M2 60,28,68,60
M2 76,28,72,76
M2 92,28,76,92
M2 108,28,80,108
M2 124,28,84,124
M3 236,28,88,236
s_waitcnt vmcnt(18) lgkmcnt(0)
M3 252,28,92,252
s_barrier
M2 128,32,96,128
s_add_u32 m0,s43,98304
T 0,2,32768
M2 32,36,96,32
T 2,2,33792
M2 132,40,96,132
L 22,16,41
M2 36,44,96,36
M2 136,48,96,136
T 4,3,32768
M2 40,52,96,40
M2 140,56,96,140
C 128,128,129
C 129,130,131
M2 44,60,96,44
C 130,32,33
C 131,34,35
M2 144,32,100,144
L1 23,16,41,1024
C 132,132,133
M2 48,36,100,48
C 133,134,135
C 134,36,37
M2 148,40,100,148
T 6,3,33792
C 135,38,39
M2 52,44,100,52
C 136,136,137
C 137,138,139
M2 152,48,100,152
C 138,40,41
C 139,42,43
M2 56,52,100,56
s_add_u32 s41,s41,262144
s_cmp_eq_u32 s41,s5
s_cselect_b32 s41,s4,s41
M2 156,56,100,156
T 8,4,32768
C 140,140,141
M2 60,60,100,60
C 141,142,143
C 142,44,45
M2 160,32,104,160
T 10,4,33792
C 143,46,47
M2 64,36,104,64
L4 64,30,20,42
C 144,144,145
M2 164,40,104,164
C 145,146,147
C 146,48,49
M2 68,44,104,68
C 147,50,51
C 148,148,149
M2 168,48,104,168
C 149,150,151
C 150,52,53
M2 72,52,104,72
T 12,5,32768
C 151,54,55
M2 172,56,104,172
L5 68,30,20,42,1024
C 152,152,153
M2 76,60,104,76
C 153,154,155
C 154,56,57
M2 176,32,108,176
T 14,5,33792
C 155,58,59
M2 80,36,108,80
C 156,156,157
C 157,158,159
M2 180,40,108,180
C 158,60,61
C 159,62,63
M2 84,44,108,84
L4 72,31,20,42
T 16,14,32768
M2 184,48,108,184
C 160,160,161
C 161,162,163
M2 88,52,108,88
C 162,64,65
C 163,66,67
M2 188,56,108,188
C 164,164,165
C 165,166,167
M2 92,60,108,92
C 166,68,69
C 167,70,71
M2 192,32,112,192
L5 76,31,20,42,1024
T 18,14,33792
M2 96,36,112,96
C 168,168,169
C 169,170,171
M2 196,40,112,196
C 170,72,73
C 171,74,75
M2 100,44,112,100
T 20,15,32768
C 172,172,173
M2 200,48,112,200
s_add_u32 s42,s42,131072
s_cmp_eq_u32 s42,s7
s_cselect_b32 s42,s6,s42
M2 104,52,112,104
s_add_u32 m0,s43,106496
C 173,174,175
C 174,76,77
M2 204,56,112,204
C 175,78,79
C 176,176,177
M2 108,60,112,108
C 177,178,179
C 178,80,81
M2 208,32,116,208
T 22,15,33792
C 179,82,83
M2 112,36,116,112
C 180,180,181
C 181,182,183
M2 212,40,116,212
C 182,84,85
C 183,86,87
M2 116,44,116,116
T 24,16,32768
C 184,184,185
M2 216,48,116,216
C 185,186,187
C 186,88,89
M2 120,52,116,120
L 22,16,41
C 187,90,91
M2 220,56,116,220
T 26,16,33792
C 188,188,189
M2 124,60,116,124
C 189,190,191
C 190,92,93
M2 224,32,120,224
C 191,94,95
C 192,192,193
M3 224,36,120,224
C 193,194,195
C 194,96,97
M2 228,40,120,228
T 28,17,32768
C 195,98,99
M3 228,44,120,228
L1 23,16,41,1024
C 196,196,197
M2 232,48,120,232
C 197,198,199
C 198,100,101
M3 232,52,120,232
T 30,17,33792
C 199,102,103
M2 236,56,120,236
s_add_u32 s41,s41,262144
s_cmp_eq_u32 s41,s5
s_cselect_b32 s41,s4,s41
M3 236,60,120,236
C 200,200,201
C 201,202,203
C 202,104,105
M2 240,32,124,240
C 203,106,107
C 204,204,205
C 205,206,207
M3 240,36,124,240
C 206,108,109
C 207,110,111
M2 244,40,124,244
L4 80,30,20,42
C 208,208,209
M3 244,44,124,244
C 209,210,211
C 210,112,113
M2 248,48,124,248
C 211,114,115
C 212,212,213
M3 248,52,124,248
C 213,214,215
C 214,116,117
M2 252,56,124,252
L5 84,30,20,42,1024
C 215,118,119
M3 252,60,124,252
L4 88,31,20,42
L5 92,31,20,42,1024
s_add_u32 s42,s42,131072
s_cmp_eq_u32 s42,s7
s_cselect_b32 s42,s6,s42
l12_q0:
s_waitcnt lgkmcnt(0)
s_waitcnt vmcnt(22)
s_barrier
M 32,0,128,0
s_add_u32 m0,s43,114688
C 216,216,217
C 217,218,219
C 218,120,121
C 219,122,123
M 36,0,132,0
s_add_u32 s40,s38,0
C 220,220,221
C 221,222,223
C 222,124,125
M 40,0,136,0
C 223,126,127
C 224,224,225
C 225,226,227
M 44,0,140,0
AR 18,224
AR 19,225
AR 20,226
M 48,4,128,0
AR 21,227
C 226,18,19
C 227,20,21
M 52,4,132,0
C 228,228,229
C 229,230,231
AR 18,228
M 56,4,136,0
AR 19,229
AR 20,230
AR 21,231
M 60,4,140,0
C 230,18,19
C 231,20,21
C 232,232,233
M 64,8,128,0
C 233,234,235
AR 18,232
AR 19,233
M 68,8,132,0
AR 20,234
AR 21,235
C 234,18,19
M 72,8,136,0
C 235,20,21
C 236,236,237
C 237,238,239
AR 18,236
M 76,8,140,0
AR 19,237
AR 20,238
AR 21,239
M 80,12,128,0
C 238,18,19
C 239,20,21
C 240,240,241
M 84,12,132,0
C 241,242,243
AR 18,240
AR 19,241
M 88,12,136,0
AR 20,242
AR 21,243
C 242,18,19
M 92,12,140,0
C 243,20,21
C 244,244,245
C 245,246,247
M 96,16,128,0
AR 18,244
AR 19,245
AR 20,246
M 100,16,132,0
AR 21,247
C 246,18,19
C 247,20,21
M 104,16,136,0
C 248,248,249
C 249,250,251
AR 18,248
M 108,16,140,0
AR 19,249
AR 20,250
AR 21,251
M 112,20,128,0
C 250,18,19
C 251,20,21
C 252,252,253
M 116,20,132,0
C 253,254,255
AR 18,252
AR 19,253
AR 20,254
M 120,20,136,0
AR 21,255
C 254,18,19
C 255,20,21
M 124,20,140,0
T 32,2,40960
T 34,2,41984
L 22,16,41
M1 224,24,128,0
T 36,3,40960
T 38,3,41984
L1 23,16,41,1024
M1 228,24,132,0
T 40,4,40960
S1 128,27,96,40,0
T 42,4,41984
M1 232,24,136,0
s_add_u32 s41,s41,262144
s_cmp_eq_u32 s41,s5
s_cselect_b32 s41,s4,s41
T 44,5,40960
M1 236,24,140,0
s_add_u32 m0,s43,122880
T 46,5,41984
T 48,14,40960
S1 132,27,96,40,1024
T 50,14,41984
M1 240,28,128,0
L 22,16,41
L1 23,16,41,1024
T 52,15,40960
T 54,15,41984
M1 244,28,132,0
s_add_u32 s41,s41,262144
s_cmp_eq_u32 s41,s5
s_cselect_b32 s41,s4,s41
T 56,16,40960
M1 248,28,136,0
s_add_u32 m0,s43,131072
S1 136,27,96,40,2048
T 58,16,41984
T 60,17,40960
T 62,17,41984
M1 252,28,140,0
L 22,16,41
L1 23,16,41,1024
S1 140,27,96,40,3072
s_add_u32 s41,s41,262144
s_cmp_eq_u32 s41,s5
s_cselect_b32 s41,s4,s41
L4 96,30,20,42
s_waitcnt lgkmcnt(0)
M2 32,32,144,32
s_add_u32 s40,s38,4096
T 0,2,49152
L5 100,30,20,42,1024
M2 36,32,148,36
T 2,2,50176
T 4,3,49152
M2 40,32,152,40
L4 104,31,20,42
M2 44,32,156,44
T 6,3,50176
M2 48,36,144,48
T 8,4,49152
S1 144,27,96,40,0
M2 52,36,148,52
L5 108,31,20,42,1024
T 10,4,50176
M2 56,36,152,56
M2 60,36,156,60
T 12,5,49152
M2 64,40,144,64
s_add_u32 s42,s42,131072
s_cmp_eq_u32 s42,s7
s_cselect_b32 s42,s6,s42
M2 68,40,148,68
T 14,5,50176
M2 72,40,152,72
T 16,14,49152
S1 148,27,96,40,1024
M2 76,40,156,76
T 18,14,50176
L4 112,30,20,42
M2 80,44,144,80
T 20,15,49152
M2 84,44,148,84
M2 88,44,152,88
T 22,15,50176
L5 116,30,20,42,1024
M2 92,44,156,92
T 24,16,49152
S1 152,27,96,40,2048
M2 96,48,144,96
T 26,16,50176
M2 100,48,148,100
L4 120,31,20,42
M2 104,48,152,104
T 28,17,49152
M2 108,48,156,108
T 30,17,50176
M2 112,52,144,112
L5 124,31,20,42,1024
M2 116,52,148,116
S1 156,27,96,40,3072
M2 120,52,152,120
M2 124,52,156,124
s_add_u32 s42,s42,131072
s_cmp_eq_u32 s42,s7
s_cselect_b32 s42,s6,s42
M3 224,56,144,224
M3 228,56,148,228
M3 232,56,152,232
M3 236,56,156,236
M3 240,60,144,240
M3 244,60,148,244
M3 248,60,152,248
s_waitcnt vmcnt(32) lgkmcnt(0)
M3 252,60,156,252
s_barrier
M2 32,0,160,32
s_add_u32 m0,s43,139264
T 32,2,57344
T 34,2,58368
M2 36,0,164,36
s_add_u32 s40,s38,16384
L 22,16,41
T 36,3,57344
M2 40,0,168,40
M2 44,0,172,44
T 38,3,58368
M2 48,4,160,48
L1 23,16,41,1024
T 40,4,57344
M2 52,4,164,52
S1 160,27,96,40,0
T 42,4,58368
M2 56,4,168,56
s_add_u32 s41,s41,262144
s_cmp_eq_u32 s41,s5
s_cselect_b32 s41,s4,s41
M2 60,4,172,60
T 44,5,57344
M2 64,8,160,64
T 46,5,58368
M2 68,8,164,68
s_add_u32 m0,s43,147456
M2 72,8,168,72
T 48,14,57344
S1 164,27,96,40,1024
M2 76,8,172,76
T 50,14,58368
L 22,16,41
M2 80,12,160,80
T 52,15,57344
M2 84,12,164,84
M2 88,12,168,88
T 54,15,58368
L1 23,16,41,1024
M2 92,12,172,92
T 56,16,57344
S1 168,27,96,40,2048
M2 96,16,160,96
s_add_u32 s41,s41,262144
s_cmp_eq_u32 s41,s5
s_cselect_b32 s41,s4,s41
M2 100,16,164,100
T 58,16,58368
M2 104,16,168,104
T 60,17,57344
M2 108,16,172,108
L4 128,30,20,42
T 62,17,58368
M2 112,20,160,112
M2 116,20,164,116
S1 172,27,96,40,3072
L5 132,30,20,42,1024
M2 120,20,168,120
M2 124,20,172,124
M3 224,24,160,224
L4 136,31,20,42
M3 228,24,164,228
M3 232,24,168,232
M3 236,24,172,236
M3 240,28,160,240
M3 244,28,164,244
M3 248,28,168,248
M3 252,28,172,252
s_waitcnt lgkmcnt(0)
M2 32,32,176,32
s_add_u32 s40,s38,20480
T 0,2,0
L5 140,31,20,42,1024
M2 36,32,180,36
T 2,2,1024
T 4,3,0
M2 40,32,184,40
s_add_u32 s42,s42,131072
s_cmp_eq_u32 s42,s7
s_cselect_b32 s42,s6,s42
M2 44,32,188,44
T 6,3,1024
M2 48,36,176,48
T 8,4,0
S1 176,27,96,40,0
M2 52,36,180,52
L4 144,30,20,42
T 10,4,1024
M2 56,36,184,56
M2 60,36,188,60
T 12,5,0
M2 64,40,176,64
L5 148,30,20,42,1024
T 14,5,1024
M2 68,40,180,68
M2 72,40,184,72
T 16,14,0
S1 180,27,96,40,1024
M2 76,40,188,76
T 18,14,1024
L4 152,31,20,42
M2 80,44,176,80
T 20,15,0
M2 84,44,180,84
M2 88,44,184,88
T 22,15,1024
L5 156,31,20,42,1024
M2 92,44,188,92
T 24,16,0
S1 184,27,96,40,2048
M2 96,48,176,96
T 26,16,1024
M2 100,48,180,100
s_add_u32 s42,s42,131072
s_cmp_eq_u32 s42,s7
s_cselect_b32 s42,s6,s42
M2 104,48,184,104
T 28,17,0
M2 108,48,188,108
T 30,17,1024
M2 112,52,176,112
L4 160,30,20,42
M2 116,52,180,116
S1 188,27,96,40,3072
M2 120,52,184,120
M2 124,52,188,124
L5 164,30,20,42,1024
M3 224,56,176,224
M3 228,56,180,228
M3 232,56,184,232
M3 236,56,188,236
M3 240,60,176,240
M3 244,60,180,244
M3 248,60,184,248
s_waitcnt vmcnt(42) lgkmcnt(0)
M3 252,60,188,252
s_barrier
M2 32,0,64,32
s_add_u32 s40,s38,32768
T 32,2,8192
L4 168,31,20,42
M2 36,0,68,36
T 34,2,9216
L5 172,31,20,42,1024
M2 40,0,72,40
T 36,3,8192
M2 44,0,76,44
T 38,3,9216
M2 48,4,64,48
s_add_u32 s42,s42,131072
s_cmp_eq_u32 s42,s7
s_cselect_b32 s42,s6,s42
M2 52,4,68,52
T 40,4,8192
S1 192,27,96,40,0
M2 56,4,72,56
s_add_u32 m0,s43,155648
T 42,4,9216
M2 60,4,76,60
T 44,5,8192
M2 64,8,64,64
L 22,16,41
T 46,5,9216
M2 68,8,68,68
M2 72,8,72,72
T 48,14,8192
S1 196,27,96,40,1024
M2 76,8,76,76
L1 23,16,41,1024
T 50,14,9216
M2 80,12,64,80
T 52,15,8192
M2 84,12,68,84
s_add_u32 s41,s41,262144
s_cmp_eq_u32 s41,s5
s_cselect_b32 s41,s4,s41
M2 88,12,72,88
T 54,15,9216
M2 92,12,76,92
s_add_u32 m0,s43,98304
T 56,16,8192
S1 200,27,96,40,2048
M2 96,16,64,96
T 58,16,9216
M2 100,16,68,100
L 22,16,41
M2 104,16,72,104
T 60,17,8192
M2 108,16,76,108
T 62,17,9216
M2 112,20,64,112
L1 23,16,41,1024
M2 116,20,68,116
S1 204,27,96,40,3072
M2 120,20,72,120
s_add_u32 s41,s41,262144
s_cmp_eq_u32 s41,s5
s_cselect_b32 s41,s4,s41
M2 124,20,76,124
M3 224,24,64,224
L4 176,30,20,42
M3 228,24,68,228
M3 232,24,72,232
M3 236,24,76,236
M3 240,28,64,240
M3 244,28,68,244
M3 248,28,72,248
M3 252,28,76,252
s_waitcnt lgkmcnt(0)
M2 32,32,80,32
s_add_u32 s40,s38,36864
T 0,2,16384
L5 180,30,20,42,1024
M2 36,32,84,36
T 2,2,17408
T 4,3,16384
M2 40,32,88,40
L4 184,31,20,42
M2 44,32,92,44
T 6,3,17408
M2 48,36,80,48
T 8,4,16384
S1 208,27,96,40,0
M2 52,36,84,52
L5 188,31,20,42,1024
T 10,4,17408
M2 56,36,88,56
M2 60,36,92,60
T 12,5,16384
M2 64,40,80,64
s_add_u32 s42,s42,131072
s_cmp_eq_u32 s42,s7
s_cselect_b32 s42,s6,s42
M2 68,40,84,68
T 14,5,17408
M2 72,40,88,72
T 16,14,16384
S1 212,27,96,40,1024
M2 76,40,92,76
T 18,14,17408
L4 64,30,20,42
M2 80,44,80,80
T 20,15,16384
M2 84,44,84,84
M2 88,44,88,88
T 22,15,17408
L5 68,30,20,42,1024
M2 92,44,92,92
T 24,16,16384
S1 216,27,96,40,2048
M2 96,48,80,96
T 26,16,17408
M2 100,48,84,100
L4 72,31,20,42
M2 104,48,88,104
T 28,17,16384
M2 108,48,92,108
T 30,17,17408
M2 112,52,80,112
L5 76,31,20,42,1024
M2 116,52,84,116
S1 220,27,96,40,3072
M2 120,52,88,120
M2 124,52,92,124
s_add_u32 s42,s42,131072
s_cmp_eq_u32 s42,s7
s_cselect_b32 s42,s6,s42
M3 224,56,80,224
M3 228,56,84,228
M3 232,56,88,232
M3 236,56,92,236
M3 240,60,80,240
M3 244,60,84,244
M3 248,60,88,248
s_waitcnt vmcnt(51) lgkmcnt(0)
M3 252,60,92,252
s_barrier
M2 32,0,96,32
s_add_u32 m0,s43,106496
T 32,2,24576
T 34,2,25600
M2 36,0,100,36
s_add_u32 s40,s38,49152
L 22,16,41
T 36,3,24576
M2 40,0,104,40
M2 44,0,108,44
T 38,3,25600
M2 48,4,96,48
L1 23,16,41,1024
T 40,4,24576
M2 52,4,100,52
S1 224,27,96,40,0
T 42,4,25600
M2 56,4,104,56
s_add_u32 s41,s41,262144
s_cmp_eq_u32 s41,s5
s_cselect_b32 s41,s4,s41
M2 60,4,108,60
T 44,5,24576
M2 64,8,96,64
T 46,5,25600
M2 68,8,100,68
s_add_u32 m0,s43,114688
M2 72,8,104,72
T 48,14,24576
S1 228,27,96,40,1024
M2 76,8,108,76
T 50,14,25600
L 22,16,41
M2 80,12,96,80
T 52,15,24576
M2 84,12,100,84
M2 88,12,104,88
T 54,15,25600
L1 23,16,41,1024
M2 92,12,108,92
T 56,16,24576
S1 232,27,96,40,2048
M2 96,16,96,96
s_add_u32 s41,s41,262144
s_cmp_eq_u32 s41,s5
s_cselect_b32 s41,s4,s41
M2 100,16,100,100
T 58,16,25600
M2 104,16,104,104
T 60,17,24576
M2 108,16,108,108
L4 80,30,20,42
T 62,17,25600
M2 112,20,96,112
M2 116,20,100,116
S1 236,27,96,40,3072
L5 84,30,20,42,1024
M2 120,20,104,120
M2 124,20,108,124
M3 224,24,96,224
L4 88,31,20,42
M3 228,24,100,228
M3 232,24,104,232
M3 236,24,108,236
M3 240,28,96,240
M3 244,28,100,244
M3 248,28,104,248
M3 252,28,108,252
s_waitcnt vmcnt(56) lgkmcnt(0)
M2 32,32,112,32
s_add_u32 s40,s38,53248
T 0,2,32768
L5 92,31,20,42,1024
M2 36,32,116,36
T 2,2,33792
T 4,3,32768
M2 40,32,120,40
M2 44,32,124,44
s_add_u32 s42,s42,131072
s_cmp_eq_u32 s42,s7
s_cselect_b32 s42,s6,s42
M2 48,36,112,48
T 6,3,33792
T 8,4,32768
M2 52,36,116,52
S1 240,27,96,40,0
T 10,4,33792
M2 56,36,120,56
M2 60,36,124,60
L4 96,30,20,42
T 12,5,32768
M2 64,40,112,64
T 14,5,33792
M2 68,40,116,68
M2 72,40,120,72
T 16,14,32768
S1 244,27,96,40,1024
M2 76,40,124,76
L5 100,30,20,42,1024
T 18,14,33792
M2 80,44,112,80
T 20,15,32768
M2 84,44,116,84
M2 88,44,120,88
T 22,15,33792
M2 92,44,124,92
L4 104,31,20,42
T 24,16,32768
M2 96,48,112,96
S1 248,27,96,40,2048
T 26,16,33792
M2 100,48,116,100
M2 104,48,120,104
T 28,17,32768
M2 108,48,124,108
L5 108,31,20,42,1024
T 30,17,33792
M2 112,52,112,112
M2 116,52,116,116
S1 252,27,96,40,3072
M2 120,52,120,120
M2 124,52,124,124
s_add_u32 s42,s42,131072
s_cmp_eq_u32 s42,s7
s_cselect_b32 s42,s6,s42
M3 224,56,112,224
M3 228,56,116,228
M3 232,56,120,232
M3 236,56,124,236
M3 240,60,112,240
M3 244,60,116,244
M3 248,60,120,248
s_waitcnt vmcnt(52) lgkmcnt(0)
M3 252,60,124,252
s_barrier
M2 32,0,128,32
s_add_u32 m0,s43,122880
T 32,2,40960
T 34,2,41984
M2 36,0,132,36
L 22,16,41
T 36,3,40960
M2 40,0,136,40
M2 44,0,140,44
T 38,3,41984
M2 48,4,128,48
L1 23,16,41,1024
T 40,4,40960
M2 52,4,132,52
T 42,4,41984
M2 56,4,136,56
s_add_u32 s41,s41,262144
s_cmp_eq_u32 s41,s5
s_cselect_b32 s41,s4,s41
M2 60,4,140,60
T 44,5,40960
M2 64,8,128,64
T 46,5,41984
M2 68,8,132,68
s_add_u32 m0,s43,131072
M2 72,8,136,72
T 48,14,40960
M2 76,8,140,76
T 50,14,41984
L 22,16,41
M2 80,12,128,80
T 52,15,40960
M2 84,12,132,84
M2 88,12,136,88
T 54,15,41984
L1 23,16,41,1024
M2 92,12,140,92
T 56,16,40960
M2 96,16,128,96
s_add_u32 s41,s41,262144
s_cmp_eq_u32 s41,s5
s_cselect_b32 s41,s4,s41
M2 100,16,132,100
T 58,16,41984
M2 104,16,136,104
T 60,17,40960
M2 108,16,140,108
L4 112,30,20,42
T 62,17,41984
M2 112,20,128,112
M2 116,20,132,116
L5 116,30,20,42,1024
M2 120,20,136,120
M2 124,20,140,124
M3 224,24,128,224
L4 120,31,20,42
M3 228,24,132,228
M3 232,24,136,232
M3 236,24,140,236
M3 240,28,128,240
M3 244,28,132,244
M3 248,28,136,248
M3 252,28,140,252
s_waitcnt vmcnt(53) lgkmcnt(0)
M2 32,32,144,32
T 0,2,49152
L5 124,31,20,42,1024
M2 36,32,148,36
T 2,2,50176
T 4,3,49152
M2 40,32,152,40
M2 44,32,156,44
s_add_u32 s42,s42,131072
s_cmp_eq_u32 s42,s7
s_cselect_b32 s42,s6,s42
M2 48,36,144,48
T 6,3,50176
T 8,4,49152
M2 52,36,148,52
T 10,4,50176
M2 56,36,152,56
M2 60,36,156,60
L4 128,30,20,42
T 12,5,49152
M2 64,40,144,64
T 14,5,50176
M2 68,40,148,68
M2 72,40,152,72
T 16,14,49152
M2 76,40,156,76
L5 132,30,20,42,1024
T 18,14,50176
M2 80,44,144,80
T 20,15,49152
M2 84,44,148,84
M2 88,44,152,88
T 22,15,50176
M2 92,44,156,92
L4 136,31,20,42
T 24,16,49152
M2 96,48,144,96
T 26,16,50176
M2 100,48,148,100
M2 104,48,152,104
T 28,17,49152
M2 108,48,156,108
L5 140,31,20,42,1024
T 30,17,50176
M2 112,52,144,112
M2 116,52,148,116
M2 120,52,152,120
M2 124,52,156,124
s_add_u32 s42,s42,131072
s_cmp_eq_u32 s42,s7
s_cselect_b32 s42,s6,s42
M3 224,56,144,224
M3 228,56,148,228
M3 232,56,152,232
M3 236,56,156,236
M3 240,60,144,240
M3 244,60,148,244
M3 248,60,152,248
s_waitcnt vmcnt(12) lgkmcnt(0)
M3 252,60,156,252
s_barrier
M2 32,0,160,32
s_add_u32 m0,s43,139264
T 32,2,57344
T 34,2,58368
M2 36,0,164,36
T 36,3,57344
M2 40,0,168,40
L 22,16,41
M2 44,0,172,44
T 38,3,58368
M2 48,4,160,48
T 40,4,57344
M2 52,4,164,52
L1 23,16,41,1024
T 42,4,58368
M2 56,4,168,56
M2 60,4,172,60
T 44,5,57344
M2 64,8,160,64
s_add_u32 s41,s41,262144
s_cmp_eq_u32 s41,s5
s_cselect_b32 s41,s4,s41
M2 68,8,164,68
T 46,5,58368
M2 72,8,168,72
T 48,14,57344
M2 76,8,172,76
T 50,14,58368
L4 144,30,20,42
M2 80,12,160,80
T 52,15,57344
M2 84,12,164,84
M2 88,12,168,88
T 54,15,58368
L5 148,30,20,42,1024
M2 92,12,172,92
T 56,16,57344
M2 96,16,160,96
T 58,16,58368
M2 100,16,164,100
L4 152,31,20,42
M2 104,16,168,104
T 60,17,57344
M2 108,16,172,108
T 62,17,58368
M2 112,20,160,112
L5 156,31,20,42,1024
M2 116,20,164,116
M2 120,20,168,120
M2 124,20,172,124
s_add_u32 s42,s42,131072
s_cmp_eq_u32 s42,s7
s_cselect_b32 s42,s6,s42
M3 224,24,160,224
M3 228,24,164,228
M3 232,24,168,232
M3 236,24,172,236
M3 240,28,160,240
M3 244,28,164,244
M3 248,28,168,248
M3 252,28,172,252
s_waitcnt lgkmcnt(0)
M2 32,32,176,32
s_bfe_u32 s40,s38,0x40015
T 0,2,0
T 2,2,1024
M2 36,32,180,36
T 4,3,0
M2 40,32,184,40
M2 44,32,188,44
T 6,3,1024
M2 48,36,176,48
T 8,4,0
M2 52,36,180,52
T 10,4,1024
M2 56,36,184,56
M2 60,36,188,60
T 12,5,0
M2 64,40,176,64
s_lshl_b32 s40,s40,8
T 14,5,1024
M2 68,40,180,68
M2 72,40,184,72
T 16,14,0
M2 76,40,188,76
T 18,14,1024
M2 80,44,176,80
T 20,15,0
M2 84,44,180,84
M2 88,44,184,88
T 22,15,1024
M2 92,44,188,92
T 24,16,0
M2 96,48,176,96
T 26,16,1024
M2 100,48,180,100
buffer_atomic_add v28,v29,s[92:95],s40 offen sc1
M2 104,48,184,104
T 28,17,0
M2 108,48,188,108
T 30,17,1024
M2 112,52,176,112
M2 116,52,180,116
M2 120,52,184,120
M2 124,52,188,124
M3 224,56,176,224
M3 228,56,180,228
M3 232,56,184,232
M3 236,56,188,236
M3 240,60,176,240
M3 244,60,180,244
M3 248,60,184,248
s_waitcnt lgkmcnt(0)
M3 252,60,188,252
s_barrier
M2 32,0,64,32
T 32,2,8192
T 34,2,9216
M2 36,0,68,36
T 36,3,8192
M2 40,0,72,40
M2 44,0,76,44
T 38,3,9216
M2 48,4,64,48
T 40,4,8192
M2 52,4,68,52
T 42,4,9216
M2 56,4,72,56
M2 60,4,76,60
T 44,5,8192
M2 64,8,64,64
T 46,5,9216
M2 68,8,68,68
M2 72,8,72,72
T 48,14,8192
M2 76,8,76,76
T 50,14,9216
M2 80,12,64,80
T 52,15,8192
M2 84,12,68,84
M2 88,12,72,88
T 54,15,9216
M2 92,12,76,92
T 56,16,8192
M2 96,16,64,96
T 58,16,9216
M2 100,16,68,100
M2 104,16,72,104
T 60,17,8192
M2 108,16,76,108
T 62,17,9216
M2 112,20,64,112
M2 116,20,68,116
M2 120,20,72,120
M2 124,20,76,124
M3 224,24,64,224
M3 228,24,68,228
M3 232,24,72,232
M3 236,24,76,236
M3 240,28,64,240
M3 244,28,68,244
M3 248,28,72,248
M3 252,28,76,252
s_waitcnt lgkmcnt(0)
M2 32,32,80,32
T 0,2,16384
T 2,2,17408
M2 36,32,84,36
T 4,3,16384
M2 40,32,88,40
M2 44,32,92,44
T 6,3,17408
M2 48,36,80,48
T 8,4,16384
M2 52,36,84,52
T 10,4,17408
M2 56,36,88,56
M2 60,36,92,60
T 12,5,16384
M2 64,40,80,64
T 14,5,17408
M2 68,40,84,68
M2 72,40,88,72
T 16,14,16384
M2 76,40,92,76
T 18,14,17408
M2 80,44,80,80
T 20,15,16384
M2 84,44,84,84
M2 88,44,88,88
T 22,15,17408
M2 92,44,92,92
T 24,16,16384
M2 96,48,80,96
T 26,16,17408
M2 100,48,84,100
M2 104,48,88,104
T 28,17,16384
M2 108,48,92,108
T 30,17,17408
M2 112,52,80,112
M2 116,52,84,116
M2 120,52,88,120
M2 124,52,92,124
M3 224,56,80,224
M3 228,56,84,228
M3 232,56,88,232
M3 236,56,92,236
M3 240,60,80,240
M3 244,60,84,244
M3 248,60,88,248
s_waitcnt vmcnt(15) lgkmcnt(0)
M3 252,60,92,252
s_barrier
M2 32,0,96,32
T 32,2,24576
T 34,2,25600
M2 36,0,100,36
T 36,3,24576
M2 40,0,104,40
M2 44,0,108,44
T 38,3,25600
M2 48,4,96,48
T 40,4,24576
M2 52,4,100,52
T 42,4,25600
M2 56,4,104,56
M2 60,4,108,60
T 44,5,24576
M2 64,8,96,64
T 46,5,25600
M2 68,8,100,68
M2 72,8,104,72
T 48,14,24576
M2 76,8,108,76
T 50,14,25600
M2 80,12,96,80
T 52,15,24576
M2 84,12,100,84
M2 88,12,104,88
T 54,15,25600
M2 92,12,108,92
T 56,16,24576
M2 96,16,96,96
T 58,16,25600
M2 100,16,100,100
M2 104,16,104,104
T 60,17,24576
M2 108,16,108,108
T 62,17,25600
M2 112,20,96,112
M2 116,20,100,116
M2 120,20,104,120
M2 124,20,108,124
M3 224,24,96,224
M3 228,24,100,228
M3 232,24,104,232
M3 236,24,108,236
M3 240,28,96,240
M3 244,28,100,244
M3 248,28,104,248
M3 252,28,108,252
s_waitcnt vmcnt(11) lgkmcnt(0)
M2 32,32,112,32
T 0,2,32768
T 2,2,33792
M2 36,32,116,36
T 4,3,32768
M2 40,32,120,40
M2 44,32,124,44
T 6,3,33792
M2 48,36,112,48
T 8,4,32768
M2 52,36,116,52
T 10,4,33792
M2 56,36,120,56
M2 60,36,124,60
T 12,5,32768
M2 64,40,112,64
T 14,5,33792
M2 68,40,116,68
M2 72,40,120,72
T 16,14,32768
M2 76,40,124,76
T 18,14,33792
M2 80,44,112,80
T 20,15,32768
M2 84,44,116,84
M2 88,44,120,88
T 22,15,33792
M2 92,44,124,92
T 24,16,32768
M2 96,48,112,96
T 26,16,33792
M2 100,48,116,100
M2 104,48,120,104
T 28,17,32768
M2 108,48,124,108
T 30,17,33792
M2 112,52,112,112
M2 116,52,116,116
M2 120,52,120,120
M2 124,52,124,124
M3 224,56,112,224
M3 228,56,116,228
M3 232,56,120,232
M3 236,56,124,236
M3 240,60,112,240
M3 244,60,116,244
M3 248,60,120,248
s_waitcnt vmcnt(5) lgkmcnt(0)
M3 252,60,124,252
s_barrier
M2 32,0,128,32
T 32,2,40960
T 34,2,41984
M2 36,0,132,36
T 36,3,40960
M2 40,0,136,40
M2 44,0,140,44
T 38,3,41984
M2 48,4,128,48
T 40,4,40960
M2 52,4,132,52
T 42,4,41984
M2 56,4,136,56
M2 60,4,140,60
T 44,5,40960
M2 64,8,128,64
T 46,5,41984
M2 68,8,132,68
M2 72,8,136,72
T 48,14,40960
M2 76,8,140,76
T 50,14,41984
M2 80,12,128,80
T 52,15,40960
M2 84,12,132,84
M2 88,12,136,88
T 54,15,41984
M2 92,12,140,92
T 56,16,40960
M2 96,16,128,96
T 58,16,41984
M2 100,16,132,100
M2 104,16,136,104
T 60,17,40960
M2 108,16,140,108
T 62,17,41984
M2 112,20,128,112
M2 116,20,132,116
M2 120,20,136,120
M2 124,20,140,124
M3 224,24,128,224
M3 228,24,132,228
M3 232,24,136,232
M3 236,24,140,236
M3 240,28,128,240
M3 244,28,132,244
M3 248,28,136,248
M3 252,28,140,252
s_waitcnt vmcnt(1) lgkmcnt(0)
M2 32,32,144,32
s_lshr_b32 s40,s29,1
M2 36,32,148,36
M2 40,32,152,40
M2 44,32,156,44
M2 48,36,144,48
M2 52,36,148,52
M2 56,36,152,56
M2 60,36,156,60
M2 64,40,144,64
M2 68,40,148,68
s_lshl_b32 s40,s40,8
M2 72,40,152,72
M2 76,40,156,76
M2 80,44,144,80
M2 84,44,148,84
M2 88,44,152,88
M2 92,44,156,92
M2 96,48,144,96
M2 100,48,148,100
M2 104,48,152,104
M2 108,48,156,108
buffer_load_dword v0,v26,s[92:95],s40 offen sc1
M2 112,52,144,112
M2 116,52,148,116
M2 120,52,152,120
M2 124,52,156,124
M3 224,56,144,224
M3 228,56,148,228
M3 232,56,152,232
M3 236,56,156,236
M3 240,60,144,240
M3 244,60,148,244
M3 248,60,152,248
M3 252,60,156,252
s_branch l12_attpost
spin_lnatt0:
s_mov_b32 s100,0
spinl_lnatt0:
s_sleep 4
buffer_load_dword v0,v26,s[92:95],0 offen sc1
s_add_u32 s100,s100,1
s_cmp_ge_u32 s100,16384
s_cbranch_scc1 spinret_lnatt0
s_waitcnt vmcnt(0)
v_cmp_le_u32 vcc,32,v0
s_nop 3
s_and_b32 s39,vcc_lo,0xff
s_cmp_lg_u32 s39,0xff
s_cbranch_scc1 spinl_lnatt0
s_branch spinret_lnatt0
l12_g0:
s_waitcnt vmcnt(12)
s_cmp_lg_u32 s30,0
s_cbranch_scc1 spinret_lng0
v_cmp_le_u32 vcc,32,v0
s_nop 3
s_and_b32 s39,vcc_lo,0xff
s_cmp_lg_u32 s39,0xff
s_cbranch_scc1 spin_lng0
spinret_lng0:
s_add_u32 s92,s8,48168960
s_addc_u32 s93,s9,0
s_and_b32 s93,s93,0xffff
s_mov_b32 s94,65536
s_mov_b32 s95,0x00020000
V1 26,29
s_lshr_b32 s39,s2,5
s_lshl_b32 s39,s39,1
s_add_u32 s39,s39,s28
s_cmp_ge_u32 s39,6
s_cselect_b32 s4,6,0
s_sub_u32 s39,s39,s4
s_mov_b32 s4,s41
s_mul_i32 s5,s39,393216
s_add_u32 s41,s41,s5
s_add_u32 s5,s4,2359296
s_mov_b32 s6,s42
s_mul_i32 s7,s39,884736
s_add_u32 s42,s42,s7
s_add_u32 s7,s6,5308416
s_waitcnt lgkmcnt(0)
s_barrier
s_mul_i32 s11,s30,3072
M2 128,0,64,128
s_add_u32 m0,s43,131072
T 32,6,16384
R 96,19,0
M2 144,0,68,144
M2 160,0,72,160
T 34,6,18432
M2 176,0,76,176
M2 192,0,80,192
L6 22,20,41
T 36,7,16384
M2 208,0,84,208
M2 224,0,88,224
R 100,19,2048
M2 240,0,92,240
M2 32,4,64,32
T 38,7,18432
M2 48,4,68,48
L7 22,20,41,1024
M2 64,4,72,64
T 40,8,16384
M2 80,4,76,80
R 104,19,4096
M2 96,4,80,96
M2 112,4,84,112
T 42,8,18432
M3 224,4,88,224
M3 240,4,92,240
L7 22,20,41,2048
T 44,9,16384
M2 132,8,64,132
M2 148,8,68,148
R 108,19,6144
M2 164,8,72,164
M2 180,8,76,180
T 46,9,18432
M2 196,8,80,196
L7 22,20,41,3072
M2 212,8,84,212
T 48,10,16384
M2 228,8,88,228
R 112,19,8192
M2 244,8,92,244
M2 36,12,64,36
T 50,10,18432
M2 52,12,68,52
M2 68,12,72,68
s_add_u32 s41,s41,131072
s_cmp_eq_u32 s41,s5
s_cselect_b32 s41,s4,s41
M2 84,12,76,84
T 52,11,16384
M2 100,12,80,100
R 116,19,10240
M2 116,12,84,116
M3 228,12,88,228
T 54,11,18432
M3 244,12,92,244
s_add_u32 m0,s11,0
M2 136,16,64,136
T 56,12,16384
M2 152,16,68,152
R 120,19,12288
M2 168,16,72,168
M2 184,16,76,184
T 58,12,18432
M2 200,16,80,200
M2 216,16,84,216
L 23,16,42
T 60,13,16384
M2 232,16,88,232
M2 248,16,92,248
R 124,19,14336
M2 40,20,64,40
M2 56,20,68,56
T 62,13,18432
M2 72,20,72,72
L1 24,16,42,1024
M2 88,20,76,88
M2 104,20,80,104
M2 120,20,84,120
M3 232,20,88,232
M3 248,20,92,248
M2 140,24,64,140
L1 25,16,42,2048
M2 156,24,68,156
M2 172,24,72,172
M2 188,24,76,188
M2 204,24,80,204
M2 220,24,84,220
s_add_u32 s42,s42,294912
s_cmp_eq_u32 s42,s7
s_cselect_b32 s42,s6,s42
M2 236,24,88,236
M2 252,24,92,252
M2 44,28,64,44
M2 60,28,68,60
M2 76,28,72,76
M2 92,28,76,92
M2 108,28,80,108
M2 124,28,84,124
M3 236,28,88,236
s_waitcnt vmcnt(11) lgkmcnt(0)
M3 252,28,92,252
s_barrier
M2 128,32,96,128
s_add_u32 m0,s43,147456
T 0,6,32768
R 64,18,32768
M2 144,32,100,144
M2 160,32,104,160
T 2,6,34816
M2 176,32,108,176
M2 192,32,112,192
L6 22,20,41
T 4,7,32768
M2 208,32,116,208
M2 224,32,120,224
R 68,18,34816
M2 240,32,124,240
M2 32,36,96,32
T 6,7,34816
M2 48,36,100,48
L7 22,20,41,1024
M2 64,36,104,64
T 8,8,32768
M2 80,36,108,80
R 72,18,36864
M2 96,36,112,96
M2 112,36,116,112
T 10,8,34816
M3 224,36,120,224
M3 240,36,124,240
L7 22,20,41,2048
T 12,9,32768
M2 132,40,96,132
M2 148,40,100,148
R 76,18,38912
M2 164,40,104,164
M2 180,40,108,180
T 14,9,34816
M2 196,40,112,196
L7 22,20,41,3072
M2 212,40,116,212
T 16,10,32768
M2 228,40,120,228
R 80,18,40960
M2 244,40,124,244
M2 36,44,96,36
T 18,10,34816
M2 52,44,100,52
M2 68,44,104,68
s_add_u32 s41,s41,131072
s_cmp_eq_u32 s41,s5
s_cselect_b32 s41,s4,s41
M2 84,44,108,84
T 20,11,32768
M2 100,44,112,100
R 84,18,43008
M2 116,44,116,116
M3 228,44,120,228
T 22,11,34816
M3 244,44,124,244
s_add_u32 m0,s11,12288
M2 136,48,96,136
T 24,12,32768
M2 152,48,100,152
R 88,18,45056
M2 168,48,104,168
M2 184,48,108,184
T 26,12,34816
M2 200,48,112,200
M2 216,48,116,216
L 23,16,42
T 28,13,32768
M2 232,48,120,232
M2 248,48,124,248
R 92,18,47104
M2 40,52,96,40
M2 56,52,100,56
T 30,13,34816
M2 72,52,104,72
L1 24,16,42,1024
M2 88,52,108,88
M2 104,52,112,104
M2 120,52,116,120
M3 232,52,120,232
M3 248,52,124,248
M2 140,56,96,140
L1 25,16,42,2048
M2 156,56,100,156
M2 172,56,104,172
M2 188,56,108,188
M2 204,56,112,204
M2 220,56,116,220
s_add_u32 s42,s42,294912
s_cmp_eq_u32 s42,s7
s_cselect_b32 s42,s6,s42
M2 236,56,120,236
M2 252,56,124,252
M2 44,60,96,44
M2 60,60,100,60
M2 76,60,104,76
M2 92,60,108,92
M2 108,60,112,108
M2 124,60,116,124
M3 236,60,120,236
s_waitcnt vmcnt(14) lgkmcnt(0)
M3 252,60,124,252
s_barrier
M2 128,0,64,128
s_add_u32 m0,s11,24576
T 32,6,49152
AR 2,196
M2 144,0,68,144
R 96,19,32768
M2 160,0,72,160
T 34,6,51200
M2 176,0,76,176
M2 192,0,80,192
T 36,7,49152
M2 208,0,84,208
L 23,16,42
M2 224,0,88,224
R 100,19,34816
AR 3,197
M2 240,0,92,240
M2 32,4,64,32
T 38,7,51200
M2 48,4,68,48
M2 64,4,72,64
T 40,8,49152
M2 80,4,76,80
L1 24,16,42,1024
R 104,19,36864
M2 96,4,80,96
M2 112,4,84,112
T 42,8,51200
M3 224,4,88,224
M3 240,4,92,240
T 44,9,49152
AR 4,198
M2 132,8,64,132
M2 148,8,68,148
L1 25,16,42,2048
R 108,19,38912
M2 164,8,72,164
M2 180,8,76,180
T 46,9,51200
M2 196,8,80,196
M2 212,8,84,212
T 48,10,49152
M2 228,8,88,228
R 112,19,40960
M2 244,8,92,244
s_add_u32 s42,s42,294912
s_cmp_eq_u32 s42,s7
s_cselect_b32 s42,s6,s42
M2 36,12,64,36
T 50,10,51200
AR 5,199
M2 52,12,68,52
M2 68,12,72,68
T 52,11,49152
M2 84,12,76,84
M2 100,12,80,100
R 116,19,43008
M2 116,12,84,116
s_add_u32 m0,s11,36864
M3 228,12,88,228
T 54,11,51200
M3 244,12,92,244
M2 136,16,64,136
T 56,12,49152
AR 14,200
M2 152,16,68,152
R 120,19,45056
M2 168,16,72,168
M2 184,16,76,184
L 23,16,42
T 58,12,51200
M2 200,16,80,200
M2 216,16,84,216
T 60,13,49152
M2 232,16,88,232
M2 248,16,92,248
R 124,19,47104
M2 40,20,64,40
AR 15,201
M2 56,20,68,56
L1 24,16,42,1024
T 62,13,51200
M2 72,20,72,72
M2 88,20,76,88
M2 104,20,80,104
M2 120,20,84,120
M3 232,20,88,232
M3 248,20,92,248
L1 25,16,42,2048
M2 140,24,64,140
M2 156,24,68,156
AR 16,202
M2 172,24,72,172
M2 188,24,76,188
M2 204,24,80,204
M2 220,24,84,220
s_add_u32 s42,s42,294912
s_cmp_eq_u32 s42,s7
s_cselect_b32 s42,s6,s42
M2 236,24,88,236
M2 252,24,92,252
M2 44,28,64,44
M2 60,28,68,60
M2 76,28,72,76
M2 92,28,76,92
M2 108,28,80,108
M2 124,28,84,124
M3 236,28,88,236
s_waitcnt vmcnt(13) lgkmcnt(0)
M3 252,28,92,252
s_barrier
M2 128,32,96,128
s_add_u32 m0,s43,98304
R 0,2,32768
M2 32,36,96,32
T 64,3,0
M2 132,40,96,132
L6 22,20,41
M2 36,44,96,36
T 66,3,1536
M2 136,48,96,136
M2 40,52,96,40
R 4,2,32832
M2 140,56,96,140
C 128,128,129
C 129,130,131
M2 44,60,96,44
C 130,32,33
C 131,34,35
M2 144,32,100,144
L7 22,20,41,1024
C 132,132,133
M2 48,36,100,48
C 133,134,135
C 134,36,37
M2 148,40,100,148
T 68,4,0
C 135,38,39
M2 52,44,100,52
C 136,136,137
C 137,138,139
M2 152,48,100,152
C 138,40,41
C 139,42,43
M2 56,52,100,56
R 8,2,34816
L7 22,20,41,2048
M2 156,56,100,156
C 140,140,141
C 141,142,143
M2 60,60,100,60
C 142,44,45
C 143,46,47
M2 160,32,104,160
T 70,4,1536
C 144,144,145
M2 64,36,104,64
C 145,146,147
C 146,48,49
M2 164,40,104,164
L7 22,20,41,3072
C 147,50,51
M2 68,44,104,68
T 72,5,0
C 148,148,149
M2 168,48,104,168
C 149,150,151
C 150,52,53
M2 72,52,104,72
R 12,2,34880
C 151,54,55
M2 172,56,104,172
C 152,152,153
C 153,154,155
M2 76,60,104,76
C 154,56,57
C 155,58,59
M2 176,32,108,176
s_add_u32 s41,s41,131072
s_cmp_eq_u32 s41,s5
s_cselect_b32 s41,s4,s41
M2 80,36,108,80
s_add_u32 m0,s43,114688
T 74,5,1536
C 156,156,157
M2 180,40,108,180
C 157,158,159
C 158,60,61
M2 84,44,108,84
R 16,2,36864
C 159,62,63
M2 184,48,108,184
C 160,160,161
C 161,162,163
M2 88,52,108,88
C 162,64,65
C 163,66,67
M2 188,56,108,188
C 164,164,165
C 165,166,167
M2 92,60,108,92
T 76,14,0
C 166,68,69
M2 192,32,112,192
L6 22,20,41
C 167,70,71
M2 96,36,112,96
C 168,168,169
C 169,170,171
M2 196,40,112,196
C 170,72,73
C 171,74,75
M2 100,44,112,100
T 78,14,1536
C 172,172,173
M2 200,48,112,200
C 173,174,175
C 174,76,77
M2 104,52,112,104
R 20,2,36928
C 175,78,79
M2 204,56,112,204
L7 22,20,41,1024
C 176,176,177
M2 108,60,112,108
C 177,178,179
C 178,80,81
M2 208,32,116,208
T 80,15,0
C 179,82,83
M2 112,36,116,112
C 180,180,181
C 181,182,183
M2 212,40,116,212
C 182,84,85
C 183,86,87
M2 116,44,116,116
R 24,2,38912
L7 22,20,41,2048
M2 216,48,116,216
C 184,184,185
C 185,186,187
M2 120,52,116,120
C 186,88,89
C 187,90,91
M2 220,56,116,220
T 82,15,1536
C 188,188,189
M2 124,60,116,124
C 189,190,191
C 190,92,93
M2 224,32,120,224
L7 22,20,41,3072
C 191,94,95
M3 224,36,120,224
T 84,16,0
C 192,192,193
M2 228,40,120,228
C 193,194,195
C 194,96,97
M3 228,44,120,228
R 28,2,38976
C 195,98,99
M2 232,48,120,232
C 196,196,197
C 197,198,199
M3 232,52,120,232
C 198,100,101
C 199,102,103
M2 236,56,120,236
s_add_u32 s41,s41,131072
s_cmp_eq_u32 s41,s5
s_cselect_b32 s41,s4,s41
M3 236,60,120,236
s_add_u32 m0,s11,49152
T 86,16,1536
C 200,200,201
C 201,202,203
M2 240,32,124,240
C 202,104,105
C 203,106,107
C 204,204,205
M3 240,36,124,240
C 205,206,207
C 206,108,109
M2 244,40,124,244
C 207,110,111
C 208,208,209
M3 244,44,124,244
C 209,210,211
C 210,112,113
M2 248,48,124,248
C 211,114,115
C 212,212,213
M3 248,52,124,248
L 23,16,42
C 213,214,215
M2 252,56,124,252
C 214,116,117
C 215,118,119
M3 252,60,124,252
L1 24,16,42,1024
L1 25,16,42,2048
s_add_u32 s42,s42,294912
s_cmp_eq_u32 s42,s7
s_cselect_b32 s42,s6,s42
s_waitcnt lgkmcnt(0)
s_waitcnt vmcnt(17)
s_barrier
M1 128,0,64,0
s_add_u32 m0,s43,131072
C 216,216,217
C 217,218,219
C 218,120,121
M1 132,0,68,0
s_add_u32 s40,s38,0
C 219,122,123
C 220,220,221
M1 136,0,72,0
C 221,222,223
C 222,124,125
M1 140,0,76,0
C 223,126,127
C 224,224,225
M1 144,0,80,0
C 225,226,227
AR 18,224
M1 148,0,84,0
AR 19,225
AR 20,226
M1 152,4,64,0
AR 21,227
C 226,18,19
M1 156,4,68,0
C 227,20,21
C 228,228,229
M1 160,4,72,0
C 229,230,231
AR 18,228
M1 164,4,76,0
AR 19,229
AR 20,230
AR 21,231
M1 168,4,80,0
C 230,18,19
C 231,20,21
M1 172,4,84,0
C 232,232,233
C 233,234,235
M1 176,8,64,0
AR 18,232
AR 19,233
M1 180,8,68,0
AR 20,234
AR 21,235
M1 184,8,72,0
C 234,18,19
C 235,20,21
M1 188,8,76,0
C 236,236,237
C 237,238,239
M1 192,8,80,0
AR 18,236
AR 19,237
M1 196,8,84,0
AR 20,238
AR 21,239
M1 200,12,64,0
C 238,18,19
C 239,20,21
M1 204,12,68,0
C 240,240,241
C 241,242,243
AR 18,240
M1 208,12,72,0
AR 19,241
AR 20,242
M1 212,12,76,0
AR 21,243
C 242,18,19
M1 216,12,80,0
C 243,20,21
C 244,244,245
M1 220,12,84,0
C 245,246,247
AR 18,244
M 32,16,64,0
AR 19,245
AR 20,246
M 36,16,68,0
AR 21,247
C 246,18,19
M 40,16,72,0
C 247,20,21
C 248,248,249
M 44,16,76,0
C 249,250,251
AR 18,248
M 48,16,80,0
AR 19,249
AR 20,250
AR 21,251
M 52,16,84,0
C 250,18,19
C 251,20,21
M 56,20,64,0
C 252,252,253
C 253,254,255
M 60,20,68,0
AR 18,252
AR 19,253
M 64,20,72,0
AR 20,254
AR 21,255
M 68,20,76,0
C 254,18,19
C 255,20,21
M 72,20,80,0
R 32,2,49152
T 88,3,12288
M 76,20,84,0
T 90,3,13824
L6 22,20,41
M 80,24,64,0
R 36,2,49216
T 92,4,12288
M 84,24,68,0
L7 22,20,41,1024
R 40,2,51200
M 88,24,72,0
T 94,4,13824
T 96,5,12288
L7 22,20,41,2048
M 92,24,76,0
R 44,2,51264
S1 128,27,96,40,0
M 96,24,80,0
T 98,5,13824
L7 22,20,41,3072
M 100,24,84,0
R 48,2,53248
T 100,14,12288
M 104,28,64,0
T 102,14,13824
R 52,2,53312
M 108,28,68,0
s_add_u32 s41,s41,131072
s_cmp_eq_u32 s41,s5
s_cselect_b32 s41,s4,s41
M 112,28,72,0
s_add_u32 m0,s11,0
T 104,15,12288
R 56,2,55296
T 106,15,13824
M 116,28,76,0
L 23,16,42
T 108,16,12288
S1 132,27,96,40,1024
M 120,28,80,0
R 60,2,55360
T 110,16,13824
M 124,28,84,0
L1 24,16,42,1024
L1 25,16,42,2048
s_add_u32 s42,s42,294912
s_cmp_eq_u32 s42,s7
s_cselect_b32 s42,s6,s42
s_waitcnt vmcnt(16) lgkmcnt(0)
s_barrier
M3 128,32,88,128
s_add_u32 m0,s43,147456
R 0,2,0
S1 136,27,96,40,2048
M3 132,32,92,132
T 64,3,24576
M3 136,32,96,136
T 66,3,26112
M3 140,32,100,140
L6 22,20,41
R 4,2,64
M3 144,32,104,144
M3 148,32,108,148
T 68,4,24576
M3 152,36,88,152
M3 156,36,92,156
L7 22,20,41,1024
R 8,2,2048
M3 160,36,96,160
T 70,4,26112
M3 164,36,100,164
M3 168,36,104,168
T 72,5,24576
M3 172,36,108,172
L7 22,20,41,2048
M3 176,40,88,176
R 12,2,2112
M3 180,40,92,180
T 74,5,26112
M3 184,40,96,184
M3 188,40,100,188
L7 22,20,41,3072
R 16,2,4096
M3 192,40,104,192
M3 196,40,108,196
T 76,14,24576
M3 200,44,88,200
T 78,14,26112
M3 204,44,92,204
s_add_u32 s41,s41,131072
s_cmp_eq_u32 s41,s5
s_cselect_b32 s41,s4,s41
M3 208,44,96,208
R 20,2,4160
M3 212,44,100,212
S1 140,27,96,40,3072
M3 216,44,104,216
T 80,15,24576
M3 220,44,108,220
s_add_u32 m0,s11,12288
R 24,2,6144
M2 32,48,88,32
M2 36,48,92,36
T 82,15,26112
M2 40,48,96,40
M2 44,48,100,44
L 23,16,42
T 84,16,24576
M2 48,48,104,48
R 28,2,6208
M2 52,48,108,52
M2 56,52,88,56
T 86,16,26112
M2 60,52,92,60
L1 24,16,42,1024
M2 64,52,96,64
M2 68,52,100,68
M2 72,52,104,72
M2 76,52,108,76
L1 25,16,42,2048
M2 80,56,88,80
M2 84,56,92,84
M2 88,56,96,88
M2 92,56,100,92
s_add_u32 s42,s42,294912
s_cmp_eq_u32 s42,s7
s_cselect_b32 s42,s6,s42
M2 96,56,104,96
M2 100,56,108,100
M2 104,60,88,104
M2 108,60,92,108
M2 112,60,96,112
M2 116,60,100,116
M2 120,60,104,120
s_waitcnt vmcnt(21) lgkmcnt(0)
M2 124,60,108,124
s_barrier
M3 128,0,64,128
s_add_u32 m0,s43,98304
R 32,2,16384
T 88,3,36864
M3 132,0,68,132
s_add_u32 s40,s38,4096
M3 136,0,72,136
T 90,3,38400
M3 140,0,76,140
L6 22,20,41
R 36,2,16448
M3 144,0,80,144
M3 148,0,84,148
T 92,4,36864
M3 152,4,64,152
M3 156,4,68,156
L7 22,20,41,1024
R 40,2,18432
M3 160,4,72,160
T 94,4,38400
M3 164,4,76,164
M3 168,4,80,168
T 96,5,36864
M3 172,4,84,172
L7 22,20,41,2048
M3 176,8,64,176
R 44,2,18496
M3 180,8,68,180
S1 144,27,96,40,0
T 98,5,38400
M3 184,8,72,184
M3 188,8,76,188
L7 22,20,41,3072
R 48,2,20480
M3 192,8,80,192
M3 196,8,84,196
T 100,14,36864
M3 200,12,64,200
T 102,14,38400
M3 204,12,68,204
s_add_u32 s41,s41,131072
s_cmp_eq_u32 s41,s5
s_cselect_b32 s41,s4,s41
M3 208,12,72,208
R 52,2,20544
M3 212,12,76,212
M3 216,12,80,216
T 104,15,36864
M3 220,12,84,220
s_add_u32 m0,s11,24576
R 56,2,22528
M2 32,16,64,32
M2 36,16,68,36
T 106,15,38400
M2 40,16,72,40
M2 44,16,76,44
L 23,16,42
T 108,16,36864
M2 48,16,80,48
S1 148,27,96,40,1024
R 60,2,22592
M2 52,16,84,52
M2 56,20,64,56
T 110,16,38400
M2 60,20,68,60
L1 24,16,42,1024
M2 64,20,72,64
M2 68,20,76,68
M2 72,20,80,72
M2 76,20,84,76
L1 25,16,42,2048
M2 80,24,64,80
M2 84,24,68,84
M2 88,24,72,88
M2 92,24,76,92
s_add_u32 s42,s42,294912
s_cmp_eq_u32 s42,s7
s_cselect_b32 s42,s6,s42
M2 96,24,80,96
M2 100,24,84,100
M2 104,28,64,104
M2 108,28,68,108
M2 112,28,72,112
M2 116,28,76,116
M2 120,28,80,120
s_waitcnt vmcnt(22) lgkmcnt(0)
M2 124,28,84,124
s_barrier
M3 128,32,88,128
s_add_u32 m0,s43,114688
R 0,2,32768
S1 152,27,96,40,2048
M3 132,32,92,132
T 64,3,49152
M3 136,32,96,136
T 66,3,50688
M3 140,32,100,140
L6 22,20,41
R 4,2,32832
M3 144,32,104,144
M3 148,32,108,148
T 68,4,49152
M3 152,36,88,152
M3 156,36,92,156
L7 22,20,41,1024
R 8,2,34816
M3 160,36,96,160
T 70,4,50688
M3 164,36,100,164
M3 168,36,104,168
S1 156,27,96,40,3072
T 72,5,49152
M3 172,36,108,172
L7 22,20,41,2048
M3 176,40,88,176
R 12,2,34880
M3 180,40,92,180
T 74,5,50688
M3 184,40,96,184
M3 188,40,100,188
L7 22,20,41,3072
R 16,2,36864
M3 192,40,104,192
M3 196,40,108,196
T 76,14,49152
M3 200,44,88,200
T 78,14,50688
M3 204,44,92,204
s_add_u32 s41,s41,131072
s_cmp_eq_u32 s41,s5
s_cselect_b32 s41,s4,s41
M3 208,44,96,208
R 20,2,36928
M3 212,44,100,212
s_add_u32 s40,s38,16384
M3 216,44,104,216
T 80,15,49152
M3 220,44,108,220
s_add_u32 m0,s11,36864
R 24,2,38912
M2 32,48,88,32
M2 36,48,92,36
T 82,15,50688
M2 40,48,96,40
M2 44,48,100,44
L 23,16,42
T 84,16,49152
M2 48,48,104,48
R 28,2,38976
M2 52,48,108,52
M2 56,52,88,56
T 86,16,50688
M2 60,52,92,60
L1 24,16,42,1024
M2 64,52,96,64
S1 160,27,96,40,0
M2 68,52,100,68
M2 72,52,104,72
M2 76,52,108,76
L1 25,16,42,2048
M2 80,56,88,80
M2 84,56,92,84
M2 88,56,96,88
M2 92,56,100,92
s_add_u32 s42,s42,294912
s_cmp_eq_u32 s42,s7
s_cselect_b32 s42,s6,s42
M2 96,56,104,96
M2 100,56,108,100
M2 104,60,88,104
M2 108,60,92,108
M2 112,60,96,112
M2 116,60,100,116
M2 120,60,104,120
s_waitcnt vmcnt(23) lgkmcnt(0)
M2 124,60,108,124
s_barrier
M3 128,0,64,128
s_add_u32 m0,s43,131072
R 32,2,49152
S1 164,27,96,40,1024
M3 132,0,68,132
T 88,3,0
M3 136,0,72,136
T 90,3,1536
M3 140,0,76,140
L6 22,20,41
R 36,2,49216
M3 144,0,80,144
M3 148,0,84,148
T 92,4,0
M3 152,4,64,152
M3 156,4,68,156
L7 22,20,41,1024
R 40,2,51200
M3 160,4,72,160
T 94,4,1536
M3 164,4,76,164
M3 168,4,80,168
T 96,5,0
M3 172,4,84,172
L7 22,20,41,2048
M3 176,8,64,176
R 44,2,51264
M3 180,8,68,180
T 98,5,1536
M3 184,8,72,184
M3 188,8,76,188
L7 22,20,41,3072
R 48,2,53248
M3 192,8,80,192
M3 196,8,84,196
T 100,14,0
M3 200,12,64,200
T 102,14,1536
M3 204,12,68,204
s_add_u32 s41,s41,131072
s_cmp_eq_u32 s41,s5
s_cselect_b32 s41,s4,s41
M3 208,12,72,208
R 52,2,53312
M3 212,12,76,212
S1 168,27,96,40,2048
M3 216,12,80,216
T 104,15,0
M3 220,12,84,220
s_add_u32 m0,s11,49152
R 56,2,55296
M2 32,16,64,32
M2 36,16,68,36
T 106,15,1536
M2 40,16,72,40
M2 44,16,76,44
L 23,16,42
T 108,16,0
M2 48,16,80,48
R 60,2,55360
M2 52,16,84,52
M2 56,20,64,56
T 110,16,1536
M2 60,20,68,60
L1 24,16,42,1024
M2 64,20,72,64
M2 68,20,76,68
M2 72,20,80,72
M2 76,20,84,76
L1 25,16,42,2048
M2 80,24,64,80
M2 84,24,68,84
M2 88,24,72,88
M2 92,24,76,92
s_add_u32 s42,s42,294912
s_cmp_eq_u32 s42,s7
s_cselect_b32 s42,s6,s42
M2 96,24,80,96
M2 100,24,84,100
M2 104,28,64,104
M2 108,28,68,108
M2 112,28,72,112
M2 116,28,76,116
M2 120,28,80,120
s_waitcnt vmcnt(23) lgkmcnt(0)
M2 124,28,84,124
s_barrier
M3 128,32,88,128
s_add_u32 m0,s43,147456
R 0,2,0
S1 172,27,96,40,3072
M3 132,32,92,132
T 64,3,12288
M3 136,32,96,136
T 66,3,13824
M3 140,32,100,140
L6 22,20,41
R 4,2,64
M3 144,32,104,144
M3 148,32,108,148
T 68,4,12288
M3 152,36,88,152
M3 156,36,92,156
L7 22,20,41,1024
R 8,2,2048
M3 160,36,96,160
T 70,4,13824
M3 164,36,100,164
M3 168,36,104,168
T 72,5,12288
M3 172,36,108,172
L7 22,20,41,2048
M3 176,40,88,176
R 12,2,2112
M3 180,40,92,180
s_add_u32 s40,s38,20480
T 74,5,13824
M3 184,40,96,184
M3 188,40,100,188
L7 22,20,41,3072
R 16,2,4096
M3 192,40,104,192
M3 196,40,108,196
T 76,14,12288
M3 200,44,88,200
T 78,14,13824
M3 204,44,92,204
s_add_u32 s41,s41,131072
s_cmp_eq_u32 s41,s5
s_cselect_b32 s41,s4,s41
M3 208,44,96,208
R 20,2,4160
M3 212,44,100,212
M3 216,44,104,216
T 80,15,12288
M3 220,44,108,220
s_add_u32 m0,s11,0
R 24,2,6144
M2 32,48,88,32
M2 36,48,92,36
T 82,15,13824
M2 40,48,96,40
M2 44,48,100,44
L 23,16,42
T 84,16,12288
M2 48,48,104,48
S1 176,27,96,40,0
R 28,2,6208
M2 52,48,108,52
M2 56,52,88,56
T 86,16,13824
M2 60,52,92,60
L1 24,16,42,1024
M2 64,52,96,64
M2 68,52,100,68
M2 72,52,104,72
M2 76,52,108,76
L1 25,16,42,2048
M2 80,56,88,80
M2 84,56,92,84
M2 88,56,96,88
M2 92,56,100,92
s_add_u32 s42,s42,294912
s_cmp_eq_u32 s42,s7
s_cselect_b32 s42,s6,s42
M2 96,56,104,96
M2 100,56,108,100
M2 104,60,88,104
M2 108,60,92,108
M2 112,60,96,112
M2 116,60,100,116
M2 120,60,104,120
s_waitcnt vmcnt(22) lgkmcnt(0)
M2 124,60,108,124
s_barrier
M3 128,0,64,128
s_add_u32 m0,s43,98304
R 32,2,16384
S1 180,27,96,40,1024
M3 132,0,68,132
T 88,3,24576
M3 136,0,72,136
T 90,3,26112
M3 140,0,76,140
L6 22,20,41
R 36,2,16448
M3 144,0,80,144
M3 148,0,84,148
T 92,4,24576
M3 152,4,64,152
M3 156,4,68,156
L7 22,20,41,1024
R 40,2,18432
M3 160,4,72,160
T 94,4,26112
M3 164,4,76,164
M3 168,4,80,168
T 96,5,24576
M3 172,4,84,172
L7 22,20,41,2048
M3 176,8,64,176
R 44,2,18496
M3 180,8,68,180
S1 184,27,96,40,2048
T 98,5,26112
M3 184,8,72,184
M3 188,8,76,188
L7 22,20,41,3072
R 48,2,20480
M3 192,8,80,192
M3 196,8,84,196
T 100,14,24576
M3 200,12,64,200
T 102,14,26112
M3 204,12,68,204
s_add_u32 s41,s41,131072
s_cmp_eq_u32 s41,s5
s_cselect_b32 s41,s4,s41
M3 208,12,72,208
R 52,2,20544
M3 212,12,76,212
M3 216,12,80,216
T 104,15,24576
M3 220,12,84,220
s_add_u32 m0,s11,12288
R 56,2,22528
M2 32,16,64,32
M2 36,16,68,36
T 106,15,26112
M2 40,16,72,40
M2 44,16,76,44
L 23,16,42
T 108,16,24576
M2 48,16,80,48
S1 188,27,96,40,3072
R 60,2,22592
M2 52,16,84,52
M2 56,20,64,56
T 110,16,26112
M2 60,20,68,60
L1 24,16,42,1024
M2 64,20,72,64
M2 68,20,76,68
M2 72,20,80,72
M2 76,20,84,76
L1 25,16,42,2048
M2 80,24,64,80
M2 84,24,68,84
M2 88,24,72,88
M2 92,24,76,92
s_add_u32 s42,s42,294912
s_cmp_eq_u32 s42,s7
s_cselect_b32 s42,s6,s42
M2 96,24,80,96
M2 100,24,84,100
M2 104,28,64,104
M2 108,28,68,108
M2 112,28,72,112
M2 116,28,76,116
M2 120,28,80,120
s_waitcnt vmcnt(23) lgkmcnt(0)
M2 124,28,84,124
s_barrier
M3 128,32,88,128
s_add_u32 m0,s43,114688
R 0,2,32768
T 64,3,36864
M3 132,32,92,132
s_add_u32 s40,s38,32768
M3 136,32,96,136
T 66,3,38400
M3 140,32,100,140
L6 22,20,41
R 4,2,32832
M3 144,32,104,144
M3 148,32,108,148
T 68,4,36864
M3 152,36,88,152
M3 156,36,92,156
L7 22,20,41,1024
R 8,2,34816
M3 160,36,96,160
T 70,4,38400
M3 164,36,100,164
M3 168,36,104,168
T 72,5,36864
M3 172,36,108,172
L7 22,20,41,2048
M3 176,40,88,176
R 12,2,34880
M3 180,40,92,180
S1 192,27,96,40,0
T 74,5,38400
M3 184,40,96,184
M3 188,40,100,188
L7 22,20,41,3072
R 16,2,36864
M3 192,40,104,192
M3 196,40,108,196
T 76,14,36864
M3 200,44,88,200
T 78,14,38400
M3 204,44,92,204
s_add_u32 s41,s41,131072
s_cmp_eq_u32 s41,s5
s_cselect_b32 s41,s4,s41
M3 208,44,96,208
R 20,2,36928
M3 212,44,100,212
M3 216,44,104,216
T 80,15,36864
M3 220,44,108,220
s_add_u32 m0,s11,24576
R 24,2,38912
M2 32,48,88,32
M2 36,48,92,36
T 82,15,38400
M2 40,48,96,40
M2 44,48,100,44
L 23,16,42
T 84,16,36864
M2 48,48,104,48
S1 196,27,96,40,1024
R 28,2,38976
M2 52,48,108,52
M2 56,52,88,56
T 86,16,38400
M2 60,52,92,60
L1 24,16,42,1024
M2 64,52,96,64
M2 68,52,100,68
M2 72,52,104,72
M2 76,52,108,76
L1 25,16,42,2048
M2 80,56,88,80
M2 84,56,92,84
M2 88,56,96,88
M2 92,56,100,92
s_add_u32 s42,s42,294912
s_cmp_eq_u32 s42,s7
s_cselect_b32 s42,s6,s42
M2 96,56,104,96
M2 100,56,108,100
M2 104,60,88,104
M2 108,60,92,108
M2 112,60,96,112
M2 116,60,100,116
M2 120,60,104,120
s_waitcnt vmcnt(23) lgkmcnt(0)
M2 124,60,108,124
s_barrier
M3 128,0,64,128
s_add_u32 m0,s43,131072
R 32,2,49152
S1 200,27,96,40,2048
M3 132,0,68,132
T 88,3,49152
M3 136,0,72,136
T 90,3,50688
M3 140,0,76,140
L6 22,20,41
R 36,2,49216
M3 144,0,80,144
M3 148,0,84,148
T 92,4,49152
M3 152,4,64,152
M3 156,4,68,156
L7 22,20,41,1024
R 40,2,51200
M3 160,4,72,160
T 94,4,50688
M3 164,4,76,164
M3 168,4,80,168
T 96,5,49152
M3 172,4,84,172
L7 22,20,41,2048
M3 176,8,64,176
R 44,2,51264
M3 180,8,68,180
T 98,5,50688
M3 184,8,72,184
M3 188,8,76,188
L7 22,20,41,3072
R 48,2,53248
M3 192,8,80,192
M3 196,8,84,196
T 100,14,49152
M3 200,12,64,200
T 102,14,50688
M3 204,12,68,204
s_add_u32 s41,s41,131072
s_cmp_eq_u32 s41,s5
s_cselect_b32 s41,s4,s41
M3 208,12,72,208
R 52,2,53312
M3 212,12,76,212
S1 204,27,96,40,3072
M3 216,12,80,216
T 104,15,49152
M3 220,12,84,220
s_add_u32 m0,s11,36864
R 56,2,55296
M2 32,16,64,32
M2 36,16,68,36
T 106,15,50688
M2 40,16,72,40
M2 44,16,76,44
L 23,16,42
T 108,16,49152
M2 48,16,80,48
R 60,2,55360
M2 52,16,84,52
M2 56,20,64,56
T 110,16,50688
M2 60,20,68,60
L1 24,16,42,1024
M2 64,20,72,64
M2 68,20,76,68
M2 72,20,80,72
M2 76,20,84,76
L1 25,16,42,2048
M2 80,24,64,80
M2 84,24,68,84
M2 88,24,72,88
M2 92,24,76,92
s_add_u32 s42,s42,294912
s_cmp_eq_u32 s42,s7
s_cselect_b32 s42,s6,s42
M2 96,24,80,96
M2 100,24,84,100
M2 104,28,64,104
M2 108,28,68,108
M2 112,28,72,112
M2 116,28,76,116
M2 120,28,80,120
s_waitcnt vmcnt(22) lgkmcnt(0)
M2 124,28,84,124
s_barrier
M3 128,32,88,128
s_add_u32 m0,s43,147456
R 0,2,0
T 64,3,0
M3 132,32,92,132
s_add_u32 s40,s38,36864
M3 136,32,96,136
T 66,3,1536
M3 140,32,100,140
L6 22,20,41
R 4,2,64
M3 144,32,104,144
M3 148,32,108,148
T 68,4,0
M3 152,36,88,152
M3 156,36,92,156
L7 22,20,41,1024
R 8,2,2048
M3 160,36,96,160
T 70,4,1536
M3 164,36,100,164
M3 168,36,104,168
T 72,5,0
M3 172,36,108,172
L7 22,20,41,2048
M3 176,40,88,176
R 12,2,2112
M3 180,40,92,180
S1 208,27,96,40,0
T 74,5,1536
M3 184,40,96,184
M3 188,40,100,188
L7 22,20,41,3072
R 16,2,4096
M3 192,40,104,192
M3 196,40,108,196
T 76,14,0
M3 200,44,88,200
T 78,14,1536
M3 204,44,92,204
s_add_u32 s41,s41,131072
s_cmp_eq_u32 s41,s5
s_cselect_b32 s41,s4,s41
M3 208,44,96,208
R 20,2,4160
M3 212,44,100,212
M3 216,44,104,216
T 80,15,0
M3 220,44,108,220
s_add_u32 m0,s11,49152
R 24,2,6144
M2 32,48,88,32
M2 36,48,92,36
T 82,15,1536
M2 40,48,96,40
M2 44,48,100,44
L 23,16,42
T 84,16,0
M2 48,48,104,48
S1 212,27,96,40,1024
R 28,2,6208
M2 52,48,108,52
M2 56,52,88,56
T 86,16,1536
M2 60,52,92,60
L1 24,16,42,1024
M2 64,52,96,64
M2 68,52,100,68
M2 72,52,104,72
M2 76,52,108,76
L1 25,16,42,2048
M2 80,56,88,80
M2 84,56,92,84
M2 88,56,96,88
M2 92,56,100,92
s_add_u32 s42,s42,294912
s_cmp_eq_u32 s42,s7
s_cselect_b32 s42,s6,s42
M2 96,56,104,96
M2 100,56,108,100
M2 104,60,88,104
M2 108,60,92,108
M2 112,60,96,112
M2 116,60,100,116
M2 120,60,104,120
s_waitcnt vmcnt(22) lgkmcnt(0)
M2 124,60,108,124
s_barrier
M3 128,0,64,128
s_add_u32 m0,s43,98304
R 32,2,16384
S1 216,27,96,40,2048
M3 132,0,68,132
T 88,3,12288
M3 136,0,72,136
T 90,3,13824
M3 140,0,76,140
L6 22,20,41
R 36,2,16448
M3 144,0,80,144
M3 148,0,84,148
T 92,4,12288
M3 152,4,64,152
M3 156,4,68,156
L7 22,20,41,1024
R 40,2,18432
M3 160,4,72,160
T 94,4,13824
M3 164,4,76,164
M3 168,4,80,168
S1 220,27,96,40,3072
T 96,5,12288
M3 172,4,84,172
L7 22,20,41,2048
M3 176,8,64,176
R 44,2,18496
M3 180,8,68,180
T 98,5,13824
M3 184,8,72,184
M3 188,8,76,188
L7 22,20,41,3072
R 48,2,20480
M3 192,8,80,192
M3 196,8,84,196
T 100,14,12288
M3 200,12,64,200
T 102,14,13824
M3 204,12,68,204
s_add_u32 s41,s41,131072
s_cmp_eq_u32 s41,s5
s_cselect_b32 s41,s4,s41
M3 208,12,72,208
R 52,2,20544
M3 212,12,76,212
s_add_u32 s40,s38,49152
M3 216,12,80,216
T 104,15,12288
M3 220,12,84,220
s_add_u32 m0,s11,0
R 56,2,22528
M2 32,16,64,32
M2 36,16,68,36
T 106,15,13824
M2 40,16,72,40
M2 44,16,76,44
L 23,16,42
T 108,16,12288
M2 48,16,80,48
R 60,2,22592
M2 52,16,84,52
M2 56,20,64,56
T 110,16,13824
M2 60,20,68,60
L1 24,16,42,1024
M2 64,20,72,64
S1 224,27,96,40,0
M2 68,20,76,68
M2 72,20,80,72
M2 76,20,84,76
L1 25,16,42,2048
M2 80,24,64,80
M2 84,24,68,84
M2 88,24,72,88
M2 92,24,76,92
s_add_u32 s42,s42,294912
s_cmp_eq_u32 s42,s7
s_cselect_b32 s42,s6,s42
M2 96,24,80,96
M2 100,24,84,100
M2 104,28,64,104
M2 108,28,68,108
M2 112,28,72,112
M2 116,28,76,116
M2 120,28,80,120
s_waitcnt vmcnt(23) lgkmcnt(0)
M2 124,28,84,124
s_barrier
M3 128,32,88,128
s_add_u32 m0,s43,114688
R 0,2,32768
S1 228,27,96,40,1024
M3 132,32,92,132
T 64,3,24576
M3 136,32,96,136
T 66,3,26112
M3 140,32,100,140
L6 22,20,41
R 4,2,32832
M3 144,32,104,144
M3 148,32,108,148
T 68,4,24576
M3 152,36,88,152
M3 156,36,92,156
L7 22,20,41,1024
R 8,2,34816
M3 160,36,96,160
T 70,4,26112
M3 164,36,100,164
M3 168,36,104,168
T 72,5,24576
M3 172,36,108,172
L7 22,20,41,2048
M3 176,40,88,176
R 12,2,34880
M3 180,40,92,180
T 74,5,26112
M3 184,40,96,184
M3 188,40,100,188
L7 22,20,41,3072
R 16,2,36864
M3 192,40,104,192
M3 196,40,108,196
T 76,14,24576
M3 200,44,88,200
T 78,14,26112
M3 204,44,92,204
s_add_u32 s41,s41,131072
s_cmp_eq_u32 s41,s5
s_cselect_b32 s41,s4,s41
M3 208,44,96,208
R 20,2,36928
M3 212,44,100,212
S1 232,27,96,40,2048
M3 216,44,104,216
T 80,15,24576
M3 220,44,108,220
s_add_u32 m0,s11,12288
R 24,2,38912
M2 32,48,88,32
M2 36,48,92,36
T 82,15,26112
M2 40,48,96,40
M2 44,48,100,44
L 23,16,42
T 84,16,24576
M2 48,48,104,48
R 28,2,38976
M2 52,48,108,52
M2 56,52,88,56
T 86,16,26112
M2 60,52,92,60
L1 24,16,42,1024
M2 64,52,96,64
M2 68,52,100,68
M2 72,52,104,72
M2 76,52,108,76
L1 25,16,42,2048
M2 80,56,88,80
M2 84,56,92,84
M2 88,56,96,88
M2 92,56,100,92
s_add_u32 s42,s42,294912
s_cmp_eq_u32 s42,s7
s_cselect_b32 s42,s6,s42
M2 96,56,104,96
M2 100,56,108,100
M2 104,60,88,104
M2 108,60,92,108
M2 112,60,96,112
M2 116,60,100,116
M2 120,60,104,120
s_waitcnt vmcnt(23) lgkmcnt(0)
M2 124,60,108,124
s_barrier
M3 128,0,64,128
s_add_u32 m0,s43,131072
R 32,2,49152
S1 236,27,96,40,3072
M3 132,0,68,132
T 88,3,36864
M3 136,0,72,136
T 90,3,38400
M3 140,0,76,140
L6 22,20,41
R 36,2,49216
M3 144,0,80,144
M3 148,0,84,148
T 92,4,36864
M3 152,4,64,152
M3 156,4,68,156
L7 22,20,41,1024
R 40,2,51200
M3 160,4,72,160
T 94,4,38400
M3 164,4,76,164
M3 168,4,80,168
T 96,5,36864
M3 172,4,84,172
L7 22,20,41,2048
M3 176,8,64,176
R 44,2,51264
M3 180,8,68,180
s_add_u32 s40,s38,53248
T 98,5,38400
M3 184,8,72,184
M3 188,8,76,188
L7 22,20,41,3072
R 48,2,53248
M3 192,8,80,192
M3 196,8,84,196
T 100,14,36864
M3 200,12,64,200
T 102,14,38400
M3 204,12,68,204
s_add_u32 s41,s41,131072
s_cmp_eq_u32 s41,s5
s_cselect_b32 s41,s4,s41
M3 208,12,72,208
R 52,2,53312
M3 212,12,76,212
M3 216,12,80,216
T 104,15,36864
M3 220,12,84,220
s_add_u32 m0,s11,24576
R 56,2,55296
M2 32,16,64,32
M2 36,16,68,36
T 106,15,38400
M2 40,16,72,40
M2 44,16,76,44
L 23,16,42
T 108,16,36864
M2 48,16,80,48
S1 240,27,96,40,0
R 60,2,55360
M2 52,16,84,52
M2 56,20,64,56
T 110,16,38400
M2 60,20,68,60
L1 24,16,42,1024
M2 64,20,72,64
M2 68,20,76,68
M2 72,20,80,72
M2 76,20,84,76
L1 25,16,42,2048
M2 80,24,64,80
M2 84,24,68,84
M2 88,24,72,88
M2 92,24,76,92
s_add_u32 s42,s42,294912
s_cmp_eq_u32 s42,s7
s_cselect_b32 s42,s6,s42
M2 96,24,80,96
M2 100,24,84,100
M2 104,28,64,104
M2 108,28,68,108
M2 112,28,72,112
M2 116,28,76,116
M2 120,28,80,120
s_waitcnt vmcnt(22) lgkmcnt(0)
M2 124,28,84,124
s_barrier
M3 128,32,88,128
s_add_u32 m0,s43,147456
R 0,2,0
S1 244,27,96,40,1024
M3 132,32,92,132
T 64,3,49152
M3 136,32,96,136
L6 22,20,41
T 66,3,50688
M3 140,32,100,140
R 4,2,64
M3 144,32,104,144
M3 148,32,108,148
L7 22,20,41,1024
T 68,4,49152
M3 152,36,88,152
M3 156,36,92,156
R 8,2,2048
M3 160,36,96,160
L7 22,20,41,2048
T 70,4,50688
M3 164,36,100,164
M3 168,36,104,168
T 72,5,49152
M3 172,36,108,172
L7 22,20,41,3072
M3 176,40,88,176
R 12,2,2112
M3 180,40,92,180
S1 248,27,96,40,2048
T 74,5,50688
M3 184,40,96,184
s_add_u32 s41,s41,131072
s_cmp_eq_u32 s41,s5
s_cselect_b32 s41,s4,s41
M3 188,40,100,188
R 16,2,4096
M3 192,40,104,192
M3 196,40,108,196
s_sub_u32 s42,s42,4608
T 76,14,49152
M3 200,44,88,200
T 78,14,50688
M3 204,44,92,204
M3 208,44,96,208
R 20,2,4160
M3 212,44,100,212
s_sub_u32 s6,s6,4608
M3 216,44,104,216
T 80,15,49152
M3 220,44,108,220
R 24,2,6144
M2 32,48,88,32
s_sub_u32 s7,s7,4608
M2 36,48,92,36
T 82,15,50688
M2 40,48,96,40
M2 44,48,100,44
s_add_u32 m0,s11,36864
T 84,16,49152
M2 48,48,104,48
S1 252,27,96,40,3072
R 28,2,6208
M2 52,48,108,52
M2 56,52,88,56
T 86,16,50688
L 23,16,42
M2 60,52,92,60
M2 64,52,96,64
M2 68,52,100,68
L1 24,16,42,1024
M2 72,52,104,72
M2 76,52,108,76
M2 80,56,88,80
L1 25,16,42,2048
M2 84,56,92,84
M2 88,56,96,88
M2 92,56,100,92
s_add_u32 s42,s42,294912
s_cmp_eq_u32 s42,s7
s_cselect_b32 s42,s6,s42
M2 96,56,104,96
M2 100,56,108,100
M2 104,60,88,104
M2 108,60,92,108
M2 112,60,96,112
M2 116,60,100,116
M2 120,60,104,120
s_waitcnt vmcnt(23) lgkmcnt(0)
M2 124,60,108,124
s_barrier
M3 128,0,64,128
s_add_u32 m0,s11,49152
R 32,2,16384
T 88,3,0
M3 132,0,68,132
M3 136,0,72,136
T 90,3,1536
M3 140,0,76,140
L 23,16,42
R 36,2,16448
M3 144,0,80,144
M3 148,0,84,148
T 92,4,0
M3 152,4,64,152
M3 156,4,68,156
L1 24,16,42,1024
R 40,2,18432
M3 160,4,72,160
T 94,4,1536
M3 164,4,76,164
M3 168,4,80,168
T 96,5,0
M3 172,4,84,172
L1 25,16,42,2048
M3 176,8,64,176
R 44,2,18496
M3 180,8,68,180
T 98,5,1536
M3 184,8,72,184
M3 188,8,76,188
s_add_u32 s42,s42,294912
s_cmp_eq_u32 s42,s7
s_cselect_b32 s42,s6,s42
M3 192,8,80,192
R 48,2,20480
M3 196,8,84,196
T 100,14,0
M3 200,12,64,200
T 102,14,1536
M3 204,12,68,204
s_add_u32 m0,s43,98304
M3 208,12,72,208
R 52,2,20544
M3 212,12,76,212
M3 216,12,80,216
T 104,15,0
M3 220,12,84,220
L6 22,20,41
R 56,2,22528
M2 32,16,64,32
M2 36,16,68,36
T 106,15,1536
M2 40,16,72,40
M2 44,16,76,44
L7 22,20,41,1024
T 108,16,0
M2 48,16,80,48
R 60,2,22592
M2 52,16,84,52
M2 56,20,64,56
T 110,16,1536
M2 60,20,68,60
L7 22,20,41,2048
M2 64,20,72,64
M2 68,20,76,68
M2 72,20,80,72
M2 76,20,84,76
L7 22,20,41,3072
M2 80,24,64,80
M2 84,24,68,84
M2 88,24,72,88
M2 92,24,76,92
s_add_u32 s41,s41,131072
s_cmp_eq_u32 s41,s5
s_cselect_b32 s41,s4,s41
M2 96,24,80,96
M2 100,24,84,100
M2 104,28,64,104
M2 108,28,68,108
M2 112,28,72,112
M2 116,28,76,116
M2 120,28,80,120
s_waitcnt vmcnt(21) lgkmcnt(0)
M2 124,28,84,124
s_barrier
M3 128,32,88,128
s_add_u32 m0,s11,0
R 0,2,32768
T 64,3,12288
M3 132,32,92,132
M3 136,32,96,136
T 66,3,13824
M3 140,32,100,140
L 23,16,42
R 4,2,32832
M3 144,32,104,144
M3 148,32,108,148
T 68,4,12288
M3 152,36,88,152
M3 156,36,92,156
L1 24,16,42,1024
R 8,2,34816
M3 160,36,96,160
T 70,4,13824
M3 164,36,100,164
M3 168,36,104,168
T 72,5,12288
M3 172,36,108,172
L1 25,16,42,2048
M3 176,40,88,176
R 12,2,34880
M3 180,40,92,180
T 74,5,13824
M3 184,40,96,184
M3 188,40,100,188
s_add_u32 s42,s42,294912
s_cmp_eq_u32 s42,s7
s_cselect_b32 s42,s6,s42
M3 192,40,104,192
R 16,2,36864
M3 196,40,108,196
T 76,14,12288
M3 200,44,88,200
T 78,14,13824
M3 204,44,92,204
s_add_u32 m0,s43,114688
M3 208,44,96,208
R 20,2,36928
M3 212,44,100,212
M3 216,44,104,216
T 80,15,12288
M3 220,44,108,220
L6 22,20,41
R 24,2,38912
M2 32,48,88,32
M2 36,48,92,36
T 82,15,13824
M2 40,48,96,40
M2 44,48,100,44
L7 22,20,41,1024
T 84,16,12288
M2 48,48,104,48
R 28,2,38976
M2 52,48,108,52
M2 56,52,88,56
T 86,16,13824
M2 60,52,92,60
L7 22,20,41,2048
M2 64,52,96,64
M2 68,52,100,68
M2 72,52,104,72
M2 76,52,108,76
L7 22,20,41,3072
M2 80,56,88,80
M2 84,56,92,84
M2 88,56,96,88
M2 92,56,100,92
s_add_u32 s41,s41,131072
s_cmp_eq_u32 s41,s5
s_cselect_b32 s41,s4,s41
M2 96,56,104,96
M2 100,56,108,100
M2 104,60,88,104
M2 108,60,92,108
M2 112,60,96,112
M2 116,60,100,116
M2 120,60,104,120
s_waitcnt vmcnt(19) lgkmcnt(0)
M2 124,60,108,124
s_barrier
M3 128,0,64,128
s_add_u32 m0,s11,12288
R 32,2,49152
T 88,3,24576
M3 132,0,68,132
M3 136,0,72,136
T 90,3,26112
M3 140,0,76,140
L 23,16,42
R 36,2,49216
M3 144,0,80,144
M3 148,0,84,148
T 92,4,24576
M3 152,4,64,152
M3 156,4,68,156
L1 24,16,42,1024
R 40,2,51200
M3 160,4,72,160
T 94,4,26112
M3 164,4,76,164
M3 168,4,80,168
T 96,5,24576
M3 172,4,84,172
L1 25,16,42,2048
M3 176,8,64,176
R 44,2,51264
M3 180,8,68,180
T 98,5,26112
M3 184,8,72,184
M3 188,8,76,188
s_add_u32 s42,s42,294912
s_cmp_eq_u32 s42,s7
s_cselect_b32 s42,s6,s42
M3 192,8,80,192
R 48,2,53248
M3 196,8,84,196
T 100,14,24576
M3 200,12,64,200
T 102,14,26112
M3 204,12,68,204
s_add_u32 m0,s43,131072
M3 208,12,72,208
R 52,2,53312
M3 212,12,76,212
M3 216,12,80,216
T 104,15,24576
M3 220,12,84,220
L6 22,20,41
R 56,2,55296
M2 32,16,64,32
M2 36,16,68,36
T 106,15,26112
M2 40,16,72,40
M2 44,16,76,44
L7 22,20,41,1024
T 108,16,24576
M2 48,16,80,48
R 60,2,55360
M2 52,16,84,52
M2 56,20,64,56
T 110,16,26112
M2 60,20,68,60
L7 22,20,41,2048
M2 64,20,72,64
M2 68,20,76,68
M2 72,20,80,72
M2 76,20,84,76
L7 22,20,41,3072
M2 80,24,64,80
M2 84,24,68,84
M2 88,24,72,88
M2 92,24,76,92
s_add_u32 s41,s41,131072
s_cmp_eq_u32 s41,s5
s_cselect_b32 s41,s4,s41
M2 96,24,80,96
M2 100,24,84,100
M2 104,28,64,104
M2 108,28,68,108
M2 112,28,72,112
M2 116,28,76,116
M2 120,28,80,120
s_waitcnt lgkmcnt(0)
M2 124,28,84,124
s_barrier
M3 128,32,88,128
s_add_u32 m0,s11,24576
M3 132,32,92,132
M3 136,32,96,136
M3 140,32,100,140
L 23,16,42
M3 144,32,104,144
M3 148,32,108,148
M3 152,36,88,152
M3 156,36,92,156
L1 24,16,42,1024
M3 160,36,96,160
M3 164,36,100,164
M3 168,36,104,168
M3 172,36,108,172
L1 25,16,42,2048
M3 176,40,88,176
M3 180,40,92,180
M3 184,40,96,184
M3 188,40,100,188
M3 192,40,104,192
s_add_u32 s42,s42,294912
s_cmp_eq_u32 s42,s7
s_cselect_b32 s42,s6,s42
M3 196,40,108,196
M3 200,44,88,200
M3 204,44,92,204
M3 208,44,96,208
s_add_u32 m0,s43,147456
M3 212,44,100,212
M3 216,44,104,216
M3 220,44,108,220
M2 32,48,88,32
L6 22,20,41
M2 36,48,92,36
M2 40,48,96,40
M2 44,48,100,44
M2 48,48,104,48
L7 22,20,41,1024
M2 52,48,108,52
M2 56,52,88,56
M2 60,52,92,60
M2 64,52,96,64
M2 68,52,100,68
L7 22,20,41,2048
M2 72,52,104,72
M2 76,52,108,76
M2 80,56,88,80
M2 84,56,92,84
L7 22,20,41,3072
M2 88,56,96,88
M2 92,56,100,92
M2 96,56,104,96
M2 100,56,108,100
s_add_u32 s41,s41,131072
s_cmp_eq_u32 s41,s5
s_cselect_b32 s41,s4,s41
M2 104,60,88,104
M2 108,60,92,108
M2 112,60,96,112
M2 116,60,100,116
M2 120,60,104,120
M2 124,60,108,124
s_branch l12_gpost
spin_lng0:
s_mov_b32 s100,0
spinl_lng0:
s_sleep 4
buffer_load_dword v0,v26,s[92:95],0 offen sc1
s_add_u32 s100,s100,1
s_cmp_ge_u32 s100,16384
s_cbranch_scc1 spinret_lng0
s_waitcnt vmcnt(0)
v_cmp_le_u32 vcc,32,v0
s_nop 3
s_and_b32 s39,vcc_lo,0xff
s_cmp_lg_u32 s39,0xff
s_cbranch_scc1 spinl_lng0
s_branch spinret_lng0
l12_v:
s_waitcnt lgkmcnt(0)
s_waitcnt vmcnt(21)
s_barrier
M 128,64,0,0
s_add_u32 m0,s34,0
T 32,6,16384
R 96,19,0
M 32,68,0,0
L 2,48,31
M 160,72,0,0
T 34,6,18432
M 64,76,0,0
M 192,80,0,0
T 36,7,16384
L1 3,48,31,1024
M 96,84,0,0
M 224,88,0,0
R 100,19,2048
M1 224,92,0,0
L1 4,48,31,2048
M 132,64,4,0
T 38,7,18432
M 36,68,4,0
M 164,72,4,0
T 40,8,16384
L1 5,48,31,3072
M 68,76,4,0
R 104,19,4096
M 196,80,4,0
M 100,84,4,0
s_add_u32 s31,s31,262144
T 42,8,18432
M 228,88,4,0
M1 228,92,4,0
T 44,9,16384
M 136,64,8,0
s_and_b32 s31,s31,0xffdfffff
M 40,68,8,0
R 108,19,6144
M 168,72,8,0
M 72,76,8,0
s_add_u32 m0,s35,131072
T 46,9,18432
M 200,80,8,0
M 104,84,8,0
T 48,10,16384
L 14,44,32
M 232,88,8,0
R 112,19,8192
M1 232,92,8,0
M 140,64,12,0
T 50,10,18432
L1 15,44,32,1024
M 44,68,12,0
M 172,72,12,0
T 52,11,16384
M 76,76,12,0
L1 16,44,32,2048
M 204,80,12,0
R 116,19,10240
M 108,84,12,0
M 236,88,12,0
T 54,11,18432
L1 17,44,32,3072
M1 236,92,12,0
M 144,64,16,0
T 56,12,16384
M 48,68,16,0
s_add_u32 s32,s32,128
R 120,19,12288
M 176,72,16,0
M 80,76,16,0
T 58,12,18432
M 208,80,16,0
s_and_b32 s32,s32,0xfffffdff
M 112,84,16,0
T 60,13,16384
M 240,88,16,0
M1 240,92,16,0
s_add_u32 m0,s35,135168
R 124,19,14336
M 148,64,20,0
M 52,68,20,0
T 62,13,18432
L 14,44,33
M 180,72,20,0
M 84,76,20,0
M 212,80,20,0
L1 15,44,33,1024
M 116,84,20,0
M 244,88,20,0
M1 244,92,20,0
L1 16,44,33,2048
M 152,64,24,0
M 56,68,24,0
M 184,72,24,0
L1 17,44,33,3072
M 88,76,24,0
M 216,80,24,0
M 120,84,24,0
s_add_u32 s33,s33,128
M 248,88,24,0
M1 248,92,24,0
M 156,64,28,0
s_and_b32 s33,s33,0xfffffdff
M 60,68,28,0
M 188,72,28,0
M 92,76,28,0
M 220,80,28,0
M 124,84,28,0
M 252,88,28,0
s_waitcnt vmcnt(20) lgkmcnt(0)
M1 252,92,28,0
s_barrier
M2 128,96,32,128
s_add_u32 m0,s34,16384
T 0,6,32768
R 64,18,32768
M2 32,100,32,32
L 2,48,31
M2 160,104,32,160
T 2,6,34816
M2 64,108,32,64
M2 192,112,32,192
T 4,7,32768
L1 3,48,31,1024
M2 96,116,32,96
M2 224,120,32,224
R 68,18,34816
M3 224,124,32,224
L1 4,48,31,2048
M2 132,96,36,132
T 6,7,34816
M2 36,100,36,36
M2 164,104,36,164
T 8,8,32768
L1 5,48,31,3072
M2 68,108,36,68
R 72,18,36864
M2 196,112,36,196
M2 100,116,36,100
s_add_u32 s31,s31,262144
T 10,8,34816
M2 228,120,36,228
M3 228,124,36,228
T 12,9,32768
M2 136,96,40,136
s_and_b32 s31,s31,0xffdfffff
M2 40,100,40,40
R 76,18,38912
M2 168,104,40,168
M2 72,108,40,72
s_add_u32 m0,s35,65536
T 14,9,34816
M2 200,112,40,200
M2 104,116,40,104
T 16,10,32768
L 14,44,32
M2 232,120,40,232
R 80,18,40960
M3 232,124,40,232
M2 140,96,44,140
T 18,10,34816
L1 15,44,32,1024
M2 44,100,44,44
M2 172,104,44,172
T 20,11,32768
M2 76,108,44,76
L1 16,44,32,2048
M2 204,112,44,204
R 84,18,43008
M2 108,116,44,108
M2 236,120,44,236
T 22,11,34816
L1 17,44,32,3072
M3 236,124,44,236
M2 144,96,48,144
T 24,12,32768
M2 48,100,48,48
s_add_u32 s32,s32,128
R 88,18,45056
M2 176,104,48,176
M2 80,108,48,80
T 26,12,34816
M2 208,112,48,208
s_or_b32 s32,s32,0x200
M2 112,116,48,112
T 28,13,32768
M2 240,120,48,240
M3 240,124,48,240
s_add_u32 m0,s35,69632
R 92,18,47104
M2 148,96,52,148
M2 52,100,52,52
T 30,13,34816
L 14,44,33
M2 180,104,52,180
M2 84,108,52,84
M2 212,112,52,212
L1 15,44,33,1024
M2 116,116,52,116
M2 244,120,52,244
M3 244,124,52,244
L1 16,44,33,2048
M2 152,96,56,152
M2 56,100,56,56
M2 184,104,56,184
L1 17,44,33,3072
M2 88,108,56,88
M2 216,112,56,216
M2 120,116,56,120
s_add_u32 s33,s33,128
M2 248,120,56,248
M3 248,124,56,248
M2 156,96,60,156
s_or_b32 s33,s33,0x200
M2 60,100,60,60
M2 188,104,60,188
M2 92,108,60,92
M2 220,112,60,220
M2 124,116,60,124
M2 252,120,60,252
s_waitcnt vmcnt(24) lgkmcnt(0)
M3 252,124,60,252
s_barrier
M2 128,64,0,128
s_add_u32 m0,s34,32768
T 32,6,49152
R 96,19,32768
M2 32,68,0,32
M2 160,72,0,160
T 34,6,51200
M2 64,76,0,64
M2 192,80,0,192
L 2,48,31
T 36,7,49152
M2 96,84,0,96
M2 224,88,0,224
R 100,19,34816
M3 224,92,0,224
M2 132,64,4,132
T 38,7,51200
M2 36,68,4,36
L1 3,48,31,1024
M2 164,72,4,164
T 40,8,49152
M2 68,76,4,68
R 104,19,36864
M2 196,80,4,196
M2 100,84,4,100
T 42,8,51200
M2 228,88,4,228
M3 228,92,4,228
L1 4,48,31,2048
T 44,9,49152
M2 136,64,8,136
M2 40,68,8,40
R 108,19,38912
M2 168,72,8,168
M2 72,76,8,72
T 46,9,51200
M2 200,80,8,200
L1 5,48,31,3072
M2 104,84,8,104
T 48,10,49152
M2 232,88,8,232
R 112,19,40960
M3 232,92,8,232
M2 140,64,12,140
T 50,10,51200
M2 44,68,12,44
M2 172,72,12,172
s_add_u32 s31,s31,262144
T 52,11,49152
M2 76,76,12,76
M2 204,80,12,204
R 116,19,43008
M2 108,84,12,108
M2 236,88,12,236
T 54,11,51200
M3 236,92,12,236
s_and_b32 s31,s31,0xffdfffff
M2 144,64,16,144
T 56,12,49152
M2 48,68,16,48
R 120,19,45056
M2 176,72,16,176
M2 80,76,16,80
T 58,12,51200
M2 208,80,16,208
M2 112,84,16,112
s_and_b32 s39,s2,0xe0
T 60,13,49152
M2 240,88,16,240
M3 240,92,16,240
R 124,19,47104
M2 148,64,20,148
M2 52,68,20,52
T 62,13,51200
M2 180,72,20,180
s_bfe_u32 s40,s2,0x20003
M2 84,76,20,84
M2 212,80,20,212
M2 116,84,20,116
M2 244,88,20,244
M3 244,92,20,244
M2 152,64,24,152
s_cmp_eq_u32 s40,0
s_cselect_b32 s39,s39,1073741824
M2 56,68,24,56
M2 184,72,24,184
M2 88,76,24,88
M2 216,80,24,216
M2 120,84,24,120
buffer_atomic_add v28,v29,s[92:95],s39 offen sc1
M2 248,88,24,248
M3 248,92,24,248
M2 156,64,28,156
M2 60,68,28,60
M2 188,72,28,188
M2 92,76,28,92
M2 220,80,28,220
M2 124,84,28,124
M2 252,88,28,252
s_waitcnt vmcnt(17) lgkmcnt(0)
M3 252,92,28,252
s_barrier
M2 128,96,32,128
s_add_u32 m0,s34,49152
T 0,6,0
R 64,20,0
M2 32,100,32,32
M2 160,104,32,160
L 2,48,31
T 2,6,2048
M2 64,108,32,64
M2 192,112,32,192
T 4,7,0
M2 96,116,32,96
L1 3,48,31,1024
M2 224,120,32,224
R 68,20,2048
M3 224,124,32,224
M2 132,96,36,132
T 6,7,2048
L1 4,48,31,2048
M2 36,100,36,36
M2 164,104,36,164
T 8,8,0
M2 68,108,36,68
L1 5,48,31,3072
R 72,20,4096
M2 196,112,36,196
M2 100,116,36,100
T 10,8,2048
M2 228,120,36,228
s_add_u32 s31,s31,262144
M3 228,124,36,228
T 12,9,0
M2 136,96,40,136
M2 40,100,40,40
s_or_b32 s31,s31,0x200000
R 76,20,6144
M2 168,104,40,168
M2 72,108,40,72
T 14,9,2048
M2 200,112,40,200
M2 104,116,40,104
s_add_u32 m0,s35,98304
T 16,10,0
M2 232,120,40,232
R 80,20,8192
M3 232,124,40,232
M2 140,96,44,140
L 14,44,32
T 18,10,2048
M2 44,100,44,44
M2 172,104,44,172
T 20,11,0
M2 76,108,44,76
L1 15,44,32,1024
M2 204,112,44,204
R 84,20,10240
M2 108,116,44,108
M2 236,120,44,236
T 22,11,2048
L1 16,44,32,2048
M3 236,124,44,236
M2 144,96,48,144
T 24,12,0
M2 48,100,48,48
L1 17,44,32,3072
R 88,20,12288
M2 176,104,48,176
M2 80,108,48,80
T 26,12,2048
M2 208,112,48,208
s_add_u32 s32,s32,128
M2 112,116,48,112
T 28,13,0
M2 240,120,48,240
M3 240,124,48,240
R 92,20,14336
M2 148,96,52,148
s_and_b32 s32,s32,0xfffffbff
M2 52,100,52,52
T 30,13,2048
M2 180,104,52,180
M2 84,108,52,84
s_or_b32 s32,s32,0x200
M2 212,112,52,212
M2 116,116,52,116
M2 244,120,52,244
s_and_b32 s39,s2,0xe0
M3 244,124,52,244
M2 152,96,56,152
M2 56,100,56,56
s_bfe_u32 s40,s2,0x20003
M2 184,104,56,184
M2 88,108,56,88
M2 216,112,56,216
s_cmp_eq_u32 s40,1
s_cselect_b32 s39,s39,1073741824
M2 120,116,56,120
M2 248,120,56,248
M3 248,124,56,248
buffer_atomic_add v28,v29,s[92:95],s39 offen sc1
M2 156,96,60,156
M2 60,100,60,60
M2 188,104,60,188
M2 92,108,60,92
M2 220,112,60,220
M2 124,116,60,124
M2 252,120,60,252
s_waitcnt vmcnt(22) lgkmcnt(0)
M3 252,124,60,252
s_barrier
M2 128,64,0,128
s_add_u32 m0,s35,102400
T 32,6,16384
R 96,21,0
M2 32,68,0,32
M2 160,72,0,160
L 14,44,33
T 34,6,18432
M2 64,76,0,64
M2 192,80,0,192
T 36,7,16384
M2 96,84,0,96
L1 15,44,33,1024
M2 224,88,0,224
R 100,21,2048
M3 224,92,0,224
M2 132,64,4,132
L1 16,44,33,2048
T 38,7,18432
M2 36,68,4,36
M2 164,72,4,164
T 40,8,16384
M2 68,76,4,68
L1 17,44,33,3072
R 104,21,4096
M2 196,80,4,196
M2 100,84,4,100
T 42,8,18432
M2 228,88,4,228
s_add_u32 s33,s33,128
M3 228,92,4,228
T 44,9,16384
M2 136,64,8,136
M2 40,68,8,40
s_and_b32 s33,s33,0xfffffbff
R 108,21,6144
M2 168,72,8,168
M2 72,76,8,72
T 46,9,18432
M2 200,80,8,200
s_or_b32 s33,s33,0x200
M2 104,84,8,104
T 48,10,16384
M2 232,88,8,232
R 112,21,8192
M3 232,92,8,232
s_add_u32 m0,s34,0
M2 140,64,12,140
T 50,10,18432
M2 44,68,12,44
M2 172,72,12,172
L 2,48,31
T 52,11,16384
M2 76,76,12,76
M2 204,80,12,204
R 116,21,10240
M2 108,84,12,108
L1 3,48,31,1024
M2 236,88,12,236
T 54,11,18432
M3 236,92,12,236
M2 144,64,16,144
T 56,12,16384
L1 4,48,31,2048
M2 48,68,16,48
R 120,21,12288
M2 176,72,16,176
M2 80,76,16,80
L1 5,48,31,3072
T 58,12,18432
M2 208,80,16,208
M2 112,84,16,112
T 60,13,16384
M2 240,88,16,240
s_add_u32 s31,s31,262144
M3 240,92,16,240
R 124,21,14336
M2 148,64,20,148
M2 52,68,20,52
s_and_b32 s31,s31,0xffbfffff
T 62,13,18432
M2 180,72,20,180
M2 84,76,20,84
M2 212,80,20,212
s_or_b32 s31,s31,0x200000
M2 116,84,20,116
M2 244,88,20,244
M3 244,92,20,244
s_and_b32 s39,s2,0xe0
M2 152,64,24,152
M2 56,68,24,56
M2 184,72,24,184
s_bfe_u32 s40,s2,0x20003
M2 88,76,24,88
M2 216,80,24,216
M2 120,84,24,120
s_cmp_eq_u32 s40,2
s_cselect_b32 s39,s39,1073741824
M2 248,88,24,248
M3 248,92,24,248
M2 156,64,28,156
buffer_atomic_add v28,v29,s[92:95],s39 offen sc1
M2 60,68,28,60
M2 188,72,28,188
M2 92,76,28,92
M2 220,80,28,220
M2 124,84,28,124
M2 252,88,28,252
s_waitcnt vmcnt(19) lgkmcnt(0)
M3 252,92,28,252
s_barrier
M2 128,96,32,128
s_add_u32 m0,s34,16384
T 0,6,32768
R 64,18,0
M2 32,100,32,32
M2 160,104,32,160
L 2,48,31
T 2,6,34816
M2 64,108,32,64
M2 192,112,32,192
T 4,7,32768
M2 96,116,32,96
L1 3,48,31,1024
M2 224,120,32,224
R 68,18,2048
M3 224,124,32,224
M2 132,96,36,132
L1 4,48,31,2048
T 6,7,34816
M2 36,100,36,36
M2 164,104,36,164
T 8,8,32768
M2 68,108,36,68
L1 5,48,31,3072
R 72,18,4096
M2 196,112,36,196
M2 100,116,36,100
T 10,8,34816
M2 228,120,36,228
s_add_u32 s31,s31,262144
M3 228,124,36,228
T 12,9,32768
M2 136,96,40,136
M2 40,100,40,40
s_and_b32 s31,s31,0xffbfffff
R 76,18,6144
M2 168,104,40,168
M2 72,108,40,72
T 14,9,34816
M2 200,112,40,200
s_or_b32 s31,s31,0x200000
M2 104,116,40,104
T 16,10,32768
M2 232,120,40,232
R 80,18,8192
M3 232,124,40,232
s_add_u32 m0,s35,131072
M2 140,96,44,140
T 18,10,34816
M2 44,100,44,44
M2 172,104,44,172
L 14,44,32
T 20,11,32768
M2 76,108,44,76
M2 204,112,44,204
R 84,18,10240
M2 108,116,44,108
L1 15,44,32,1024
M2 236,120,44,236
T 22,11,34816
M3 236,124,44,236
M2 144,96,48,144
T 24,12,32768
L1 16,44,32,2048
M2 48,100,48,48
R 88,18,12288
M2 176,104,48,176
M2 80,108,48,80
L1 17,44,32,3072
T 26,12,34816
M2 208,112,48,208
M2 112,116,48,112
T 28,13,32768
M2 240,120,48,240
s_add_u32 s32,s32,128
M3 240,124,48,240
R 92,18,14336
M2 148,96,52,148
M2 52,100,52,52
s_and_b32 s32,s32,0xfffffbff
T 30,13,34816
M2 180,104,52,180
M2 84,108,52,84
M2 212,112,52,212
s_or_b32 s32,s32,0x200
M2 116,116,52,116
M2 244,120,52,244
M3 244,124,52,244
s_and_b32 s39,s2,0xe0
M2 152,96,56,152
M2 56,100,56,56
M2 184,104,56,184
s_bfe_u32 s40,s2,0x20003
M2 88,108,56,88
M2 216,112,56,216
M2 120,116,56,120
s_cmp_eq_u32 s40,3
s_cselect_b32 s39,s39,1073741824
M2 248,120,56,248
M3 248,124,56,248
M2 156,96,60,156
buffer_atomic_add v28,v29,s[92:95],s39 offen sc1
M2 60,100,60,60
M2 188,104,60,188
M2 92,108,60,92
M2 220,112,60,220
M2 124,116,60,124
M2 252,120,60,252
s_waitcnt vmcnt(23) lgkmcnt(0)
M3 252,124,60,252
s_barrier
M2 128,64,0,128
s_add_u32 m0,s35,135168
T 32,6,49152
R 96,19,0
M2 32,68,0,32
M2 160,72,0,160
T 34,6,51200
L 14,44,33
M2 64,76,0,64
M2 192,80,0,192
T 36,7,49152
M2 96,84,0,96
M2 224,88,0,224
R 100,19,2048
L1 15,44,33,1024
M3 224,92,0,224
M2 132,64,4,132
T 38,7,51200
M2 36,68,4,36
M2 164,72,4,164
T 40,8,49152
L1 16,44,33,2048
M2 68,76,4,68
R 104,19,4096
M2 196,80,4,196
M2 100,84,4,100
T 42,8,51200
M2 228,88,4,228
L1 17,44,33,3072
M3 228,92,4,228
T 44,9,49152
M2 136,64,8,136
M2 40,68,8,40
s_add_u32 s33,s33,128
R 108,19,6144
M2 168,72,8,168
M2 72,76,8,72
T 46,9,51200
M2 200,80,8,200
M2 104,84,8,104
s_and_b32 s33,s33,0xfffffbff
T 48,10,49152
M2 232,88,8,232
R 112,19,8192
M3 232,92,8,232
M2 140,64,12,140
T 50,10,51200
M2 44,68,12,44
s_or_b32 s33,s33,0x200
M2 172,72,12,172
T 52,11,49152
M2 76,76,12,76
M2 204,80,12,204
R 116,19,10240
M2 108,84,12,108
s_add_u32 m0,s34,32768
M2 236,88,12,236
T 54,11,51200
M3 236,92,12,236
M2 144,64,16,144
T 56,12,49152
L 2,48,31
M2 48,68,16,48
R 120,19,12288
M2 176,72,16,176
M2 80,76,16,80
T 58,12,51200
M2 208,80,16,208
L1 3,48,31,1024
M2 112,84,16,112
T 60,13,49152
M2 240,88,16,240
M3 240,92,16,240
R 124,19,14336
M2 148,64,20,148
L1 4,48,31,2048
M2 52,68,20,52
T 62,13,51200
M2 180,72,20,180
M2 84,76,20,84
M2 212,80,20,212
L1 5,48,31,3072
M2 116,84,20,116
M2 244,88,20,244
M3 244,92,20,244
s_add_u32 s31,s31,262144
M2 152,64,24,152
M2 56,68,24,56
M2 184,72,24,184
M2 88,76,24,88
s_and_b32 s31,s31,0xffbfffff
M2 216,80,24,216
M2 120,84,24,120
M2 248,88,24,248
M3 248,92,24,248
s_or_b32 s31,s31,0x200000
M2 156,64,28,156
M2 60,68,28,60
M2 188,72,28,188
M2 92,76,28,92
M2 220,80,28,220
M2 124,84,28,124
M2 252,88,28,252
s_waitcnt vmcnt(18) lgkmcnt(0)
M3 252,92,28,252
s_barrier
M2 128,96,32,128
s_add_u32 m0,s34,49152
T 0,6,0
R 64,18,32768
M2 32,100,32,32
M2 160,104,32,160
T 2,6,2048
L 2,48,31
M2 64,108,32,64
M2 192,112,32,192
T 4,7,0
M2 96,116,32,96
M2 224,120,32,224
R 68,18,34816
L1 3,48,31,1024
M3 224,124,32,224
M2 132,96,36,132
T 6,7,2048
M2 36,100,36,36
M2 164,104,36,164
T 8,8,0
L1 4,48,31,2048
M2 68,108,36,68
R 72,18,36864
M2 196,112,36,196
M2 100,116,36,100
T 10,8,2048
M2 228,120,36,228
L1 5,48,31,3072
M3 228,124,36,228
T 12,9,0
M2 136,96,40,136
M2 40,100,40,40
s_add_u32 s31,s31,262144
R 76,18,38912
M2 168,104,40,168
M2 72,108,40,72
T 14,9,2048
M2 200,112,40,200
M2 104,116,40,104
s_and_b32 s31,s31,0xffbfffff
T 16,10,0
M2 232,120,40,232
R 80,18,40960
M3 232,124,40,232
M2 140,96,44,140
T 18,10,2048
M2 44,100,44,44
s_or_b32 s31,s31,0x200000
M2 172,104,44,172
T 20,11,0
M2 76,108,44,76
M2 204,112,44,204
R 84,18,43008
M2 108,116,44,108
s_add_u32 m0,s35,65536
M2 236,120,44,236
T 22,11,2048
M3 236,124,44,236
M2 144,96,48,144
T 24,12,0
L 14,44,32
M2 48,100,48,48
R 88,18,45056
M2 176,104,48,176
M2 80,108,48,80
T 26,12,2048
M2 208,112,48,208
L1 15,44,32,1024
M2 112,116,48,112
T 28,13,0
M2 240,120,48,240
M3 240,124,48,240
R 92,18,47104
M2 148,96,52,148
L1 16,44,32,2048
M2 52,100,52,52
T 30,13,2048
M2 180,104,52,180
M2 84,108,52,84
M2 212,112,52,212
L1 17,44,32,3072
M2 116,116,52,116
M2 244,120,52,244
M3 244,124,52,244
s_add_u32 s32,s32,128
M2 152,96,56,152
M2 56,100,56,56
M2 184,104,56,184
M2 88,108,56,88
s_and_b32 s32,s32,0xfffffbff
M2 216,112,56,216
M2 120,116,56,120
M2 248,120,56,248
M3 248,124,56,248
s_or_b32 s32,s32,0x200
M2 156,96,60,156
M2 60,100,60,60
M2 188,104,60,188
M2 92,108,60,92
M2 220,112,60,220
M2 124,116,60,124
M2 252,120,60,252
s_waitcnt vmcnt(21) lgkmcnt(0)
M3 252,124,60,252
s_barrier
M2 128,64,0,128
s_add_u32 m0,s35,69632
T 32,6,16384
R 96,19,32768
M2 32,68,0,32
M2 160,72,0,160
T 34,6,18432
L 14,44,33
M2 64,76,0,64
M2 192,80,0,192
T 36,7,16384
M2 96,84,0,96
M2 224,88,0,224
R 100,19,34816
L1 15,44,33,1024
M3 224,92,0,224
M2 132,64,4,132
T 38,7,18432
M2 36,68,4,36
M2 164,72,4,164
T 40,8,16384
L1 16,44,33,2048
M2 68,76,4,68
R 104,19,36864
M2 196,80,4,196
M2 100,84,4,100
T 42,8,18432
M2 228,88,4,228
L1 17,44,33,3072
M3 228,92,4,228
T 44,9,16384
M2 136,64,8,136
M2 40,68,8,40
s_add_u32 s33,s33,128
R 108,19,38912
M2 168,72,8,168
M2 72,76,8,72
T 46,9,18432
M2 200,80,8,200
M2 104,84,8,104
s_and_b32 s33,s33,0xfffffbff
T 48,10,16384
M2 232,88,8,232
R 112,19,40960
M3 232,92,8,232
M2 140,64,12,140
T 50,10,18432
M2 44,68,12,44
s_or_b32 s33,s33,0x200
M2 172,72,12,172
T 52,11,16384
M2 76,76,12,76
M2 204,80,12,204
R 116,19,43008
M2 108,84,12,108
s_add_u32 m0,s34,0
M2 236,88,12,236
T 54,11,18432
M3 236,92,12,236
M2 144,64,16,144
T 56,12,16384
L 2,48,31
M2 48,68,16,48
R 120,19,45056
M2 176,72,16,176
M2 80,76,16,80
T 58,12,18432
M2 208,80,16,208
L1 3,48,31,1024
M2 112,84,16,112
T 60,13,16384
M2 240,88,16,240
M3 240,92,16,240
R 124,19,47104
M2 148,64,20,148
L1 4,48,31,2048
M2 52,68,20,52
T 62,13,18432
M2 180,72,20,180
M2 84,76,20,84
M2 212,80,20,212
L1 5,48,31,3072
M2 116,84,20,116
M2 244,88,20,244
M3 244,92,20,244
s_add_u32 s31,s31,262144
M2 152,64,24,152
M2 56,68,24,56
M2 184,72,24,184
M2 88,76,24,88
s_and_b32 s31,s31,0xffbfffff
M2 216,80,24,216
M2 120,84,24,120
M2 248,88,24,248
M3 248,92,24,248
s_or_b32 s31,s31,0x200000
M2 156,64,28,156
M2 60,68,28,60
M2 188,72,28,188
M2 92,76,28,92
M2 220,80,28,220
M2 124,84,28,124
M2 252,88,28,252
s_waitcnt vmcnt(16) lgkmcnt(0)
M3 252,92,28,252
s_barrier
M2 128,96,32,128
s_add_u32 m0,s34,16384
T 0,6,32768
R 64,20,0
M2 32,100,32,32
M2 160,104,32,160
L 2,48,31
T 2,6,34816
M2 64,108,32,64
M2 192,112,32,192
T 4,7,32768
M2 96,116,32,96
L1 3,48,31,1024
M2 224,120,32,224
R 68,20,2048
M3 224,124,32,224
M2 132,96,36,132
T 6,7,34816
L1 4,48,31,2048
M2 36,100,36,36
M2 164,104,36,164
T 8,8,32768
M2 68,108,36,68
L1 5,48,31,3072
R 72,20,4096
M2 196,112,36,196
M2 100,116,36,100
T 10,8,34816
M2 228,120,36,228
s_add_u32 s31,s31,262144
M3 228,124,36,228
T 12,9,32768
M2 136,96,40,136
M2 40,100,40,40
s_and_b32 s31,s31,0xffbfffff
R 76,20,6144
M2 168,104,40,168
M2 72,108,40,72
T 14,9,34816
M2 200,112,40,200
M2 104,116,40,104
s_or_b32 s31,s31,0x200000
T 16,10,32768
M2 232,120,40,232
R 80,20,8192
M3 232,124,40,232
M2 140,96,44,140
s_add_u32 m0,s35,98304
T 18,10,34816
M2 44,100,44,44
M2 172,104,44,172
T 20,11,32768
M2 76,108,44,76
L 14,44,32
M2 204,112,44,204
R 84,20,10240
M2 108,116,44,108
M2 236,120,44,236
T 22,11,34816
L1 15,44,32,1024
M3 236,124,44,236
M2 144,96,48,144
T 24,12,32768
M2 48,100,48,48
L1 16,44,32,2048
R 88,20,12288
M2 176,104,48,176
M2 80,108,48,80
T 26,12,34816
M2 208,112,48,208
L1 17,44,32,3072
M2 112,116,48,112
T 28,13,32768
M2 240,120,48,240
M3 240,124,48,240
R 92,20,14336
M2 148,96,52,148
s_add_u32 s32,s32,128
M2 52,100,52,52
T 30,13,34816
M2 180,104,52,180
M2 84,108,52,84
s_and_b32 s32,s32,0xfffffbff
M2 212,112,52,212
M2 116,116,52,116
M2 244,120,52,244
s_or_b32 s32,s32,0x200
M3 244,124,52,244
M2 152,96,56,152
M2 56,100,56,56
s_cmp_eq_u32 s30,0
s_cselect_b32 s40,0,1073741824
M2 184,104,56,184
M2 88,108,56,88
M2 216,112,56,216
v_lshl_add_u32 v26,v1,5,s40
M2 120,116,56,120
M2 248,120,56,248
M3 248,124,56,248
buffer_load_dword v0,v26,s[92:95],0 offen sc1
M2 156,96,60,156
M2 60,100,60,60
M2 188,104,60,188
M2 92,108,60,92
M2 220,112,60,220
M2 124,116,60,124
M2 252,120,60,252
s_waitcnt vmcnt(21) lgkmcnt(0)
M3 252,124,60,252
s_barrier
M2 128,64,0,128
s_add_u32 m0,s35,102400
T 32,6,49152
R 96,21,0
M2 32,68,0,32
M2 160,72,0,160
T 34,6,51200
L 14,44,33
M2 64,76,0,64
M2 192,80,0,192
T 36,7,49152
M2 96,84,0,96
M2 224,88,0,224
R 100,21,2048
L1 15,44,33,1024
M3 224,92,0,224
M2 132,64,4,132
T 38,7,51200
M2 36,68,4,36
M2 164,72,4,164
T 40,8,49152
L1 16,44,33,2048
M2 68,76,4,68
R 104,21,4096
M2 196,80,4,196
M2 100,84,4,100
T 42,8,51200
M2 228,88,4,228
L1 17,44,33,3072
M3 228,92,4,228
T 44,9,49152
M2 136,64,8,136
M2 40,68,8,40
s_add_u32 s33,s33,128
R 108,21,6144
M2 168,72,8,168
M2 72,76,8,72
T 46,9,51200
M2 200,80,8,200
M2 104,84,8,104
s_and_b32 s33,s33,0xfffffbff
T 48,10,49152
M2 232,88,8,232
R 112,21,8192
M3 232,92,8,232
M2 140,64,12,140
T 50,10,51200
M2 44,68,12,44
s_or_b32 s33,s33,0x200
M2 172,72,12,172
T 52,11,49152
M2 76,76,12,76
M2 204,80,12,204
R 116,21,10240
M2 108,84,12,108
s_add_u32 m0,s34,32768
M2 236,88,12,236
T 54,11,51200
M3 236,92,12,236
M2 144,64,16,144
T 56,12,49152
L 2,48,31
M2 48,68,16,48
R 120,21,12288
M2 176,72,16,176
M2 80,76,16,80
T 58,12,51200
M2 208,80,16,208
L1 3,48,31,1024
M2 112,84,16,112
T 60,13,49152
M2 240,88,16,240
M3 240,92,16,240
R 124,21,14336
M2 148,64,20,148
L1 4,48,31,2048
M2 52,68,20,52
T 62,13,51200
M2 180,72,20,180
M2 84,76,20,84
M2 212,80,20,212
L1 5,48,31,3072
M2 116,84,20,116
M2 244,88,20,244
M3 244,92,20,244
s_add_u32 s31,s31,262144
M2 152,64,24,152
M2 56,68,24,56
M2 184,72,24,184
M2 88,76,24,88
s_and_b32 s31,s31,0xffbfffff
M2 216,80,24,216
M2 120,84,24,120
M2 248,88,24,248
M3 248,92,24,248
s_or_b32 s31,s31,0x200000
M2 156,64,28,156
M2 60,68,28,60
M2 188,72,28,188
M2 92,76,28,92
M2 220,80,28,220
M2 124,84,28,124
M2 252,88,28,252
s_waitcnt vmcnt(17) lgkmcnt(0)
M3 252,92,28,252
s_barrier
M2 128,96,32,128
s_add_u32 m0,s34,49152
T 0,6,0
R 64,18,0
M2 32,100,32,32
M2 160,104,32,160
T 2,6,2048
M2 64,108,32,64
M2 192,112,32,192
T 4,7,0
M2 96,116,32,96
M2 224,120,32,224
R 68,18,2048
L 2,48,31
M3 224,124,32,224
M2 132,96,36,132
T 6,7,2048
M2 36,100,36,36
M2 164,104,36,164
T 8,8,0
M2 68,108,36,68
R 72,18,4096
M2 196,112,36,196
M2 100,116,36,100
T 10,8,2048
M2 228,120,36,228
L1 3,48,31,1024
M3 228,124,36,228
T 12,9,0
M2 136,96,40,136
M2 40,100,40,40
R 76,18,6144
M2 168,104,40,168
M2 72,108,40,72
T 14,9,2048
M2 200,112,40,200
M2 104,116,40,104
T 16,10,0
M2 232,120,40,232
L1 4,48,31,2048
R 80,18,8192
M3 232,124,40,232
M2 140,96,44,140
T 18,10,2048
M2 44,100,44,44
M2 172,104,44,172
T 20,11,0
M2 76,108,44,76
M2 204,112,44,204
R 84,18,10240
M2 108,116,44,108
M2 236,120,44,236
T 22,11,2048
L1 5,48,31,3072
M3 236,124,44,236
M2 144,96,48,144
T 24,12,0
M2 48,100,48,48
R 88,18,12288
M2 176,104,48,176
M2 80,108,48,80
T 26,12,2048
M2 208,112,48,208
M2 112,116,48,112
T 28,13,0
M2 240,120,48,240
s_add_u32 s31,s31,262144
M3 240,124,48,240
R 92,18,14336
M2 148,96,52,148
M2 52,100,52,52
T 30,13,2048
M2 180,104,52,180
M2 84,108,52,84
M2 212,112,52,212
M2 116,116,52,116
M2 244,120,52,244
s_and_b32 s31,s31,0xffbfffff
M3 244,124,52,244
M2 152,96,56,152
M2 56,100,56,56
M2 184,104,56,184
M2 88,108,56,88
M2 216,112,56,216
M2 120,116,56,120
M2 248,120,56,248
s_or_b32 s31,s31,0x200000
M3 248,124,56,248
M2 156,96,60,156
M2 60,100,60,60
M2 188,104,60,188
M2 92,108,60,92
M2 220,112,60,220
M2 124,116,60,124
M2 252,120,60,252
M3 252,124,60,252
l12_s1:
s_cmp_lt_u32 s2,96
s_cbranch_scc1 l12_g1
s_waitcnt vmcnt(12)
s_cmp_lg_u32 s30,0
s_cbranch_scc1 spinret_lnatt1
v_cmp_le_u32 vcc,32,v0
s_nop 3
s_and_b32 s39,vcc_lo,0xff
s_cmp_lg_u32 s39,0xff
s_cbranch_scc1 spin_lnatt1
spinret_lnatt1:
s_add_u32 s92,s8,48168960
s_addc_u32 s93,s9,0
s_and_b32 s93,s93,0xffff
s_mov_b32 s94,65536
s_mov_b32 s95,0x00020000
V1 26,29
s_and_b32 s39,s29,3
s_add_u32 s39,s39,s28
s_cmp_ge_u32 s39,6
s_cselect_b32 s4,6,0
s_sub_u32 s39,s39,s4
s_mov_b32 s4,s41
s_mul_i32 s5,s39,786432
s_add_u32 s41,s41,s5
s_add_u32 s5,s4,4718592
s_mov_b32 s6,s42
s_mul_i32 s7,s39,393216
s_add_u32 s42,s42,s7
s_add_u32 s7,s6,2359296
s_waitcnt lgkmcnt(0)
s_barrier
s_sub_i32 s10,5,s28
M2 128,64,0,128
s_add_u32 m0,s43,131072
T 32,6,16384
R 96,19,0
M2 32,68,0,32
M2 160,72,0,160
T 34,6,18432
M2 64,76,0,64
L 22,16,41
M2 192,80,0,192
T 36,7,16384
M2 96,84,0,96
M2 224,88,0,224
R 100,19,2048
M3 224,92,0,224
M2 132,64,4,132
T 38,7,18432
L1 23,16,41,1024
M2 36,68,4,36
M2 164,72,4,164
T 40,8,16384
M2 68,76,4,68
R 104,19,4096
M2 196,80,4,196
s_add_u32 s41,s41,262144
s_cmp_eq_u32 s41,s5
s_cselect_b32 s41,s4,s41
M2 100,84,4,100
T 42,8,18432
M2 228,88,4,228
M3 228,92,4,228
T 44,9,16384
M2 136,64,8,136
M2 40,68,8,40
R 108,19,6144
L4 128,30,20,42
M2 168,72,8,168
M2 72,76,8,72
T 46,9,18432
M2 200,80,8,200
M2 104,84,8,104
T 48,10,16384
M2 232,88,8,232
L5 132,30,20,42,1024
R 112,19,8192
M3 232,92,8,232
M2 140,64,12,140
T 50,10,18432
M2 44,68,12,44
M2 172,72,12,172
T 52,11,16384
L4 136,31,20,42
M2 76,76,12,76
M2 204,80,12,204
R 116,19,10240
M2 108,84,12,108
M2 236,88,12,236
T 54,11,18432
M3 236,92,12,236
L5 140,31,20,42,1024
M2 144,64,16,144
T 56,12,16384
M2 48,68,16,48
R 120,19,12288
M2 176,72,16,176
M2 80,76,16,80
T 58,12,18432
M2 208,80,16,208
s_add_u32 s42,s42,131072
s_cmp_eq_u32 s42,s7
s_cselect_b32 s42,s6,s42
M2 112,84,16,112
T 60,13,16384
M2 240,88,16,240
M3 240,92,16,240
R 124,19,14336
M2 148,64,20,148
s_add_u32 m0,s43,139264
M2 52,68,20,52
T 62,13,18432
M2 180,72,20,180
M2 84,76,20,84
M2 212,80,20,212
M2 116,84,20,116
L 22,16,41
M2 244,88,20,244
M3 244,92,20,244
M2 152,64,24,152
M2 56,68,24,56
L1 23,16,41,1024
M2 184,72,24,184
M2 88,76,24,88
M2 216,80,24,216
M2 120,84,24,120
M2 248,88,24,248
s_add_u32 s41,s41,262144
s_cmp_eq_u32 s41,s5
s_cselect_b32 s41,s4,s41
M3 248,92,24,248
M2 156,64,28,156
M2 60,68,28,60
M2 188,72,28,188
M2 92,76,28,92
M2 220,80,28,220
M2 124,84,28,124
M2 252,88,28,252
s_waitcnt vmcnt(12) lgkmcnt(0)
M3 252,92,28,252
s_barrier
M2 128,96,32,128
T 0,6,32768
L4 144,30,20,42
M2 32,100,32,32
R 64,18,32768
M2 160,104,32,160
L5 148,30,20,42,1024
T 2,6,34816
M2 64,108,32,64
M2 192,112,32,192
T 4,7,32768
M2 96,116,32,96
L4 152,31,20,42
M2 224,120,32,224
R 68,18,34816
M3 224,124,32,224
M2 132,96,36,132
T 6,7,34816
M2 36,100,36,36
L5 156,31,20,42,1024
M2 164,104,36,164
T 8,8,32768
M2 68,108,36,68
R 72,18,36864
M2 196,112,36,196
s_add_u32 s42,s42,131072
s_cmp_eq_u32 s42,s7
s_cselect_b32 s42,s6,s42
M2 100,116,36,100
T 10,8,34816
M2 228,120,36,228
M3 228,124,36,228
s_add_u32 m0,s43,147456
T 12,9,32768
M2 136,96,40,136
M2 40,100,40,40
R 76,18,38912
M2 168,104,40,168
M2 72,108,40,72
L 22,16,41
T 14,9,34816
M2 200,112,40,200
M2 104,116,40,104
T 16,10,32768
M2 232,120,40,232
L1 23,16,41,1024
R 80,18,40960
M3 232,124,40,232
M2 140,96,44,140
T 18,10,34816
M2 44,100,44,44
s_add_u32 s41,s41,262144
s_cmp_eq_u32 s41,s5
s_cselect_b32 s41,s4,s41
M2 172,104,44,172
T 20,11,32768
M2 76,108,44,76
M2 204,112,44,204
R 84,18,43008
M2 108,116,44,108
L4 160,30,20,42
M2 236,120,44,236
T 22,11,34816
M3 236,124,44,236
M2 144,96,48,144
T 24,12,32768
L5 164,30,20,42,1024
M2 48,100,48,48
R 88,18,45056
M2 176,104,48,176
M2 80,108,48,80
T 26,12,34816
L4 168,31,20,42
M2 208,112,48,208
M2 112,116,48,112
T 28,13,32768
M2 240,120,48,240
M3 240,124,48,240
L5 172,31,20,42,1024
R 92,18,47104
M2 148,96,52,148
M2 52,100,52,52
T 30,13,34816
M2 180,104,52,180
s_add_u32 s42,s42,131072
s_cmp_eq_u32 s42,s7
s_cselect_b32 s42,s6,s42
M2 84,108,52,84
M2 212,112,52,212
M2 116,116,52,116
s_add_u32 m0,s43,155648
M2 244,120,52,244
M3 244,124,52,244
M2 152,96,56,152
M2 56,100,56,56
L 22,16,41
M2 184,104,56,184
M2 88,108,56,88
M2 216,112,56,216
L1 23,16,41,1024
M2 120,116,56,120
M2 248,120,56,248
M3 248,124,56,248
s_add_u32 s41,s41,262144
s_cmp_eq_u32 s41,s5
s_cselect_b32 s41,s4,s41
M2 156,96,60,156
M2 60,100,60,60
M2 188,104,60,188
M2 92,108,60,92
M2 220,112,60,220
M2 124,116,60,124
M2 252,120,60,252
s_waitcnt vmcnt(20) lgkmcnt(0)
M3 252,124,60,252
s_barrier
M2 128,64,0,128
T 32,6,49152
L4 176,30,20,42
M2 32,68,0,32
R 96,19,32768
AR 2,196
M2 160,72,0,160
T 34,6,51200
M2 64,76,0,64
M2 192,80,0,192
T 36,7,49152
M2 96,84,0,96
AR 3,197
M2 224,88,0,224
R 100,19,34816
M3 224,92,0,224
M2 132,64,4,132
T 38,7,51200
M2 36,68,4,36
M2 164,72,4,164
T 40,8,49152
M2 68,76,4,68
L5 180,30,20,42,1024
R 104,19,36864
M2 196,80,4,196
M2 100,84,4,100
T 42,8,51200
AR 4,198
M2 228,88,4,228
M3 228,92,4,228
T 44,9,49152
M2 136,64,8,136
M2 40,68,8,40
R 108,19,38912
M2 168,72,8,168
M2 72,76,8,72
T 46,9,51200
M2 200,80,8,200
AR 5,199
M2 104,84,8,104
T 48,10,49152
M2 232,88,8,232
R 112,19,40960
M3 232,92,8,232
L4 184,31,20,42
M2 140,64,12,140
T 50,10,51200
M2 44,68,12,44
M2 172,72,12,172
T 52,11,49152
M2 76,76,12,76
M2 204,80,12,204
R 116,19,43008
AR 14,200
M2 108,84,12,108
M2 236,88,12,236
T 54,11,51200
M3 236,92,12,236
M2 144,64,16,144
T 56,12,49152
M2 48,68,16,48
R 120,19,45056
M2 176,72,16,176
M2 80,76,16,80
L5 188,31,20,42,1024
T 58,12,51200
M2 208,80,16,208
AR 15,201
M2 112,84,16,112
T 60,13,49152
M2 240,88,16,240
M3 240,92,16,240
R 124,19,47104
M2 148,64,20,148
M2 52,68,20,52
T 62,13,51200
M2 180,72,20,180
M2 84,76,20,84
AR 16,202
M2 212,80,20,212
M2 116,84,20,116
M2 244,88,20,244
M3 244,92,20,244
s_add_u32 s42,s42,131072
s_cmp_eq_u32 s42,s7
s_cselect_b32 s42,s6,s42
M2 152,64,24,152
M2 56,68,24,56
M2 184,72,24,184
AR 17,203
M2 88,76,24,88
M2 216,80,24,216
M2 120,84,24,120
M2 248,88,24,248
M3 248,92,24,248
M2 156,64,28,156
M2 60,68,28,60
M2 188,72,28,188
M2 92,76,28,92
M2 220,80,28,220
M2 124,84,28,124
M2 252,88,28,252
s_waitcnt vmcnt(18) lgkmcnt(0)
M3 252,92,28,252
s_barrier
M2 128,96,32,128
s_add_u32 m0,s43,98304
T 0,2,32768
M2 32,100,32,32
T 2,2,33792
M2 132,96,36,132
L 22,16,41
M2 36,100,36,36
M2 136,96,40,136
T 4,3,32768
M2 40,100,40,40
M2 140,96,44,140
C 128,128,129
C 129,130,131
M2 44,100,44,44
C 130,32,33
C 131,34,35
M2 144,96,48,144
L1 23,16,41,1024
C 132,132,133
M2 48,100,48,48
C 133,134,135
C 134,36,37
M2 148,96,52,148
T 6,3,33792
C 135,38,39
M2 52,100,52,52
C 136,136,137
C 137,138,139
M2 152,96,56,152
C 138,40,41
C 139,42,43
M2 56,100,56,56
s_add_u32 s41,s41,262144
s_cmp_eq_u32 s41,s5
s_cselect_b32 s41,s4,s41
M2 156,96,60,156
T 8,4,32768
C 140,140,141
M2 60,100,60,60
C 141,142,143
C 142,44,45
M2 160,104,32,160
T 10,4,33792
C 143,46,47
M2 64,108,32,64
L4 64,30,20,42
C 144,144,145
M2 164,104,36,164
C 145,146,147
C 146,48,49
M2 68,108,36,68
C 147,50,51
C 148,148,149
M2 168,104,40,168
C 149,150,151
C 150,52,53
M2 72,108,40,72
T 12,5,32768
C 151,54,55
M2 172,104,44,172
L5 68,30,20,42,1024
C 152,152,153
M2 76,108,44,76
C 153,154,155
C 154,56,57
M2 176,104,48,176
T 14,5,33792
C 155,58,59
M2 80,108,48,80
C 156,156,157
C 157,158,159
M2 180,104,52,180
C 158,60,61
C 159,62,63
M2 84,108,52,84
L4 72,31,20,42
T 16,14,32768
M2 184,104,56,184
C 160,160,161
C 161,162,163
M2 88,108,56,88
C 162,64,65
C 163,66,67
M2 188,104,60,188
C 164,164,165
C 165,166,167
M2 92,108,60,92
C 166,68,69
C 167,70,71
M2 192,112,32,192
L5 76,31,20,42,1024
T 18,14,33792
M2 96,116,32,96
C 168,168,169
C 169,170,171
M2 196,112,36,196
C 170,72,73
C 171,74,75
M2 100,116,36,100
T 20,15,32768
C 172,172,173
M2 200,112,40,200
s_add_u32 s42,s42,131072
s_cmp_eq_u32 s42,s7
s_cselect_b32 s42,s6,s42
M2 104,116,40,104
s_add_u32 m0,s43,106496
C 173,174,175
C 174,76,77
M2 204,112,44,204
C 175,78,79
C 176,176,177
M2 108,116,44,108
C 177,178,179
C 178,80,81
M2 208,112,48,208
T 22,15,33792
C 179,82,83
M2 112,116,48,112
C 180,180,181
C 181,182,183
M2 212,112,52,212
C 182,84,85
C 183,86,87
M2 116,116,52,116
T 24,16,32768
C 184,184,185
M2 216,112,56,216
C 185,186,187
C 186,88,89
M2 120,116,56,120
L 22,16,41
C 187,90,91
M2 220,112,60,220
T 26,16,33792
C 188,188,189
M2 124,116,60,124
C 189,190,191
C 190,92,93
M2 224,120,32,224
C 191,94,95
C 192,192,193
M3 224,124,32,224
C 193,194,195
C 194,96,97
M2 228,120,36,228
T 28,17,32768
C 195,98,99
M3 228,124,36,228
L1 23,16,41,1024
C 196,196,197
M2 232,120,40,232
C 197,198,199
C 198,100,101
M3 232,124,40,232
T 30,17,33792
C 199,102,103
M2 236,120,44,236
s_add_u32 s41,s41,262144
s_cmp_eq_u32 s41,s5
s_cselect_b32 s41,s4,s41
M3 236,124,44,236
C 200,200,201
C 201,202,203
C 202,104,105
M2 240,120,48,240
C 203,106,107
C 204,204,205
C 205,206,207
M3 240,124,48,240
C 206,108,109
C 207,110,111
M2 244,120,52,244
L4 80,30,20,42
C 208,208,209
M3 244,124,52,244
C 209,210,211
C 210,112,113
M2 248,120,56,248
C 211,114,115
C 212,212,213
M3 248,124,56,248
C 213,214,215
C 214,116,117
M2 252,120,60,252
L5 84,30,20,42,1024
C 215,118,119
M3 252,124,60,252
L4 88,31,20,42
L5 92,31,20,42,1024
s_add_u32 s42,s42,131072
s_cmp_eq_u32 s42,s7
s_cselect_b32 s42,s6,s42
l12_q1:
s_waitcnt lgkmcnt(0)
s_waitcnt vmcnt(22)
s_barrier
M 32,0,128,0
s_add_u32 m0,s43,114688
C 216,216,217
C 217,218,219
C 218,120,121
C 219,122,123
M 36,0,132,0
s_add_u32 s40,s38,8192
C 220,220,221
C 221,222,223
C 222,124,125
M 40,0,136,0
C 223,126,127
C 224,224,225
C 225,226,227
M 44,0,140,0
AR 18,224
AR 19,225
AR 20,226
M 48,4,128,0
AR 21,227
C 226,18,19
C 227,20,21
M 52,4,132,0
C 228,228,229
C 229,230,231
AR 18,228
M 56,4,136,0
AR 19,229
AR 20,230
AR 21,231
M 60,4,140,0
C 230,18,19
C 231,20,21
C 232,232,233
M 64,8,128,0
C 233,234,235
AR 18,232
AR 19,233
M 68,8,132,0
AR 20,234
AR 21,235
C 234,18,19
M 72,8,136,0
C 235,20,21
C 236,236,237
C 237,238,239
AR 18,236
M 76,8,140,0
AR 19,237
AR 20,238
AR 21,239
M 80,12,128,0
C 238,18,19
C 239,20,21
C 240,240,241
M 84,12,132,0
C 241,242,243
AR 18,240
AR 19,241
M 88,12,136,0
AR 20,242
AR 21,243
C 242,18,19
M 92,12,140,0
C 243,20,21
C 244,244,245
C 245,246,247
M 96,16,128,0
AR 18,244
AR 19,245
AR 20,246
M 100,16,132,0
AR 21,247
C 246,18,19
C 247,20,21
M 104,16,136,0
C 248,248,249
C 249,250,251
AR 18,248
M 108,16,140,0
AR 19,249
AR 20,250
AR 21,251
M 112,20,128,0
C 250,18,19
C 251,20,21
C 252,252,253
M 116,20,132,0
C 253,254,255
AR 18,252
AR 19,253
AR 20,254
M 120,20,136,0
AR 21,255
C 254,18,19
C 255,20,21
M 124,20,140,0
T 32,2,40960
T 34,2,41984
L 22,16,41
M1 224,24,128,0
T 36,3,40960
T 38,3,41984
L1 23,16,41,1024
M1 228,24,132,0
T 40,4,40960
S1 128,27,96,40,0
T 42,4,41984
M1 232,24,136,0
s_add_u32 s41,s41,262144
s_cmp_eq_u32 s41,s5
s_cselect_b32 s41,s4,s41
T 44,5,40960
M1 236,24,140,0
s_add_u32 m0,s43,122880
T 46,5,41984
T 48,14,40960
S1 132,27,96,40,1024
T 50,14,41984
M1 240,28,128,0
L 22,16,41
L1 23,16,41,1024
T 52,15,40960
T 54,15,41984
M1 244,28,132,0
s_add_u32 s41,s41,262144
s_cmp_eq_u32 s41,s5
s_cselect_b32 s41,s4,s41
T 56,16,40960
M1 248,28,136,0
s_add_u32 m0,s43,131072
S1 136,27,96,40,2048
T 58,16,41984
T 60,17,40960
T 62,17,41984
M1 252,28,140,0
L 22,16,41
L1 23,16,41,1024
S1 140,27,96,40,3072
s_add_u32 s41,s41,262144
s_cmp_eq_u32 s41,s5
s_cselect_b32 s41,s4,s41
L4 96,30,20,42
s_waitcnt lgkmcnt(0)
M2 32,32,144,32
s_add_u32 s40,s38,12288
T 0,2,49152
L5 100,30,20,42,1024
M2 36,32,148,36
T 2,2,50176
T 4,3,49152
M2 40,32,152,40
L4 104,31,20,42
M2 44,32,156,44
T 6,3,50176
M2 48,36,144,48
T 8,4,49152
S1 144,27,96,40,0
M2 52,36,148,52
L5 108,31,20,42,1024
T 10,4,50176
M2 56,36,152,56
M2 60,36,156,60
T 12,5,49152
M2 64,40,144,64
s_add_u32 s42,s42,131072
s_cmp_eq_u32 s42,s7
s_cselect_b32 s42,s6,s42
M2 68,40,148,68
T 14,5,50176
M2 72,40,152,72
T 16,14,49152
S1 148,27,96,40,1024
M2 76,40,156,76
T 18,14,50176
L4 112,30,20,42
M2 80,44,144,80
T 20,15,49152
M2 84,44,148,84
M2 88,44,152,88
T 22,15,50176
L5 116,30,20,42,1024
M2 92,44,156,92
T 24,16,49152
S1 152,27,96,40,2048
M2 96,48,144,96
T 26,16,50176
M2 100,48,148,100
L4 120,31,20,42
M2 104,48,152,104
T 28,17,49152
M2 108,48,156,108
T 30,17,50176
M2 112,52,144,112
L5 124,31,20,42,1024
M2 116,52,148,116
S1 156,27,96,40,3072
M2 120,52,152,120
M2 124,52,156,124
s_add_u32 s42,s42,131072
s_cmp_eq_u32 s42,s7
s_cselect_b32 s42,s6,s42
M3 224,56,144,224
M3 228,56,148,228
M3 232,56,152,232
M3 236,56,156,236
M3 240,60,144,240
M3 244,60,148,244
M3 248,60,152,248
s_waitcnt vmcnt(32) lgkmcnt(0)
M3 252,60,156,252
s_barrier
M2 32,0,160,32
s_add_u32 m0,s43,139264
T 32,2,57344
T 34,2,58368
M2 36,0,164,36
s_add_u32 s40,s38,24576
L 22,16,41
T 36,3,57344
M2 40,0,168,40
M2 44,0,172,44
T 38,3,58368
M2 48,4,160,48
L1 23,16,41,1024
T 40,4,57344
M2 52,4,164,52
S1 160,27,96,40,0
T 42,4,58368
M2 56,4,168,56
s_add_u32 s41,s41,262144
s_cmp_eq_u32 s41,s5
s_cselect_b32 s41,s4,s41
M2 60,4,172,60
T 44,5,57344
M2 64,8,160,64
T 46,5,58368
M2 68,8,164,68
s_add_u32 m0,s43,147456
M2 72,8,168,72
T 48,14,57344
S1 164,27,96,40,1024
M2 76,8,172,76
T 50,14,58368
L 22,16,41
M2 80,12,160,80
T 52,15,57344
M2 84,12,164,84
M2 88,12,168,88
T 54,15,58368
L1 23,16,41,1024
M2 92,12,172,92
T 56,16,57344
S1 168,27,96,40,2048
M2 96,16,160,96
s_add_u32 s41,s41,262144
s_cmp_eq_u32 s41,s5
s_cselect_b32 s41,s4,s41
M2 100,16,164,100
T 58,16,58368
M2 104,16,168,104
T 60,17,57344
M2 108,16,172,108
L4 128,30,20,42
T 62,17,58368
M2 112,20,160,112
M2 116,20,164,116
S1 172,27,96,40,3072
L5 132,30,20,42,1024
M2 120,20,168,120
M2 124,20,172,124
M3 224,24,160,224
L4 136,31,20,42
M3 228,24,164,228
M3 232,24,168,232
M3 236,24,172,236
M3 240,28,160,240
M3 244,28,164,244
M3 248,28,168,248
M3 252,28,172,252
s_waitcnt lgkmcnt(0)
M2 32,32,176,32
s_add_u32 s40,s38,28672
T 0,2,0
L5 140,31,20,42,1024
M2 36,32,180,36
T 2,2,1024
T 4,3,0
M2 40,32,184,40
s_add_u32 s42,s42,131072
s_cmp_eq_u32 s42,s7
s_cselect_b32 s42,s6,s42
M2 44,32,188,44
T 6,3,1024
M2 48,36,176,48
T 8,4,0
S1 176,27,96,40,0
M2 52,36,180,52
L4 144,30,20,42
T 10,4,1024
M2 56,36,184,56
M2 60,36,188,60
T 12,5,0
M2 64,40,176,64
L5 148,30,20,42,1024
T 14,5,1024
M2 68,40,180,68
M2 72,40,184,72
T 16,14,0
S1 180,27,96,40,1024
M2 76,40,188,76
T 18,14,1024
L4 152,31,20,42
M2 80,44,176,80
T 20,15,0
M2 84,44,180,84
M2 88,44,184,88
T 22,15,1024
L5 156,31,20,42,1024
M2 92,44,188,92
T 24,16,0
S1 184,27,96,40,2048
M2 96,48,176,96
T 26,16,1024
M2 100,48,180,100
s_add_u32 s42,s42,131072
s_cmp_eq_u32 s42,s7
s_cselect_b32 s42,s6,s42
M2 104,48,184,104
T 28,17,0
M2 108,48,188,108
T 30,17,1024
M2 112,52,176,112
L4 160,30,20,42
M2 116,52,180,116
S1 188,27,96,40,3072
M2 120,52,184,120
M2 124,52,188,124
L5 164,30,20,42,1024
M3 224,56,176,224
M3 228,56,180,228
M3 232,56,184,232
M3 236,56,188,236
M3 240,60,176,240
M3 244,60,180,244
M3 248,60,184,248
s_waitcnt vmcnt(42) lgkmcnt(0)
M3 252,60,188,252
s_barrier
M2 32,0,64,32
s_add_u32 s40,s38,40960
T 32,2,8192
L4 168,31,20,42
M2 36,0,68,36
T 34,2,9216
L5 172,31,20,42,1024
M2 40,0,72,40
T 36,3,8192
M2 44,0,76,44
T 38,3,9216
M2 48,4,64,48
s_add_u32 s42,s42,131072
s_cmp_eq_u32 s42,s7
s_cselect_b32 s42,s6,s42
M2 52,4,68,52
T 40,4,8192
S1 192,27,96,40,0
M2 56,4,72,56
s_add_u32 m0,s43,155648
T 42,4,9216
M2 60,4,76,60
T 44,5,8192
M2 64,8,64,64
L 22,16,41
T 46,5,9216
M2 68,8,68,68
M2 72,8,72,72
T 48,14,8192
S1 196,27,96,40,1024
M2 76,8,76,76
L1 23,16,41,1024
T 50,14,9216
M2 80,12,64,80
T 52,15,8192
M2 84,12,68,84
s_add_u32 s41,s41,262144
s_cmp_eq_u32 s41,s5
s_cselect_b32 s41,s4,s41
M2 88,12,72,88
T 54,15,9216
M2 92,12,76,92
s_add_u32 m0,s43,98304
T 56,16,8192
S1 200,27,96,40,2048
M2 96,16,64,96
T 58,16,9216
M2 100,16,68,100
L 22,16,41
M2 104,16,72,104
T 60,17,8192
M2 108,16,76,108
T 62,17,9216
M2 112,20,64,112
L1 23,16,41,1024
M2 116,20,68,116
S1 204,27,96,40,3072
M2 120,20,72,120
s_add_u32 s41,s41,262144
s_cmp_eq_u32 s41,s5
s_cselect_b32 s41,s4,s41
M2 124,20,76,124
M3 224,24,64,224
L4 176,30,20,42
M3 228,24,68,228
M3 232,24,72,232
M3 236,24,76,236
M3 240,28,64,240
M3 244,28,68,244
M3 248,28,72,248
M3 252,28,76,252
s_waitcnt lgkmcnt(0)
M2 32,32,80,32
s_add_u32 s40,s38,45056
T 0,2,16384
L5 180,30,20,42,1024
M2 36,32,84,36
T 2,2,17408
T 4,3,16384
M2 40,32,88,40
L4 184,31,20,42
M2 44,32,92,44
T 6,3,17408
M2 48,36,80,48
T 8,4,16384
S1 208,27,96,40,0
M2 52,36,84,52
L5 188,31,20,42,1024
T 10,4,17408
M2 56,36,88,56
M2 60,36,92,60
T 12,5,16384
M2 64,40,80,64
s_add_u32 s42,s42,131072
s_cmp_eq_u32 s42,s7
s_cselect_b32 s42,s6,s42
M2 68,40,84,68
T 14,5,17408
M2 72,40,88,72
T 16,14,16384
S1 212,27,96,40,1024
M2 76,40,92,76
T 18,14,17408
L4 64,30,20,42
M2 80,44,80,80
T 20,15,16384
M2 84,44,84,84
M2 88,44,88,88
T 22,15,17408
L5 68,30,20,42,1024
M2 92,44,92,92
T 24,16,16384
S1 216,27,96,40,2048
M2 96,48,80,96
T 26,16,17408
M2 100,48,84,100
L4 72,31,20,42
M2 104,48,88,104
T 28,17,16384
M2 108,48,92,108
T 30,17,17408
M2 112,52,80,112
L5 76,31,20,42,1024
M2 116,52,84,116
S1 220,27,96,40,3072
M2 120,52,88,120
M2 124,52,92,124
s_add_u32 s42,s42,131072
s_cmp_eq_u32 s42,s7
s_cselect_b32 s42,s6,s42
M3 224,56,80,224
M3 228,56,84,228
M3 232,56,88,232
M3 236,56,92,236
M3 240,60,80,240
M3 244,60,84,244
M3 248,60,88,248
s_waitcnt vmcnt(51) lgkmcnt(0)
M3 252,60,92,252
s_barrier
M2 32,0,96,32
s_add_u32 m0,s43,106496
T 32,2,24576
T 34,2,25600
M2 36,0,100,36
s_add_u32 s40,s38,57344
L 22,16,41
T 36,3,24576
M2 40,0,104,40
M2 44,0,108,44
T 38,3,25600
M2 48,4,96,48
L1 23,16,41,1024
T 40,4,24576
M2 52,4,100,52
S1 224,27,96,40,0
T 42,4,25600
M2 56,4,104,56
s_add_u32 s41,s41,262144
s_cmp_eq_u32 s41,s5
s_cselect_b32 s41,s4,s41
M2 60,4,108,60
T 44,5,24576
M2 64,8,96,64
T 46,5,25600
M2 68,8,100,68
s_add_u32 m0,s43,114688
M2 72,8,104,72
T 48,14,24576
S1 228,27,96,40,1024
M2 76,8,108,76
T 50,14,25600
L 22,16,41
M2 80,12,96,80
T 52,15,24576
M2 84,12,100,84
M2 88,12,104,88
T 54,15,25600
L1 23,16,41,1024
M2 92,12,108,92
T 56,16,24576
S1 232,27,96,40,2048
M2 96,16,96,96
s_add_u32 s41,s41,262144
s_cmp_eq_u32 s41,s5
s_cselect_b32 s41,s4,s41
M2 100,16,100,100
T 58,16,25600
M2 104,16,104,104
T 60,17,24576
M2 108,16,108,108
L4 80,30,20,42
T 62,17,25600
M2 112,20,96,112
M2 116,20,100,116
S1 236,27,96,40,3072
L5 84,30,20,42,1024
M2 120,20,104,120
M2 124,20,108,124
M3 224,24,96,224
L4 88,31,20,42
M3 228,24,100,228
M3 232,24,104,232
M3 236,24,108,236
M3 240,28,96,240
M3 244,28,100,244
M3 248,28,104,248
M3 252,28,108,252
s_waitcnt vmcnt(56) lgkmcnt(0)
M2 32,32,112,32
s_add_u32 s40,s38,61440
T 0,2,32768
L5 92,31,20,42,1024
M2 36,32,116,36
T 2,2,33792
T 4,3,32768
M2 40,32,120,40
M2 44,32,124,44
s_add_u32 s42,s42,131072
s_cmp_eq_u32 s42,s7
s_cselect_b32 s42,s6,s42
M2 48,36,112,48
T 6,3,33792
T 8,4,32768
M2 52,36,116,52
S1 240,27,96,40,0
T 10,4,33792
M2 56,36,120,56
M2 60,36,124,60
L4 96,30,20,42
T 12,5,32768
M2 64,40,112,64
T 14,5,33792
M2 68,40,116,68
M2 72,40,120,72
T 16,14,32768
S1 244,27,96,40,1024
M2 76,40,124,76
L5 100,30,20,42,1024
T 18,14,33792
M2 80,44,112,80
T 20,15,32768
M2 84,44,116,84
M2 88,44,120,88
T 22,15,33792
M2 92,44,124,92
L4 104,31,20,42
T 24,16,32768
M2 96,48,112,96
S1 248,27,96,40,2048
T 26,16,33792
M2 100,48,116,100
M2 104,48,120,104
T 28,17,32768
M2 108,48,124,108
L5 108,31,20,42,1024
T 30,17,33792
M2 112,52,112,112
M2 116,52,116,116
S1 252,27,96,40,3072
M2 120,52,120,120
M2 124,52,124,124
s_add_u32 s42,s42,131072
s_cmp_eq_u32 s42,s7
s_cselect_b32 s42,s6,s42
M3 224,56,112,224
M3 228,56,116,228
M3 232,56,120,232
M3 236,56,124,236
M3 240,60,112,240
M3 244,60,116,244
M3 248,60,120,248
s_waitcnt vmcnt(52) lgkmcnt(0)
M3 252,60,124,252
s_barrier
M2 32,0,128,32
s_add_u32 m0,s43,122880
T 32,2,40960
T 34,2,41984
M2 36,0,132,36
L 22,16,41
T 36,3,40960
M2 40,0,136,40
M2 44,0,140,44
T 38,3,41984
M2 48,4,128,48
L1 23,16,41,1024
T 40,4,40960
M2 52,4,132,52
T 42,4,41984
M2 56,4,136,56
s_add_u32 s41,s41,262144
s_cmp_eq_u32 s41,s5
s_cselect_b32 s41,s4,s41
M2 60,4,140,60
T 44,5,40960
M2 64,8,128,64
T 46,5,41984
M2 68,8,132,68
s_add_u32 m0,s43,131072
M2 72,8,136,72
T 48,14,40960
M2 76,8,140,76
T 50,14,41984
L 22,16,41
M2 80,12,128,80
T 52,15,40960
M2 84,12,132,84
M2 88,12,136,88
T 54,15,41984
L1 23,16,41,1024
M2 92,12,140,92
T 56,16,40960
M2 96,16,128,96
s_add_u32 s41,s41,262144
s_cmp_eq_u32 s41,s5
s_cselect_b32 s41,s4,s41
M2 100,16,132,100
T 58,16,41984
M2 104,16,136,104
T 60,17,40960
M2 108,16,140,108
L4 112,30,20,42
T 62,17,41984
M2 112,20,128,112
M2 116,20,132,116
L5 116,30,20,42,1024
M2 120,20,136,120
M2 124,20,140,124
M3 224,24,128,224
L4 120,31,20,42
M3 228,24,132,228
M3 232,24,136,232
M3 236,24,140,236
M3 240,28,128,240
M3 244,28,132,244
M3 248,28,136,248
M3 252,28,140,252
s_waitcnt vmcnt(53) lgkmcnt(0)
M2 32,32,144,32
T 0,2,49152
L5 124,31,20,42,1024
M2 36,32,148,36
T 2,2,50176
T 4,3,49152
M2 40,32,152,40
M2 44,32,156,44
s_add_u32 s42,s42,131072
s_cmp_eq_u32 s42,s7
s_cselect_b32 s42,s6,s42
M2 48,36,144,48
T 6,3,50176
T 8,4,49152
M2 52,36,148,52
T 10,4,50176
M2 56,36,152,56
M2 60,36,156,60
L4 128,30,20,42
T 12,5,49152
M2 64,40,144,64
T 14,5,50176
M2 68,40,148,68
M2 72,40,152,72
T 16,14,49152
M2 76,40,156,76
L5 132,30,20,42,1024
T 18,14,50176
M2 80,44,144,80
T 20,15,49152
M2 84,44,148,84
M2 88,44,152,88
T 22,15,50176
M2 92,44,156,92
L4 136,31,20,42
T 24,16,49152
M2 96,48,144,96
T 26,16,50176
M2 100,48,148,100
M2 104,48,152,104
T 28,17,49152
M2 108,48,156,108
L5 140,31,20,42,1024
T 30,17,50176
M2 112,52,144,112
M2 116,52,148,116
M2 120,52,152,120
M2 124,52,156,124
s_add_u32 s42,s42,131072
s_cmp_eq_u32 s42,s7
s_cselect_b32 s42,s6,s42
M3 224,56,144,224
M3 228,56,148,228
M3 232,56,152,232
M3 236,56,156,236
M3 240,60,144,240
M3 244,60,148,244
M3 248,60,152,248
s_waitcnt vmcnt(12) lgkmcnt(0)
M3 252,60,156,252
s_barrier
M2 32,0,160,32
s_add_u32 m0,s43,139264
T 32,2,57344
T 34,2,58368
M2 36,0,164,36
T 36,3,57344
M2 40,0,168,40
L 22,16,41
M2 44,0,172,44
T 38,3,58368
M2 48,4,160,48
T 40,4,57344
M2 52,4,164,52
L1 23,16,41,1024
T 42,4,58368
M2 56,4,168,56
M2 60,4,172,60
T 44,5,57344
M2 64,8,160,64
s_add_u32 s41,s41,262144
s_cmp_eq_u32 s41,s5
s_cselect_b32 s41,s4,s41
M2 68,8,164,68
T 46,5,58368
M2 72,8,168,72
T 48,14,57344
M2 76,8,172,76
T 50,14,58368
L4 144,30,20,42
M2 80,12,160,80
T 52,15,57344
M2 84,12,164,84
M2 88,12,168,88
T 54,15,58368
L5 148,30,20,42,1024
M2 92,12,172,92
T 56,16,57344
M2 96,16,160,96
T 58,16,58368
M2 100,16,164,100
L4 152,31,20,42
M2 104,16,168,104
T 60,17,57344
M2 108,16,172,108
T 62,17,58368
M2 112,20,160,112
L5 156,31,20,42,1024
M2 116,20,164,116
M2 120,20,168,120
M2 124,20,172,124
s_add_u32 s42,s42,131072
s_cmp_eq_u32 s42,s7
s_cselect_b32 s42,s6,s42
M3 224,24,160,224
M3 228,24,164,228
M3 232,24,168,232
M3 236,24,172,236
M3 240,28,160,240
M3 244,28,164,244
M3 248,28,168,248
M3 252,28,172,252
s_waitcnt lgkmcnt(0)
M2 32,32,176,32
s_bfe_u32 s40,s38,0x40015
T 0,2,0
T 2,2,1024
M2 36,32,180,36
T 4,3,0
M2 40,32,184,40
M2 44,32,188,44
T 6,3,1024
M2 48,36,176,48
T 8,4,0
M2 52,36,180,52
T 10,4,1024
M2 56,36,184,56
M2 60,36,188,60
T 12,5,0
M2 64,40,176,64
s_lshl_b32 s40,s40,8
T 14,5,1024
M2 68,40,180,68
M2 72,40,184,72
T 16,14,0
M2 76,40,188,76
T 18,14,1024
M2 80,44,176,80
T 20,15,0
M2 84,44,180,84
M2 88,44,184,88
T 22,15,1024
M2 92,44,188,92
T 24,16,0
M2 96,48,176,96
T 26,16,1024
M2 100,48,180,100
buffer_atomic_add v28,v29,s[92:95],s40 offen sc1
M2 104,48,184,104
T 28,17,0
M2 108,48,188,108
T 30,17,1024
M2 112,52,176,112
M2 116,52,180,116
M2 120,52,184,120
M2 124,52,188,124
M3 224,56,176,224
M3 228,56,180,228
M3 232,56,184,232
M3 236,56,188,236
M3 240,60,176,240
M3 244,60,180,244
M3 248,60,184,248
s_waitcnt lgkmcnt(0)
M3 252,60,188,252
s_barrier
M2 32,0,64,32
T 32,2,8192
T 34,2,9216
M2 36,0,68,36
T 36,3,8192
M2 40,0,72,40
M2 44,0,76,44
T 38,3,9216
M2 48,4,64,48
T 40,4,8192
M2 52,4,68,52
T 42,4,9216
M2 56,4,72,56
M2 60,4,76,60
T 44,5,8192
M2 64,8,64,64
T 46,5,9216
M2 68,8,68,68
M2 72,8,72,72
T 48,14,8192
M2 76,8,76,76
T 50,14,9216
M2 80,12,64,80
T 52,15,8192
M2 84,12,68,84
M2 88,12,72,88
T 54,15,9216
M2 92,12,76,92
T 56,16,8192
M2 96,16,64,96
T 58,16,9216
M2 100,16,68,100
M2 104,16,72,104
T 60,17,8192
M2 108,16,76,108
T 62,17,9216
M2 112,20,64,112
M2 116,20,68,116
M2 120,20,72,120
M2 124,20,76,124
M3 224,24,64,224
M3 228,24,68,228
M3 232,24,72,232
M3 236,24,76,236
M3 240,28,64,240
M3 244,28,68,244
M3 248,28,72,248
M3 252,28,76,252
s_waitcnt lgkmcnt(0)
M2 32,32,80,32
T 0,2,16384
T 2,2,17408
M2 36,32,84,36
T 4,3,16384
M2 40,32,88,40
M2 44,32,92,44
T 6,3,17408
M2 48,36,80,48
T 8,4,16384
M2 52,36,84,52
T 10,4,17408
M2 56,36,88,56
M2 60,36,92,60
T 12,5,16384
M2 64,40,80,64
T 14,5,17408
M2 68,40,84,68
M2 72,40,88,72
T 16,14,16384
M2 76,40,92,76
T 18,14,17408
M2 80,44,80,80
T 20,15,16384
M2 84,44,84,84
M2 88,44,88,88
T 22,15,17408
M2 92,44,92,92
T 24,16,16384
M2 96,48,80,96
T 26,16,17408
M2 100,48,84,100
M2 104,48,88,104
T 28,17,16384
M2 108,48,92,108
T 30,17,17408
M2 112,52,80,112
M2 116,52,84,116
M2 120,52,88,120
M2 124,52,92,124
M3 224,56,80,224
M3 228,56,84,228
M3 232,56,88,232
M3 236,56,92,236
M3 240,60,80,240
M3 244,60,84,244
M3 248,60,88,248
s_waitcnt vmcnt(15) lgkmcnt(0)
M3 252,60,92,252
s_barrier
M2 32,0,96,32
T 32,2,24576
T 34,2,25600
M2 36,0,100,36
T 36,3,24576
M2 40,0,104,40
M2 44,0,108,44
T 38,3,25600
M2 48,4,96,48
T 40,4,24576
M2 52,4,100,52
T 42,4,25600
M2 56,4,104,56
M2 60,4,108,60
T 44,5,24576
M2 64,8,96,64
T 46,5,25600
M2 68,8,100,68
M2 72,8,104,72
T 48,14,24576
M2 76,8,108,76
T 50,14,25600
M2 80,12,96,80
T 52,15,24576
M2 84,12,100,84
M2 88,12,104,88
T 54,15,25600
M2 92,12,108,92
T 56,16,24576
M2 96,16,96,96
T 58,16,25600
M2 100,16,100,100
M2 104,16,104,104
T 60,17,24576
M2 108,16,108,108
T 62,17,25600
M2 112,20,96,112
M2 116,20,100,116
M2 120,20,104,120
M2 124,20,108,124
M3 224,24,96,224
M3 228,24,100,228
M3 232,24,104,232
M3 236,24,108,236
M3 240,28,96,240
M3 244,28,100,244
M3 248,28,104,248
M3 252,28,108,252
s_waitcnt vmcnt(11) lgkmcnt(0)
M2 32,32,112,32
T 0,2,32768
T 2,2,33792
M2 36,32,116,36
T 4,3,32768
M2 40,32,120,40
M2 44,32,124,44
T 6,3,33792
M2 48,36,112,48
T 8,4,32768
M2 52,36,116,52
T 10,4,33792
M2 56,36,120,56
M2 60,36,124,60
T 12,5,32768
M2 64,40,112,64
T 14,5,33792
M2 68,40,116,68
M2 72,40,120,72
T 16,14,32768
M2 76,40,124,76
T 18,14,33792
M2 80,44,112,80
T 20,15,32768
M2 84,44,116,84
M2 88,44,120,88
T 22,15,33792
M2 92,44,124,92
T 24,16,32768
M2 96,48,112,96
T 26,16,33792
M2 100,48,116,100
M2 104,48,120,104
T 28,17,32768
M2 108,48,124,108
T 30,17,33792
M2 112,52,112,112
M2 116,52,116,116
M2 120,52,120,120
M2 124,52,124,124
M3 224,56,112,224
M3 228,56,116,228
M3 232,56,120,232
M3 236,56,124,236
M3 240,60,112,240
M3 244,60,116,244
M3 248,60,120,248
s_waitcnt vmcnt(5) lgkmcnt(0)
M3 252,60,124,252
s_barrier
M2 32,0,128,32
T 32,2,40960
T 34,2,41984
M2 36,0,132,36
T 36,3,40960
M2 40,0,136,40
M2 44,0,140,44
T 38,3,41984
M2 48,4,128,48
T 40,4,40960
M2 52,4,132,52
T 42,4,41984
M2 56,4,136,56
M2 60,4,140,60
T 44,5,40960
M2 64,8,128,64
T 46,5,41984
M2 68,8,132,68
M2 72,8,136,72
T 48,14,40960
M2 76,8,140,76
T 50,14,41984
M2 80,12,128,80
T 52,15,40960
M2 84,12,132,84
M2 88,12,136,88
T 54,15,41984
M2 92,12,140,92
T 56,16,40960
M2 96,16,128,96
T 58,16,41984
M2 100,16,132,100
M2 104,16,136,104
T 60,17,40960
M2 108,16,140,108
T 62,17,41984
M2 112,20,128,112
M2 116,20,132,116
M2 120,20,136,120
M2 124,20,140,124
M3 224,24,128,224
M3 228,24,132,228
M3 232,24,136,232
M3 236,24,140,236
M3 240,28,128,240
M3 244,28,132,244
M3 248,28,136,248
M3 252,28,140,252
s_waitcnt vmcnt(1) lgkmcnt(0)
M2 32,32,144,32
s_lshr_b32 s40,s29,1
M2 36,32,148,36
M2 40,32,152,40
M2 44,32,156,44
M2 48,36,144,48
M2 52,36,148,52
M2 56,36,152,56
M2 60,36,156,60
M2 64,40,144,64
M2 68,40,148,68
s_lshl_b32 s40,s40,8
M2 72,40,152,72
M2 76,40,156,76
M2 80,44,144,80
M2 84,44,148,84
M2 88,44,152,88
M2 92,44,156,92
M2 96,48,144,96
M2 100,48,148,100
M2 104,48,152,104
M2 108,48,156,108
buffer_load_dword v0,v26,s[92:95],s40 offen sc1
M2 112,52,144,112
M2 116,52,148,116
M2 120,52,152,120
M2 124,52,156,124
M3 224,56,144,224
M3 228,56,148,228
M3 232,56,152,232
M3 236,56,156,236
M3 240,60,144,240
M3 244,60,148,244
M3 248,60,152,248
M3 252,60,156,252
s_branch l12_attpost
spin_lnatt1:
s_mov_b32 s100,0
spinl_lnatt1:
s_sleep 4
buffer_load_dword v0,v26,s[92:95],0 offen sc1
s_add_u32 s100,s100,1
s_cmp_ge_u32 s100,16384
s_cbranch_scc1 spinret_lnatt1
s_waitcnt vmcnt(0)
v_cmp_le_u32 vcc,32,v0
s_nop 3
s_and_b32 s39,vcc_lo,0xff
s_cmp_lg_u32 s39,0xff
s_cbranch_scc1 spinl_lnatt1
s_branch spinret_lnatt1
l12_g1:
s_waitcnt vmcnt(12)
s_cmp_lg_u32 s30,0
s_cbranch_scc1 spinret_lng1
v_cmp_le_u32 vcc,32,v0
s_nop 3
s_and_b32 s39,vcc_lo,0xff
s_cmp_lg_u32 s39,0xff
s_cbranch_scc1 spin_lng1
spinret_lng1:
s_add_u32 s92,s8,48168960
s_addc_u32 s93,s9,0
s_and_b32 s93,s93,0xffff
s_mov_b32 s94,65536
s_mov_b32 s95,0x00020000
v_mov_b32_e64 v26,v29
s_lshr_b32 s39,s2,5
s_lshl_b32 s39,s39,1
s_add_u32 s39,s39,s28
s_cmp_ge_u32 s39,6
s_cselect_b32 s4,6,0
s_sub_u32 s39,s39,s4
s_mov_b32 s4,s41
s_mul_i32 s5,s39,393216
s_add_u32 s41,s41,s5
s_add_u32 s5,s4,2359296
s_mov_b32 s6,s42
s_mul_i32 s7,s39,884736
s_add_u32 s42,s42,s7
s_add_u32 s7,s6,5308416
s_waitcnt lgkmcnt(0)
s_barrier
s_mul_i32 s11,s30,3072
M2 128,64,0,128
s_add_u32 m0,s43,131072
T 32,6,16384
R 96,19,0
M2 32,68,0,32
M2 160,72,0,160
T 34,6,18432
M2 64,76,0,64
M2 192,80,0,192
L6 22,20,41
T 36,7,16384
M2 96,84,0,96
M2 224,88,0,224
R 100,19,2048
M3 224,92,0,224
M2 132,64,4,132
T 38,7,18432
M2 36,68,4,36
L7 22,20,41,1024
M2 164,72,4,164
T 40,8,16384
M2 68,76,4,68
R 104,19,4096
M2 196,80,4,196
M2 100,84,4,100
T 42,8,18432
M2 228,88,4,228
M3 228,92,4,228
L7 22,20,41,2048
T 44,9,16384
M2 136,64,8,136
M2 40,68,8,40
R 108,19,6144
M2 168,72,8,168
M2 72,76,8,72
T 46,9,18432
M2 200,80,8,200
L7 22,20,41,3072
M2 104,84,8,104
T 48,10,16384
M2 232,88,8,232
R 112,19,8192
M3 232,92,8,232
M2 140,64,12,140
T 50,10,18432
M2 44,68,12,44
M2 172,72,12,172
s_add_u32 s41,s41,131072
s_cmp_eq_u32 s41,s5
s_cselect_b32 s41,s4,s41
M2 76,76,12,76
T 52,11,16384
M2 204,80,12,204
R 116,19,10240
M2 108,84,12,108
M2 236,88,12,236
T 54,11,18432
M3 236,92,12,236
s_add_u32 m0,s11,0
M2 144,64,16,144
T 56,12,16384
M2 48,68,16,48
R 120,19,12288
M2 176,72,16,176
M2 80,76,16,80
T 58,12,18432
M2 208,80,16,208
M2 112,84,16,112
L 23,16,42
T 60,13,16384
M2 240,88,16,240
M3 240,92,16,240
R 124,19,14336
M2 148,64,20,148
M2 52,68,20,52
T 62,13,18432
M2 180,72,20,180
L1 24,16,42,1024
M2 84,76,20,84
M2 212,80,20,212
M2 116,84,20,116
M2 244,88,20,244
M3 244,92,20,244
M2 152,64,24,152
L1 25,16,42,2048
M2 56,68,24,56
M2 184,72,24,184
M2 88,76,24,88
M2 216,80,24,216
M2 120,84,24,120
s_add_u32 s42,s42,294912
s_cmp_eq_u32 s42,s7
s_cselect_b32 s42,s6,s42
M2 248,88,24,248
M3 248,92,24,248
M2 156,64,28,156
M2 60,68,28,60
M2 188,72,28,188
M2 92,76,28,92
M2 220,80,28,220
M2 124,84,28,124
M2 252,88,28,252
s_waitcnt vmcnt(11) lgkmcnt(0)
M3 252,92,28,252
s_barrier
M2 128,96,32,128
s_add_u32 m0,s43,147456
T 0,6,32768
R 64,18,32768
M2 32,100,32,32
M2 160,104,32,160
T 2,6,34816
M2 64,108,32,64
M2 192,112,32,192
L6 22,20,41
T 4,7,32768
M2 96,116,32,96
M2 224,120,32,224
R 68,18,34816
M3 224,124,32,224
M2 132,96,36,132
T 6,7,34816
M2 36,100,36,36
L7 22,20,41,1024
M2 164,104,36,164
T 8,8,32768
M2 68,108,36,68
R 72,18,36864
M2 196,112,36,196
M2 100,116,36,100
T 10,8,34816
M2 228,120,36,228
M3 228,124,36,228
L7 22,20,41,2048
T 12,9,32768
M2 136,96,40,136
M2 40,100,40,40
R 76,18,38912
M2 168,104,40,168
M2 72,108,40,72
T 14,9,34816
M2 200,112,40,200
L7 22,20,41,3072
M2 104,116,40,104
T 16,10,32768
M2 232,120,40,232
R 80,18,40960
M3 232,124,40,232
M2 140,96,44,140
T 18,10,34816
M2 44,100,44,44
M2 172,104,44,172
s_add_u32 s41,s41,131072
s_cmp_eq_u32 s41,s5
s_cselect_b32 s41,s4,s41
M2 76,108,44,76
T 20,11,32768
M2 204,112,44,204
R 84,18,43008
M2 108,116,44,108
M2 236,120,44,236
T 22,11,34816
M3 236,124,44,236
s_add_u32 m0,s11,12288
M2 144,96,48,144
T 24,12,32768
M2 48,100,48,48
R 88,18,45056
M2 176,104,48,176
M2 80,108,48,80
T 26,12,34816
M2 208,112,48,208
M2 112,116,48,112
L 23,16,42
T 28,13,32768
M2 240,120,48,240
M3 240,124,48,240
R 92,18,47104
M2 148,96,52,148
M2 52,100,52,52
T 30,13,34816
M2 180,104,52,180
L1 24,16,42,1024
M2 84,108,52,84
M2 212,112,52,212
M2 116,116,52,116
M2 244,120,52,244
M3 244,124,52,244
M2 152,96,56,152
L1 25,16,42,2048
M2 56,100,56,56
M2 184,104,56,184
M2 88,108,56,88
M2 216,112,56,216
M2 120,116,56,120
s_add_u32 s42,s42,294912
s_cmp_eq_u32 s42,s7
s_cselect_b32 s42,s6,s42
M2 248,120,56,248
M3 248,124,56,248
M2 156,96,60,156
M2 60,100,60,60
M2 188,104,60,188
M2 92,108,60,92
M2 220,112,60,220
M2 124,116,60,124
M2 252,120,60,252
s_waitcnt vmcnt(14) lgkmcnt(0)
M3 252,124,60,252
s_barrier
M2 128,64,0,128
s_add_u32 m0,s11,24576
T 32,6,49152
AR 2,196
M2 32,68,0,32
R 96,19,32768
M2 160,72,0,160
T 34,6,51200
M2 64,76,0,64
M2 192,80,0,192
T 36,7,49152
M2 96,84,0,96
L 23,16,42
M2 224,88,0,224
R 100,19,34816
AR 3,197
M3 224,92,0,224
M2 132,64,4,132
T 38,7,51200
M2 36,68,4,36
M2 164,72,4,164
T 40,8,49152
M2 68,76,4,68
L1 24,16,42,1024
R 104,19,36864
M2 196,80,4,196
M2 100,84,4,100
T 42,8,51200
M2 228,88,4,228
M3 228,92,4,228
T 44,9,49152
AR 4,198
M2 136,64,8,136
M2 40,68,8,40
L1 25,16,42,2048
R 108,19,38912
M2 168,72,8,168
M2 72,76,8,72
T 46,9,51200
M2 200,80,8,200
M2 104,84,8,104
T 48,10,49152
M2 232,88,8,232
R 112,19,40960
M3 232,92,8,232
s_add_u32 s42,s42,294912
s_cmp_eq_u32 s42,s7
s_cselect_b32 s42,s6,s42
M2 140,64,12,140
T 50,10,51200
AR 5,199
M2 44,68,12,44
M2 172,72,12,172
T 52,11,49152
M2 76,76,12,76
M2 204,80,12,204
R 116,19,43008
M2 108,84,12,108
s_add_u32 m0,s11,36864
M2 236,88,12,236
T 54,11,51200
M3 236,92,12,236
M2 144,64,16,144
T 56,12,49152
AR 14,200
M2 48,68,16,48
R 120,19,45056
M2 176,72,16,176
M2 80,76,16,80
L 23,16,42
T 58,12,51200
M2 208,80,16,208
M2 112,84,16,112
T 60,13,49152
M2 240,88,16,240
M3 240,92,16,240
R 124,19,47104
M2 148,64,20,148
AR 15,201
M2 52,68,20,52
L1 24,16,42,1024
T 62,13,51200
M2 180,72,20,180
M2 84,76,20,84
M2 212,80,20,212
M2 116,84,20,116
M2 244,88,20,244
M3 244,92,20,244
L1 25,16,42,2048
M2 152,64,24,152
M2 56,68,24,56
AR 16,202
M2 184,72,24,184
M2 88,76,24,88
M2 216,80,24,216
M2 120,84,24,120
s_add_u32 s42,s42,294912
s_cmp_eq_u32 s42,s7
s_cselect_b32 s42,s6,s42
M2 248,88,24,248
M3 248,92,24,248
M2 156,64,28,156
M2 60,68,28,60
M2 188,72,28,188
M2 92,76,28,92
M2 220,80,28,220
M2 124,84,28,124
M2 252,88,28,252
s_waitcnt vmcnt(13) lgkmcnt(0)
M3 252,92,28,252
s_barrier
M2 128,96,32,128
s_add_u32 m0,s43,98304
R 0,2,32768
M2 32,100,32,32
T 64,3,0
M2 132,96,36,132
L6 22,20,41
M2 36,100,36,36
T 66,3,1536
M2 136,96,40,136
M2 40,100,40,40
R 4,2,32832
M2 140,96,44,140
C 128,128,129
C 129,130,131
M2 44,100,44,44
C 130,32,33
C 131,34,35
M2 144,96,48,144
L7 22,20,41,1024
C 132,132,133
M2 48,100,48,48
C 133,134,135
C 134,36,37
M2 148,96,52,148
T 68,4,0
C 135,38,39
M2 52,100,52,52
C 136,136,137
C 137,138,139
M2 152,96,56,152
C 138,40,41
C 139,42,43
M2 56,100,56,56
R 8,2,34816
L7 22,20,41,2048
M2 156,96,60,156
C 140,140,141
C 141,142,143
M2 60,100,60,60
C 142,44,45
C 143,46,47
M2 160,104,32,160
T 70,4,1536
C 144,144,145
M2 64,108,32,64
C 145,146,147
C 146,48,49
M2 164,104,36,164
L7 22,20,41,3072
C 147,50,51
M2 68,108,36,68
T 72,5,0
C 148,148,149
M2 168,104,40,168
C 149,150,151
C 150,52,53
M2 72,108,40,72
R 12,2,34880
C 151,54,55
M2 172,104,44,172
C 152,152,153
C 153,154,155
M2 76,108,44,76
C 154,56,57
C 155,58,59
M2 176,104,48,176
s_add_u32 s41,s41,131072
s_cmp_eq_u32 s41,s5
s_cselect_b32 s41,s4,s41
M2 80,108,48,80
s_add_u32 m0,s43,114688
T 74,5,1536
C 156,156,157
M2 180,104,52,180
C 157,158,159
C 158,60,61
M2 84,108,52,84
R 16,2,36864
C 159,62,63
M2 184,104,56,184
C 160,160,161
C 161,162,163
M2 88,108,56,88
C 162,64,65
C 163,66,67
M2 188,104,60,188
C 164,164,165
C 165,166,167
M2 92,108,60,92
T 76,14,0
C 166,68,69
M2 192,112,32,192
L6 22,20,41
C 167,70,71
M2 96,116,32,96
C 168,168,169
C 169,170,171
M2 196,112,36,196
C 170,72,73
C 171,74,75
M2 100,116,36,100
T 78,14,1536
C 172,172,173
M2 200,112,40,200
C 173,174,175
C 174,76,77
M2 104,116,40,104
R 20,2,36928
C 175,78,79
M2 204,112,44,204
L7 22,20,41,1024
C 176,176,177
M2 108,116,44,108
C 177,178,179
C 178,80,81
M2 208,112,48,208
T 80,15,0
C 179,82,83
M2 112,116,48,112
C 180,180,181
C 181,182,183
M2 212,112,52,212
C 182,84,85
C 183,86,87
M2 116,116,52,116
R 24,2,38912
L7 22,20,41,2048
M2 216,112,56,216
C 184,184,185
C 185,186,187
M2 120,116,56,120
C 186,88,89
C 187,90,91
M2 220,112,60,220
T 82,15,1536
C 188,188,189
M2 124,116,60,124
C 189,190,191
C 190,92,93
M2 224,120,32,224
L7 22,20,41,3072
C 191,94,95
M3 224,124,32,224
T 84,16,0
C 192,192,193
M2 228,120,36,228
C 193,194,195
C 194,96,97
M3 228,124,36,228
R 28,2,38976
C 195,98,99
M2 232,120,40,232
C 196,196,197
C 197,198,199
M3 232,124,40,232
C 198,100,101
C 199,102,103
M2 236,120,44,236
s_add_u32 s41,s41,131072
s_cmp_eq_u32 s41,s5
s_cselect_b32 s41,s4,s41
M3 236,124,44,236
s_add_u32 m0,s11,49152
T 86,16,1536
C 200,200,201
C 201,202,203
M2 240,120,48,240
C 202,104,105
C 203,106,107
C 204,204,205
M3 240,124,48,240
C 205,206,207
C 206,108,109
M2 244,120,52,244
C 207,110,111
C 208,208,209
M3 244,124,52,244
C 209,210,211
C 210,112,113
M2 248,120,56,248
C 211,114,115
C 212,212,213
M3 248,124,56,248
L 23,16,42
C 213,214,215
M2 252,120,60,252
C 214,116,117
C 215,118,119
M3 252,124,60,252
L1 24,16,42,1024
L1 25,16,42,2048
s_add_u32 s42,s42,294912
s_cmp_eq_u32 s42,s7
s_cselect_b32 s42,s6,s42
s_waitcnt lgkmcnt(0)
s_waitcnt vmcnt(17)
s_barrier
M1 128,0,64,0
s_add_u32 m0,s43,131072
C 216,216,217
C 217,218,219
C 218,120,121
M1 132,0,68,0
s_add_u32 s40,s38,8192
C 219,122,123
C 220,220,221
M1 136,0,72,0
C 221,222,223
C 222,124,125
M1 140,0,76,0
C 223,126,127
C 224,224,225
M1 144,0,80,0
C 225,226,227
AR 18,224
M1 148,0,84,0
AR 19,225
AR 20,226
M1 152,4,64,0
AR 21,227
C 226,18,19
M1 156,4,68,0
C 227,20,21
C 228,228,229
M1 160,4,72,0
C 229,230,231
AR 18,228
M1 164,4,76,0
AR 19,229
AR 20,230
AR 21,231
M1 168,4,80,0
C 230,18,19
C 231,20,21
M1 172,4,84,0
C 232,232,233
C 233,234,235
M1 176,8,64,0
AR 18,232
AR 19,233
M1 180,8,68,0
AR 20,234
AR 21,235
M1 184,8,72,0
C 234,18,19
C 235,20,21
M1 188,8,76,0
C 236,236,237
C 237,238,239
M1 192,8,80,0
AR 18,236
AR 19,237
M1 196,8,84,0
AR 20,238
AR 21,239
M1 200,12,64,0
C 238,18,19
C 239,20,21
M1 204,12,68,0
C 240,240,241
C 241,242,243
AR 18,240
M1 208,12,72,0
AR 19,241
AR 20,242
M1 212,12,76,0
AR 21,243
C 242,18,19
M1 216,12,80,0
C 243,20,21
C 244,244,245
M1 220,12,84,0
C 245,246,247
AR 18,244
M 32,16,64,0
AR 19,245
AR 20,246
M 36,16,68,0
AR 21,247
C 246,18,19
M 40,16,72,0
C 247,20,21
C 248,248,249
M 44,16,76,0
C 249,250,251
AR 18,248
M 48,16,80,0
AR 19,249
AR 20,250
AR 21,251
M 52,16,84,0
C 250,18,19
C 251,20,21
M 56,20,64,0
C 252,252,253
C 253,254,255
M 60,20,68,0
AR 18,252
AR 19,253
M 64,20,72,0
AR 20,254
AR 21,255
M 68,20,76,0
C 254,18,19
C 255,20,21
M 72,20,80,0
R 32,2,49152
T 88,3,12288
M 76,20,84,0
T 90,3,13824
L6 22,20,41
M 80,24,64,0
R 36,2,49216
T 92,4,12288
M 84,24,68,0
L7 22,20,41,1024
R 40,2,51200
M 88,24,72,0
T 94,4,13824
T 96,5,12288
L7 22,20,41,2048
M 92,24,76,0
R 44,2,51264
S1 128,27,96,40,0
M 96,24,80,0
T 98,5,13824
L7 22,20,41,3072
M 100,24,84,0
R 48,2,53248
T 100,14,12288
M 104,28,64,0
T 102,14,13824
R 52,2,53312
M 108,28,68,0
s_add_u32 s41,s41,131072
s_cmp_eq_u32 s41,s5
s_cselect_b32 s41,s4,s41
M 112,28,72,0
s_add_u32 m0,s11,0
T 104,15,12288
R 56,2,55296
T 106,15,13824
M 116,28,76,0
L 23,16,42
T 108,16,12288
S1 132,27,96,40,1024
M 120,28,80,0
R 60,2,55360
T 110,16,13824
M 124,28,84,0
L1 24,16,42,1024
L1 25,16,42,2048
s_add_u32 s42,s42,294912
s_cmp_eq_u32 s42,s7
s_cselect_b32 s42,s6,s42
s_waitcnt vmcnt(16) lgkmcnt(0)
s_barrier
M3 128,32,88,128
s_add_u32 m0,s43,147456
R 0,2,0
S1 136,27,96,40,2048
M3 132,32,92,132
T 64,3,24576
M3 136,32,96,136
T 66,3,26112
M3 140,32,100,140
L6 22,20,41
R 4,2,64
M3 144,32,104,144
M3 148,32,108,148
T 68,4,24576
M3 152,36,88,152
M3 156,36,92,156
L7 22,20,41,1024
R 8,2,2048
M3 160,36,96,160
T 70,4,26112
M3 164,36,100,164
M3 168,36,104,168
T 72,5,24576
M3 172,36,108,172
L7 22,20,41,2048
M3 176,40,88,176
R 12,2,2112
M3 180,40,92,180
T 74,5,26112
M3 184,40,96,184
M3 188,40,100,188
L7 22,20,41,3072
R 16,2,4096
M3 192,40,104,192
M3 196,40,108,196
T 76,14,24576
M3 200,44,88,200
T 78,14,26112
M3 204,44,92,204
s_add_u32 s41,s41,131072
s_cmp_eq_u32 s41,s5
s_cselect_b32 s41,s4,s41
M3 208,44,96,208
R 20,2,4160
M3 212,44,100,212
S1 140,27,96,40,3072
M3 216,44,104,216
T 80,15,24576
M3 220,44,108,220
s_add_u32 m0,s11,12288
R 24,2,6144
M2 32,48,88,32
M2 36,48,92,36
T 82,15,26112
M2 40,48,96,40
M2 44,48,100,44
L 23,16,42
T 84,16,24576
M2 48,48,104,48
R 28,2,6208
M2 52,48,108,52
M2 56,52,88,56
T 86,16,26112
M2 60,52,92,60
L1 24,16,42,1024
M2 64,52,96,64
M2 68,52,100,68
M2 72,52,104,72
M2 76,52,108,76
L1 25,16,42,2048
M2 80,56,88,80
M2 84,56,92,84
M2 88,56,96,88
M2 92,56,100,92
s_add_u32 s42,s42,294912
s_cmp_eq_u32 s42,s7
s_cselect_b32 s42,s6,s42
M2 96,56,104,96
M2 100,56,108,100
M2 104,60,88,104
M2 108,60,92,108
M2 112,60,96,112
M2 116,60,100,116
M2 120,60,104,120
s_waitcnt vmcnt(21) lgkmcnt(0)
M2 124,60,108,124
s_barrier
M3 128,0,64,128
s_add_u32 m0,s43,98304
R 32,2,16384
T 88,3,36864
M3 132,0,68,132
s_add_u32 s40,s38,12288
M3 136,0,72,136
T 90,3,38400
M3 140,0,76,140
L6 22,20,41
R 36,2,16448
M3 144,0,80,144
M3 148,0,84,148
T 92,4,36864
M3 152,4,64,152
M3 156,4,68,156
L7 22,20,41,1024
R 40,2,18432
M3 160,4,72,160
T 94,4,38400
M3 164,4,76,164
M3 168,4,80,168
T 96,5,36864
M3 172,4,84,172
L7 22,20,41,2048
M3 176,8,64,176
R 44,2,18496
M3 180,8,68,180
S1 144,27,96,40,0
T 98,5,38400
M3 184,8,72,184
M3 188,8,76,188
L7 22,20,41,3072
R 48,2,20480
M3 192,8,80,192
M3 196,8,84,196
T 100,14,36864
M3 200,12,64,200
T 102,14,38400
M3 204,12,68,204
s_add_u32 s41,s41,131072
s_cmp_eq_u32 s41,s5
s_cselect_b32 s41,s4,s41
M3 208,12,72,208
R 52,2,20544
M3 212,12,76,212
M3 216,12,80,216
T 104,15,36864
M3 220,12,84,220
s_add_u32 m0,s11,24576
R 56,2,22528
M2 32,16,64,32
M2 36,16,68,36
T 106,15,38400
M2 40,16,72,40
M2 44,16,76,44
L 23,16,42
T 108,16,36864
M2 48,16,80,48
S1 148,27,96,40,1024
R 60,2,22592
M2 52,16,84,52
M2 56,20,64,56
T 110,16,38400
M2 60,20,68,60
L1 24,16,42,1024
M2 64,20,72,64
M2 68,20,76,68
M2 72,20,80,72
M2 76,20,84,76
L1 25,16,42,2048
M2 80,24,64,80
M2 84,24,68,84
M2 88,24,72,88
M2 92,24,76,92
s_add_u32 s42,s42,294912
s_cmp_eq_u32 s42,s7
s_cselect_b32 s42,s6,s42
M2 96,24,80,96
M2 100,24,84,100
M2 104,28,64,104
M2 108,28,68,108
M2 112,28,72,112
M2 116,28,76,116
M2 120,28,80,120
s_waitcnt vmcnt(22) lgkmcnt(0)
M2 124,28,84,124
s_barrier
M3 128,32,88,128
s_add_u32 m0,s43,114688
R 0,2,32768
S1 152,27,96,40,2048
M3 132,32,92,132
T 64,3,49152
M3 136,32,96,136
T 66,3,50688
M3 140,32,100,140
L6 22,20,41
R 4,2,32832
M3 144,32,104,144
M3 148,32,108,148
T 68,4,49152
M3 152,36,88,152
M3 156,36,92,156
L7 22,20,41,1024
R 8,2,34816
M3 160,36,96,160
T 70,4,50688
M3 164,36,100,164
M3 168,36,104,168
S1 156,27,96,40,3072
T 72,5,49152
M3 172,36,108,172
L7 22,20,41,2048
M3 176,40,88,176
R 12,2,34880
M3 180,40,92,180
T 74,5,50688
M3 184,40,96,184
M3 188,40,100,188
L7 22,20,41,3072
R 16,2,36864
M3 192,40,104,192
M3 196,40,108,196
T 76,14,49152
M3 200,44,88,200
T 78,14,50688
M3 204,44,92,204
s_add_u32 s41,s41,131072
s_cmp_eq_u32 s41,s5
s_cselect_b32 s41,s4,s41
M3 208,44,96,208
R 20,2,36928
M3 212,44,100,212
s_add_u32 s40,s38,24576
M3 216,44,104,216
T 80,15,49152
M3 220,44,108,220
s_add_u32 m0,s11,36864
R 24,2,38912
M2 32,48,88,32
M2 36,48,92,36
T 82,15,50688
M2 40,48,96,40
M2 44,48,100,44
L 23,16,42
T 84,16,49152
M2 48,48,104,48
R 28,2,38976
M2 52,48,108,52
M2 56,52,88,56
T 86,16,50688
M2 60,52,92,60
L1 24,16,42,1024
M2 64,52,96,64
S1 160,27,96,40,0
M2 68,52,100,68
M2 72,52,104,72
M2 76,52,108,76
L1 25,16,42,2048
M2 80,56,88,80
M2 84,56,92,84
M2 88,56,96,88
M2 92,56,100,92
s_add_u32 s42,s42,294912
s_cmp_eq_u32 s42,s7
s_cselect_b32 s42,s6,s42
M2 96,56,104,96
M2 100,56,108,100
M2 104,60,88,104
M2 108,60,92,108
M2 112,60,96,112
M2 116,60,100,116
M2 120,60,104,120
s_waitcnt vmcnt(23) lgkmcnt(0)
M2 124,60,108,124
s_barrier
M3 128,0,64,128
s_add_u32 m0,s43,131072
R 32,2,49152
S1 164,27,96,40,1024
M3 132,0,68,132
T 88,3,0
M3 136,0,72,136
T 90,3,1536
M3 140,0,76,140
L6 22,20,41
R 36,2,49216
M3 144,0,80,144
M3 148,0,84,148
T 92,4,0
M3 152,4,64,152
M3 156,4,68,156
L7 22,20,41,1024
R 40,2,51200
M3 160,4,72,160
T 94,4,1536
M3 164,4,76,164
M3 168,4,80,168
T 96,5,0
M3 172,4,84,172
L7 22,20,41,2048
M3 176,8,64,176
R 44,2,51264
M3 180,8,68,180
T 98,5,1536
M3 184,8,72,184
M3 188,8,76,188
L7 22,20,41,3072
R 48,2,53248
M3 192,8,80,192
M3 196,8,84,196
T 100,14,0
M3 200,12,64,200
T 102,14,1536
M3 204,12,68,204
s_add_u32 s41,s41,131072
s_cmp_eq_u32 s41,s5
s_cselect_b32 s41,s4,s41
M3 208,12,72,208
R 52,2,53312
M3 212,12,76,212
S1 168,27,96,40,2048
M3 216,12,80,216
T 104,15,0
M3 220,12,84,220
s_add_u32 m0,s11,49152
R 56,2,55296
M2 32,16,64,32
M2 36,16,68,36
T 106,15,1536
M2 40,16,72,40
M2 44,16,76,44
L 23,16,42
T 108,16,0
M2 48,16,80,48
R 60,2,55360
M2 52,16,84,52
M2 56,20,64,56
T 110,16,1536
M2 60,20,68,60
L1 24,16,42,1024
M2 64,20,72,64
M2 68,20,76,68
M2 72,20,80,72
M2 76,20,84,76
L1 25,16,42,2048
M2 80,24,64,80
M2 84,24,68,84
M2 88,24,72,88
M2 92,24,76,92
s_add_u32 s42,s42,294912
s_cmp_eq_u32 s42,s7
s_cselect_b32 s42,s6,s42
M2 96,24,80,96
M2 100,24,84,100
M2 104,28,64,104
M2 108,28,68,108
M2 112,28,72,112
M2 116,28,76,116
M2 120,28,80,120
s_waitcnt vmcnt(23) lgkmcnt(0)
M2 124,28,84,124
s_barrier
M3 128,32,88,128
s_add_u32 m0,s43,147456
R 0,2,0
S1 172,27,96,40,3072
M3 132,32,92,132
T 64,3,12288
M3 136,32,96,136
T 66,3,13824
M3 140,32,100,140
L6 22,20,41
R 4,2,64
M3 144,32,104,144
M3 148,32,108,148
T 68,4,12288
M3 152,36,88,152
M3 156,36,92,156
L7 22,20,41,1024
R 8,2,2048
M3 160,36,96,160
T 70,4,13824
M3 164,36,100,164
M3 168,36,104,168
T 72,5,12288
M3 172,36,108,172
L7 22,20,41,2048
M3 176,40,88,176
R 12,2,2112
M3 180,40,92,180
s_add_u32 s40,s38,28672
T 74,5,13824
M3 184,40,96,184
M3 188,40,100,188
L7 22,20,41,3072
R 16,2,4096
M3 192,40,104,192
M3 196,40,108,196
T 76,14,12288
M3 200,44,88,200
T 78,14,13824
M3 204,44,92,204
s_add_u32 s41,s41,131072
s_cmp_eq_u32 s41,s5
s_cselect_b32 s41,s4,s41
M3 208,44,96,208
R 20,2,4160
M3 212,44,100,212
M3 216,44,104,216
T 80,15,12288
M3 220,44,108,220
s_add_u32 m0,s11,0
R 24,2,6144
M2 32,48,88,32
M2 36,48,92,36
T 82,15,13824
M2 40,48,96,40
M2 44,48,100,44
L 23,16,42
T 84,16,12288
M2 48,48,104,48
S1 176,27,96,40,0
R 28,2,6208
M2 52,48,108,52
M2 56,52,88,56
T 86,16,13824
M2 60,52,92,60
L1 24,16,42,1024
M2 64,52,96,64
M2 68,52,100,68
M2 72,52,104,72
M2 76,52,108,76
L1 25,16,42,2048
M2 80,56,88,80
M2 84,56,92,84
M2 88,56,96,88
M2 92,56,100,92
s_add_u32 s42,s42,294912
s_cmp_eq_u32 s42,s7
s_cselect_b32 s42,s6,s42
M2 96,56,104,96
M2 100,56,108,100
M2 104,60,88,104
M2 108,60,92,108
M2 112,60,96,112
M2 116,60,100,116
M2 120,60,104,120
s_waitcnt vmcnt(22) lgkmcnt(0)
M2 124,60,108,124
s_barrier
M3 128,0,64,128
s_add_u32 m0,s43,98304
R 32,2,16384
S1 180,27,96,40,1024
M3 132,0,68,132
T 88,3,24576
M3 136,0,72,136
T 90,3,26112
M3 140,0,76,140
L6 22,20,41
R 36,2,16448
M3 144,0,80,144
M3 148,0,84,148
T 92,4,24576
M3 152,4,64,152
M3 156,4,68,156
L7 22,20,41,1024
R 40,2,18432
M3 160,4,72,160
T 94,4,26112
M3 164,4,76,164
M3 168,4,80,168
T 96,5,24576
M3 172,4,84,172
L7 22,20,41,2048
M3 176,8,64,176
R 44,2,18496
M3 180,8,68,180
S1 184,27,96,40,2048
T 98,5,26112
M3 184,8,72,184
M3 188,8,76,188
L7 22,20,41,3072
R 48,2,20480
M3 192,8,80,192
M3 196,8,84,196
T 100,14,24576
M3 200,12,64,200
T 102,14,26112
M3 204,12,68,204
s_add_u32 s41,s41,131072
s_cmp_eq_u32 s41,s5
s_cselect_b32 s41,s4,s41
M3 208,12,72,208
R 52,2,20544
M3 212,12,76,212
M3 216,12,80,216
T 104,15,24576
M3 220,12,84,220
s_add_u32 m0,s11,12288
R 56,2,22528
M2 32,16,64,32
M2 36,16,68,36
T 106,15,26112
M2 40,16,72,40
M2 44,16,76,44
L 23,16,42
T 108,16,24576
M2 48,16,80,48
S1 188,27,96,40,3072
R 60,2,22592
M2 52,16,84,52
M2 56,20,64,56
T 110,16,26112
M2 60,20,68,60
L1 24,16,42,1024
M2 64,20,72,64
M2 68,20,76,68
M2 72,20,80,72
M2 76,20,84,76
L1 25,16,42,2048
M2 80,24,64,80
M2 84,24,68,84
M2 88,24,72,88
M2 92,24,76,92
s_add_u32 s42,s42,294912
s_cmp_eq_u32 s42,s7
s_cselect_b32 s42,s6,s42
M2 96,24,80,96
M2 100,24,84,100
M2 104,28,64,104
M2 108,28,68,108
M2 112,28,72,112
M2 116,28,76,116
M2 120,28,80,120
s_waitcnt vmcnt(23) lgkmcnt(0)
M2 124,28,84,124
s_barrier
M3 128,32,88,128
s_add_u32 m0,s43,114688
R 0,2,32768
T 64,3,36864
M3 132,32,92,132
s_add_u32 s40,s38,40960
M3 136,32,96,136
T 66,3,38400
M3 140,32,100,140
L6 22,20,41
R 4,2,32832
M3 144,32,104,144
M3 148,32,108,148
T 68,4,36864
M3 152,36,88,152
M3 156,36,92,156
L7 22,20,41,1024
R 8,2,34816
M3 160,36,96,160
T 70,4,38400
M3 164,36,100,164
M3 168,36,104,168
T 72,5,36864
M3 172,36,108,172
L7 22,20,41,2048
M3 176,40,88,176
R 12,2,34880
M3 180,40,92,180
S1 192,27,96,40,0
T 74,5,38400
M3 184,40,96,184
M3 188,40,100,188
L7 22,20,41,3072
R 16,2,36864
M3 192,40,104,192
M3 196,40,108,196
T 76,14,36864
M3 200,44,88,200
T 78,14,38400
M3 204,44,92,204
s_add_u32 s41,s41,131072
s_cmp_eq_u32 s41,s5
s_cselect_b32 s41,s4,s41
M3 208,44,96,208
R 20,2,36928
M3 212,44,100,212
M3 216,44,104,216
T 80,15,36864
M3 220,44,108,220
s_add_u32 m0,s11,24576
R 24,2,38912
M2 32,48,88,32
M2 36,48,92,36
T 82,15,38400
M2 40,48,96,40
M2 44,48,100,44
L 23,16,42
T 84,16,36864
M2 48,48,104,48
S1 196,27,96,40,1024
R 28,2,38976
M2 52,48,108,52
M2 56,52,88,56
T 86,16,38400
M2 60,52,92,60
L1 24,16,42,1024
M2 64,52,96,64
M2 68,52,100,68
M2 72,52,104,72
M2 76,52,108,76
L1 25,16,42,2048
M2 80,56,88,80
M2 84,56,92,84
M2 88,56,96,88
M2 92,56,100,92
s_add_u32 s42,s42,294912
s_cmp_eq_u32 s42,s7
s_cselect_b32 s42,s6,s42
M2 96,56,104,96
M2 100,56,108,100
M2 104,60,88,104
M2 108,60,92,108
M2 112,60,96,112
M2 116,60,100,116
M2 120,60,104,120
s_waitcnt vmcnt(23) lgkmcnt(0)
M2 124,60,108,124
s_barrier
M3 128,0,64,128
s_add_u32 m0,s43,131072
R 32,2,49152
S1 200,27,96,40,2048
M3 132,0,68,132
T 88,3,49152
M3 136,0,72,136
T 90,3,50688
M3 140,0,76,140
L6 22,20,41
R 36,2,49216
M3 144,0,80,144
M3 148,0,84,148
T 92,4,49152
M3 152,4,64,152
M3 156,4,68,156
L7 22,20,41,1024
R 40,2,51200
M3 160,4,72,160
T 94,4,50688
M3 164,4,76,164
M3 168,4,80,168
T 96,5,49152
M3 172,4,84,172
L7 22,20,41,2048
M3 176,8,64,176
R 44,2,51264
M3 180,8,68,180
T 98,5,50688
M3 184,8,72,184
M3 188,8,76,188
L7 22,20,41,3072
R 48,2,53248
M3 192,8,80,192
M3 196,8,84,196
T 100,14,49152
M3 200,12,64,200
T 102,14,50688
M3 204,12,68,204
s_add_u32 s41,s41,131072
s_cmp_eq_u32 s41,s5
s_cselect_b32 s41,s4,s41
M3 208,12,72,208
R 52,2,53312
M3 212,12,76,212
S1 204,27,96,40,3072
M3 216,12,80,216
T 104,15,49152
M3 220,12,84,220
s_add_u32 m0,s11,36864
R 56,2,55296
M2 32,16,64,32
M2 36,16,68,36
T 106,15,50688
M2 40,16,72,40
M2 44,16,76,44
L 23,16,42
T 108,16,49152
M2 48,16,80,48
R 60,2,55360
M2 52,16,84,52
M2 56,20,64,56
T 110,16,50688
M2 60,20,68,60
L1 24,16,42,1024
M2 64,20,72,64
M2 68,20,76,68
M2 72,20,80,72
M2 76,20,84,76
L1 25,16,42,2048
M2 80,24,64,80
M2 84,24,68,84
M2 88,24,72,88
M2 92,24,76,92
s_add_u32 s42,s42,294912
s_cmp_eq_u32 s42,s7
s_cselect_b32 s42,s6,s42
M2 96,24,80,96
M2 100,24,84,100
M2 104,28,64,104
M2 108,28,68,108
M2 112,28,72,112
M2 116,28,76,116
M2 120,28,80,120
s_waitcnt vmcnt(22) lgkmcnt(0)
M2 124,28,84,124
s_barrier
M3 128,32,88,128
s_add_u32 m0,s43,147456
R 0,2,0
T 64,3,0
M3 132,32,92,132
s_add_u32 s40,s38,45056
M3 136,32,96,136
T 66,3,1536
M3 140,32,100,140
L6 22,20,41
R 4,2,64
M3 144,32,104,144
M3 148,32,108,148
T 68,4,0
M3 152,36,88,152
M3 156,36,92,156
L7 22,20,41,1024
R 8,2,2048
M3 160,36,96,160
T 70,4,1536
M3 164,36,100,164
M3 168,36,104,168
T 72,5,0
M3 172,36,108,172
L7 22,20,41,2048
M3 176,40,88,176
R 12,2,2112
M3 180,40,92,180
S1 208,27,96,40,0
T 74,5,1536
M3 184,40,96,184
M3 188,40,100,188
L7 22,20,41,3072
R 16,2,4096
M3 192,40,104,192
M3 196,40,108,196
T 76,14,0
M3 200,44,88,200
T 78,14,1536
M3 204,44,92,204
s_add_u32 s41,s41,131072
s_cmp_eq_u32 s41,s5
s_cselect_b32 s41,s4,s41
M3 208,44,96,208
R 20,2,4160
M3 212,44,100,212
M3 216,44,104,216
T 80,15,0
M3 220,44,108,220
s_add_u32 m0,s11,49152
R 24,2,6144
M2 32,48,88,32
M2 36,48,92,36
T 82,15,1536
M2 40,48,96,40
M2 44,48,100,44
L 23,16,42
T 84,16,0
M2 48,48,104,48
S1 212,27,96,40,1024
R 28,2,6208
M2 52,48,108,52
M2 56,52,88,56
T 86,16,1536
M2 60,52,92,60
L1 24,16,42,1024
M2 64,52,96,64
M2 68,52,100,68
M2 72,52,104,72
M2 76,52,108,76
L1 25,16,42,2048
M2 80,56,88,80
M2 84,56,92,84
M2 88,56,96,88
M2 92,56,100,92
s_add_u32 s42,s42,294912
s_cmp_eq_u32 s42,s7
s_cselect_b32 s42,s6,s42
M2 96,56,104,96
M2 100,56,108,100
M2 104,60,88,104
M2 108,60,92,108
M2 112,60,96,112
M2 116,60,100,116
M2 120,60,104,120
s_waitcnt vmcnt(22) lgkmcnt(0)
M2 124,60,108,124
s_barrier
M3 128,0,64,128
s_add_u32 m0,s43,98304
R 32,2,16384
S1 216,27,96,40,2048
M3 132,0,68,132
T 88,3,12288
M3 136,0,72,136
T 90,3,13824
M3 140,0,76,140
L6 22,20,41
R 36,2,16448
M3 144,0,80,144
M3 148,0,84,148
T 92,4,12288
M3 152,4,64,152
M3 156,4,68,156
L7 22,20,41,1024
R 40,2,18432
M3 160,4,72,160
T 94,4,13824
M3 164,4,76,164
M3 168,4,80,168
S1 220,27,96,40,3072
T 96,5,12288
M3 172,4,84,172
L7 22,20,41,2048
M3 176,8,64,176
R 44,2,18496
M3 180,8,68,180
T 98,5,13824
M3 184,8,72,184
M3 188,8,76,188
L7 22,20,41,3072
R 48,2,20480
M3 192,8,80,192
M3 196,8,84,196
T 100,14,12288
M3 200,12,64,200
T 102,14,13824
M3 204,12,68,204
s_add_u32 s41,s41,131072
s_cmp_eq_u32 s41,s5
s_cselect_b32 s41,s4,s41
M3 208,12,72,208
R 52,2,20544
M3 212,12,76,212
s_add_u32 s40,s38,57344
M3 216,12,80,216
T 104,15,12288
M3 220,12,84,220
s_add_u32 m0,s11,0
R 56,2,22528
M2 32,16,64,32
M2 36,16,68,36
T 106,15,13824
M2 40,16,72,40
M2 44,16,76,44
L 23,16,42
T 108,16,12288
M2 48,16,80,48
R 60,2,22592
M2 52,16,84,52
M2 56,20,64,56
T 110,16,13824
M2 60,20,68,60
L1 24,16,42,1024
M2 64,20,72,64
S1 224,27,96,40,0
M2 68,20,76,68
M2 72,20,80,72
M2 76,20,84,76
L1 25,16,42,2048
M2 80,24,64,80
M2 84,24,68,84
M2 88,24,72,88
M2 92,24,76,92
s_add_u32 s42,s42,294912
s_cmp_eq_u32 s42,s7
s_cselect_b32 s42,s6,s42
M2 96,24,80,96
M2 100,24,84,100
M2 104,28,64,104
M2 108,28,68,108
M2 112,28,72,112
M2 116,28,76,116
M2 120,28,80,120
s_waitcnt vmcnt(23) lgkmcnt(0)
M2 124,28,84,124
s_barrier
M3 128,32,88,128
s_add_u32 m0,s43,114688
R 0,2,32768
S1 228,27,96,40,1024
M3 132,32,92,132
T 64,3,24576
M3 136,32,96,136
T 66,3,26112
M3 140,32,100,140
L6 22,20,41
R 4,2,32832
M3 144,32,104,144
M3 148,32,108,148
T 68,4,24576
M3 152,36,88,152
M3 156,36,92,156
L7 22,20,41,1024
R 8,2,34816
M3 160,36,96,160
T 70,4,26112
M3 164,36,100,164
M3 168,36,104,168
T 72,5,24576
M3 172,36,108,172
L7 22,20,41,2048
M3 176,40,88,176
R 12,2,34880
M3 180,40,92,180
T 74,5,26112
M3 184,40,96,184
M3 188,40,100,188
L7 22,20,41,3072
R 16,2,36864
M3 192,40,104,192
M3 196,40,108,196
T 76,14,24576
M3 200,44,88,200
T 78,14,26112
M3 204,44,92,204
s_add_u32 s41,s41,131072
s_cmp_eq_u32 s41,s5
s_cselect_b32 s41,s4,s41
M3 208,44,96,208
R 20,2,36928
M3 212,44,100,212
S1 232,27,96,40,2048
M3 216,44,104,216
T 80,15,24576
M3 220,44,108,220
s_add_u32 m0,s11,12288
R 24,2,38912
M2 32,48,88,32
M2 36,48,92,36
T 82,15,26112
M2 40,48,96,40
M2 44,48,100,44
L 23,16,42
T 84,16,24576
M2 48,48,104,48
R 28,2,38976
M2 52,48,108,52
M2 56,52,88,56
T 86,16,26112
M2 60,52,92,60
L1 24,16,42,1024
M2 64,52,96,64
M2 68,52,100,68
M2 72,52,104,72
M2 76,52,108,76
L1 25,16,42,2048
M2 80,56,88,80
M2 84,56,92,84
M2 88,56,96,88
M2 92,56,100,92
s_add_u32 s42,s42,294912
s_cmp_eq_u32 s42,s7
s_cselect_b32 s42,s6,s42
M2 96,56,104,96
M2 100,56,108,100
M2 104,60,88,104
M2 108,60,92,108
M2 112,60,96,112
M2 116,60,100,116
M2 120,60,104,120
s_waitcnt vmcnt(23) lgkmcnt(0)
M2 124,60,108,124
s_barrier
M3 128,0,64,128
s_add_u32 m0,s43,131072
R 32,2,49152
S1 236,27,96,40,3072
M3 132,0,68,132
T 88,3,36864
M3 136,0,72,136
T 90,3,38400
M3 140,0,76,140
L6 22,20,41
R 36,2,49216
M3 144,0,80,144
M3 148,0,84,148
T 92,4,36864
M3 152,4,64,152
M3 156,4,68,156
L7 22,20,41,1024
R 40,2,51200
M3 160,4,72,160
T 94,4,38400
M3 164,4,76,164
M3 168,4,80,168
T 96,5,36864
M3 172,4,84,172
L7 22,20,41,2048
M3 176,8,64,176
R 44,2,51264
M3 180,8,68,180
s_add_u32 s40,s38,61440
T 98,5,38400
M3 184,8,72,184
M3 188,8,76,188
L7 22,20,41,3072
R 48,2,53248
M3 192,8,80,192
M3 196,8,84,196
T 100,14,36864
M3 200,12,64,200
T 102,14,38400
M3 204,12,68,204
s_add_u32 s41,s41,131072
s_cmp_eq_u32 s41,s5
s_cselect_b32 s41,s4,s41
M3 208,12,72,208
R 52,2,53312
M3 212,12,76,212
M3 216,12,80,216
T 104,15,36864
M3 220,12,84,220
s_add_u32 m0,s11,24576
R 56,2,55296
M2 32,16,64,32
M2 36,16,68,36
T 106,15,38400
M2 40,16,72,40
M2 44,16,76,44
L 23,16,42
T 108,16,36864
M2 48,16,80,48
S1 240,27,96,40,0
R 60,2,55360
M2 52,16,84,52
M2 56,20,64,56
T 110,16,38400
M2 60,20,68,60
L1 24,16,42,1024
M2 64,20,72,64
M2 68,20,76,68
M2 72,20,80,72
M2 76,20,84,76
L1 25,16,42,2048
M2 80,24,64,80
M2 84,24,68,84
M2 88,24,72,88
M2 92,24,76,92
s_add_u32 s42,s42,294912
s_cmp_eq_u32 s42,s7
s_cselect_b32 s42,s6,s42
M2 96,24,80,96
M2 100,24,84,100
M2 104,28,64,104
M2 108,28,68,108
M2 112,28,72,112
M2 116,28,76,116
M2 120,28,80,120
s_waitcnt vmcnt(22) lgkmcnt(0)
M2 124,28,84,124
s_barrier
M3 128,32,88,128
s_add_u32 m0,s43,147456
R 0,2,0
S1 244,27,96,40,1024
M3 132,32,92,132
T 64,3,49152
M3 136,32,96,136
L6 22,20,41
T 66,3,50688
M3 140,32,100,140
R 4,2,64
M3 144,32,104,144
M3 148,32,108,148
L7 22,20,41,1024
T 68,4,49152
M3 152,36,88,152
M3 156,36,92,156
R 8,2,2048
M3 160,36,96,160
L7 22,20,41,2048
T 70,4,50688
M3 164,36,100,164
M3 168,36,104,168
T 72,5,49152
M3 172,36,108,172
L7 22,20,41,3072
M3 176,40,88,176
R 12,2,2112
M3 180,40,92,180
S1 248,27,96,40,2048
T 74,5,50688
M3 184,40,96,184
s_add_u32 s41,s41,131072
s_cmp_eq_u32 s41,s5
s_cselect_b32 s41,s4,s41
M3 188,40,100,188
R 16,2,4096
M3 192,40,104,192
M3 196,40,108,196
s_sub_u32 s42,s42,4608
T 76,14,49152
M3 200,44,88,200
T 78,14,50688
M3 204,44,92,204
M3 208,44,96,208
R 20,2,4160
M3 212,44,100,212
s_sub_u32 s6,s6,4608
M3 216,44,104,216
T 80,15,49152
M3 220,44,108,220
R 24,2,6144
M2 32,48,88,32
s_sub_u32 s7,s7,4608
M2 36,48,92,36
T 82,15,50688
M2 40,48,96,40
M2 44,48,100,44
s_add_u32 m0,s11,36864
T 84,16,49152
M2 48,48,104,48
S1 252,27,96,40,3072
R 28,2,6208
M2 52,48,108,52
M2 56,52,88,56
T 86,16,50688
L 23,16,42
M2 60,52,92,60
M2 64,52,96,64
M2 68,52,100,68
L1 24,16,42,1024
M2 72,52,104,72
M2 76,52,108,76
M2 80,56,88,80
L1 25,16,42,2048
M2 84,56,92,84
M2 88,56,96,88
M2 92,56,100,92
s_add_u32 s42,s42,294912
s_cmp_eq_u32 s42,s7
s_cselect_b32 s42,s6,s42
M2 96,56,104,96
M2 100,56,108,100
M2 104,60,88,104
M2 108,60,92,108
M2 112,60,96,112
M2 116,60,100,116
M2 120,60,104,120
s_waitcnt vmcnt(23) lgkmcnt(0)
M2 124,60,108,124
s_barrier
M3 128,0,64,128
s_add_u32 m0,s11,49152
R 32,2,16384
T 88,3,0
M3 132,0,68,132
M3 136,0,72,136
T 90,3,1536
M3 140,0,76,140
L 23,16,42
R 36,2,16448
M3 144,0,80,144
M3 148,0,84,148
T 92,4,0
M3 152,4,64,152
M3 156,4,68,156
L1 24,16,42,1024
R 40,2,18432
M3 160,4,72,160
T 94,4,1536
M3 164,4,76,164
M3 168,4,80,168
T 96,5,0
M3 172,4,84,172
L1 25,16,42,2048
M3 176,8,64,176
R 44,2,18496
M3 180,8,68,180
T 98,5,1536
M3 184,8,72,184
M3 188,8,76,188
s_add_u32 s42,s42,294912
s_cmp_eq_u32 s42,s7
s_cselect_b32 s42,s6,s42
M3 192,8,80,192
R 48,2,20480
M3 196,8,84,196
T 100,14,0
M3 200,12,64,200
T 102,14,1536
M3 204,12,68,204
s_add_u32 m0,s43,98304
M3 208,12,72,208
R 52,2,20544
M3 212,12,76,212
M3 216,12,80,216
T 104,15,0
M3 220,12,84,220
L6 22,20,41
R 56,2,22528
M2 32,16,64,32
M2 36,16,68,36
T 106,15,1536
M2 40,16,72,40
M2 44,16,76,44
L7 22,20,41,1024
T 108,16,0
M2 48,16,80,48
R 60,2,22592
M2 52,16,84,52
M2 56,20,64,56
T 110,16,1536
M2 60,20,68,60
L7 22,20,41,2048
M2 64,20,72,64
M2 68,20,76,68
M2 72,20,80,72
M2 76,20,84,76
L7 22,20,41,3072
M2 80,24,64,80
M2 84,24,68,84
M2 88,24,72,88
M2 92,24,76,92
s_add_u32 s41,s41,131072
s_cmp_eq_u32 s41,s5
s_cselect_b32 s41,s4,s41
M2 96,24,80,96
M2 100,24,84,100
M2 104,28,64,104
M2 108,28,68,108
M2 112,28,72,112
M2 116,28,76,116
M2 120,28,80,120
s_waitcnt vmcnt(21) lgkmcnt(0)
M2 124,28,84,124
s_barrier
M3 128,32,88,128
s_add_u32 m0,s11,0
R 0,2,32768
T 64,3,12288
M3 132,32,92,132
M3 136,32,96,136
T 66,3,13824
M3 140,32,100,140
L 23,16,42
R 4,2,32832
M3 144,32,104,144
M3 148,32,108,148
T 68,4,12288
M3 152,36,88,152
M3 156,36,92,156
L1 24,16,42,1024
R 8,2,34816
M3 160,36,96,160
T 70,4,13824
M3 164,36,100,164
M3 168,36,104,168
T 72,5,12288
M3 172,36,108,172
L1 25,16,42,2048
M3 176,40,88,176
R 12,2,34880
M3 180,40,92,180
T 74,5,13824
M3 184,40,96,184
M3 188,40,100,188
s_add_u32 s42,s42,294912
s_cmp_eq_u32 s42,s7
s_cselect_b32 s42,s6,s42
M3 192,40,104,192
R 16,2,36864
M3 196,40,108,196
T 76,14,12288
M3 200,44,88,200
T 78,14,13824
M3 204,44,92,204
s_add_u32 m0,s43,114688
M3 208,44,96,208
R 20,2,36928
M3 212,44,100,212
M3 216,44,104,216
T 80,15,12288
M3 220,44,108,220
L6 22,20,41
R 24,2,38912
M2 32,48,88,32
M2 36,48,92,36
T 82,15,13824
M2 40,48,96,40
M2 44,48,100,44
L7 22,20,41,1024
T 84,16,12288
M2 48,48,104,48
R 28,2,38976
M2 52,48,108,52
M2 56,52,88,56
T 86,16,13824
M2 60,52,92,60
L7 22,20,41,2048
M2 64,52,96,64
M2 68,52,100,68
M2 72,52,104,72
M2 76,52,108,76
L7 22,20,41,3072
M2 80,56,88,80
M2 84,56,92,84
M2 88,56,96,88
M2 92,56,100,92
s_add_u32 s41,s41,131072
s_cmp_eq_u32 s41,s5
s_cselect_b32 s41,s4,s41
M2 96,56,104,96
M2 100,56,108,100
M2 104,60,88,104
M2 108,60,92,108
M2 112,60,96,112
M2 116,60,100,116
M2 120,60,104,120
s_waitcnt vmcnt(19) lgkmcnt(0)
M2 124,60,108,124
s_barrier
M3 128,0,64,128
s_add_u32 m0,s11,12288
R 32,2,49152
T 88,3,24576
M3 132,0,68,132
M3 136,0,72,136
T 90,3,26112
M3 140,0,76,140
L 23,16,42
R 36,2,49216
M3 144,0,80,144
M3 148,0,84,148
T 92,4,24576
M3 152,4,64,152
M3 156,4,68,156
L1 24,16,42,1024
R 40,2,51200
M3 160,4,72,160
T 94,4,26112
M3 164,4,76,164
M3 168,4,80,168
T 96,5,24576
M3 172,4,84,172
L1 25,16,42,2048
M3 176,8,64,176
R 44,2,51264
M3 180,8,68,180
T 98,5,26112
M3 184,8,72,184
M3 188,8,76,188
s_add_u32 s42,s42,294912
s_cmp_eq_u32 s42,s7
s_cselect_b32 s42,s6,s42
M3 192,8,80,192
R 48,2,53248
M3 196,8,84,196
T 100,14,24576
M3 200,12,64,200
T 102,14,26112
M3 204,12,68,204
s_add_u32 m0,s43,131072
M3 208,12,72,208
R 52,2,53312
M3 212,12,76,212
M3 216,12,80,216
T 104,15,24576
M3 220,12,84,220
L6 22,20,41
R 56,2,55296
M2 32,16,64,32
M2 36,16,68,36
T 106,15,26112
M2 40,16,72,40
M2 44,16,76,44
L7 22,20,41,1024
T 108,16,24576
M2 48,16,80,48
R 60,2,55360
M2 52,16,84,52
M2 56,20,64,56
T 110,16,26112
M2 60,20,68,60
L7 22,20,41,2048
M2 64,20,72,64
M2 68,20,76,68
M2 72,20,80,72
M2 76,20,84,76
L7 22,20,41,3072
M2 80,24,64,80
M2 84,24,68,84
M2 88,24,72,88
M2 92,24,76,92
s_add_u32 s41,s41,131072
s_cmp_eq_u32 s41,s5
s_cselect_b32 s41,s4,s41
M2 96,24,80,96
M2 100,24,84,100
M2 104,28,64,104
M2 108,28,68,108
M2 112,28,72,112
M2 116,28,76,116
M2 120,28,80,120
s_waitcnt lgkmcnt(0)
M2 124,28,84,124
s_barrier
M3 128,32,88,128
s_add_u32 m0,s11,24576
M3 132,32,92,132
M3 136,32,96,136
M3 140,32,100,140
L 23,16,42
M3 144,32,104,144
M3 148,32,108,148
M3 152,36,88,152
M3 156,36,92,156
L1 24,16,42,1024
M3 160,36,96,160
M3 164,36,100,164
M3 168,36,104,168
M3 172,36,108,172
L1 25,16,42,2048
M3 176,40,88,176
M3 180,40,92,180
M3 184,40,96,184
M3 188,40,100,188
M3 192,40,104,192
s_add_u32 s42,s42,294912
s_cmp_eq_u32 s42,s7
s_cselect_b32 s42,s6,s42
M3 196,40,108,196
M3 200,44,88,200
M3 204,44,92,204
M3 208,44,96,208
s_add_u32 m0,s43,147456
M3 212,44,100,212
M3 216,44,104,216
M3 220,44,108,220
M2 32,48,88,32
L6 22,20,41
M2 36,48,92,36
M2 40,48,96,40
M2 44,48,100,44
M2 48,48,104,48
L7 22,20,41,1024
M2 52,48,108,52
M2 56,52,88,56
M2 60,52,92,60
M2 64,52,96,64
M2 68,52,100,68
L7 22,20,41,2048
M2 72,52,104,72
M2 76,52,108,76
M2 80,56,88,80
M2 84,56,92,84
L7 22,20,41,3072
M2 88,56,96,88
M2 92,56,100,92
M2 96,56,104,96
M2 100,56,108,100
s_add_u32 s41,s41,131072
s_cmp_eq_u32 s41,s5
s_cselect_b32 s41,s4,s41
M2 104,60,88,104
M2 108,60,92,108
M2 112,60,96,112
M2 116,60,100,116
M2 120,60,104,120
M2 124,60,108,124
s_branch l12_gpost
spin_lng1:
s_mov_b32 s100,0
spinl_lng1:
s_sleep 4
buffer_load_dword v0,v26,s[92:95],0 offen sc1
s_add_u32 s100,s100,1
s_cmp_ge_u32 s100,16384
s_cbranch_scc1 spinret_lng1
s_waitcnt vmcnt(0)
v_cmp_le_u32 vcc,32,v0
s_nop 3
s_and_b32 s39,vcc_lo,0xff
s_cmp_lg_u32 s39,0xff
s_cbranch_scc1 spinl_lng1
s_branch spinret_lng1
l12_attpost:
s_waitcnt vmcnt(0)
s_cmp_lg_u32 s30,0
s_cbranch_scc1 spinret_kv
v_readfirstlane_b32 s39,v0
s_nop 3
s_cmp_lt_u32 s39,10
s_cbranch_scc1 spin_kv
spinret_kv:
s_barrier
s_lshl_b32 s45,s30,13
v_add_u32 v6,s45,v27
s_lshl_b32 s44,s29,20
s_add_u32 m0,s45,0
s_nop 0
L6 6,12,44
L7 6,12,44,1024
L7 6,12,44,2048
L7 6,12,44,3072
s_add_u32 s44,s44,4096
s_add_u32 m0,s45,4096
s_nop 0
L6 6,12,44
L7 6,12,44,1024
L7 6,12,44,2048
L7 6,12,44,3072
s_add_u32 s44,s44,28672
s_add_u32 m0,s45,32768
s_nop 0
L6 6,12,44
L7 6,12,44,1024
L7 6,12,44,2048
L7 6,12,44,3072
s_add_u32 s44,s44,4096
s_add_u32 m0,s45,36864
s_nop 0
L6 6,12,44
L7 6,12,44,1024
L7 6,12,44,2048
L7 6,12,44,3072
s_add_u32 s44,s44,28672
s_add_u32 m0,s45,65536
s_nop 0
L6 6,12,44
L7 6,12,44,1024
L7 6,12,44,2048
L7 6,12,44,3072
s_add_u32 s44,s44,4096
s_add_u32 m0,s45,69632
s_nop 0
L6 6,12,44
L7 6,12,44,1024
L7 6,12,44,2048
L7 6,12,44,3072
s_add_u32 s44,s44,28672
s_load_dwordx2 s[100:101],s[0:1],64
s_sub_u32 s39,s3,384
s_mul_i32 s39,s39,13312
s_add_u32 s62,s39,13312
s_min_u32 s62,s62,8388608
s_mov_b32 s63,0x00020000
SL 10,7,1
s_waitcnt lgkmcnt(0)
s_mov_b32 s60,s100
s_and_b32 s61,s101,0xffff
buffer_load_dword a210,v10,s[60:63],s39 offen
s_add_u32 s39,s39,8192
buffer_load_dword a211,v10,s[60:63],s39 offen
l12_attq:
s_lshl_b32 s39,s28,3
s_add_u32 s32,s39,s30
s_add_u32 s33,s39,2
s_mov_b32 s34,0x53800000
s_mov_b32 s31,0
s_mov_b32 s37,32768
s_mov_b32 s36,65536
s_mov_b32 s35,98304
V1 4,27
N 8,15,1
v_lshrrev_b32 v9,4,v1
SL 9,2,9
v_cmp_gt_u32 s[46:47],v9,v8
v_add_u32 v9,1,v9
v_cmp_gt_u32 s[48:49],v9,v8
v_add_u32 v9,1,v9
v_cmp_gt_u32 s[50:51],v9,v8
v_add_u32 v9,1,v9
v_cmp_gt_u32 s[52:53],v9,v8
v_add_u32 v9,1,v9
V 8,0.12751743082459868
V 9,0.12751743082459868
PM 32,32,8
PM 34,34,8
C 192,32,33
C 193,34,35
PM 48,48,8
PM 50,50,8
C 194,48,49
C 195,50,51
PM 36,36,8
PM 38,38,8
C 208,36,37
C 209,38,39
PM 52,52,8
PM 54,54,8
C 210,52,53
C 211,54,55
PM 40,40,8
PM 42,42,8
C 224,40,41
C 225,42,43
PM 56,56,8
PM 58,58,8
C 226,56,57
C 227,58,59
PM 44,44,8
PM 46,46,8
C 240,44,45
C 241,46,47
PM 60,60,8
PM 62,62,8
C 242,60,61
C 243,62,63
PM 64,64,8
PM 66,66,8
C 196,64,65
C 197,66,67
PM 80,80,8
PM 82,82,8
C 198,80,81
C 199,82,83
PM 68,68,8
PM 70,70,8
C 212,68,69
C 213,70,71
PM 84,84,8
PM 86,86,8
C 214,84,85
C 215,86,87
PM 72,72,8
PM 74,74,8
C 228,72,73
C 229,74,75
PM 88,88,8
PM 90,90,8
C 230,88,89
C 231,90,91
PM 76,76,8
PM 78,78,8
C 244,76,77
C 245,78,79
PM 92,92,8
PM 94,94,8
C 246,92,93
C 247,94,95
PM 96,96,8
PM 98,98,8
C 200,96,97
C 201,98,99
PM 112,112,8
PM 114,114,8
C 202,112,113
C 203,114,115
PM 100,100,8
PM 102,102,8
C 216,100,101
C 217,102,103
PM 116,116,8
PM 118,118,8
C 218,116,117
C 219,118,119
PM 104,104,8
PM 106,106,8
C 232,104,105
C 233,106,107
PM 120,120,8
PM 122,122,8
C 234,120,121
C 235,122,123
PM 108,108,8
PM 110,110,8
C 248,108,109
C 249,110,111
PM 124,124,8
PM 126,126,8
C 250,124,125
C 251,126,127
AR 12,224
AR 13,225
AR 14,226
AR 15,227
PM 12,12,8
PM 14,14,8
C 204,12,13
C 205,14,15
AR 12,240
AR 13,241
AR 14,242
AR 15,243
PM 12,12,8
PM 14,14,8
C 206,12,13
C 207,14,15
AR 12,228
AR 13,229
AR 14,230
AR 15,231
PM 12,12,8
PM 14,14,8
C 220,12,13
C 221,14,15
AR 12,244
AR 13,245
AR 14,246
AR 15,247
PM 12,12,8
PM 14,14,8
C 222,12,13
C 223,14,15
AR 12,232
AR 13,233
AR 14,234
AR 15,235
PM 12,12,8
PM 14,14,8
C 236,12,13
C 237,14,15
AR 12,248
AR 13,249
AR 14,250
AR 15,251
PM 12,12,8
PM 14,14,8
C 238,12,13
C 239,14,15
AR 12,236
AR 13,237
AR 14,238
AR 15,239
PM 12,12,8
PM 14,14,8
C 252,12,13
C 253,14,15
AR 12,252
AR 13,253
AR 14,254
AR 15,255
PM 12,12,8
PM 14,14,8
C 254,12,13
C 255,14,15
s_waitcnt vmcnt(18)
s_barrier
R 128,4,0
R 144,4,4096
R 132,4,1024
R 148,4,5120
R 136,4,2048
R 152,4,6144
R 140,4,3072
R 156,4,7168
s_waitcnt lgkmcnt(0)
M4 64,128,192,0
M4 68,128,208,0
M4 72,128,224,0
M4 76,128,240,0
M4 80,144,192,0
M4 84,144,208,0
M4 88,144,224,0
M4 92,144,240,0
M5 64,132,196,64
M5 68,132,212,68
M5 72,132,228,72
M5 76,132,244,76
M5 80,148,196,80
M5 84,148,212,84
M5 88,148,228,88
M5 92,148,244,92
M5 64,136,200,64
M5 68,136,216,68
M5 72,136,232,72
M5 76,136,248,76
M5 80,152,200,80
M5 84,152,216,84
M5 88,152,232,88
M5 92,152,248,92
M5 64,140,204,64
M5 68,140,220,68
M5 72,140,236,72
M5 76,140,252,76
M5 80,156,204,80
M5 84,156,220,84
M5 88,156,236,88
M5 92,156,252,92
R 128,4,16384
R 144,4,20480
R 132,4,17408
R 148,4,21504
R 136,4,18432
R 152,4,22528
R 140,4,19456
R 156,4,23552
V 180,0
V 181,0
V 182,0
V 183,0
V 56,0
V 57,0
V 58,0
V 59,0
V 60,0
V 61,0
V 62,0
V 63,0
V 8,0x3f803f80
AW 192,8
AW 193,8
AW 194,8
AW 195,8
s_nop 3
s_cmp_ge_u32 s31,s32
s_cbranch_scc0 att_nomask0
V 21,0xff800000
K1 64,64,21,46
K1 65,65,21,48
K1 66,66,21,50
K1 67,67,21,52
K1 84,84,21,46
K1 85,85,21,48
K1 86,86,21,50
K1 87,87,21,52
V 80,0xff800000
V 81,0xff800000
V 82,0xff800000
V 83,0xff800000
att_nomask0:
v_max3_f32 v8,v64,v65,v66
v_max3_f32 v8,v8,v67,v80
v_max3_f32 v8,v8,v81,v82
v_max_f32 v8,v8,v83
v_max3_f32 v9,v68,v69,v70
v_max3_f32 v9,v9,v71,v84
v_max3_f32 v9,v9,v85,v86
v_max_f32 v9,v9,v87
v_max3_f32 v10,v72,v73,v74
v_max3_f32 v10,v10,v75,v88
v_max3_f32 v10,v10,v89,v90
v_max_f32 v10,v10,v91
v_max3_f32 v11,v76,v77,v78
v_max3_f32 v11,v11,v79,v92
v_max3_f32 v11,v11,v93,v94
v_max_f32 v11,v11,v95
V1 12,8
s_nop 1
v_permlane16_swap_b32 v12,v8
s_nop 1
v_max_f32 v8,v8,v12
V1 12,8
s_nop 1
v_permlane32_swap_b32 v12,v8
s_nop 1
v_max_f32 v8,v8,v12
V1 12,9
s_nop 1
v_permlane16_swap_b32 v12,v9
s_nop 1
v_max_f32 v9,v9,v12
V1 12,9
s_nop 1
v_permlane32_swap_b32 v12,v9
s_nop 1
v_max_f32 v9,v9,v12
V1 12,10
s_nop 1
v_permlane16_swap_b32 v12,v10
s_nop 1
v_max_f32 v10,v10,v12
V1 12,10
s_nop 1
v_permlane32_swap_b32 v12,v10
s_nop 1
v_max_f32 v10,v10,v12
V1 12,11
s_nop 1
v_permlane16_swap_b32 v12,v11
s_nop 1
v_max_f32 v11,v11,v12
V1 12,11
s_nop 1
v_permlane32_swap_b32 v12,v11
s_nop 1
v_max_f32 v11,v11,v12
B 160,0,8
B 161,0,8
B 162,0,8
B 163,0,8
B1 64,64,8
B1 65,65,8
B1 66,66,8
B1 67,67,8
B1 80,80,8
B1 81,81,8
B1 82,82,8
B1 83,83,8
B 164,0,9
B 165,0,9
B 166,0,9
B 167,0,9
B1 68,68,9
B1 69,69,9
B1 70,70,9
B1 71,71,9
B1 84,84,9
B1 85,85,9
B1 86,86,9
B1 87,87,9
B 168,0,10
B 169,0,10
B 170,0,10
B 171,0,10
B1 72,72,10
B1 73,73,10
B1 74,74,10
B1 75,75,10
B1 88,88,10
B1 89,89,10
B1 90,90,10
B1 91,91,10
B 172,0,11
B 173,0,11
B 174,0,11
B 175,0,11
B1 76,76,11
B1 77,77,11
B1 78,78,11
B1 79,79,11
B1 92,92,11
B1 93,93,11
B1 94,94,11
B1 95,95,11
E 8,72
E 9,73
E 10,74
E 11,75
V1 2,3
V1 3,4
s_waitcnt vmcnt(10)
s_waitcnt lgkmcnt(0)
s_barrier
M5 96,128,192,160
C 136,8,9
v_add_u32_e64 v4,s37,v27
C 137,10,11
M5 100,128,208,164
s_mov_b32 s37,s36
E 12,88
M5 104,128,224,168
s_mov_b32 s36,s35
E 13,89
M5 108,128,240,172
s_add_u32 s35,s35,32768
v_exp_f32_e64 v14,v90
C 138,12,13
M5 112,144,192,160
s_cmp_eq_u32 s35,163840
v_exp_f32_e64 v15,v91
M5 116,144,208,164
s_cselect_b32 s35,0,s35
E 16,76
C 139,14,15
M5 120,144,224,168
v_exp_f32_e64 v17,v77
M5 124,144,240,172
v_exp_f32_e64 v18,v78
C 140,16,17
M5 40,192,136,56
v_exp_f32_e64 v19,v79
M5 96,132,196,96
v_exp_f32_e64 v8,v92
C 141,18,19
M5 100,132,212,100
v_exp_f32_e64 v9,v93
M5 104,132,228,104
v_exp_f32_e64 v10,v94
C 142,8,9
M5 108,132,244,108
v_exp_f32_e64 v11,v95
M5 112,148,196,112
v_exp_f32_e64 v12,v64
C 143,10,11
M5 116,148,212,116
E 13,65
A 176,180,12
M5 120,148,228,120
v_exp_f32_e64 v14,v66
C 128,12,13
M5 44,192,140,60
A 176,176,13
E 15,67
M5 124,148,244,124
s_add_u32 m0,s36,s45
A 176,176,14
v_exp_f32_e64 v16,v80
M5 96,136,200,96
C 129,14,15
A 176,176,15
A 176,176,16
M5 100,136,216,100
L6 6,12,44
v_exp_f32_e64 v17,v81
M5 104,136,232,104
v_exp_f32_e64 v18,v82
C 130,16,17
M5 108,136,248,108
A 176,176,17
E 19,83
M5 112,152,200,112
L7 6,12,44,1024
v_add_f32_e64 v176,v176,v18
C 131,18,19
M5 116,152,216,116
E 8,68
A 176,176,19
M5 120,152,232,120
v_max3_f32 v20,v40,v44,v176
v_exp_f32_e64 v9,v69
M5 124,152,248,124
L7 6,12,44,2048
v_add_f32_e64 v177,v181,v8
C 132,8,9
M5 96,140,204,96
E 10,70
A 177,177,9
M5 100,140,220,100
L7 6,12,44,3072
v_exp_f32_e64 v11,v71
M5 104,140,236,104
s_add_u32 s44,s44,4096
A 177,177,10
E 12,84
M5 108,140,252,108
C 133,10,11
A 177,177,11
A 177,177,12
M5 112,156,204,112
v_exp_f32_e64 v13,v85
M5 116,156,220,116
v_exp_f32_e64 v14,v86
C 134,12,13
M5 120,156,236,120
A 177,177,13
E 15,87
M5 124,156,252,124
A 177,177,14
C 135,14,15
A 177,177,15
v_max_f32 v20,v20,v177
v_cmp_lt_f32 vcc,s34,v20
s_cbranch_vccnz fb_i0
fbret_i0:
R 128,4,0
R 144,4,4096
R 132,4,1024
R 148,4,5120
R 136,4,2048
R 152,4,6144
R 140,4,3072
R 156,4,7168
s_waitcnt lgkmcnt(0)
s_add_u32 s31,s31,1
s_cmp_ge_u32 s31,s32
s_cbranch_scc1 mask_i0
maskret_i0:
E 8,104
E 9,105
E 10,106
v_exp_f32_e64 v11,v107
M5 64,128,192,160
s_add_u32 m0,m0,4096
R 160,3,8192
C 152,8,9
M5 68,128,208,164
v_exp_f32_e64 v12,v120
M5 72,128,224,168
R 164,3,9216
C 153,10,11
M5 76,128,240,172
v_exp_f32_e64 v13,v121
M5 80,144,192,160
v_exp_f32_e64 v14,v122
M5 84,144,208,164
R 168,3,10240
C 154,12,13
M5 88,144,224,168
v_exp_f32_e64 v15,v123
M5 92,144,240,172
R 172,3,11264
C 155,14,15
M5 64,132,196,64
v_exp_f32_e64 v16,v108
M5 68,132,212,68
L6 6,12,44
R 176,3,12288
M5 72,132,228,72
v_exp_f32_e64 v17,v109
M5 76,132,244,76
v_exp_f32_e64 v18,v110
M5 80,148,196,80
R 180,3,13312
C 156,16,17
M5 56,192,152,40
v_exp_f32_e64 v19,v111
M5 84,148,212,84
R 184,3,14336
C 157,18,19
M5 88,148,228,88
v_exp_f32_e64 v8,v124
M5 92,148,244,92
R 188,3,15360
M5 64,136,200,64
v_exp_f32_e64 v9,v125
M5 68,136,216,68
L7 6,12,44,1024
C 158,8,9
M5 72,136,232,72
v_exp_f32_e64 v10,v126
M5 76,136,248,76
v_exp_f32_e64 v11,v127
M5 80,152,200,80
C 159,10,11
M5 84,152,216,84
v_exp_f32_e64 v12,v96
M5 88,152,232,88
v_add_f32_e64 v180,v176,v12
M5 92,152,248,92
v_exp_f32_e64 v13,v97
M5 64,140,204,64
C 144,12,13
v_add_f32_e64 v180,v180,v13
M5 68,140,220,68
v_exp_f32_e64 v14,v98
M5 72,140,236,72
L7 6,12,44,2048
v_add_f32_e64 v180,v180,v14
M5 76,140,252,76
v_exp_f32_e64 v15,v99
M5 60,192,156,44
C 145,14,15
v_add_f32_e64 v180,v180,v15
M5 80,156,204,80
v_exp_f32_e64 v16,v112
M5 84,156,220,84
v_add_f32_e64 v180,v180,v16
M5 88,156,236,88
v_exp_f32_e64 v17,v113
M5 92,156,252,92
s_waitcnt lgkmcnt(0)
C 146,16,17
A 180,180,17
M6 0,160,128,0
R 128,4,16384
R 144,4,20480
M6 4,160,132,0
v_exp_f32_e64 v18,v114
M6 8,160,136,0
L7 6,12,44,3072
R 132,4,17408
M6 12,160,140,0
v_exp_f32_e64 v19,v115
M6 16,164,128,0
R 148,4,21504
v_add_f32_e64 v180,v180,v18
M6 20,164,132,0
C 147,18,19
v_add_f32_e64 v180,v180,v19
M6 24,164,136,0
v_max3_f32 v20,v56,v60,v180
M6 28,164,140,0
v_exp_f32_e64 v8,v100
M6 32,168,128,0
s_add_u32 s31,s31,1
R 136,4,18432
A 181,177,8
M6 36,168,132,0
s_cmp_ge_u32 s31,s32
s_cbranch_scc1 mask_i1
maskret_i1:
R 152,4,22528
M6 40,168,136,0
v_exp_f32_e64 v9,v101
M6 44,168,140,0
v_exp_f32_e64 v10,v102
M6 48,172,128,0
s_add_u32 s44,s44,28672
C 148,8,9
v_add_f32_e64 v181,v181,v9
M6 52,172,132,0
v_exp_f32_e64 v11,v103
M6 56,172,136,0
R 140,4,19456
v_add_f32_e64 v181,v181,v10
M6 60,172,140,0
v_exp_f32_e64 v12,v116
M6 64,176,128,0
C 149,10,11
v_add_f32_e64 v181,v181,v11
M6 68,176,132,0
R 156,4,23552
v_add_f32_e64 v181,v181,v12
M6 72,176,136,0
v_exp_f32_e64 v13,v117
M6 76,176,140,0
C 150,12,13
v_add_f32_e64 v181,v181,v13
M6 80,180,128,0
v_exp_f32_e64 v14,v118
M6 84,180,132,0
v_exp_f32_e64 v15,v119
M6 88,180,136,0
v_exp_f32_e64 v8,v72
M6 92,180,140,0
v_exp_f32_e64 v9,v73
M6 96,184,128,0
v_exp_f32_e64 v10,v74
M6 100,184,132,0
v_exp_f32_e64 v11,v75
M6 104,184,136,0
v_add_f32_e64 v181,v181,v14
C 151,14,15
M6 108,184,140,0
A 181,181,15
v_max_f32 v20,v20,v181
M6 112,188,128,0
v_cmp_lt_f32 vcc,s34,v20
V1 2,3
M6 116,188,132,0
v_mov_b32_e64 v3,v4
M6 120,188,136,0
M6 124,188,140,0
s_waitcnt lgkmcnt(0)
s_cbranch_vccnz fb_i1
fbret_i1:
s_branch att_mend
att_m0:
M5 96,128,192,160
s_waitcnt vmcnt(8)
R 160,2,24576
C 136,8,9
M5 100,128,208,164
s_barrier
E 12,88
M5 104,128,224,168
s_cmp_eq_u32 s31,34
s_cbranch_scc1 kvb
kvbret:
C 137,10,11
M5 108,128,240,172
v_exp_f32_e64 v13,v89
M5 112,144,192,160
R 164,2,25600
v_add_u32_e64 v4,s37,v27
M5 116,144,208,164
s_mov_b32 s37,s36
E 14,90
M5 120,144,224,168
s_mov_b32 s36,s35
R 168,2,26624
C 138,12,13
M5 124,144,240,172
s_add_u32 s35,s35,32768
E 15,91
M5 96,132,196,96
s_cmp_eq_u32 s35,163840
R 172,2,27648
C 139,14,15
M5 100,132,212,100
s_cselect_b32 s35,0,s35
E 16,76
M5 104,132,228,104
R 176,2,28672
R 180,2,29696
M5 108,132,244,108
v_exp_f32_e64 v17,v77
M5 112,148,196,112
v_exp_f32_e64 v18,v78
M5 40,192,136,56
R 184,2,30720
C 140,16,17
M5 116,148,212,116
v_exp_f32_e64 v19,v79
M5 120,148,228,120
v_exp_f32_e64 v8,v92
M5 124,148,244,124
R 188,2,31744
C 141,18,19
M5 96,136,200,96
s_add_u32 m0,s36,s45
E 9,93
M5 100,136,216,100
v_exp_f32_e64 v10,v94
M5 104,136,232,104
C 142,8,9
M5 108,136,248,108
v_exp_f32_e64 v11,v95
M5 112,152,200,112
L6 6,12,44
C 143,10,11
M5 116,152,216,116
v_exp_f32_e64 v12,v64
M5 120,152,232,120
v_add_f32_e64 v176,v180,v12
M5 124,152,248,124
v_exp_f32_e64 v13,v65
M5 96,140,204,96
C 128,12,13
v_add_f32_e64 v176,v176,v13
M5 100,140,220,100
v_exp_f32_e64 v14,v66
M5 104,140,236,104
v_add_f32_e64 v176,v176,v14
M5 108,140,252,108
L7 6,12,44,1024
M5 44,192,140,60
v_exp_f32_e64 v15,v67
M5 112,156,204,112
v_exp_f32_e64 v16,v80
M5 116,156,220,116
C 129,14,15
v_add_f32_e64 v176,v176,v15
M5 120,156,236,120
v_exp_f32_e64 v17,v81
M5 124,156,252,124
s_waitcnt lgkmcnt(0)
A 176,176,16
C 130,16,17
M7 0,160,144,0
R 128,4,0
R 144,4,4096
M7 4,160,148,4
L7 6,12,44,2048
v_add_f32_e64 v176,v176,v17
M7 8,160,152,8
v_exp_f32_e64 v18,v82
M7 12,160,156,12
R 132,4,1024
v_add_f32_e64 v176,v176,v18
M7 16,164,144,16
v_exp_f32_e64 v19,v83
M7 20,164,148,20
R 148,4,5120
C 131,18,19
M7 24,164,152,24
v_exp_f32_e64 v8,v68
M7 28,164,156,28
v_add_f32_e64 v176,v176,v19
v_max3_f32 v20,v40,v44,v176
M7 32,168,144,32
s_add_u32 s31,s31,1
R 136,4,2048
L7 6,12,44,3072
M7 36,168,148,36
s_cmp_ge_u32 s31,s32
s_cbranch_scc1 mask_m0
maskret_m0:
A 177,181,8
M7 40,168,152,40
v_exp_f32_e64 v9,v69
M7 44,168,156,44
v_exp_f32_e64 v10,v70
M7 48,172,144,48
C 132,8,9
v_add_f32_e64 v177,v177,v9
M7 52,172,148,52
R 152,4,6144
R 140,4,3072
M7 56,172,152,56
v_exp_f32_e64 v11,v71
M7 60,172,156,60
s_add_u32 s44,s44,4096
v_add_f32_e64 v177,v177,v10
C 133,10,11
M7 64,176,144,64
v_exp_f32_e64 v12,v84
M7 68,176,148,68
R 156,4,7168
v_add_f32_e64 v177,v177,v11
M7 72,176,152,72
v_exp_f32_e64 v13,v85
M7 76,176,156,76
v_add_f32_e64 v177,v177,v12
C 134,12,13
M7 80,180,144,80
v_exp_f32_e64 v14,v86
M7 84,180,148,84
A 177,177,13
A 177,177,14
M7 88,180,152,88
v_exp_f32_e64 v15,v87
M7 92,180,156,92
v_exp_f32_e64 v8,v104
M7 96,184,144,96
v_exp_f32_e64 v9,v105
M7 100,184,148,100
v_exp_f32_e64 v10,v106
M7 104,184,152,104
v_exp_f32_e64 v11,v107
M7 108,184,156,108
C 135,14,15
v_add_f32_e64 v177,v177,v15
M7 112,188,144,112
v_max_f32 v20,v20,v177
v_cmp_lt_f32 vcc,s34,v20
M7 116,188,148,116
M7 120,188,152,120
M7 124,188,156,124
s_waitcnt lgkmcnt(0)
s_cbranch_vccnz fb_m0
fbret_m0:
att_m1:
M5 64,128,192,160
s_add_u32 m0,m0,4096
R 160,3,8192
C 152,8,9
M5 68,128,208,164
v_exp_f32_e64 v12,v120
M5 72,128,224,168
R 164,3,9216
C 153,10,11
M5 76,128,240,172
v_exp_f32_e64 v13,v121
M5 80,144,192,160
v_exp_f32_e64 v14,v122
M5 84,144,208,164
R 168,3,10240
C 154,12,13
M5 88,144,224,168
v_exp_f32_e64 v15,v123
M5 92,144,240,172
R 172,3,11264
C 155,14,15
M5 64,132,196,64
v_exp_f32_e64 v16,v108
M5 68,132,212,68
L6 6,12,44
R 176,3,12288
M5 72,132,228,72
v_exp_f32_e64 v17,v109
M5 76,132,244,76
v_exp_f32_e64 v18,v110
M5 80,148,196,80
R 180,3,13312
C 156,16,17
M5 56,192,152,40
v_exp_f32_e64 v19,v111
M5 84,148,212,84
R 184,3,14336
C 157,18,19
M5 88,148,228,88
v_exp_f32_e64 v8,v124
M5 92,148,244,92
R 188,3,15360
M5 64,136,200,64
v_exp_f32_e64 v9,v125
M5 68,136,216,68
L7 6,12,44,1024
C 158,8,9
M5 72,136,232,72
v_exp_f32_e64 v10,v126
M5 76,136,248,76
v_exp_f32_e64 v11,v127
M5 80,152,200,80
C 159,10,11
M5 84,152,216,84
v_exp_f32_e64 v12,v96
M5 88,152,232,88
v_add_f32_e64 v180,v176,v12
M5 92,152,248,92
v_exp_f32_e64 v13,v97
M5 64,140,204,64
C 144,12,13
v_add_f32_e64 v180,v180,v13
M5 68,140,220,68
v_exp_f32_e64 v14,v98
M5 72,140,236,72
L7 6,12,44,2048
v_add_f32_e64 v180,v180,v14
M5 76,140,252,76
v_exp_f32_e64 v15,v99
M5 60,192,156,44
C 145,14,15
v_add_f32_e64 v180,v180,v15
M5 80,156,204,80
v_exp_f32_e64 v16,v112
M5 84,156,220,84
v_add_f32_e64 v180,v180,v16
M5 88,156,236,88
v_exp_f32_e64 v17,v113
M5 92,156,252,92
s_waitcnt lgkmcnt(0)
C 146,16,17
A 180,180,17
M7 0,160,128,0
R 128,4,16384
R 144,4,20480
M7 4,160,132,4
v_exp_f32_e64 v18,v114
M7 8,160,136,8
L7 6,12,44,3072
R 132,4,17408
M7 12,160,140,12
v_exp_f32_e64 v19,v115
M7 16,164,128,16
R 148,4,21504
v_add_f32_e64 v180,v180,v18
M7 20,164,132,20
C 147,18,19
v_add_f32_e64 v180,v180,v19
M7 24,164,136,24
v_max3_f32 v20,v56,v60,v180
M7 28,164,140,28
v_exp_f32_e64 v8,v100
M7 32,168,128,32
s_add_u32 s31,s31,1
R 136,4,18432
A 181,177,8
M7 36,168,132,36
s_cmp_ge_u32 s31,s32
s_cbranch_scc1 mask_m1
maskret_m1:
R 152,4,22528
M7 40,168,136,40
v_exp_f32_e64 v9,v101
M7 44,168,140,44
v_exp_f32_e64 v10,v102
M7 48,172,128,48
s_add_u32 s44,s44,28672
C 148,8,9
v_add_f32_e64 v181,v181,v9
M7 52,172,132,52
v_exp_f32_e64 v11,v103
M7 56,172,136,56
R 140,4,19456
v_add_f32_e64 v181,v181,v10
M7 60,172,140,60
v_exp_f32_e64 v12,v116
M7 64,176,128,64
C 149,10,11
v_add_f32_e64 v181,v181,v11
M7 68,176,132,68
R 156,4,23552
v_add_f32_e64 v181,v181,v12
M7 72,176,136,72
v_exp_f32_e64 v13,v117
M7 76,176,140,76
C 150,12,13
v_add_f32_e64 v181,v181,v13
M7 80,180,128,80
v_exp_f32_e64 v14,v118
M7 84,180,132,84
v_exp_f32_e64 v15,v119
M7 88,180,136,88
v_exp_f32_e64 v8,v72
M7 92,180,140,92
v_exp_f32_e64 v9,v73
M7 96,184,128,96
v_exp_f32_e64 v10,v74
M7 100,184,132,100
v_exp_f32_e64 v11,v75
M7 104,184,136,104
v_add_f32_e64 v181,v181,v14
C 151,14,15
M7 108,184,140,108
A 181,181,15
v_max_f32 v20,v20,v181
M7 112,188,128,112
v_cmp_lt_f32 vcc,s34,v20
V1 2,3
M7 116,188,132,116
v_mov_b32_e64 v3,v4
M7 120,188,136,120
M7 124,188,140,124
s_waitcnt lgkmcnt(0)
s_cbranch_vccnz fb_m1
fbret_m1:
att_mend:
s_cmp_lt_u32 s31,s33
s_cbranch_scc1 att_m0
s_waitcnt vmcnt(0)
s_barrier
s_cmp_lt_i32 s10,0
s_cbranch_scc1 l12_nopf
s_load_dwordx2 s[60:61],s[0:1],40
s_load_dwordx2 s[100:101],s[0:1],80
v_lshlrev_b32_e64 v184,7,v1
s_mov_b32 s63,0x00020000
s_sub_u32 s40,s3,640
s_mul_i32 s39,s40,12288
s_add_u32 s62,s39,12288
s_waitcnt lgkmcnt(0)
s_and_b32 s61,s61,0xffff
buffer_load_dword a210,v184,s[60:63],s39 offen
s_add_u32 s39,s39,8192
buffer_load_dword a211,v184,s[60:63],s39 offen
s_mul_i32 s39,s40,6912
s_add_u32 s62,s39,6912
s_mov_b32 s60,s100
s_and_b32 s61,s101,0xffff
buffer_load_dword a212,v184,s[60:63],s39 offen
l12_nopf:
s_mov_b32 s56,s30
s_lshl_b32 s57,s30,1
s_sub_i32 s57,5,s57
att_d0:
s_cmp_eq_u32 s56,0
s_cbranch_scc1 att_nb0
s_sub_u32 s56,s56,1
M5 96,128,192,160
R 160,2,24576
C 136,8,9
M5 100,128,208,164
v_add_u32_e64 v4,s37,v27
C 137,10,11
M5 104,128,224,168
s_mov_b32 s37,s36
E 12,88
M5 108,128,240,172
s_mov_b32 s36,s35
E 13,89
M5 112,144,192,160
s_add_u32 s35,s35,32768
R 164,2,25600
C 138,12,13
M5 116,144,208,164
s_cmp_eq_u32 s35,163840
v_exp_f32_e64 v14,v90
M5 120,144,224,168
s_cselect_b32 s35,0,s35
R 168,2,26624
R 172,2,27648
M5 124,144,240,172
E 15,91
M5 96,132,196,96
v_exp_f32_e64 v16,v76
M5 100,132,212,100
R 176,2,28672
C 139,14,15
M5 104,132,228,104
v_exp_f32_e64 v17,v77
M5 108,132,244,108
v_exp_f32_e64 v18,v78
M5 112,148,196,112
R 180,2,29696
C 140,16,17
M5 40,192,136,56
v_exp_f32_e64 v19,v79
M5 116,148,212,116
R 184,2,30720
C 141,18,19
M5 120,148,228,120
v_exp_f32_e64 v8,v92
M5 124,148,244,124
R 188,2,31744
M5 96,136,200,96
v_exp_f32_e64 v9,v93
M5 100,136,216,100
v_exp_f32_e64 v10,v94
M5 104,136,232,104
C 142,8,9
M5 108,136,248,108
v_exp_f32_e64 v11,v95
M5 112,152,200,112
C 143,10,11
M5 116,152,216,116
v_exp_f32_e64 v12,v64
M5 120,152,232,120
v_add_f32_e64 v176,v180,v12
M5 124,152,248,124
v_exp_f32_e64 v13,v65
M5 96,140,204,96
C 128,12,13
v_add_f32_e64 v176,v176,v13
M5 100,140,220,100
v_exp_f32_e64 v14,v66
M5 104,140,236,104
v_add_f32_e64 v176,v176,v14
M5 108,140,252,108
v_exp_f32_e64 v15,v67
M5 44,192,140,60
C 129,14,15
v_add_f32_e64 v176,v176,v15
M5 112,156,204,112
v_exp_f32_e64 v16,v80
M5 116,156,220,116
v_add_f32_e64 v176,v176,v16
M5 120,156,236,120
v_exp_f32_e64 v17,v81
M5 124,156,252,124
s_waitcnt lgkmcnt(0)
C 130,16,17
A 176,176,17
M7 0,160,144,0
R 128,4,0
R 144,4,4096
M7 4,160,148,4
v_exp_f32_e64 v18,v82
M7 8,160,152,8
R 132,4,1024
v_add_f32_e64 v176,v176,v18
M7 12,160,156,12
v_exp_f32_e64 v19,v83
M7 16,164,144,16
R 148,4,5120
C 131,18,19
M7 20,164,148,20
v_exp_f32_e64 v8,v68
M7 24,164,152,24
v_add_f32_e64 v176,v176,v19
v_max3_f32 v20,v40,v44,v176
M7 28,164,156,28
R 136,4,2048
v_add_f32_e64 v177,v181,v8
M7 32,168,144,32
s_add_u32 s31,s31,1
E 9,69
M7 36,168,148,36
s_cmp_ge_u32 s31,s32
s_cbranch_scc1 mask_b0
maskret_b0:
C 132,8,9
M7 40,168,152,40
v_exp_f32_e64 v10,v70
M7 44,168,156,44
R 152,4,6144
v_add_f32_e64 v177,v177,v9
M7 48,172,144,48
v_exp_f32_e64 v11,v71
M7 52,172,148,52
R 140,4,3072
v_add_f32_e64 v177,v177,v10
M7 56,172,152,56
v_exp_f32_e64 v12,v84
M7 60,172,156,60
C 133,10,11
v_add_f32_e64 v177,v177,v11
M7 64,176,144,64
R 156,4,7168
v_add_f32_e64 v177,v177,v12
M7 68,176,148,68
v_exp_f32_e64 v13,v85
M7 72,176,152,72
C 134,12,13
v_add_f32_e64 v177,v177,v13
M7 76,176,156,76
v_exp_f32_e64 v14,v86
M7 80,180,144,80
v_exp_f32_e64 v15,v87
M7 84,180,148,84
v_exp_f32_e64 v8,v104
M7 88,180,152,88
v_exp_f32_e64 v9,v105
M7 92,180,156,92
v_exp_f32_e64 v10,v106
M7 96,184,144,96
v_exp_f32_e64 v11,v107
M7 100,184,148,100
v_add_f32_e64 v177,v177,v14
C 135,14,15
M7 104,184,152,104
A 177,177,15
v_max_f32 v20,v20,v177
M7 108,184,156,108
v_cmp_lt_f32 vcc,s34,v20
M7 112,188,144,112
M7 116,188,148,116
M7 120,188,152,120
M7 124,188,156,124
s_waitcnt lgkmcnt(0)
s_cbranch_vccnz fb_b0
fbret_b0:
s_branch att_d1
att_nb0:
s_cmp_lt_i32 s57,0
s_cbranch_scc1 att_t2_0
s_cmp_eq_u32 s57,0
s_cbranch_scc1 att_t1_0
s_sub_u32 s57,s57,1
M5 104,128,224,168
R 160,2,24576
C 136,8,9
M5 108,128,240,172
v_add_u32 v4,s37,v27
C 137,10,11
M5 120,144,224,168
s_mov_b32 s37,s36
E 12,88
M5 124,144,240,172
s_mov_b32 s36,s35
R 164,2,25600
R 168,2,26624
M5 104,132,228,104
s_add_u32 s35,s35,32768
E 13,89
M5 108,132,244,108
s_cmp_eq_u32 s35,163840
R 172,2,27648
C 138,12,13
M5 120,148,228,120
s_cselect_b32 s35,0,s35
E 14,90
M5 124,148,244,124
R 176,2,28672
R 180,2,29696
M5 104,136,232,104
v_exp_f32_e64 v15,v91
M5 108,136,248,108
R 184,2,30720
C 139,14,15
M5 120,152,232,120
v_exp_f32_e64 v16,v76
M5 124,152,248,124
R 188,2,31744
M5 104,140,236,104
v_exp_f32_e64 v17,v77
M5 40,192,136,56
v_exp_f32_e64 v18,v78
M5 108,140,252,108
C 140,16,17
M5 120,156,236,120
v_exp_f32_e64 v19,v79
M5 124,156,252,124
s_waitcnt lgkmcnt(0)
E 8,92
M7 8,160,152,8
R 128,4,0
C 141,18,19
M7 12,160,156,12
v_exp_f32_e64 v9,v93
M7 24,164,152,24
R 144,4,4096
C 142,8,9
M7 28,164,156,28
v_exp_f32_e64 v10,v94
M7 40,168,152,40
R 132,4,1024
R 148,4,5120
M7 44,168,156,44
v_exp_f32_e64 v11,v95
M7 56,172,152,56
R 136,4,2048
C 143,10,11
M7 60,172,156,60
R 152,4,6144
R 140,4,3072
M7 72,176,152,72
R 156,4,7168
M7 76,176,156,76
s_cmp_eq_u32 s57,0
s_cbranch_scc1 mask_s0
maskret_s0:
M5 44,192,140,60
v_exp_f32_e64 v8,v104
M7 88,180,152,88
v_exp_f32_e64 v9,v105
M7 92,180,156,92
v_exp_f32_e64 v10,v106
M7 104,184,152,104
v_exp_f32_e64 v11,v107
M7 108,184,156,108
v_max_f32 v20,v40,v44
v_cmp_lt_f32 vcc,s34,v20
M7 120,188,152,120
M7 124,188,156,124
s_waitcnt lgkmcnt(0)
s_cbranch_vccnz fb_s0
fbret_s0:
s_branch att_nb1
att_t1_0:
R 160,2,24576
R 164,2,25600
R 168,2,26624
R 172,2,27648
R 176,2,28672
R 180,2,29696
R 184,2,30720
R 188,2,31744
s_waitcnt lgkmcnt(0)
M7 8,160,152,8
C 136,8,9
v_add_u32_e64 v4,s37,v27
M7 12,160,156,12
s_mov_b32 s37,s36
E 12,88
M7 24,164,152,24
s_mov_b32 s36,s35
C 137,10,11
M7 28,164,156,28
s_add_u32 s35,s35,32768
E 13,89
M7 40,168,152,40
s_cmp_eq_u32 s35,163840
v_exp_f32_e64 v14,v90
M7 44,168,156,44
s_cselect_b32 s35,0,s35
C 138,12,13
M7 56,172,152,56
E 15,91
M7 60,172,156,60
v_exp_f32_e64 v16,v76
C 139,14,15
M7 72,176,152,72
v_exp_f32_e64 v17,v77
M7 76,176,156,76
v_exp_f32_e64 v18,v78
M7 88,180,152,88
C 140,16,17
s_nop 0
E 19,79
M7 92,180,156,92
v_exp_f32_e64 v8,v92
C 141,18,19
M7 104,184,152,104
v_exp_f32_e64 v9,v93
M7 108,184,156,108
v_exp_f32_e64 v10,v94
M7 120,188,152,120
C 142,8,9
M7 124,188,156,124
v_exp_f32_e64 v11,v95
s_nop 0
C 143,10,11
s_nop 1
M5 40,192,136,56
M5 44,192,140,60
s_nop 7
v_max_f32 v20,v40,v44
v_cmp_lt_f32 vcc,s34,v20
s_cbranch_vccnz fb_t0
fbret_t0:
s_branch att_t2_1
att_d1:
s_cmp_eq_u32 s56,0
s_cbranch_scc1 att_nb1
s_sub_u32 s56,s56,1
M5 64,128,192,160
R 160,3,8192
C 152,8,9
M5 68,128,208,164
v_exp_f32_e64 v12,v120
M5 72,128,224,168
R 164,3,9216
C 153,10,11
M5 76,128,240,172
v_exp_f32_e64 v13,v121
M5 80,144,192,160
v_exp_f32_e64 v14,v122
M5 84,144,208,164
R 168,3,10240
C 154,12,13
M5 88,144,224,168
v_exp_f32_e64 v15,v123
M5 92,144,240,172
R 172,3,11264
C 155,14,15
M5 64,132,196,64
v_exp_f32_e64 v16,v108
M5 68,132,212,68
R 176,3,12288
M5 72,132,228,72
v_exp_f32_e64 v17,v109
M5 76,132,244,76
v_exp_f32_e64 v18,v110
M5 80,148,196,80
R 180,3,13312
C 156,16,17
M5 56,192,152,40
v_exp_f32_e64 v19,v111
M5 84,148,212,84
R 184,3,14336
C 157,18,19
M5 88,148,228,88
v_exp_f32_e64 v8,v124
M5 92,148,244,92
R 188,3,15360
M5 64,136,200,64
v_exp_f32_e64 v9,v125
M5 68,136,216,68
v_exp_f32_e64 v10,v126
M5 72,136,232,72
C 158,8,9
M5 76,136,248,76
v_exp_f32_e64 v11,v127
M5 80,152,200,80
C 159,10,11
M5 84,152,216,84
v_exp_f32_e64 v12,v96
M5 88,152,232,88
v_add_f32_e64 v180,v176,v12
M5 92,152,248,92
v_exp_f32_e64 v13,v97
M5 64,140,204,64
C 144,12,13
v_add_f32_e64 v180,v180,v13
M5 68,140,220,68
v_exp_f32_e64 v14,v98
M5 72,140,236,72
v_add_f32_e64 v180,v180,v14
M5 76,140,252,76
v_exp_f32_e64 v15,v99
M5 60,192,156,44
C 145,14,15
v_add_f32_e64 v180,v180,v15
M5 80,156,204,80
v_exp_f32_e64 v16,v112
M5 84,156,220,84
v_add_f32_e64 v180,v180,v16
M5 88,156,236,88
v_exp_f32_e64 v17,v113
M5 92,156,252,92
s_waitcnt lgkmcnt(0)
C 146,16,17
A 180,180,17
M7 0,160,128,0
R 128,4,16384
R 144,4,20480
M7 4,160,132,4
v_exp_f32_e64 v18,v114
M7 8,160,136,8
R 132,4,17408
v_add_f32_e64 v180,v180,v18
M7 12,160,140,12
v_exp_f32_e64 v19,v115
M7 16,164,128,16
R 148,4,21504
C 147,18,19
M7 20,164,132,20
v_exp_f32_e64 v8,v100
M7 24,164,136,24
v_add_f32_e64 v180,v180,v19
v_max3_f32 v20,v56,v60,v180
M7 28,164,140,28
R 136,4,18432
v_add_f32_e64 v181,v177,v8
M7 32,168,128,32
s_add_u32 s31,s31,1
E 9,101
M7 36,168,132,36
s_cmp_ge_u32 s31,s32
s_cbranch_scc1 mask_b1
maskret_b1:
C 148,8,9
M7 40,168,136,40
v_exp_f32_e64 v10,v102
M7 44,168,140,44
R 152,4,22528
v_add_f32_e64 v181,v181,v9
M7 48,172,128,48
v_exp_f32_e64 v11,v103
M7 52,172,132,52
R 140,4,19456
v_add_f32_e64 v181,v181,v10
M7 56,172,136,56
v_exp_f32_e64 v12,v116
M7 60,172,140,60
C 149,10,11
v_add_f32_e64 v181,v181,v11
M7 64,176,128,64
R 156,4,23552
v_add_f32_e64 v181,v181,v12
M7 68,176,132,68
v_exp_f32_e64 v13,v117
M7 72,176,136,72
C 150,12,13
v_add_f32_e64 v181,v181,v13
M7 76,176,140,76
v_exp_f32_e64 v14,v118
M7 80,180,128,80
v_exp_f32_e64 v15,v119
M7 84,180,132,84
v_exp_f32_e64 v8,v72
M7 88,180,136,88
v_exp_f32_e64 v9,v73
M7 92,180,140,92
v_exp_f32_e64 v10,v74
M7 96,184,128,96
v_exp_f32_e64 v11,v75
M7 100,184,132,100
v_add_f32_e64 v181,v181,v14
C 151,14,15
M7 104,184,136,104
A 181,181,15
v_max_f32 v20,v20,v181
M7 108,184,140,108
v_cmp_lt_f32 vcc,s34,v20
V1 2,3
M7 112,188,128,112
v_mov_b32_e64 v3,v4
M7 116,188,132,116
M7 120,188,136,120
M7 124,188,140,124
s_waitcnt lgkmcnt(0)
s_cbranch_vccnz fb_b1
fbret_b1:
s_branch att_d0
att_nb1:
s_cmp_lt_i32 s57,0
s_cbranch_scc1 att_t2_1
s_cmp_eq_u32 s57,0
s_cbranch_scc1 att_t1_1
s_sub_u32 s57,s57,1
M5 72,128,224,168
R 160,3,8192
C 152,8,9
M5 76,128,240,172
v_exp_f32_e64 v12,v120
M5 88,144,224,168
R 164,3,9216
C 153,10,11
M5 92,144,240,172
v_exp_f32_e64 v13,v121
M5 72,132,228,72
R 168,3,10240
R 172,3,11264
M5 76,132,244,76
v_exp_f32_e64 v14,v122
M5 88,148,228,88
R 176,3,12288
C 154,12,13
M5 92,148,244,92
v_exp_f32_e64 v15,v123
M5 72,136,232,72
R 180,3,13312
R 184,3,14336
M5 76,136,248,76
v_exp_f32_e64 v16,v108
M5 88,152,232,88
R 188,3,15360
C 155,14,15
M5 92,152,248,92
v_exp_f32_e64 v17,v109
M5 72,140,236,72
v_exp_f32_e64 v18,v110
M5 56,192,152,40
C 156,16,17
M5 76,140,252,76
v_exp_f32_e64 v19,v111
M5 88,156,236,88
v_exp_f32_e64 v8,v124
M5 92,156,252,92
s_waitcnt lgkmcnt(0)
C 157,18,19
M7 8,160,136,8
R 128,4,16384
R 144,4,20480
M7 12,160,140,12
E 9,125
M7 24,164,136,24
v_exp_f32_e64 v10,v126
M7 28,164,140,28
R 132,4,17408
C 158,8,9
M7 40,168,136,40
R 148,4,21504
R 136,4,18432
M7 44,168,140,44
v_exp_f32_e64 v11,v127
M7 56,172,136,56
R 152,4,22528
C 159,10,11
M7 60,172,140,60
R 140,4,19456
R 156,4,23552
M7 72,176,136,72
M7 76,176,140,76
s_cmp_eq_u32 s57,0
s_cbranch_scc1 mask_s1
maskret_s1:
M5 60,192,156,44
v_exp_f32_e64 v8,v72
M7 88,180,136,88
V1 2,3
V1 3,4
M7 92,180,140,92
v_exp_f32_e64 v9,v73
M7 104,184,136,104
v_exp_f32_e64 v10,v74
M7 108,184,140,108
v_max_f32 v20,v56,v60
v_cmp_lt_f32 vcc,s34,v20
M7 120,188,136,120
v_exp_f32_e64 v11,v75
M7 124,188,140,124
s_waitcnt lgkmcnt(0)
s_cbranch_vccnz fb_s1
fbret_s1:
s_branch att_nb0
att_t1_1:
R 160,3,8192
R 164,3,9216
R 168,3,10240
R 172,3,11264
R 176,3,12288
R 180,3,13312
R 184,3,14336
R 188,3,15360
s_waitcnt lgkmcnt(0)
M7 8,160,136,8
C 152,8,9
C 153,10,11
M7 12,160,140,12
v_exp_f32_e64 v12,v120
M7 24,164,136,24
v_exp_f32_e64 v13,v121
M7 28,164,140,28
v_exp_f32_e64 v14,v122
M7 40,168,136,40
C 154,12,13
M7 44,168,140,44
v_exp_f32_e64 v15,v123
M7 56,172,136,56
v_exp_f32_e64 v16,v108
C 155,14,15
M7 60,172,140,60
v_exp_f32_e64 v17,v109
M7 72,176,136,72
v_exp_f32_e64 v18,v110
M7 76,176,140,76
C 156,16,17
M7 88,180,136,88
E 19,111
s_nop 0
v_exp_f32_e64 v8,v124
C 157,18,19
M7 92,180,140,92
v_exp_f32_e64 v9,v125
M7 104,184,136,104
v_exp_f32_e64 v10,v126
M7 108,184,140,108
C 158,8,9
v_mov_b32_e64 v2,v3
M7 120,188,136,120
v_mov_b32_e64 v3,v4
M7 124,188,140,124
v_exp_f32_e64 v11,v127
s_nop 0
C 159,10,11
s_nop 1
M5 56,192,152,40
M5 60,192,156,44
s_nop 7
v_max_f32 v20,v56,v60
v_cmp_lt_f32 vcc,s34,v20
s_cbranch_vccnz fb_t1
fbret_t1:
s_branch att_t2_0
att_t2_0:
R 160,2,24576
R 164,2,25600
R 168,2,26624
R 172,2,27648
R 176,2,28672
R 180,2,29696
R 184,2,30720
R 188,2,31744
s_waitcnt lgkmcnt(0)
M7 8,160,152,8
v_add_u32_e64 v4,s37,v27
M7 12,160,156,12
s_mov_b32 s37,s36
M7 24,164,152,24
s_mov_b32 s36,s35
M7 28,164,156,28
s_add_u32 s35,s35,32768
M7 40,168,152,40
s_cmp_eq_u32 s35,163840
M7 44,168,156,44
s_cselect_b32 s35,0,s35
M7 56,172,152,56
M7 60,172,156,60
M7 72,176,152,72
M7 76,176,156,76
M7 88,180,152,88
M7 92,180,156,92
M7 104,184,152,104
M7 108,184,156,108
M7 120,188,152,120
M7 124,188,156,124
V1 40,56
v_mov_b32_e64 v44,v60
s_branch att_epi
att_t2_1:
R 160,3,8192
R 164,3,9216
R 168,3,10240
R 172,3,11264
R 176,3,12288
R 180,3,13312
R 184,3,14336
R 188,3,15360
s_waitcnt lgkmcnt(0)
M7 8,160,136,8
M7 12,160,140,12
M7 24,164,136,24
M7 28,164,140,28
M7 40,168,136,40
M7 44,168,140,44
M7 56,172,136,56
M7 60,172,140,60
M7 72,176,136,72
M7 76,176,140,76
M7 88,180,136,88
V1 2,3
V1 3,4
M7 92,180,140,92
M7 104,184,136,104
M7 108,184,140,108
M7 120,188,136,120
M7 124,188,140,124
att_epi:
V1 24,30
V1 25,31
s_mov_b32 s59,s10
s_cmp_lt_i32 s10,0
s_cbranch_scc1 l12_lasttask
s_lshl_b32 s60,s28,8
s_add_u32 s60,s60,9216
s_mov_b32 s28,s10
s_mov_b32 s10,-1
V 29,1073741824
s_lshl_b32 s41,s29,8
s_mov_b32 s42,0
s_lshl_b32 s39,s28,3
s_add_u32 s39,s39,s30
s_lshl_b32 s39,s39,11
v_add_u32 v30,s39,v27
s_lshl_b32 s39,s28,3
s_add_u32 s39,s39,7
s_sub_u32 s39,s39,s30
s_lshl_b32 s39,s39,11
v_add_u32 v31,s39,v27
AR 2,196
AR 3,197
AR 4,198
AR 5,199
AR 14,200
AR 15,201
AR 16,202
AR 17,203
s_barrier
s_add_u32 m0,s43,98304
s_nop 0
L 22,16,41
L1 23,16,41,1024
s_add_u32 s41,s41,262144
L4 128,30,20,42
L5 132,30,20,42,1024
L4 136,31,20,42
L5 140,31,20,42,1024
s_add_u32 s42,s42,131072
s_add_u32 m0,s43,106496
s_nop 0
L 22,16,41
L1 23,16,41,1024
s_add_u32 s41,s41,262144
s_add_u32 m0,s43,114688
s_nop 0
L 22,16,41
L1 23,16,41,1024
s_add_u32 s41,s41,262144
L4 144,30,20,42
L5 148,30,20,42,1024
L4 152,31,20,42
L5 156,31,20,42,1024
s_add_u32 s42,s42,131072
s_add_u32 m0,s43,122880
s_nop 0
L 22,16,41
L1 23,16,41,1024
s_add_u32 s41,s41,262144
L4 160,30,20,42
L5 164,30,20,42,1024
L4 168,31,20,42
L5 172,31,20,42,1024
s_add_u32 s42,s42,131072
L4 176,30,20,42
L5 180,30,20,42,1024
L4 184,31,20,42
L5 188,31,20,42,1024
s_add_u32 s42,s42,131072
l12_nosec:
V1 8,176
s_nop 1
v_permlane16_swap_b32 v8,v176
s_nop 1
A 176,176,8
V1 8,176
s_nop 1
v_permlane32_swap_b32 v8,v176
s_nop 1
A 176,176,8
RC 176,176
V1 8,177
s_nop 1
v_permlane16_swap_b32 v8,v177
s_nop 1
A 177,177,8
V1 8,177
s_nop 1
v_permlane32_swap_b32 v8,v177
s_nop 1
A 177,177,8
RC 177,177
RC 178,40
RC 179,44
s_nop 7
s_lshl_b32 s39,s29,19
V1 112,176
V1 113,176
V1 114,177
V1 115,177
V1 116,178
V1 117,178
V1 118,179
V1 119,179
AR 96,0
AR 97,1
AR 98,2
AR 99,3
AR 100,16
AR 101,17
AR 102,18
AR 103,19
PM 96,96,112
PM 98,98,112
PM 100,100,112
PM 102,102,112
C 64,96,97
C 65,98,99
C 66,100,101
C 67,102,103
S 64,24,24,39
AR 104,4
AR 105,5
AR 106,6
AR 107,7
AR 108,20
AR 109,21
AR 110,22
AR 111,23
PM 104,104,114
PM 106,106,114
PM 108,108,114
PM 110,110,114
C 68,104,105
C 69,106,107
C 70,108,109
C 71,110,111
S1 68,24,24,39,1024
AR 96,8
AR 97,9
AR 98,10
AR 99,11
AR 100,24
AR 101,25
AR 102,26
AR 103,27
PM 96,96,116
PM 98,98,116
PM 100,100,116
PM 102,102,116
C 72,96,97
C 73,98,99
C 74,100,101
C 75,102,103
S 72,25,24,39
AR 104,12
AR 105,13
AR 106,14
AR 107,15
AR 108,28
AR 109,29
AR 110,30
AR 111,31
PM 104,104,118
PM 106,106,118
PM 108,108,118
PM 110,110,118
C 76,104,105
C 77,106,107
C 78,108,109
C 79,110,111
S1 76,25,24,39,1024
s_add_u32 s39,s39,131072
AR 96,32
AR 97,33
AR 98,34
AR 99,35
AR 100,48
AR 101,49
AR 102,50
AR 103,51
PM 96,96,112
PM 98,98,112
PM 100,100,112
PM 102,102,112
C 64,96,97
C 65,98,99
C 66,100,101
C 67,102,103
S 64,24,24,39
AR 104,36
AR 105,37
AR 106,38
AR 107,39
AR 108,52
AR 109,53
AR 110,54
AR 111,55
PM 104,104,114
PM 106,106,114
PM 108,108,114
PM 110,110,114
C 68,104,105
C 69,106,107
C 70,108,109
C 71,110,111
S1 68,24,24,39,1024
AR 96,40
AR 97,41
AR 98,42
AR 99,43
AR 100,56
AR 101,57
AR 102,58
AR 103,59
PM 96,96,116
PM 98,98,116
PM 100,100,116
PM 102,102,116
C 72,96,97
C 73,98,99
C 74,100,101
C 75,102,103
S 72,25,24,39
AR 104,44
AR 105,45
AR 106,46
AR 107,47
AR 108,60
AR 109,61
AR 110,62
AR 111,63
PM 104,104,118
PM 106,106,118
PM 108,108,118
PM 110,110,118
C 76,104,105
C 77,106,107
C 78,108,109
C 79,110,111
S1 76,25,24,39,1024
s_add_u32 s39,s39,131072
AR 96,64
AR 97,65
AR 98,66
AR 99,67
AR 100,80
AR 101,81
AR 102,82
AR 103,83
PM 96,96,112
PM 98,98,112
PM 100,100,112
PM 102,102,112
C 64,96,97
C 65,98,99
C 66,100,101
C 67,102,103
S 64,24,24,39
AR 104,68
AR 105,69
AR 106,70
AR 107,71
AR 108,84
AR 109,85
AR 110,86
AR 111,87
PM 104,104,114
PM 106,106,114
PM 108,108,114
PM 110,110,114
C 68,104,105
C 69,106,107
C 70,108,109
C 71,110,111
S1 68,24,24,39,1024
AR 96,72
AR 97,73
AR 98,74
AR 99,75
AR 100,88
AR 101,89
AR 102,90
AR 103,91
PM 96,96,116
PM 98,98,116
PM 100,100,116
PM 102,102,116
C 72,96,97
C 73,98,99
C 74,100,101
C 75,102,103
S 72,25,24,39
AR 104,76
AR 105,77
AR 106,78
AR 107,79
AR 108,92
AR 109,93
AR 110,94
AR 111,95
PM 104,104,118
PM 106,106,118
PM 108,108,118
PM 110,110,118
C 76,104,105
C 77,106,107
C 78,108,109
C 79,110,111
S1 76,25,24,39,1024
s_add_u32 s39,s39,131072
AR 96,96
AR 97,97
AR 98,98
AR 99,99
AR 100,112
AR 101,113
AR 102,114
AR 103,115
PM 96,96,112
PM 98,98,112
PM 100,100,112
PM 102,102,112
C 64,96,97
C 65,98,99
C 66,100,101
C 67,102,103
S 64,24,24,39
AR 104,100
AR 105,101
AR 106,102
AR 107,103
AR 108,116
AR 109,117
AR 110,118
AR 111,119
PM 104,104,114
PM 106,106,114
PM 108,108,114
PM 110,110,114
C 68,104,105
C 69,106,107
C 70,108,109
C 71,110,111
S1 68,24,24,39,1024
AR 96,104
AR 97,105
AR 98,106
AR 99,107
AR 100,120
AR 101,121
AR 102,122
AR 103,123
PM 96,96,116
PM 98,98,116
PM 100,100,116
PM 102,102,116
C 72,96,97
C 73,98,99
C 74,100,101
C 75,102,103
S 72,25,24,39
AR 104,108
AR 105,109
AR 106,110
AR 107,111
AR 108,124
AR 109,125
AR 110,126
AR 111,127
PM 104,104,118
PM 106,106,118
PM 108,108,118
PM 110,110,118
C 76,104,105
C 77,106,107
C 78,108,109
C 79,110,111
S1 76,25,24,39,1024
s_add_u32 s39,s39,131072
s_cmp_lt_i32 s59,0
s_cbranch_scc0 l12_second
s_lshl_b32 s40,s28,8
s_add_u32 s40,s40,9216
s_and_b32 s11,s2,0x18
s_branch l12_fin
l12_second:
s_waitcnt vmcnt(34)
s_barrier
T 0,2,0
T 2,2,1024
T 4,3,0
T 6,3,1024
T 8,4,0
T 10,4,1024
T 12,5,0
T 14,5,1024
T 16,14,0
T 18,14,1024
T 20,15,0
T 22,15,1024
T 24,16,0
T 26,16,1024
T 28,17,0
T 30,17,1024
s_lshl_b32 s44,s29,20
s_waitcnt lgkmcnt(0)
s_waitcnt vmcnt(30)
s_barrier
M 32,0,128,0
s_add_u32 m0,s43,98304
T 32,2,8192
T 34,2,9216
M 36,0,132,0
T 36,3,8192
M 40,0,136,0
M 44,0,140,0
T 38,3,9216
M 48,4,128,0
T 40,4,8192
M 52,4,132,0
T 42,4,9216
M 56,4,136,0
L 22,16,41
M 60,4,140,0
T 44,5,8192
M 64,8,128,0
T 46,5,9216
M 68,8,132,0
M 72,8,136,0
T 48,14,8192
M 76,8,140,0
T 50,14,9216
M 80,12,128,0
T 52,15,8192
M 84,12,132,0
L1 23,16,41,1024
M 88,12,136,0
T 54,15,9216
M 92,12,140,0
T 56,16,8192
M 96,16,128,0
T 58,16,9216
M 100,16,132,0
M 104,16,136,0
T 60,17,8192
M 108,16,140,0
T 62,17,9216
M 112,20,128,0
s_add_u32 s41,s41,262144
M 116,20,132,0
M 120,20,136,0
M 124,20,140,0
M1 224,24,128,0
M1 228,24,132,0
M1 232,24,136,0
M1 236,24,140,0
M1 240,28,128,0
M1 244,28,132,0
M1 248,28,136,0
M1 252,28,140,0
s_waitcnt vmcnt(28) lgkmcnt(0)
M2 32,32,144,32
T 0,2,16384
L4 128,30,20,42
M2 36,32,148,36
T 2,2,17408
T 4,3,16384
M2 40,32,152,40
M2 44,32,156,44
T 6,3,17408
M2 48,36,144,48
T 8,4,16384
L5 132,30,20,42,1024
M2 52,36,148,52
T 10,4,17408
M2 56,36,152,56
M2 60,36,156,60
T 12,5,16384
M2 64,40,144,64
T 14,5,17408
M2 68,40,148,68
M2 72,40,152,72
T 16,14,16384
L4 136,31,20,42
M2 76,40,156,76
T 18,14,17408
M2 80,44,144,80
T 20,15,16384
M2 84,44,148,84
M2 88,44,152,88
T 22,15,17408
M2 92,44,156,92
T 24,16,16384
L5 140,31,20,42,1024
M2 96,48,144,96
T 26,16,17408
M2 100,48,148,100
M2 104,48,152,104
T 28,17,16384
M2 108,48,156,108
T 30,17,17408
M2 112,52,144,112
M2 116,52,148,116
s_add_u32 s42,s42,131072
M2 120,52,152,120
M2 124,52,156,124
M3 224,56,144,224
M3 228,56,148,228
M3 232,56,152,232
M3 236,56,156,236
M3 240,60,144,240
M3 244,60,148,244
M3 248,60,152,248
s_waitcnt vmcnt(4) lgkmcnt(0)
M3 252,60,156,252
s_barrier
M2 32,0,160,32
s_add_u32 m0,s43,106496
T 32,2,24576
T 34,2,25600
M2 36,0,164,36
L 22,16,41
T 36,3,24576
M2 40,0,168,40
M2 44,0,172,44
T 38,3,25600
M2 48,4,160,48
L1 23,16,41,1024
T 40,4,24576
M2 52,4,164,52
T 42,4,25600
M2 56,4,168,56
s_add_u32 s41,s41,262144
M2 60,4,172,60
T 44,5,24576
M2 64,8,160,64
T 46,5,25600
M2 68,8,164,68
s_add_u32 m0,s43,114688
M2 72,8,168,72
T 48,14,24576
M2 76,8,172,76
T 50,14,25600
L 22,16,41
M2 80,12,160,80
T 52,15,24576
M2 84,12,164,84
M2 88,12,168,88
T 54,15,25600
L1 23,16,41,1024
M2 92,12,172,92
T 56,16,24576
M2 96,16,160,96
s_add_u32 s41,s41,262144
T 58,16,25600
M2 100,16,164,100
M2 104,16,168,104
T 60,17,24576
M2 108,16,172,108
L4 144,30,20,42
T 62,17,25600
M2 112,20,160,112
M2 116,20,164,116
L5 148,30,20,42,1024
M2 120,20,168,120
M2 124,20,172,124
M3 224,24,160,224
buffer_atomic_add v28,v26,s[92:95],s60 offen sc1
M3 228,24,164,228
M3 232,24,168,232
M3 236,24,172,236
M3 240,28,160,240
M3 244,28,164,244
M3 248,28,168,248
M3 252,28,172,252
s_waitcnt lgkmcnt(0)
M2 32,32,176,32
T 0,2,0
L4 152,31,20,42
M2 36,32,180,36
T 2,2,1024
T 4,3,0
M2 40,32,184,40
L5 156,31,20,42,1024
M2 44,32,188,44
T 6,3,1024
M2 48,36,176,48
T 8,4,0
M2 52,36,180,52
T 10,4,1024
M2 56,36,184,56
s_add_u32 s42,s42,131072
M2 60,36,188,60
T 12,5,0
M2 64,40,176,64
T 14,5,1024
M2 68,40,180,68
L4 160,30,20,42
M2 72,40,184,72
T 16,14,0
M2 76,40,188,76
T 18,14,1024
M2 80,44,176,80
T 20,15,0
M2 84,44,180,84
L5 164,30,20,42,1024
M2 88,44,184,88
T 22,15,1024
M2 92,44,188,92
T 24,16,0
M2 96,48,176,96
L4 168,31,20,42
T 26,16,1024
M2 100,48,180,100
M2 104,48,184,104
T 28,17,0
M2 108,48,188,108
T 30,17,1024
M2 112,52,176,112
L5 172,31,20,42,1024
M2 116,52,180,116
M2 120,52,184,120
M2 124,52,188,124
s_add_u32 s42,s42,131072
M3 224,56,176,224
M3 228,56,180,228
M3 232,56,184,232
M3 236,56,188,236
M3 240,60,176,240
M3 244,60,180,244
M3 248,60,184,248
s_waitcnt vmcnt(9) lgkmcnt(0)
M3 252,60,188,252
s_barrier
s_mov_b32 s58,2
q2l_1:
M2 32,0,128,32
s_add_u32 m0,s43,122880
T 32,2,8192
T 34,2,9216
M2 36,0,132,36
T 36,3,8192
L 22,16,41
M2 40,0,136,40
M2 44,0,140,44
T 38,3,9216
M2 48,4,128,48
T 40,4,8192
L1 23,16,41,1024
M2 52,4,132,52
T 42,4,9216
M2 56,4,136,56
M2 60,4,140,60
s_add_u32 s41,s41,262144
T 44,5,8192
M2 64,8,128,64
T 46,5,9216
M2 68,8,132,68
M2 72,8,136,72
s_add_u32 m0,s43,98304
T 48,14,8192
M2 76,8,140,76
T 50,14,9216
M2 80,12,128,80
T 52,15,8192
M2 84,12,132,84
L 22,16,41
M2 88,12,136,88
T 54,15,9216
M2 92,12,140,92
T 56,16,8192
L1 23,16,41,1024
M2 96,16,128,96
T 58,16,9216
M2 100,16,132,100
M2 104,16,136,104
s_add_u32 s41,s41,262144
T 60,17,8192
M2 108,16,140,108
T 62,17,9216
M2 112,20,128,112
M2 116,20,132,116
L4 176,30,20,42
M2 120,20,136,120
M2 124,20,140,124
M3 224,24,128,224
L5 180,30,20,42,1024
M3 228,24,132,228
M3 232,24,136,232
M3 236,24,140,236
M3 240,28,128,240
M3 244,28,132,244
M3 248,28,136,248
M3 252,28,140,252
s_waitcnt vmcnt(10) lgkmcnt(0)
M2 32,32,144,32
T 0,2,16384
L4 184,31,20,42
M2 36,32,148,36
T 2,2,17408
T 4,3,16384
M2 40,32,152,40
L5 188,31,20,42,1024
M2 44,32,156,44
T 6,3,17408
M2 48,36,144,48
T 8,4,16384
M2 52,36,148,52
T 10,4,17408
M2 56,36,152,56
s_add_u32 s42,s42,131072
M2 60,36,156,60
T 12,5,16384
M2 64,40,144,64
T 14,5,17408
M2 68,40,148,68
L4 128,30,20,42
M2 72,40,152,72
T 16,14,16384
M2 76,40,156,76
T 18,14,17408
M2 80,44,144,80
T 20,15,16384
M2 84,44,148,84
L5 132,30,20,42,1024
M2 88,44,152,88
T 22,15,17408
M2 92,44,156,92
T 24,16,16384
M2 96,48,144,96
L4 136,31,20,42
T 26,16,17408
M2 100,48,148,100
M2 104,48,152,104
T 28,17,16384
M2 108,48,156,108
T 30,17,17408
M2 112,52,144,112
L5 140,31,20,42,1024
M2 116,52,148,116
M2 120,52,152,120
M2 124,52,156,124
s_add_u32 s42,s42,131072
M3 224,56,144,224
M3 228,56,148,228
M3 232,56,152,232
M3 236,56,156,236
M3 240,60,144,240
M3 244,60,148,244
M3 248,60,152,248
s_waitcnt vmcnt(8) lgkmcnt(0)
M3 252,60,156,252
s_barrier
M2 32,0,160,32
s_add_u32 m0,s43,106496
T 32,2,24576
T 34,2,25600
M2 36,0,164,36
T 36,3,24576
L 22,16,41
M2 40,0,168,40
M2 44,0,172,44
T 38,3,25600
M2 48,4,160,48
T 40,4,24576
L1 23,16,41,1024
M2 52,4,164,52
T 42,4,25600
M2 56,4,168,56
M2 60,4,172,60
s_add_u32 s41,s41,262144
T 44,5,24576
M2 64,8,160,64
T 46,5,25600
M2 68,8,164,68
M2 72,8,168,72
s_add_u32 m0,s43,114688
T 48,14,24576
M2 76,8,172,76
T 50,14,25600
M2 80,12,160,80
T 52,15,24576
M2 84,12,164,84
L 22,16,41
M2 88,12,168,88
T 54,15,25600
M2 92,12,172,92
T 56,16,24576
L1 23,16,41,1024
M2 96,16,160,96
T 58,16,25600
M2 100,16,164,100
M2 104,16,168,104
s_add_u32 s41,s41,262144
T 60,17,24576
M2 108,16,172,108
T 62,17,25600
M2 112,20,160,112
M2 116,20,164,116
L4 144,30,20,42
M2 120,20,168,120
M2 124,20,172,124
M3 224,24,160,224
L5 148,30,20,42,1024
M3 228,24,164,228
M3 232,24,168,232
M3 236,24,172,236
M3 240,28,160,240
M3 244,28,164,244
M3 248,28,168,248
M3 252,28,172,252
s_waitcnt vmcnt(10) lgkmcnt(0)
M2 32,32,176,32
T 0,2,0
L4 152,31,20,42
M2 36,32,180,36
T 2,2,1024
T 4,3,0
M2 40,32,184,40
L5 156,31,20,42,1024
M2 44,32,188,44
T 6,3,1024
M2 48,36,176,48
T 8,4,0
M2 52,36,180,52
T 10,4,1024
M2 56,36,184,56
s_add_u32 s42,s42,131072
M2 60,36,188,60
T 12,5,0
M2 64,40,176,64
T 14,5,1024
M2 68,40,180,68
L4 160,30,20,42
M2 72,40,184,72
T 16,14,0
M2 76,40,188,76
T 18,14,1024
M2 80,44,176,80
T 20,15,0
M2 84,44,180,84
L5 164,30,20,42,1024
M2 88,44,184,88
T 22,15,1024
M2 92,44,188,92
T 24,16,0
M2 96,48,176,96
L4 168,31,20,42
T 26,16,1024
M2 100,48,180,100
M2 104,48,184,104
T 28,17,0
M2 108,48,188,108
T 30,17,1024
M2 112,52,176,112
L5 172,31,20,42,1024
M2 116,52,180,116
M2 120,52,184,120
M2 124,52,188,124
s_add_u32 s42,s42,131072
M3 224,56,176,224
M3 228,56,180,228
M3 232,56,184,232
M3 236,56,188,236
M3 240,60,176,240
M3 244,60,180,244
M3 248,60,184,248
s_waitcnt vmcnt(8) lgkmcnt(0)
M3 252,60,188,252
s_barrier
s_sub_u32 s58,s58,1
s_cmp_lg_u32 s58,0
s_cbranch_scc1 q2l_1
M2 32,0,128,32
s_add_u32 m0,s43,122880
T 32,2,8192
T 34,2,9216
M2 36,0,132,36
T 36,3,8192
L 22,16,41
M2 40,0,136,40
M2 44,0,140,44
T 38,3,9216
M2 48,4,128,48
T 40,4,8192
L1 23,16,41,1024
M2 52,4,132,52
T 42,4,9216
M2 56,4,136,56
M2 60,4,140,60
s_add_u32 s41,s41,262144
T 44,5,8192
M2 64,8,128,64
T 46,5,9216
M2 68,8,132,68
M2 72,8,136,72
s_add_u32 m0,s43,98304
T 48,14,8192
M2 76,8,140,76
T 50,14,9216
M2 80,12,128,80
T 52,15,8192
M2 84,12,132,84
L 22,16,41
M2 88,12,136,88
T 54,15,9216
M2 92,12,140,92
T 56,16,8192
L1 23,16,41,1024
M2 96,16,128,96
T 58,16,9216
M2 100,16,132,100
M2 104,16,136,104
s_add_u32 s41,s41,262144
T 60,17,8192
M2 108,16,140,108
T 62,17,9216
M2 112,20,128,112
M2 116,20,132,116
L4 176,30,20,42
M2 120,20,136,120
M2 124,20,140,124
M3 224,24,128,224
L5 180,30,20,42,1024
M3 228,24,132,228
M3 232,24,136,232
M3 236,24,140,236
M3 240,28,128,240
M3 244,28,132,244
M3 248,28,136,248
M3 252,28,140,252
s_waitcnt vmcnt(10) lgkmcnt(0)
M2 32,32,144,32
T 0,2,16384
L4 184,31,20,42
M2 36,32,148,36
T 2,2,17408
T 4,3,16384
M2 40,32,152,40
L5 188,31,20,42,1024
M2 44,32,156,44
T 6,3,17408
M2 48,36,144,48
T 8,4,16384
M2 52,36,148,52
T 10,4,17408
M2 56,36,152,56
s_add_u32 s42,s42,131072
M2 60,36,156,60
T 12,5,16384
M2 64,40,144,64
T 14,5,17408
M2 68,40,148,68
L4 128,30,20,42
M2 72,40,152,72
T 16,14,16384
M2 76,40,156,76
T 18,14,17408
M2 80,44,144,80
T 20,15,16384
M2 84,44,148,84
L5 132,30,20,42,1024
M2 88,44,152,88
T 22,15,17408
M2 92,44,156,92
T 24,16,16384
M2 96,48,144,96
L4 136,31,20,42
T 26,16,17408
M2 100,48,148,100
M2 104,48,152,104
T 28,17,16384
M2 108,48,156,108
T 30,17,17408
M2 112,52,144,112
L5 140,31,20,42,1024
M2 116,52,148,116
M2 120,52,152,120
M2 124,52,156,124
s_add_u32 s42,s42,131072
M3 224,56,144,224
M3 228,56,148,228
M3 232,56,152,232
M3 236,56,156,236
M3 240,60,144,240
M3 244,60,148,244
M3 248,60,152,248
s_waitcnt vmcnt(8) lgkmcnt(0)
M3 252,60,156,252
s_barrier
M2 32,0,160,32
s_add_u32 m0,s43,106496
T 32,2,24576
T 34,2,25600
M2 36,0,164,36
L 22,16,41
T 36,3,24576
M2 40,0,168,40
L1 23,16,41,1024
M2 44,0,172,44
T 38,3,25600
M2 48,4,160,48
s_add_u32 s41,s41,262144
T 40,4,24576
M2 52,4,164,52
T 42,4,25600
M2 56,4,168,56
L4 144,30,20,42
M2 60,4,172,60
T 44,5,24576
M2 64,8,160,64
L5 148,30,20,42,1024
T 46,5,25600
M2 68,8,164,68
M2 72,8,168,72
T 48,14,24576
L4 152,31,20,42
M2 76,8,172,76
T 50,14,25600
M2 80,12,160,80
L5 156,31,20,42,1024
T 52,15,24576
M2 84,12,164,84
s_add_u32 s42,s42,131072
M2 88,12,168,88
T 54,15,25600
M2 92,12,172,92
s_add_u32 m0,s45,0
T 56,16,24576
M2 96,16,160,96
T 58,16,25600
M2 100,16,164,100
L6 6,12,44
M2 104,16,168,104
T 60,17,24576
M2 108,16,172,108
L7 6,12,44,1024
T 62,17,25600
M2 112,20,160,112
M2 116,20,164,116
L7 6,12,44,2048
M2 120,20,168,120
M2 124,20,172,124
L7 6,12,44,3072
M3 224,24,160,224
M3 228,24,164,228
s_add_u32 s44,s44,4096
M3 232,24,168,232
M3 236,24,172,236
M3 240,28,160,240
M3 244,28,164,244
M3 248,28,168,248
M3 252,28,172,252
s_waitcnt vmcnt(14) lgkmcnt(0)
M2 32,32,176,32
s_add_u32 m0,s45,4096
T 0,2,0
T 2,2,1024
M2 36,32,180,36
T 4,3,0
M2 40,32,184,40
M2 44,32,188,44
T 6,3,1024
L6 6,12,44
M2 48,36,176,48
T 8,4,0
M2 52,36,180,52
T 10,4,1024
M2 56,36,184,56
M2 60,36,188,60
T 12,5,0
M2 64,40,176,64
L7 6,12,44,1024
T 14,5,1024
M2 68,40,180,68
M2 72,40,184,72
T 16,14,0
M2 76,40,188,76
T 18,14,1024
M2 80,44,176,80
T 20,15,0
M2 84,44,180,84
L7 6,12,44,2048
M2 88,44,184,88
T 22,15,1024
M2 92,44,188,92
T 24,16,0
M2 96,48,176,96
T 26,16,1024
M2 100,48,180,100
L7 6,12,44,3072
M2 104,48,184,104
T 28,17,0
M2 108,48,188,108
T 30,17,1024
M2 112,52,176,112
M2 116,52,180,116
M2 120,52,184,120
s_add_u32 s44,s44,28672
M2 124,52,188,124
M3 224,56,176,224
M3 228,56,180,228
M3 232,56,184,232
M3 236,56,188,236
M3 240,60,176,240
M3 244,60,180,244
M3 248,60,184,248
s_waitcnt vmcnt(12) lgkmcnt(0)
M3 252,60,188,252
s_barrier
M2 32,0,128,32
s_add_u32 m0,s45,32768
T 32,2,8192
T 34,2,9216
M2 36,0,132,36
L6 6,12,44
T 36,3,8192
M2 40,0,136,40
M2 44,0,140,44
T 38,3,9216
L7 6,12,44,1024
M2 48,4,128,48
T 40,4,8192
M2 52,4,132,52
T 42,4,9216
M2 56,4,136,56
L7 6,12,44,2048
M2 60,4,140,60
T 44,5,8192
M2 64,8,128,64
L7 6,12,44,3072
T 46,5,9216
M2 68,8,132,68
M2 72,8,136,72
s_add_u32 s44,s44,4096
T 48,14,8192
M2 76,8,140,76
T 50,14,9216
M2 80,12,128,80
T 52,15,8192
M2 84,12,132,84
s_add_u32 m0,s45,36864
M2 88,12,136,88
T 54,15,9216
M2 92,12,140,92
L6 6,12,44
T 56,16,8192
M2 96,16,128,96
T 58,16,9216
M2 100,16,132,100
L7 6,12,44,1024
M2 104,16,136,104
T 60,17,8192
M2 108,16,140,108
T 62,17,9216
M2 112,20,128,112
L7 6,12,44,2048
M2 116,20,132,116
M2 120,20,136,120
L7 6,12,44,3072
M2 124,20,140,124
M3 224,24,128,224
s_add_u32 s44,s44,28672
M3 228,24,132,228
M3 232,24,136,232
M3 236,24,140,236
M3 240,28,128,240
M3 244,28,132,244
M3 248,28,136,248
M3 252,28,140,252
s_waitcnt vmcnt(16) lgkmcnt(0)
M2 32,32,144,32
s_add_u32 m0,s45,65536
M2 36,32,148,36
L6 6,12,44
M2 40,32,152,40
M2 44,32,156,44
M2 48,36,144,48
L7 6,12,44,1024
M2 52,36,148,52
M2 56,36,152,56
L7 6,12,44,2048
M2 60,36,156,60
M2 64,40,144,64
M2 68,40,148,68
L7 6,12,44,3072
M2 72,40,152,72
M2 76,40,156,76
s_add_u32 s44,s44,4096
M2 80,44,144,80
M2 84,44,148,84
M2 88,44,152,88
s_add_u32 m0,s45,69632
M2 92,44,156,92
M2 96,48,144,96
M2 100,48,148,100
L6 6,12,44
M2 104,48,152,104
M2 108,48,156,108
L7 6,12,44,1024
M2 112,52,144,112
M2 116,52,148,116
M2 120,52,152,120
L7 6,12,44,2048
M2 124,52,156,124
M3 224,56,144,224
L7 6,12,44,3072
M3 228,56,148,228
M3 232,56,152,232
M3 236,56,156,236
s_add_u32 s44,s44,28672
M3 240,60,144,240
M3 244,60,148,244
M3 248,60,152,248
M3 252,60,156,252
buffer_load_dword a210,v29,s[12:15],0 offen
buffer_load_dword a210,v29,s[12:15],0 offen
s_branch l12_attq
l12_lasttask:
s_and_b32 s4,s2,0xfc
s_add_u32 s4,s4,fin_tab-l12_pc
s_load_dword s5,s[88:89],s4
s_load_dwordx2 s[44:45],s[0:1],40
s_load_dwordx2 s[46:47],s[0:1],80
s_load_dwordx2 s[60:61],s[0:1],0
s_load_dwordx2 s[62:63],s[0:1],88
s_branch l12_nosec
kvb:
s_lshr_b32 s40,s29,1
s_lshl_b32 s40,s40,8
s_add_u32 s40,s40,28672
s_cmp_lg_u32 s30,0
s_cbranch_scc1 spinret_kvb
buffer_load_dword v0,v26,s[92:95],s40 offen sc1
s_waitcnt vmcnt(0)
v_readfirstlane_b32 s39,v0
s_nop 3
s_cmp_lt_u32 s39,6
s_cbranch_scc1 spin_kvb
spinret_kvb:
s_barrier
s_branch kvbret
spin_kvb:
s_mov_b32 s100,0
spinl_kvb:
s_sleep 4
buffer_load_dword v0,v26,s[92:95],s40 offen sc1
s_add_u32 s100,s100,1
s_cmp_ge_u32 s100,16384
s_cbranch_scc1 spinret_kvb
s_waitcnt vmcnt(0)
v_readfirstlane_b32 s39,v0
s_nop 3
s_cmp_lt_u32 s39,6
s_cbranch_scc1 spinl_kvb
s_branch spinret_kvb
fb_i0:
s_nop 7
s_nop 7
v_max3_f32 v184,v64,v65,v66
v_max3_f32 v184,v184,v67,v80
v_max3_f32 v184,v184,v81,v82
v_max_f32 v184,v184,v83
v_log_f32 v186,v180
s_nop 0
v_max3_f32 v184,v184,v186,0
V1 186,184
s_nop 1
v_permlane16_swap_b32 v186,v184
s_nop 1
v_max_f32 v184,v184,v186
V1 186,184
s_nop 1
v_permlane32_swap_b32 v186,v184
s_nop 1
v_max_f32 v184,v184,v186
E1 185,-v184
s_nop 0
U1 176,180,185
B1 186,64,184
B1 187,65,184
E 186,186
E 187,187
s_nop 0
A 176,176,186
A 176,176,187
C 128,186,187
B1 186,66,184
B1 187,67,184
E 186,186
E 187,187
s_nop 0
A 176,176,186
A 176,176,187
C 129,186,187
B1 186,80,184
B1 187,81,184
E 186,186
E 187,187
s_nop 0
A 176,176,186
A 176,176,187
C 130,186,187
B1 186,82,184
B1 187,83,184
E 186,186
E 187,187
s_nop 0
A 176,176,186
A 176,176,187
C 131,186,187
V1 180,176
B1 96,96,184
B1 97,97,184
B1 98,98,184
B1 99,99,184
B1 112,112,184
B1 113,113,184
B1 114,114,184
B1 115,115,184
B1 160,160,184
B1 161,161,184
B1 162,162,184
B1 163,163,184
AR 186,0
AR 187,1
AR 188,2
AR 189,3
U1 186,186,185
U1 187,187,185
U1 188,188,185
U1 189,189,185
AW 0,186
AW 1,187
AW 2,188
AW 3,189
AR 186,16
AR 187,17
AR 188,18
AR 189,19
U1 186,186,185
U1 187,187,185
U1 188,188,185
U1 189,189,185
AW 16,186
AW 17,187
AW 18,188
AW 19,189
AR 186,32
AR 187,33
AR 188,34
AR 189,35
U1 186,186,185
U1 187,187,185
U1 188,188,185
U1 189,189,185
AW 32,186
AW 33,187
AW 34,188
AW 35,189
AR 186,48
AR 187,49
AR 188,50
AR 189,51
U1 186,186,185
U1 187,187,185
U1 188,188,185
U1 189,189,185
AW 48,186
AW 49,187
AW 50,188
AW 51,189
AR 186,64
AR 187,65
AR 188,66
AR 189,67
U1 186,186,185
U1 187,187,185
U1 188,188,185
U1 189,189,185
AW 64,186
AW 65,187
AW 66,188
AW 67,189
AR 186,80
AR 187,81
AR 188,82
AR 189,83
U1 186,186,185
U1 187,187,185
U1 188,188,185
U1 189,189,185
AW 80,186
AW 81,187
AW 82,188
AW 83,189
AR 186,96
AR 187,97
AR 188,98
AR 189,99
U1 186,186,185
U1 187,187,185
U1 188,188,185
U1 189,189,185
AW 96,186
AW 97,187
AW 98,188
AW 99,189
AR 186,112
AR 187,113
AR 188,114
AR 189,115
U1 186,186,185
U1 187,187,185
U1 188,188,185
U1 189,189,185
AW 112,186
AW 113,187
AW 114,188
AW 115,189
v_max3_f32 v184,v68,v69,v70
v_max3_f32 v184,v184,v71,v84
v_max3_f32 v184,v184,v85,v86
v_max_f32 v184,v184,v87
v_log_f32 v186,v181
s_nop 0
v_max3_f32 v184,v184,v186,0
V1 186,184
s_nop 1
v_permlane16_swap_b32 v186,v184
s_nop 1
v_max_f32 v184,v184,v186
V1 186,184
s_nop 1
v_permlane32_swap_b32 v186,v184
s_nop 1
v_max_f32 v184,v184,v186
E1 185,-v184
s_nop 0
U1 177,181,185
B1 186,68,184
B1 187,69,184
E 186,186
E 187,187
s_nop 0
A 177,177,186
A 177,177,187
C 132,186,187
B1 186,70,184
B1 187,71,184
E 186,186
E 187,187
s_nop 0
A 177,177,186
A 177,177,187
C 133,186,187
B1 186,84,184
B1 187,85,184
E 186,186
E 187,187
s_nop 0
A 177,177,186
A 177,177,187
C 134,186,187
B1 186,86,184
B1 187,87,184
E 186,186
E 187,187
s_nop 0
A 177,177,186
A 177,177,187
C 135,186,187
V1 181,177
B1 100,100,184
B1 101,101,184
B1 102,102,184
B1 103,103,184
B1 116,116,184
B1 117,117,184
B1 118,118,184
B1 119,119,184
B1 164,164,184
B1 165,165,184
B1 166,166,184
B1 167,167,184
AR 186,4
AR 187,5
AR 188,6
AR 189,7
U1 186,186,185
U1 187,187,185
U1 188,188,185
U1 189,189,185
AW 4,186
AW 5,187
AW 6,188
AW 7,189
AR 186,20
AR 187,21
AR 188,22
AR 189,23
U1 186,186,185
U1 187,187,185
U1 188,188,185
U1 189,189,185
AW 20,186
AW 21,187
AW 22,188
AW 23,189
AR 186,36
AR 187,37
AR 188,38
AR 189,39
U1 186,186,185
U1 187,187,185
U1 188,188,185
U1 189,189,185
AW 36,186
AW 37,187
AW 38,188
AW 39,189
AR 186,52
AR 187,53
AR 188,54
AR 189,55
U1 186,186,185
U1 187,187,185
U1 188,188,185
U1 189,189,185
AW 52,186
AW 53,187
AW 54,188
AW 55,189
AR 186,68
AR 187,69
AR 188,70
AR 189,71
U1 186,186,185
U1 187,187,185
U1 188,188,185
U1 189,189,185
AW 68,186
AW 69,187
AW 70,188
AW 71,189
AR 186,84
AR 187,85
AR 188,86
AR 189,87
U1 186,186,185
U1 187,187,185
U1 188,188,185
U1 189,189,185
AW 84,186
AW 85,187
AW 86,188
AW 87,189
AR 186,100
AR 187,101
AR 188,102
AR 189,103
U1 186,186,185
U1 187,187,185
U1 188,188,185
U1 189,189,185
AW 100,186
AW 101,187
AW 102,188
AW 103,189
AR 186,116
AR 187,117
AR 188,118
AR 189,119
U1 186,186,185
U1 187,187,185
U1 188,188,185
U1 189,189,185
AW 116,186
AW 117,187
AW 118,188
AW 119,189
v_max3_f32 v184,v72,v73,v74
v_max3_f32 v184,v184,v75,v88
v_max3_f32 v184,v184,v89,v90
v_max_f32 v184,v184,v91
v_log_f32 v186,v56
s_nop 0
v_max3_f32 v184,v184,v186,0
V1 186,184
s_nop 1
v_permlane16_swap_b32 v186,v184
s_nop 1
v_max_f32 v184,v184,v186
V1 186,184
s_nop 1
v_permlane32_swap_b32 v186,v184
s_nop 1
v_max_f32 v184,v184,v186
E1 185,-v184
s_nop 0
V 178,0
B1 186,72,184
B1 187,73,184
E 186,186
E 187,187
s_nop 0
A 178,178,186
A 178,178,187
C 136,186,187
B1 186,74,184
B1 187,75,184
E 186,186
E 187,187
s_nop 0
A 178,178,186
A 178,178,187
C 137,186,187
B1 186,88,184
B1 187,89,184
E 186,186
E 187,187
s_nop 0
A 178,178,186
A 178,178,187
C 138,186,187
B1 186,90,184
B1 187,91,184
E 186,186
E 187,187
s_nop 0
A 178,178,186
A 178,178,187
C 139,186,187
V1 186,178
s_nop 1
v_permlane16_swap_b32 v186,v178
s_nop 1
A 178,178,186
V1 186,178
s_nop 1
v_permlane32_swap_b32 v186,v178
s_nop 1
A 178,178,186
F1 40,56,185,178
F1 41,56,185,178
F1 42,56,185,178
F1 43,56,185,178
V1 56,40
B1 104,104,184
B1 105,105,184
B1 106,106,184
B1 107,107,184
B1 120,120,184
B1 121,121,184
B1 122,122,184
B1 123,123,184
B1 168,168,184
B1 169,169,184
B1 170,170,184
B1 171,171,184
AR 186,8
AR 187,9
AR 188,10
AR 189,11
U1 186,186,185
U1 187,187,185
U1 188,188,185
U1 189,189,185
AW 8,186
AW 9,187
AW 10,188
AW 11,189
AR 186,24
AR 187,25
AR 188,26
AR 189,27
U1 186,186,185
U1 187,187,185
U1 188,188,185
U1 189,189,185
AW 24,186
AW 25,187
AW 26,188
AW 27,189
AR 186,40
AR 187,41
AR 188,42
AR 189,43
U1 186,186,185
U1 187,187,185
U1 188,188,185
U1 189,189,185
AW 40,186
AW 41,187
AW 42,188
AW 43,189
AR 186,56
AR 187,57
AR 188,58
AR 189,59
U1 186,186,185
U1 187,187,185
U1 188,188,185
U1 189,189,185
AW 56,186
AW 57,187
AW 58,188
AW 59,189
AR 186,72
AR 187,73
AR 188,74
AR 189,75
U1 186,186,185
U1 187,187,185
U1 188,188,185
U1 189,189,185
AW 72,186
AW 73,187
AW 74,188
AW 75,189
AR 186,88
AR 187,89
AR 188,90
AR 189,91
U1 186,186,185
U1 187,187,185
U1 188,188,185
U1 189,189,185
AW 88,186
AW 89,187
AW 90,188
AW 91,189
AR 186,104
AR 187,105
AR 188,106
AR 189,107
U1 186,186,185
U1 187,187,185
U1 188,188,185
U1 189,189,185
AW 104,186
AW 105,187
AW 106,188
AW 107,189
AR 186,120
AR 187,121
AR 188,122
AR 189,123
U1 186,186,185
U1 187,187,185
U1 188,188,185
U1 189,189,185
AW 120,186
AW 121,187
AW 122,188
AW 123,189
v_max3_f32 v184,v76,v77,v78
v_max3_f32 v184,v184,v79,v92
v_max3_f32 v184,v184,v93,v94
v_max_f32 v184,v184,v95
v_log_f32 v186,v60
s_nop 0
v_max3_f32 v184,v184,v186,0
V1 186,184
s_nop 1
v_permlane16_swap_b32 v186,v184
s_nop 1
v_max_f32 v184,v184,v186
V1 186,184
s_nop 1
v_permlane32_swap_b32 v186,v184
s_nop 1
v_max_f32 v184,v184,v186
E1 185,-v184
s_nop 0
V 179,0
B1 186,76,184
B1 187,77,184
E 186,186
E 187,187
s_nop 0
A 179,179,186
A 179,179,187
C 140,186,187
B1 186,78,184
B1 187,79,184
E 186,186
E 187,187
s_nop 0
A 179,179,186
A 179,179,187
C 141,186,187
B1 186,92,184
B1 187,93,184
E 186,186
E 187,187
s_nop 0
A 179,179,186
A 179,179,187
C 142,186,187
B1 186,94,184
B1 187,95,184
E 186,186
E 187,187
s_nop 0
A 179,179,186
A 179,179,187
C 143,186,187
V1 186,179
s_nop 1
v_permlane16_swap_b32 v186,v179
s_nop 1
A 179,179,186
V1 186,179
s_nop 1
v_permlane32_swap_b32 v186,v179
s_nop 1
A 179,179,186
F1 44,60,185,179
F1 45,60,185,179
F1 46,60,185,179
F1 47,60,185,179
V1 60,44
B1 108,108,184
B1 109,109,184
B1 110,110,184
B1 111,111,184
B1 124,124,184
B1 125,125,184
B1 126,126,184
B1 127,127,184
B1 172,172,184
B1 173,173,184
B1 174,174,184
B1 175,175,184
AR 186,12
AR 187,13
AR 188,14
AR 189,15
U1 186,186,185
U1 187,187,185
U1 188,188,185
U1 189,189,185
AW 12,186
AW 13,187
AW 14,188
AW 15,189
AR 186,28
AR 187,29
AR 188,30
AR 189,31
U1 186,186,185
U1 187,187,185
U1 188,188,185
U1 189,189,185
AW 28,186
AW 29,187
AW 30,188
AW 31,189
AR 186,44
AR 187,45
AR 188,46
AR 189,47
U1 186,186,185
U1 187,187,185
U1 188,188,185
U1 189,189,185
AW 44,186
AW 45,187
AW 46,188
AW 47,189
AR 186,60
AR 187,61
AR 188,62
AR 189,63
U1 186,186,185
U1 187,187,185
U1 188,188,185
U1 189,189,185
AW 60,186
AW 61,187
AW 62,188
AW 63,189
AR 186,76
AR 187,77
AR 188,78
AR 189,79
U1 186,186,185
U1 187,187,185
U1 188,188,185
U1 189,189,185
AW 76,186
AW 77,187
AW 78,188
AW 79,189
AR 186,92
AR 187,93
AR 188,94
AR 189,95
U1 186,186,185
U1 187,187,185
U1 188,188,185
U1 189,189,185
AW 92,186
AW 93,187
AW 94,188
AW 95,189
AR 186,108
AR 187,109
AR 188,110
AR 189,111
U1 186,186,185
U1 187,187,185
U1 188,188,185
U1 189,189,185
AW 108,186
AW 109,187
AW 110,188
AW 111,189
AR 186,124
AR 187,125
AR 188,126
AR 189,127
U1 186,186,185
U1 187,187,185
U1 188,188,185
U1 189,189,185
AW 124,186
AW 125,187
AW 126,188
AW 127,189
s_nop 1
s_branch fbret_i0
mask_i0:
V 21,0xff800000
s_cmp_eq_u32 s31,s32
s_cbranch_scc0 mask2_i0
K1 96,96,21,46
K1 97,97,21,48
K1 98,98,21,50
K1 99,99,21,52
K1 116,116,21,46
K1 117,117,21,48
K1 118,118,21,50
K1 119,119,21,52
V 112,0xff800000
V 113,0xff800000
V 114,0xff800000
V 115,0xff800000
s_branch maskret_i0
mask2_i0:
V 96,0xff800000
V 97,0xff800000
V 98,0xff800000
V 99,0xff800000
V 100,0xff800000
V 101,0xff800000
V 102,0xff800000
V 103,0xff800000
V 112,0xff800000
V 113,0xff800000
V 114,0xff800000
V 115,0xff800000
V 116,0xff800000
V 117,0xff800000
V 118,0xff800000
V 119,0xff800000
s_cmp_eq_u32 s30,3
s_cbranch_scc0 maskret_i0
K1 104,104,21,46
K1 105,105,21,48
K1 106,106,21,50
K1 107,107,21,52
K1 124,124,21,46
K1 125,125,21,48
K1 126,126,21,50
K1 127,127,21,52
V 120,0xff800000
V 121,0xff800000
V 122,0xff800000
V 123,0xff800000
s_branch maskret_i0
mask_i1:
V 21,0xff800000
s_cmp_eq_u32 s31,s32
s_cbranch_scc0 mask2_i1
K1 64,64,21,46
K1 65,65,21,48
K1 66,66,21,50
K1 67,67,21,52
K1 84,84,21,46
K1 85,85,21,48
K1 86,86,21,50
K1 87,87,21,52
V 80,0xff800000
V 81,0xff800000
V 82,0xff800000
V 83,0xff800000
s_branch maskret_i1
mask2_i1:
V 64,0xff800000
V 65,0xff800000
V 66,0xff800000
V 67,0xff800000
V 68,0xff800000
V 69,0xff800000
V 70,0xff800000
V 71,0xff800000
V 80,0xff800000
V 81,0xff800000
V 82,0xff800000
V 83,0xff800000
V 84,0xff800000
V 85,0xff800000
V 86,0xff800000
V 87,0xff800000
s_cmp_eq_u32 s30,3
s_cbranch_scc0 maskret_i1
K1 72,72,21,46
K1 73,73,21,48
K1 74,74,21,50
K1 75,75,21,52
K1 92,92,21,46
K1 93,93,21,48
K1 94,94,21,50
K1 95,95,21,52
V 88,0xff800000
V 89,0xff800000
V 90,0xff800000
V 91,0xff800000
s_branch maskret_i1
fb_i1:
s_nop 7
s_nop 7
v_max3_f32 v184,v96,v97,v98
v_max3_f32 v184,v184,v99,v112
v_max3_f32 v184,v184,v113,v114
v_max_f32 v184,v184,v115
v_log_f32 v186,v176
s_nop 0
v_max3_f32 v184,v184,v186,0
V1 186,184
s_nop 1
v_permlane16_swap_b32 v186,v184
s_nop 1
v_max_f32 v184,v184,v186
V1 186,184
s_nop 1
v_permlane32_swap_b32 v186,v184
s_nop 1
v_max_f32 v184,v184,v186
E1 185,-v184
s_nop 0
U1 180,176,185
B1 186,96,184
B1 187,97,184
E 186,186
E 187,187
s_nop 0
A 180,180,186
A 180,180,187
C 144,186,187
B1 186,98,184
B1 187,99,184
E 186,186
E 187,187
s_nop 0
A 180,180,186
A 180,180,187
C 145,186,187
B1 186,112,184
B1 187,113,184
E 186,186
E 187,187
s_nop 0
A 180,180,186
A 180,180,187
C 146,186,187
B1 186,114,184
B1 187,115,184
E 186,186
E 187,187
s_nop 0
A 180,180,186
A 180,180,187
C 147,186,187
V1 176,180
B1 64,64,184
B1 65,65,184
B1 66,66,184
B1 67,67,184
B1 80,80,184
B1 81,81,184
B1 82,82,184
B1 83,83,184
B1 160,160,184
B1 161,161,184
B1 162,162,184
B1 163,163,184
AR 186,0
AR 187,1
AR 188,2
AR 189,3
U1 186,186,185
U1 187,187,185
U1 188,188,185
U1 189,189,185
AW 0,186
AW 1,187
AW 2,188
AW 3,189
AR 186,16
AR 187,17
AR 188,18
AR 189,19
U1 186,186,185
U1 187,187,185
U1 188,188,185
U1 189,189,185
AW 16,186
AW 17,187
AW 18,188
AW 19,189
AR 186,32
AR 187,33
AR 188,34
AR 189,35
U1 186,186,185
U1 187,187,185
U1 188,188,185
U1 189,189,185
AW 32,186
AW 33,187
AW 34,188
AW 35,189
AR 186,48
AR 187,49
AR 188,50
AR 189,51
U1 186,186,185
U1 187,187,185
U1 188,188,185
U1 189,189,185
AW 48,186
AW 49,187
AW 50,188
AW 51,189
AR 186,64
AR 187,65
AR 188,66
AR 189,67
U1 186,186,185
U1 187,187,185
U1 188,188,185
U1 189,189,185
AW 64,186
AW 65,187
AW 66,188
AW 67,189
AR 186,80
AR 187,81
AR 188,82
AR 189,83
U1 186,186,185
U1 187,187,185
U1 188,188,185
U1 189,189,185
AW 80,186
AW 81,187
AW 82,188
AW 83,189
AR 186,96
AR 187,97
AR 188,98
AR 189,99
U1 186,186,185
U1 187,187,185
U1 188,188,185
U1 189,189,185
AW 96,186
AW 97,187
AW 98,188
AW 99,189
AR 186,112
AR 187,113
AR 188,114
AR 189,115
U1 186,186,185
U1 187,187,185
U1 188,188,185
U1 189,189,185
AW 112,186
AW 113,187
AW 114,188
AW 115,189
v_max3_f32 v184,v100,v101,v102
v_max3_f32 v184,v184,v103,v116
v_max3_f32 v184,v184,v117,v118
v_max_f32 v184,v184,v119
v_log_f32 v186,v177
s_nop 0
v_max3_f32 v184,v184,v186,0
V1 186,184
s_nop 1
v_permlane16_swap_b32 v186,v184
s_nop 1
v_max_f32 v184,v184,v186
V1 186,184
s_nop 1
v_permlane32_swap_b32 v186,v184
s_nop 1
v_max_f32 v184,v184,v186
E1 185,-v184
s_nop 0
U1 181,177,185
B1 186,100,184
B1 187,101,184
E 186,186
E 187,187
s_nop 0
A 181,181,186
A 181,181,187
C 148,186,187
B1 186,102,184
B1 187,103,184
E 186,186
E 187,187
s_nop 0
A 181,181,186
A 181,181,187
C 149,186,187
B1 186,116,184
B1 187,117,184
E 186,186
E 187,187
s_nop 0
A 181,181,186
A 181,181,187
C 150,186,187
B1 186,118,184
B1 187,119,184
E 186,186
E 187,187
s_nop 0
A 181,181,186
A 181,181,187
C 151,186,187
V1 177,181
B1 68,68,184
B1 69,69,184
B1 70,70,184
B1 71,71,184
B1 84,84,184
B1 85,85,184
B1 86,86,184
B1 87,87,184
B1 164,164,184
B1 165,165,184
B1 166,166,184
B1 167,167,184
AR 186,4
AR 187,5
AR 188,6
AR 189,7
U1 186,186,185
U1 187,187,185
U1 188,188,185
U1 189,189,185
AW 4,186
AW 5,187
AW 6,188
AW 7,189
AR 186,20
AR 187,21
AR 188,22
AR 189,23
U1 186,186,185
U1 187,187,185
U1 188,188,185
U1 189,189,185
AW 20,186
AW 21,187
AW 22,188
AW 23,189
AR 186,36
AR 187,37
AR 188,38
AR 189,39
U1 186,186,185
U1 187,187,185
U1 188,188,185
U1 189,189,185
AW 36,186
AW 37,187
AW 38,188
AW 39,189
AR 186,52
AR 187,53
AR 188,54
AR 189,55
U1 186,186,185
U1 187,187,185
U1 188,188,185
U1 189,189,185
AW 52,186
AW 53,187
AW 54,188
AW 55,189
AR 186,68
AR 187,69
AR 188,70
AR 189,71
U1 186,186,185
U1 187,187,185
U1 188,188,185
U1 189,189,185
AW 68,186
AW 69,187
AW 70,188
AW 71,189
AR 186,84
AR 187,85
AR 188,86
AR 189,87
U1 186,186,185
U1 187,187,185
U1 188,188,185
U1 189,189,185
AW 84,186
AW 85,187
AW 86,188
AW 87,189
AR 186,100
AR 187,101
AR 188,102
AR 189,103
U1 186,186,185
U1 187,187,185
U1 188,188,185
U1 189,189,185
AW 100,186
AW 101,187
AW 102,188
AW 103,189
AR 186,116
AR 187,117
AR 188,118
AR 189,119
U1 186,186,185
U1 187,187,185
U1 188,188,185
U1 189,189,185
AW 116,186
AW 117,187
AW 118,188
AW 119,189
v_max3_f32 v184,v104,v105,v106
v_max3_f32 v184,v184,v107,v120
v_max3_f32 v184,v184,v121,v122
v_max_f32 v184,v184,v123
v_log_f32 v186,v40
s_nop 0
v_max3_f32 v184,v184,v186,0
V1 186,184
s_nop 1
v_permlane16_swap_b32 v186,v184
s_nop 1
v_max_f32 v184,v184,v186
V1 186,184
s_nop 1
v_permlane32_swap_b32 v186,v184
s_nop 1
v_max_f32 v184,v184,v186
E1 185,-v184
s_nop 0
V 182,0
B1 186,104,184
B1 187,105,184
E 186,186
E 187,187
s_nop 0
A 182,182,186
A 182,182,187
C 152,186,187
B1 186,106,184
B1 187,107,184
E 186,186
E 187,187
s_nop 0
A 182,182,186
A 182,182,187
C 153,186,187
B1 186,120,184
B1 187,121,184
E 186,186
E 187,187
s_nop 0
A 182,182,186
A 182,182,187
C 154,186,187
B1 186,122,184
B1 187,123,184
E 186,186
E 187,187
s_nop 0
A 182,182,186
A 182,182,187
C 155,186,187
V1 186,182
s_nop 1
v_permlane16_swap_b32 v186,v182
s_nop 1
A 182,182,186
V1 186,182
s_nop 1
v_permlane32_swap_b32 v186,v182
s_nop 1
A 182,182,186
F1 56,40,185,182
F1 57,40,185,182
F1 58,40,185,182
F1 59,40,185,182
V1 40,56
B1 72,72,184
B1 73,73,184
B1 74,74,184
B1 75,75,184
B1 88,88,184
B1 89,89,184
B1 90,90,184
B1 91,91,184
B1 168,168,184
B1 169,169,184
B1 170,170,184
B1 171,171,184
AR 186,8
AR 187,9
AR 188,10
AR 189,11
U1 186,186,185
U1 187,187,185
U1 188,188,185
U1 189,189,185
AW 8,186
AW 9,187
AW 10,188
AW 11,189
AR 186,24
AR 187,25
AR 188,26
AR 189,27
U1 186,186,185
U1 187,187,185
U1 188,188,185
U1 189,189,185
AW 24,186
AW 25,187
AW 26,188
AW 27,189
AR 186,40
AR 187,41
AR 188,42
AR 189,43
U1 186,186,185
U1 187,187,185
U1 188,188,185
U1 189,189,185
AW 40,186
AW 41,187
AW 42,188
AW 43,189
AR 186,56
AR 187,57
AR 188,58
AR 189,59
U1 186,186,185
U1 187,187,185
U1 188,188,185
U1 189,189,185
AW 56,186
AW 57,187
AW 58,188
AW 59,189
AR 186,72
AR 187,73
AR 188,74
AR 189,75
U1 186,186,185
U1 187,187,185
U1 188,188,185
U1 189,189,185
AW 72,186
AW 73,187
AW 74,188
AW 75,189
AR 186,88
AR 187,89
AR 188,90
AR 189,91
U1 186,186,185
U1 187,187,185
U1 188,188,185
U1 189,189,185
AW 88,186
AW 89,187
AW 90,188
AW 91,189
AR 186,104
AR 187,105
AR 188,106
AR 189,107
U1 186,186,185
U1 187,187,185
U1 188,188,185
U1 189,189,185
AW 104,186
AW 105,187
AW 106,188
AW 107,189
AR 186,120
AR 187,121
AR 188,122
AR 189,123
U1 186,186,185
U1 187,187,185
U1 188,188,185
U1 189,189,185
AW 120,186
AW 121,187
AW 122,188
AW 123,189
v_max3_f32 v184,v108,v109,v110
v_max3_f32 v184,v184,v111,v124
v_max3_f32 v184,v184,v125,v126
v_max_f32 v184,v184,v127
v_log_f32 v186,v44
s_nop 0
v_max3_f32 v184,v184,v186,0
V1 186,184
s_nop 1
v_permlane16_swap_b32 v186,v184
s_nop 1
v_max_f32 v184,v184,v186
V1 186,184
s_nop 1
v_permlane32_swap_b32 v186,v184
s_nop 1
v_max_f32 v184,v184,v186
E1 185,-v184
s_nop 0
V 183,0
B1 186,108,184
B1 187,109,184
E 186,186
E 187,187
s_nop 0
A 183,183,186
A 183,183,187
C 156,186,187
B1 186,110,184
B1 187,111,184
E 186,186
E 187,187
s_nop 0
A 183,183,186
A 183,183,187
C 157,186,187
B1 186,124,184
B1 187,125,184
E 186,186
E 187,187
s_nop 0
A 183,183,186
A 183,183,187
C 158,186,187
B1 186,126,184
B1 187,127,184
E 186,186
E 187,187
s_nop 0
A 183,183,186
A 183,183,187
C 159,186,187
V1 186,183
s_nop 1
v_permlane16_swap_b32 v186,v183
s_nop 1
A 183,183,186
V1 186,183
s_nop 1
v_permlane32_swap_b32 v186,v183
s_nop 1
A 183,183,186
F1 60,44,185,183
F1 61,44,185,183
F1 62,44,185,183
F1 63,44,185,183
V1 44,60
B1 76,76,184
B1 77,77,184
B1 78,78,184
B1 79,79,184
B1 92,92,184
B1 93,93,184
B1 94,94,184
B1 95,95,184
B1 172,172,184
B1 173,173,184
B1 174,174,184
B1 175,175,184
AR 186,12
AR 187,13
AR 188,14
AR 189,15
U1 186,186,185
U1 187,187,185
U1 188,188,185
U1 189,189,185
AW 12,186
AW 13,187
AW 14,188
AW 15,189
AR 186,28
AR 187,29
AR 188,30
AR 189,31
U1 186,186,185
U1 187,187,185
U1 188,188,185
U1 189,189,185
AW 28,186
AW 29,187
AW 30,188
AW 31,189
AR 186,44
AR 187,45
AR 188,46
AR 189,47
U1 186,186,185
U1 187,187,185
U1 188,188,185
U1 189,189,185
AW 44,186
AW 45,187
AW 46,188
AW 47,189
AR 186,60
AR 187,61
AR 188,62
AR 189,63
U1 186,186,185
U1 187,187,185
U1 188,188,185
U1 189,189,185
AW 60,186
AW 61,187
AW 62,188
AW 63,189
AR 186,76
AR 187,77
AR 188,78
AR 189,79
U1 186,186,185
U1 187,187,185
U1 188,188,185
U1 189,189,185
AW 76,186
AW 77,187
AW 78,188
AW 79,189
AR 186,92
AR 187,93
AR 188,94
AR 189,95
U1 186,186,185
U1 187,187,185
U1 188,188,185
U1 189,189,185
AW 92,186
AW 93,187
AW 94,188
AW 95,189
AR 186,108
AR 187,109
AR 188,110
AR 189,111
U1 186,186,185
U1 187,187,185
U1 188,188,185
U1 189,189,185
AW 108,186
AW 109,187
AW 110,188
AW 111,189
AR 186,124
AR 187,125
AR 188,126
AR 189,127
U1 186,186,185
U1 187,187,185
U1 188,188,185
U1 189,189,185
AW 124,186
AW 125,187
AW 126,188
AW 127,189
E 8,72
E 9,73
E 10,74
E 11,75
s_nop 1
s_branch fbret_i1
mask_m0:
V 21,0xff800000
s_cmp_eq_u32 s31,s32
s_cbranch_scc0 mask2_m0
K1 96,96,21,46
K1 97,97,21,48
K1 98,98,21,50
K1 99,99,21,52
K1 116,116,21,46
K1 117,117,21,48
K1 118,118,21,50
K1 119,119,21,52
V 112,0xff800000
V 113,0xff800000
V 114,0xff800000
V 115,0xff800000
s_branch maskret_m0
mask2_m0:
V 96,0xff800000
V 97,0xff800000
V 98,0xff800000
V 99,0xff800000
V 100,0xff800000
V 101,0xff800000
V 102,0xff800000
V 103,0xff800000
V 112,0xff800000
V 113,0xff800000
V 114,0xff800000
V 115,0xff800000
V 116,0xff800000
V 117,0xff800000
V 118,0xff800000
V 119,0xff800000
s_cmp_eq_u32 s30,3
s_cbranch_scc0 maskret_m0
K1 104,104,21,46
K1 105,105,21,48
K1 106,106,21,50
K1 107,107,21,52
K1 124,124,21,46
K1 125,125,21,48
K1 126,126,21,50
K1 127,127,21,52
V 120,0xff800000
V 121,0xff800000
V 122,0xff800000
V 123,0xff800000
s_branch maskret_m0
fb_m0:
s_nop 7
s_nop 7
v_max3_f32 v184,v64,v65,v66
v_max3_f32 v184,v184,v67,v80
v_max3_f32 v184,v184,v81,v82
v_max_f32 v184,v184,v83
v_log_f32 v186,v180
s_nop 0
v_max3_f32 v184,v184,v186,0
V1 186,184
s_nop 1
v_permlane16_swap_b32 v186,v184
s_nop 1
v_max_f32 v184,v184,v186
V1 186,184
s_nop 1
v_permlane32_swap_b32 v186,v184
s_nop 1
v_max_f32 v184,v184,v186
E1 185,-v184
s_nop 0
U1 176,180,185
B1 186,64,184
B1 187,65,184
E 186,186
E 187,187
s_nop 0
A 176,176,186
A 176,176,187
C 128,186,187
B1 186,66,184
B1 187,67,184
E 186,186
E 187,187
s_nop 0
A 176,176,186
A 176,176,187
C 129,186,187
B1 186,80,184
B1 187,81,184
E 186,186
E 187,187
s_nop 0
A 176,176,186
A 176,176,187
C 130,186,187
B1 186,82,184
B1 187,83,184
E 186,186
E 187,187
s_nop 0
A 176,176,186
A 176,176,187
C 131,186,187
V1 180,176
B1 96,96,184
B1 97,97,184
B1 98,98,184
B1 99,99,184
B1 112,112,184
B1 113,113,184
B1 114,114,184
B1 115,115,184
B1 160,160,184
B1 161,161,184
B1 162,162,184
B1 163,163,184
AR 186,0
AR 187,1
AR 188,2
AR 189,3
U1 186,186,185
U1 187,187,185
U1 188,188,185
U1 189,189,185
AW 0,186
AW 1,187
AW 2,188
AW 3,189
AR 186,16
AR 187,17
AR 188,18
AR 189,19
U1 186,186,185
U1 187,187,185
U1 188,188,185
U1 189,189,185
AW 16,186
AW 17,187
AW 18,188
AW 19,189
AR 186,32
AR 187,33
AR 188,34
AR 189,35
U1 186,186,185
U1 187,187,185
U1 188,188,185
U1 189,189,185
AW 32,186
AW 33,187
AW 34,188
AW 35,189
AR 186,48
AR 187,49
AR 188,50
AR 189,51
U1 186,186,185
U1 187,187,185
U1 188,188,185
U1 189,189,185
AW 48,186
AW 49,187
AW 50,188
AW 51,189
AR 186,64
AR 187,65
AR 188,66
AR 189,67
U1 186,186,185
U1 187,187,185
U1 188,188,185
U1 189,189,185
AW 64,186
AW 65,187
AW 66,188
AW 67,189
AR 186,80
AR 187,81
AR 188,82
AR 189,83
U1 186,186,185
U1 187,187,185
U1 188,188,185
U1 189,189,185
AW 80,186
AW 81,187
AW 82,188
AW 83,189
AR 186,96
AR 187,97
AR 188,98
AR 189,99
U1 186,186,185
U1 187,187,185
U1 188,188,185
U1 189,189,185
AW 96,186
AW 97,187
AW 98,188
AW 99,189
AR 186,112
AR 187,113
AR 188,114
AR 189,115
U1 186,186,185
U1 187,187,185
U1 188,188,185
U1 189,189,185
AW 112,186
AW 113,187
AW 114,188
AW 115,189
v_max3_f32 v184,v68,v69,v70
v_max3_f32 v184,v184,v71,v84
v_max3_f32 v184,v184,v85,v86
v_max_f32 v184,v184,v87
v_log_f32 v186,v181
s_nop 0
v_max3_f32 v184,v184,v186,0
V1 186,184
s_nop 1
v_permlane16_swap_b32 v186,v184
s_nop 1
v_max_f32 v184,v184,v186
V1 186,184
s_nop 1
v_permlane32_swap_b32 v186,v184
s_nop 1
v_max_f32 v184,v184,v186
E1 185,-v184
s_nop 0
U1 177,181,185
B1 186,68,184
B1 187,69,184
E 186,186
E 187,187
s_nop 0
A 177,177,186
A 177,177,187
C 132,186,187
B1 186,70,184
B1 187,71,184
E 186,186
E 187,187
s_nop 0
A 177,177,186
A 177,177,187
C 133,186,187
B1 186,84,184
B1 187,85,184
E 186,186
E 187,187
s_nop 0
A 177,177,186
A 177,177,187
C 134,186,187
B1 186,86,184
B1 187,87,184
E 186,186
E 187,187
s_nop 0
A 177,177,186
A 177,177,187
C 135,186,187
V1 181,177
B1 100,100,184
B1 101,101,184
B1 102,102,184
B1 103,103,184
B1 116,116,184
B1 117,117,184
B1 118,118,184
B1 119,119,184
B1 164,164,184
B1 165,165,184
B1 166,166,184
B1 167,167,184
AR 186,4
AR 187,5
AR 188,6
AR 189,7
U1 186,186,185
U1 187,187,185
U1 188,188,185
U1 189,189,185
AW 4,186
AW 5,187
AW 6,188
AW 7,189
AR 186,20
AR 187,21
AR 188,22
AR 189,23
U1 186,186,185
U1 187,187,185
U1 188,188,185
U1 189,189,185
AW 20,186
AW 21,187
AW 22,188
AW 23,189
AR 186,36
AR 187,37
AR 188,38
AR 189,39
U1 186,186,185
U1 187,187,185
U1 188,188,185
U1 189,189,185
AW 36,186
AW 37,187
AW 38,188
AW 39,189
AR 186,52
AR 187,53
AR 188,54
AR 189,55
U1 186,186,185
U1 187,187,185
U1 188,188,185
U1 189,189,185
AW 52,186
AW 53,187
AW 54,188
AW 55,189
AR 186,68
AR 187,69
AR 188,70
AR 189,71
U1 186,186,185
U1 187,187,185
U1 188,188,185
U1 189,189,185
AW 68,186
AW 69,187
AW 70,188
AW 71,189
AR 186,84
AR 187,85
AR 188,86
AR 189,87
U1 186,186,185
U1 187,187,185
U1 188,188,185
U1 189,189,185
AW 84,186
AW 85,187
AW 86,188
AW 87,189
AR 186,100
AR 187,101
AR 188,102
AR 189,103
U1 186,186,185
U1 187,187,185
U1 188,188,185
U1 189,189,185
AW 100,186
AW 101,187
AW 102,188
AW 103,189
AR 186,116
AR 187,117
AR 188,118
AR 189,119
U1 186,186,185
U1 187,187,185
U1 188,188,185
U1 189,189,185
AW 116,186
AW 117,187
AW 118,188
AW 119,189
v_max3_f32 v184,v72,v73,v74
v_max3_f32 v184,v184,v75,v88
v_max3_f32 v184,v184,v89,v90
v_max_f32 v184,v184,v91
v_log_f32 v186,v56
s_nop 0
v_max3_f32 v184,v184,v186,0
V1 186,184
s_nop 1
v_permlane16_swap_b32 v186,v184
s_nop 1
v_max_f32 v184,v184,v186
V1 186,184
s_nop 1
v_permlane32_swap_b32 v186,v184
s_nop 1
v_max_f32 v184,v184,v186
E1 185,-v184
s_nop 0
V 178,0
B1 186,72,184
B1 187,73,184
E 186,186
E 187,187
s_nop 0
A 178,178,186
A 178,178,187
C 136,186,187
B1 186,74,184
B1 187,75,184
E 186,186
E 187,187
s_nop 0
A 178,178,186
A 178,178,187
C 137,186,187
B1 186,88,184
B1 187,89,184
E 186,186
E 187,187
s_nop 0
A 178,178,186
A 178,178,187
C 138,186,187
B1 186,90,184
B1 187,91,184
E 186,186
E 187,187
s_nop 0
A 178,178,186
A 178,178,187
C 139,186,187
V1 186,178
s_nop 1
v_permlane16_swap_b32 v186,v178
s_nop 1
A 178,178,186
V1 186,178
s_nop 1
v_permlane32_swap_b32 v186,v178
s_nop 1
A 178,178,186
F1 40,56,185,178
F1 41,56,185,178
F1 42,56,185,178
F1 43,56,185,178
V1 56,40
B1 104,104,184
B1 105,105,184
B1 106,106,184
B1 107,107,184
B1 120,120,184
B1 121,121,184
B1 122,122,184
B1 123,123,184
B1 168,168,184
B1 169,169,184
B1 170,170,184
B1 171,171,184
AR 186,8
AR 187,9
AR 188,10
AR 189,11
U1 186,186,185
U1 187,187,185
U1 188,188,185
U1 189,189,185
AW 8,186
AW 9,187
AW 10,188
AW 11,189
AR 186,24
AR 187,25
AR 188,26
AR 189,27
U1 186,186,185
U1 187,187,185
U1 188,188,185
U1 189,189,185
AW 24,186
AW 25,187
AW 26,188
AW 27,189
AR 186,40
AR 187,41
AR 188,42
AR 189,43
U1 186,186,185
U1 187,187,185
U1 188,188,185
U1 189,189,185
AW 40,186
AW 41,187
AW 42,188
AW 43,189
AR 186,56
AR 187,57
AR 188,58
AR 189,59
U1 186,186,185
U1 187,187,185
U1 188,188,185
U1 189,189,185
AW 56,186
AW 57,187
AW 58,188
AW 59,189
AR 186,72
AR 187,73
AR 188,74
AR 189,75
U1 186,186,185
U1 187,187,185
U1 188,188,185
U1 189,189,185
AW 72,186
AW 73,187
AW 74,188
AW 75,189
AR 186,88
AR 187,89
AR 188,90
AR 189,91
U1 186,186,185
U1 187,187,185
U1 188,188,185
U1 189,189,185
AW 88,186
AW 89,187
AW 90,188
AW 91,189
AR 186,104
AR 187,105
AR 188,106
AR 189,107
U1 186,186,185
U1 187,187,185
U1 188,188,185
U1 189,189,185
AW 104,186
AW 105,187
AW 106,188
AW 107,189
AR 186,120
AR 187,121
AR 188,122
AR 189,123
U1 186,186,185
U1 187,187,185
U1 188,188,185
U1 189,189,185
AW 120,186
AW 121,187
AW 122,188
AW 123,189
v_max3_f32 v184,v76,v77,v78
v_max3_f32 v184,v184,v79,v92
v_max3_f32 v184,v184,v93,v94
v_max_f32 v184,v184,v95
v_log_f32 v186,v60
s_nop 0
v_max3_f32 v184,v184,v186,0
V1 186,184
s_nop 1
v_permlane16_swap_b32 v186,v184
s_nop 1
v_max_f32 v184,v184,v186
V1 186,184
s_nop 1
v_permlane32_swap_b32 v186,v184
s_nop 1
v_max_f32 v184,v184,v186
E1 185,-v184
s_nop 0
V 179,0
B1 186,76,184
B1 187,77,184
E 186,186
E 187,187
s_nop 0
A 179,179,186
A 179,179,187
C 140,186,187
B1 186,78,184
B1 187,79,184
E 186,186
E 187,187
s_nop 0
A 179,179,186
A 179,179,187
C 141,186,187
B1 186,92,184
B1 187,93,184
E 186,186
E 187,187
s_nop 0
A 179,179,186
A 179,179,187
C 142,186,187
B1 186,94,184
B1 187,95,184
E 186,186
E 187,187
s_nop 0
A 179,179,186
A 179,179,187
C 143,186,187
V1 186,179
s_nop 1
v_permlane16_swap_b32 v186,v179
s_nop 1
A 179,179,186
V1 186,179
s_nop 1
v_permlane32_swap_b32 v186,v179
s_nop 1
A 179,179,186
F1 44,60,185,179
F1 45,60,185,179
F1 46,60,185,179
F1 47,60,185,179
V1 60,44
B1 108,108,184
B1 109,109,184
B1 110,110,184
B1 111,111,184
B1 124,124,184
B1 125,125,184
B1 126,126,184
B1 127,127,184
B1 172,172,184
B1 173,173,184
B1 174,174,184
B1 175,175,184
AR 186,12
AR 187,13
AR 188,14
AR 189,15
U1 186,186,185
U1 187,187,185
U1 188,188,185
U1 189,189,185
AW 12,186
AW 13,187
AW 14,188
AW 15,189
AR 186,28
AR 187,29
AR 188,30
AR 189,31
U1 186,186,185
U1 187,187,185
U1 188,188,185
U1 189,189,185
AW 28,186
AW 29,187
AW 30,188
AW 31,189
AR 186,44
AR 187,45
AR 188,46
AR 189,47
U1 186,186,185
U1 187,187,185
U1 188,188,185
U1 189,189,185
AW 44,186
AW 45,187
AW 46,188
AW 47,189
AR 186,60
AR 187,61
AR 188,62
AR 189,63
U1 186,186,185
U1 187,187,185
U1 188,188,185
U1 189,189,185
AW 60,186
AW 61,187
AW 62,188
AW 63,189
AR 186,76
AR 187,77
AR 188,78
AR 189,79
U1 186,186,185
U1 187,187,185
U1 188,188,185
U1 189,189,185
AW 76,186
AW 77,187
AW 78,188
AW 79,189
AR 186,92
AR 187,93
AR 188,94
AR 189,95
U1 186,186,185
U1 187,187,185
U1 188,188,185
U1 189,189,185
AW 92,186
AW 93,187
AW 94,188
AW 95,189
AR 186,108
AR 187,109
AR 188,110
AR 189,111
U1 186,186,185
U1 187,187,185
U1 188,188,185
U1 189,189,185
AW 108,186
AW 109,187
AW 110,188
AW 111,189
AR 186,124
AR 187,125
AR 188,126
AR 189,127
U1 186,186,185
U1 187,187,185
U1 188,188,185
U1 189,189,185
AW 124,186
AW 125,187
AW 126,188
AW 127,189
E 8,104
E 9,105
E 10,106
E 11,107
s_nop 1
s_branch fbret_m0
mask_m1:
V 21,0xff800000
s_cmp_eq_u32 s31,s32
s_cbranch_scc0 mask2_m1
K1 64,64,21,46
K1 65,65,21,48
K1 66,66,21,50
K1 67,67,21,52
K1 84,84,21,46
K1 85,85,21,48
K1 86,86,21,50
K1 87,87,21,52
V 80,0xff800000
V 81,0xff800000
V 82,0xff800000
V 83,0xff800000
s_branch maskret_m1
mask2_m1:
V 64,0xff800000
V 65,0xff800000
V 66,0xff800000
V 67,0xff800000
V 68,0xff800000
V 69,0xff800000
V 70,0xff800000
V 71,0xff800000
V 80,0xff800000
V 81,0xff800000
V 82,0xff800000
V 83,0xff800000
V 84,0xff800000
V 85,0xff800000
V 86,0xff800000
V 87,0xff800000
s_cmp_eq_u32 s30,3
s_cbranch_scc0 maskret_m1
K1 72,72,21,46
K1 73,73,21,48
K1 74,74,21,50
K1 75,75,21,52
K1 92,92,21,46
K1 93,93,21,48
K1 94,94,21,50
K1 95,95,21,52
V 88,0xff800000
V 89,0xff800000
V 90,0xff800000
V 91,0xff800000
s_branch maskret_m1
fb_m1:
s_nop 7
s_nop 7
v_max3_f32 v184,v96,v97,v98
v_max3_f32 v184,v184,v99,v112
v_max3_f32 v184,v184,v113,v114
v_max_f32 v184,v184,v115
v_log_f32 v186,v176
s_nop 0
v_max3_f32 v184,v184,v186,0
V1 186,184
s_nop 1
v_permlane16_swap_b32 v186,v184
s_nop 1
v_max_f32 v184,v184,v186
V1 186,184
s_nop 1
v_permlane32_swap_b32 v186,v184
s_nop 1
v_max_f32 v184,v184,v186
E1 185,-v184
s_nop 0
U1 180,176,185
B1 186,96,184
B1 187,97,184
E 186,186
E 187,187
s_nop 0
A 180,180,186
A 180,180,187
C 144,186,187
B1 186,98,184
B1 187,99,184
E 186,186
E 187,187
s_nop 0
A 180,180,186
A 180,180,187
C 145,186,187
B1 186,112,184
B1 187,113,184
E 186,186
E 187,187
s_nop 0
A 180,180,186
A 180,180,187
C 146,186,187
B1 186,114,184
B1 187,115,184
E 186,186
E 187,187
s_nop 0
A 180,180,186
A 180,180,187
C 147,186,187
V1 176,180
B1 64,64,184
B1 65,65,184
B1 66,66,184
B1 67,67,184
B1 80,80,184
B1 81,81,184
B1 82,82,184
B1 83,83,184
B1 160,160,184
B1 161,161,184
B1 162,162,184
B1 163,163,184
AR 186,0
AR 187,1
AR 188,2
AR 189,3
U1 186,186,185
U1 187,187,185
U1 188,188,185
U1 189,189,185
AW 0,186
AW 1,187
AW 2,188
AW 3,189
AR 186,16
AR 187,17
AR 188,18
AR 189,19
U1 186,186,185
U1 187,187,185
U1 188,188,185
U1 189,189,185
AW 16,186
AW 17,187
AW 18,188
AW 19,189
AR 186,32
AR 187,33
AR 188,34
AR 189,35
U1 186,186,185
U1 187,187,185
U1 188,188,185
U1 189,189,185
AW 32,186
AW 33,187
AW 34,188
AW 35,189
AR 186,48
AR 187,49
AR 188,50
AR 189,51
U1 186,186,185
U1 187,187,185
U1 188,188,185
U1 189,189,185
AW 48,186
AW 49,187
AW 50,188
AW 51,189
AR 186,64
AR 187,65
AR 188,66
AR 189,67
U1 186,186,185
U1 187,187,185
U1 188,188,185
U1 189,189,185
AW 64,186
AW 65,187
AW 66,188
AW 67,189
AR 186,80
AR 187,81
AR 188,82
AR 189,83
U1 186,186,185
U1 187,187,185
U1 188,188,185
U1 189,189,185
AW 80,186
AW 81,187
AW 82,188
AW 83,189
AR 186,96
AR 187,97
AR 188,98
AR 189,99
U1 186,186,185
U1 187,187,185
U1 188,188,185
U1 189,189,185
AW 96,186
AW 97,187
AW 98,188
AW 99,189
AR 186,112
AR 187,113
AR 188,114
AR 189,115
U1 186,186,185
U1 187,187,185
U1 188,188,185
U1 189,189,185
AW 112,186
AW 113,187
AW 114,188
AW 115,189
v_max3_f32 v184,v100,v101,v102
v_max3_f32 v184,v184,v103,v116
v_max3_f32 v184,v184,v117,v118
v_max_f32 v184,v184,v119
v_log_f32 v186,v177
s_nop 0
v_max3_f32 v184,v184,v186,0
V1 186,184
s_nop 1
v_permlane16_swap_b32 v186,v184
s_nop 1
v_max_f32 v184,v184,v186
V1 186,184
s_nop 1
v_permlane32_swap_b32 v186,v184
s_nop 1
v_max_f32 v184,v184,v186
E1 185,-v184
s_nop 0
U1 181,177,185
B1 186,100,184
B1 187,101,184
E 186,186
E 187,187
s_nop 0
A 181,181,186
A 181,181,187
C 148,186,187
B1 186,102,184
B1 187,103,184
E 186,186
E 187,187
s_nop 0
A 181,181,186
A 181,181,187
C 149,186,187
B1 186,116,184
B1 187,117,184
E 186,186
E 187,187
s_nop 0
A 181,181,186
A 181,181,187
C 150,186,187
B1 186,118,184
B1 187,119,184
E 186,186
E 187,187
s_nop 0
A 181,181,186
A 181,181,187
C 151,186,187
V1 177,181
B1 68,68,184
B1 69,69,184
B1 70,70,184
B1 71,71,184
B1 84,84,184
B1 85,85,184
B1 86,86,184
B1 87,87,184
B1 164,164,184
B1 165,165,184
B1 166,166,184
B1 167,167,184
AR 186,4
AR 187,5
AR 188,6
AR 189,7
U1 186,186,185
U1 187,187,185
U1 188,188,185
U1 189,189,185
AW 4,186
AW 5,187
AW 6,188
AW 7,189
AR 186,20
AR 187,21
AR 188,22
AR 189,23
U1 186,186,185
U1 187,187,185
U1 188,188,185
U1 189,189,185
AW 20,186
AW 21,187
AW 22,188
AW 23,189
AR 186,36
AR 187,37
AR 188,38
AR 189,39
U1 186,186,185
U1 187,187,185
U1 188,188,185
U1 189,189,185
AW 36,186
AW 37,187
AW 38,188
AW 39,189
AR 186,52
AR 187,53
AR 188,54
AR 189,55
U1 186,186,185
U1 187,187,185
U1 188,188,185
U1 189,189,185
AW 52,186
AW 53,187
AW 54,188
AW 55,189
AR 186,68
AR 187,69
AR 188,70
AR 189,71
U1 186,186,185
U1 187,187,185
U1 188,188,185
U1 189,189,185
AW 68,186
AW 69,187
AW 70,188
AW 71,189
AR 186,84
AR 187,85
AR 188,86
AR 189,87
U1 186,186,185
U1 187,187,185
U1 188,188,185
U1 189,189,185
AW 84,186
AW 85,187
AW 86,188
AW 87,189
AR 186,100
AR 187,101
AR 188,102
AR 189,103
U1 186,186,185
U1 187,187,185
U1 188,188,185
U1 189,189,185
AW 100,186
AW 101,187
AW 102,188
AW 103,189
AR 186,116
AR 187,117
AR 188,118
AR 189,119
U1 186,186,185
U1 187,187,185
U1 188,188,185
U1 189,189,185
AW 116,186
AW 117,187
AW 118,188
AW 119,189
v_max3_f32 v184,v104,v105,v106
v_max3_f32 v184,v184,v107,v120
v_max3_f32 v184,v184,v121,v122
v_max_f32 v184,v184,v123
v_log_f32 v186,v40
s_nop 0
v_max3_f32 v184,v184,v186,0
V1 186,184
s_nop 1
v_permlane16_swap_b32 v186,v184
s_nop 1
v_max_f32 v184,v184,v186
V1 186,184
s_nop 1
v_permlane32_swap_b32 v186,v184
s_nop 1
v_max_f32 v184,v184,v186
E1 185,-v184
s_nop 0
V 182,0
B1 186,104,184
B1 187,105,184
E 186,186
E 187,187
s_nop 0
A 182,182,186
A 182,182,187
C 152,186,187
B1 186,106,184
B1 187,107,184
E 186,186
E 187,187
s_nop 0
A 182,182,186
A 182,182,187
C 153,186,187
B1 186,120,184
B1 187,121,184
E 186,186
E 187,187
s_nop 0
A 182,182,186
A 182,182,187
C 154,186,187
B1 186,122,184
B1 187,123,184
E 186,186
E 187,187
s_nop 0
A 182,182,186
A 182,182,187
C 155,186,187
V1 186,182
s_nop 1
v_permlane16_swap_b32 v186,v182
s_nop 1
A 182,182,186
V1 186,182
s_nop 1
v_permlane32_swap_b32 v186,v182
s_nop 1
A 182,182,186
F1 56,40,185,182
F1 57,40,185,182
F1 58,40,185,182
F1 59,40,185,182
V1 40,56
B1 72,72,184
B1 73,73,184
B1 74,74,184
B1 75,75,184
B1 88,88,184
B1 89,89,184
B1 90,90,184
B1 91,91,184
B1 168,168,184
B1 169,169,184
B1 170,170,184
B1 171,171,184
AR 186,8
AR 187,9
AR 188,10
AR 189,11
U1 186,186,185
U1 187,187,185
U1 188,188,185
U1 189,189,185
AW 8,186
AW 9,187
AW 10,188
AW 11,189
AR 186,24
AR 187,25
AR 188,26
AR 189,27
U1 186,186,185
U1 187,187,185
U1 188,188,185
U1 189,189,185
AW 24,186
AW 25,187
AW 26,188
AW 27,189
AR 186,40
AR 187,41
AR 188,42
AR 189,43
U1 186,186,185
U1 187,187,185
U1 188,188,185
U1 189,189,185
AW 40,186
AW 41,187
AW 42,188
AW 43,189
AR 186,56
AR 187,57
AR 188,58
AR 189,59
U1 186,186,185
U1 187,187,185
U1 188,188,185
U1 189,189,185
AW 56,186
AW 57,187
AW 58,188
AW 59,189
AR 186,72
AR 187,73
AR 188,74
AR 189,75
U1 186,186,185
U1 187,187,185
U1 188,188,185
U1 189,189,185
AW 72,186
AW 73,187
AW 74,188
AW 75,189
AR 186,88
AR 187,89
AR 188,90
AR 189,91
U1 186,186,185
U1 187,187,185
U1 188,188,185
U1 189,189,185
AW 88,186
AW 89,187
AW 90,188
AW 91,189
AR 186,104
AR 187,105
AR 188,106
AR 189,107
U1 186,186,185
U1 187,187,185
U1 188,188,185
U1 189,189,185
AW 104,186
AW 105,187
AW 106,188
AW 107,189
AR 186,120
AR 187,121
AR 188,122
AR 189,123
U1 186,186,185
U1 187,187,185
U1 188,188,185
U1 189,189,185
AW 120,186
AW 121,187
AW 122,188
AW 123,189
v_max3_f32 v184,v108,v109,v110
v_max3_f32 v184,v184,v111,v124
v_max3_f32 v184,v184,v125,v126
v_max_f32 v184,v184,v127
v_log_f32 v186,v44
s_nop 0
v_max3_f32 v184,v184,v186,0
V1 186,184
s_nop 1
v_permlane16_swap_b32 v186,v184
s_nop 1
v_max_f32 v184,v184,v186
V1 186,184
s_nop 1
v_permlane32_swap_b32 v186,v184
s_nop 1
v_max_f32 v184,v184,v186
E1 185,-v184
s_nop 0
V 183,0
B1 186,108,184
B1 187,109,184
E 186,186
E 187,187
s_nop 0
A 183,183,186
A 183,183,187
C 156,186,187
B1 186,110,184
B1 187,111,184
E 186,186
E 187,187
s_nop 0
A 183,183,186
A 183,183,187
C 157,186,187
B1 186,124,184
B1 187,125,184
E 186,186
E 187,187
s_nop 0
A 183,183,186
A 183,183,187
C 158,186,187
B1 186,126,184
B1 187,127,184
E 186,186
E 187,187
s_nop 0
A 183,183,186
A 183,183,187
C 159,186,187
V1 186,183
s_nop 1
v_permlane16_swap_b32 v186,v183
s_nop 1
A 183,183,186
V1 186,183
s_nop 1
v_permlane32_swap_b32 v186,v183
s_nop 1
A 183,183,186
F1 60,44,185,183
F1 61,44,185,183
F1 62,44,185,183
F1 63,44,185,183
V1 44,60
B1 76,76,184
B1 77,77,184
B1 78,78,184
B1 79,79,184
B1 92,92,184
B1 93,93,184
B1 94,94,184
B1 95,95,184
B1 172,172,184
B1 173,173,184
B1 174,174,184
B1 175,175,184
AR 186,12
AR 187,13
AR 188,14
AR 189,15
U1 186,186,185
U1 187,187,185
U1 188,188,185
U1 189,189,185
AW 12,186
AW 13,187
AW 14,188
AW 15,189
AR 186,28
AR 187,29
AR 188,30
AR 189,31
U1 186,186,185
U1 187,187,185
U1 188,188,185
U1 189,189,185
AW 28,186
AW 29,187
AW 30,188
AW 31,189
AR 186,44
AR 187,45
AR 188,46
AR 189,47
U1 186,186,185
U1 187,187,185
U1 188,188,185
U1 189,189,185
AW 44,186
AW 45,187
AW 46,188
AW 47,189
AR 186,60
AR 187,61
AR 188,62
AR 189,63
U1 186,186,185
U1 187,187,185
U1 188,188,185
U1 189,189,185
AW 60,186
AW 61,187
AW 62,188
AW 63,189
AR 186,76
AR 187,77
AR 188,78
AR 189,79
U1 186,186,185
U1 187,187,185
U1 188,188,185
U1 189,189,185
AW 76,186
AW 77,187
AW 78,188
AW 79,189
AR 186,92
AR 187,93
AR 188,94
AR 189,95
U1 186,186,185
U1 187,187,185
U1 188,188,185
U1 189,189,185
AW 92,186
AW 93,187
AW 94,188
AW 95,189
AR 186,108
AR 187,109
AR 188,110
AR 189,111
U1 186,186,185
U1 187,187,185
U1 188,188,185
U1 189,189,185
AW 108,186
AW 109,187
AW 110,188
AW 111,189
AR 186,124
AR 187,125
AR 188,126
AR 189,127
U1 186,186,185
U1 187,187,185
U1 188,188,185
U1 189,189,185
AW 124,186
AW 125,187
AW 126,188
AW 127,189
E 8,72
E 9,73
E 10,74
E 11,75
s_nop 1
s_branch fbret_m1
mask_b0:
V 21,0xff800000
s_cmp_eq_u32 s31,s32
s_cbranch_scc0 mask2_b0
K1 96,96,21,46
K1 97,97,21,48
K1 98,98,21,50
K1 99,99,21,52
K1 116,116,21,46
K1 117,117,21,48
K1 118,118,21,50
K1 119,119,21,52
V 112,0xff800000
V 113,0xff800000
V 114,0xff800000
V 115,0xff800000
s_branch maskret_b0
mask2_b0:
V 96,0xff800000
V 97,0xff800000
V 98,0xff800000
V 99,0xff800000
V 100,0xff800000
V 101,0xff800000
V 102,0xff800000
V 103,0xff800000
V 112,0xff800000
V 113,0xff800000
V 114,0xff800000
V 115,0xff800000
V 116,0xff800000
V 117,0xff800000
V 118,0xff800000
V 119,0xff800000
s_cmp_eq_u32 s30,3
s_cbranch_scc0 maskret_b0
K1 104,104,21,46
K1 105,105,21,48
K1 106,106,21,50
K1 107,107,21,52
K1 124,124,21,46
K1 125,125,21,48
K1 126,126,21,50
K1 127,127,21,52
V 120,0xff800000
V 121,0xff800000
V 122,0xff800000
V 123,0xff800000
s_branch maskret_b0
fb_b0:
s_nop 7
s_nop 7
v_max3_f32 v184,v64,v65,v66
v_max3_f32 v184,v184,v67,v80
v_max3_f32 v184,v184,v81,v82
v_max_f32 v184,v184,v83
v_log_f32 v186,v180
s_nop 0
v_max3_f32 v184,v184,v186,0
V1 186,184
s_nop 1
v_permlane16_swap_b32 v186,v184
s_nop 1
v_max_f32 v184,v184,v186
V1 186,184
s_nop 1
v_permlane32_swap_b32 v186,v184
s_nop 1
v_max_f32 v184,v184,v186
E1 185,-v184
s_nop 0
U1 176,180,185
B1 186,64,184
B1 187,65,184
E 186,186
E 187,187
s_nop 0
A 176,176,186
A 176,176,187
C 128,186,187
B1 186,66,184
B1 187,67,184
E 186,186
E 187,187
s_nop 0
A 176,176,186
A 176,176,187
C 129,186,187
B1 186,80,184
B1 187,81,184
E 186,186
E 187,187
s_nop 0
A 176,176,186
A 176,176,187
C 130,186,187
B1 186,82,184
B1 187,83,184
E 186,186
E 187,187
s_nop 0
A 176,176,186
A 176,176,187
C 131,186,187
V1 180,176
B1 96,96,184
B1 97,97,184
B1 98,98,184
B1 99,99,184
B1 112,112,184
B1 113,113,184
B1 114,114,184
B1 115,115,184
B1 160,160,184
B1 161,161,184
B1 162,162,184
B1 163,163,184
AR 186,0
AR 187,1
AR 188,2
AR 189,3
U1 186,186,185
U1 187,187,185
U1 188,188,185
U1 189,189,185
AW 0,186
AW 1,187
AW 2,188
AW 3,189
AR 186,16
AR 187,17
AR 188,18
AR 189,19
U1 186,186,185
U1 187,187,185
U1 188,188,185
U1 189,189,185
AW 16,186
AW 17,187
AW 18,188
AW 19,189
AR 186,32
AR 187,33
AR 188,34
AR 189,35
U1 186,186,185
U1 187,187,185
U1 188,188,185
U1 189,189,185
AW 32,186
AW 33,187
AW 34,188
AW 35,189
AR 186,48
AR 187,49
AR 188,50
AR 189,51
U1 186,186,185
U1 187,187,185
U1 188,188,185
U1 189,189,185
AW 48,186
AW 49,187
AW 50,188
AW 51,189
AR 186,64
AR 187,65
AR 188,66
AR 189,67
U1 186,186,185
U1 187,187,185
U1 188,188,185
U1 189,189,185
AW 64,186
AW 65,187
AW 66,188
AW 67,189
AR 186,80
AR 187,81
AR 188,82
AR 189,83
U1 186,186,185
U1 187,187,185
U1 188,188,185
U1 189,189,185
AW 80,186
AW 81,187
AW 82,188
AW 83,189
AR 186,96
AR 187,97
AR 188,98
AR 189,99
U1 186,186,185
U1 187,187,185
U1 188,188,185
U1 189,189,185
AW 96,186
AW 97,187
AW 98,188
AW 99,189
AR 186,112
AR 187,113
AR 188,114
AR 189,115
U1 186,186,185
U1 187,187,185
U1 188,188,185
U1 189,189,185
AW 112,186
AW 113,187
AW 114,188
AW 115,189
v_max3_f32 v184,v68,v69,v70
v_max3_f32 v184,v184,v71,v84
v_max3_f32 v184,v184,v85,v86
v_max_f32 v184,v184,v87
v_log_f32 v186,v181
s_nop 0
v_max3_f32 v184,v184,v186,0
V1 186,184
s_nop 1
v_permlane16_swap_b32 v186,v184
s_nop 1
v_max_f32 v184,v184,v186
V1 186,184
s_nop 1
v_permlane32_swap_b32 v186,v184
s_nop 1
v_max_f32 v184,v184,v186
E1 185,-v184
s_nop 0
U1 177,181,185
B1 186,68,184
B1 187,69,184
E 186,186
E 187,187
s_nop 0
A 177,177,186
A 177,177,187
C 132,186,187
B1 186,70,184
B1 187,71,184
E 186,186
E 187,187
s_nop 0
A 177,177,186
A 177,177,187
C 133,186,187
B1 186,84,184
B1 187,85,184
E 186,186
E 187,187
s_nop 0
A 177,177,186
A 177,177,187
C 134,186,187
B1 186,86,184
B1 187,87,184
E 186,186
E 187,187
s_nop 0
A 177,177,186
A 177,177,187
C 135,186,187
V1 181,177
B1 100,100,184
B1 101,101,184
B1 102,102,184
B1 103,103,184
B1 116,116,184
B1 117,117,184
B1 118,118,184
B1 119,119,184
B1 164,164,184
B1 165,165,184
B1 166,166,184
B1 167,167,184
AR 186,4
AR 187,5
AR 188,6
AR 189,7
U1 186,186,185
U1 187,187,185
U1 188,188,185
U1 189,189,185
AW 4,186
AW 5,187
AW 6,188
AW 7,189
AR 186,20
AR 187,21
AR 188,22
AR 189,23
U1 186,186,185
U1 187,187,185
U1 188,188,185
U1 189,189,185
AW 20,186
AW 21,187
AW 22,188
AW 23,189
AR 186,36
AR 187,37
AR 188,38
AR 189,39
U1 186,186,185
U1 187,187,185
U1 188,188,185
U1 189,189,185
AW 36,186
AW 37,187
AW 38,188
AW 39,189
AR 186,52
AR 187,53
AR 188,54
AR 189,55
U1 186,186,185
U1 187,187,185
U1 188,188,185
U1 189,189,185
AW 52,186
AW 53,187
AW 54,188
AW 55,189
AR 186,68
AR 187,69
AR 188,70
AR 189,71
U1 186,186,185
U1 187,187,185
U1 188,188,185
U1 189,189,185
AW 68,186
AW 69,187
AW 70,188
AW 71,189
AR 186,84
AR 187,85
AR 188,86
AR 189,87
U1 186,186,185
U1 187,187,185
U1 188,188,185
U1 189,189,185
AW 84,186
AW 85,187
AW 86,188
AW 87,189
AR 186,100
AR 187,101
AR 188,102
AR 189,103
U1 186,186,185
U1 187,187,185
U1 188,188,185
U1 189,189,185
AW 100,186
AW 101,187
AW 102,188
AW 103,189
AR 186,116
AR 187,117
AR 188,118
AR 189,119
U1 186,186,185
U1 187,187,185
U1 188,188,185
U1 189,189,185
AW 116,186
AW 117,187
AW 118,188
AW 119,189
v_max3_f32 v184,v72,v73,v74
v_max3_f32 v184,v184,v75,v88
v_max3_f32 v184,v184,v89,v90
v_max_f32 v184,v184,v91
v_log_f32 v186,v56
s_nop 0
v_max3_f32 v184,v184,v186,0
V1 186,184
s_nop 1
v_permlane16_swap_b32 v186,v184
s_nop 1
v_max_f32 v184,v184,v186
V1 186,184
s_nop 1
v_permlane32_swap_b32 v186,v184
s_nop 1
v_max_f32 v184,v184,v186
E1 185,-v184
s_nop 0
V 178,0
B1 186,72,184
B1 187,73,184
E 186,186
E 187,187
s_nop 0
A 178,178,186
A 178,178,187
C 136,186,187
B1 186,74,184
B1 187,75,184
E 186,186
E 187,187
s_nop 0
A 178,178,186
A 178,178,187
C 137,186,187
B1 186,88,184
B1 187,89,184
E 186,186
E 187,187
s_nop 0
A 178,178,186
A 178,178,187
C 138,186,187
B1 186,90,184
B1 187,91,184
E 186,186
E 187,187
s_nop 0
A 178,178,186
A 178,178,187
C 139,186,187
V1 186,178
s_nop 1
v_permlane16_swap_b32 v186,v178
s_nop 1
A 178,178,186
V1 186,178
s_nop 1
v_permlane32_swap_b32 v186,v178
s_nop 1
A 178,178,186
F1 40,56,185,178
F1 41,56,185,178
F1 42,56,185,178
F1 43,56,185,178
V1 56,40
B1 104,104,184
B1 105,105,184
B1 106,106,184
B1 107,107,184
B1 120,120,184
B1 121,121,184
B1 122,122,184
B1 123,123,184
B1 168,168,184
B1 169,169,184
B1 170,170,184
B1 171,171,184
AR 186,8
AR 187,9
AR 188,10
AR 189,11
U1 186,186,185
U1 187,187,185
U1 188,188,185
U1 189,189,185
AW 8,186
AW 9,187
AW 10,188
AW 11,189
AR 186,24
AR 187,25
AR 188,26
AR 189,27
U1 186,186,185
U1 187,187,185
U1 188,188,185
U1 189,189,185
AW 24,186
AW 25,187
AW 26,188
AW 27,189
AR 186,40
AR 187,41
AR 188,42
AR 189,43
U1 186,186,185
U1 187,187,185
U1 188,188,185
U1 189,189,185
AW 40,186
AW 41,187
AW 42,188
AW 43,189
AR 186,56
AR 187,57
AR 188,58
AR 189,59
U1 186,186,185
U1 187,187,185
U1 188,188,185
U1 189,189,185
AW 56,186
AW 57,187
AW 58,188
AW 59,189
AR 186,72
AR 187,73
AR 188,74
AR 189,75
U1 186,186,185
U1 187,187,185
U1 188,188,185
U1 189,189,185
AW 72,186
AW 73,187
AW 74,188
AW 75,189
AR 186,88
AR 187,89
AR 188,90
AR 189,91
U1 186,186,185
U1 187,187,185
U1 188,188,185
U1 189,189,185
AW 88,186
AW 89,187
AW 90,188
AW 91,189
AR 186,104
AR 187,105
AR 188,106
AR 189,107
U1 186,186,185
U1 187,187,185
U1 188,188,185
U1 189,189,185
AW 104,186
AW 105,187
AW 106,188
AW 107,189
AR 186,120
AR 187,121
AR 188,122
AR 189,123
U1 186,186,185
U1 187,187,185
U1 188,188,185
U1 189,189,185
AW 120,186
AW 121,187
AW 122,188
AW 123,189
v_max3_f32 v184,v76,v77,v78
v_max3_f32 v184,v184,v79,v92
v_max3_f32 v184,v184,v93,v94
v_max_f32 v184,v184,v95
v_log_f32 v186,v60
s_nop 0
v_max3_f32 v184,v184,v186,0
V1 186,184
s_nop 1
v_permlane16_swap_b32 v186,v184
s_nop 1
v_max_f32 v184,v184,v186
V1 186,184
s_nop 1
v_permlane32_swap_b32 v186,v184
s_nop 1
v_max_f32 v184,v184,v186
E1 185,-v184
s_nop 0
V 179,0
B1 186,76,184
B1 187,77,184
E 186,186
E 187,187
s_nop 0
A 179,179,186
A 179,179,187
C 140,186,187
B1 186,78,184
B1 187,79,184
E 186,186
E 187,187
s_nop 0
A 179,179,186
A 179,179,187
C 141,186,187
B1 186,92,184
B1 187,93,184
E 186,186
E 187,187
s_nop 0
A 179,179,186
A 179,179,187
C 142,186,187
B1 186,94,184
B1 187,95,184
E 186,186
E 187,187
s_nop 0
A 179,179,186
A 179,179,187
C 143,186,187
V1 186,179
s_nop 1
v_permlane16_swap_b32 v186,v179
s_nop 1
A 179,179,186
V1 186,179
s_nop 1
v_permlane32_swap_b32 v186,v179
s_nop 1
A 179,179,186
F1 44,60,185,179
F1 45,60,185,179
F1 46,60,185,179
F1 47,60,185,179
V1 60,44
B1 108,108,184
B1 109,109,184
B1 110,110,184
B1 111,111,184
B1 124,124,184
B1 125,125,184
B1 126,126,184
B1 127,127,184
B1 172,172,184
B1 173,173,184
B1 174,174,184
B1 175,175,184
AR 186,12
AR 187,13
AR 188,14
AR 189,15
U1 186,186,185
U1 187,187,185
U1 188,188,185
U1 189,189,185
AW 12,186
AW 13,187
AW 14,188
AW 15,189
AR 186,28
AR 187,29
AR 188,30
AR 189,31
U1 186,186,185
U1 187,187,185
U1 188,188,185
U1 189,189,185
AW 28,186
AW 29,187
AW 30,188
AW 31,189
AR 186,44
AR 187,45
AR 188,46
AR 189,47
U1 186,186,185
U1 187,187,185
U1 188,188,185
U1 189,189,185
AW 44,186
AW 45,187
AW 46,188
AW 47,189
AR 186,60
AR 187,61
AR 188,62
AR 189,63
U1 186,186,185
U1 187,187,185
U1 188,188,185
U1 189,189,185
AW 60,186
AW 61,187
AW 62,188
AW 63,189
AR 186,76
AR 187,77
AR 188,78
AR 189,79
U1 186,186,185
U1 187,187,185
U1 188,188,185
U1 189,189,185
AW 76,186
AW 77,187
AW 78,188
AW 79,189
AR 186,92
AR 187,93
AR 188,94
AR 189,95
U1 186,186,185
U1 187,187,185
U1 188,188,185
U1 189,189,185
AW 92,186
AW 93,187
AW 94,188
AW 95,189
AR 186,108
AR 187,109
AR 188,110
AR 189,111
U1 186,186,185
U1 187,187,185
U1 188,188,185
U1 189,189,185
AW 108,186
AW 109,187
AW 110,188
AW 111,189
AR 186,124
AR 187,125
AR 188,126
AR 189,127
U1 186,186,185
U1 187,187,185
U1 188,188,185
U1 189,189,185
AW 124,186
AW 125,187
AW 126,188
AW 127,189
E 8,104
E 9,105
E 10,106
E 11,107
s_nop 1
s_branch fbret_b0
mask_s0:
V 21,0xff800000
K1 104,104,21,46
K1 105,105,21,48
K1 106,106,21,50
K1 107,107,21,52
K1 124,124,21,46
K1 125,125,21,48
K1 126,126,21,50
K1 127,127,21,52
V 120,0xff800000
V 121,0xff800000
V 122,0xff800000
V 123,0xff800000
s_branch maskret_s0
fb_s0:
s_nop 7
s_nop 7
v_max3_f32 v184,v72,v73,v74
v_max3_f32 v184,v184,v75,v88
v_max3_f32 v184,v184,v89,v90
v_max_f32 v184,v184,v91
v_log_f32 v186,v56
s_nop 0
v_max3_f32 v184,v184,v186,0
V1 186,184
s_nop 1
v_permlane16_swap_b32 v186,v184
s_nop 1
v_max_f32 v184,v184,v186
V1 186,184
s_nop 1
v_permlane32_swap_b32 v186,v184
s_nop 1
v_max_f32 v184,v184,v186
E1 185,-v184
s_nop 0
V 178,0
B1 186,72,184
B1 187,73,184
E 186,186
E 187,187
s_nop 0
A 178,178,186
A 178,178,187
C 136,186,187
B1 186,74,184
B1 187,75,184
E 186,186
E 187,187
s_nop 0
A 178,178,186
A 178,178,187
C 137,186,187
B1 186,88,184
B1 187,89,184
E 186,186
E 187,187
s_nop 0
A 178,178,186
A 178,178,187
C 138,186,187
B1 186,90,184
B1 187,91,184
E 186,186
E 187,187
s_nop 0
A 178,178,186
A 178,178,187
C 139,186,187
V1 186,178
s_nop 1
v_permlane16_swap_b32 v186,v178
s_nop 1
A 178,178,186
V1 186,178
s_nop 1
v_permlane32_swap_b32 v186,v178
s_nop 1
A 178,178,186
F1 40,56,185,178
F1 41,56,185,178
F1 42,56,185,178
F1 43,56,185,178
V1 56,40
B1 104,104,184
B1 105,105,184
B1 106,106,184
B1 107,107,184
B1 120,120,184
B1 121,121,184
B1 122,122,184
B1 123,123,184
B1 168,168,184
B1 169,169,184
B1 170,170,184
B1 171,171,184
AR 186,8
AR 187,9
AR 188,10
AR 189,11
U1 186,186,185
U1 187,187,185
U1 188,188,185
U1 189,189,185
AW 8,186
AW 9,187
AW 10,188
AW 11,189
AR 186,24
AR 187,25
AR 188,26
AR 189,27
U1 186,186,185
U1 187,187,185
U1 188,188,185
U1 189,189,185
AW 24,186
AW 25,187
AW 26,188
AW 27,189
AR 186,40
AR 187,41
AR 188,42
AR 189,43
U1 186,186,185
U1 187,187,185
U1 188,188,185
U1 189,189,185
AW 40,186
AW 41,187
AW 42,188
AW 43,189
AR 186,56
AR 187,57
AR 188,58
AR 189,59
U1 186,186,185
U1 187,187,185
U1 188,188,185
U1 189,189,185
AW 56,186
AW 57,187
AW 58,188
AW 59,189
AR 186,72
AR 187,73
AR 188,74
AR 189,75
U1 186,186,185
U1 187,187,185
U1 188,188,185
U1 189,189,185
AW 72,186
AW 73,187
AW 74,188
AW 75,189
AR 186,88
AR 187,89
AR 188,90
AR 189,91
U1 186,186,185
U1 187,187,185
U1 188,188,185
U1 189,189,185
AW 88,186
AW 89,187
AW 90,188
AW 91,189
AR 186,104
AR 187,105
AR 188,106
AR 189,107
U1 186,186,185
U1 187,187,185
U1 188,188,185
U1 189,189,185
AW 104,186
AW 105,187
AW 106,188
AW 107,189
AR 186,120
AR 187,121
AR 188,122
AR 189,123
U1 186,186,185
U1 187,187,185
U1 188,188,185
U1 189,189,185
AW 120,186
AW 121,187
AW 122,188
AW 123,189
v_max3_f32 v184,v76,v77,v78
v_max3_f32 v184,v184,v79,v92
v_max3_f32 v184,v184,v93,v94
v_max_f32 v184,v184,v95
v_log_f32 v186,v60
s_nop 0
v_max3_f32 v184,v184,v186,0
V1 186,184
s_nop 1
v_permlane16_swap_b32 v186,v184
s_nop 1
v_max_f32 v184,v184,v186
V1 186,184
s_nop 1
v_permlane32_swap_b32 v186,v184
s_nop 1
v_max_f32 v184,v184,v186
E1 185,-v184
s_nop 0
V 179,0
B1 186,76,184
B1 187,77,184
E 186,186
E 187,187
s_nop 0
A 179,179,186
A 179,179,187
C 140,186,187
B1 186,78,184
B1 187,79,184
E 186,186
E 187,187
s_nop 0
A 179,179,186
A 179,179,187
C 141,186,187
B1 186,92,184
B1 187,93,184
E 186,186
E 187,187
s_nop 0
A 179,179,186
A 179,179,187
C 142,186,187
B1 186,94,184
B1 187,95,184
E 186,186
E 187,187
s_nop 0
A 179,179,186
A 179,179,187
C 143,186,187
V1 186,179
s_nop 1
v_permlane16_swap_b32 v186,v179
s_nop 1
A 179,179,186
V1 186,179
s_nop 1
v_permlane32_swap_b32 v186,v179
s_nop 1
A 179,179,186
F1 44,60,185,179
F1 45,60,185,179
F1 46,60,185,179
F1 47,60,185,179
V1 60,44
B1 108,108,184
B1 109,109,184
B1 110,110,184
B1 111,111,184
B1 124,124,184
B1 125,125,184
B1 126,126,184
B1 127,127,184
B1 172,172,184
B1 173,173,184
B1 174,174,184
B1 175,175,184
AR 186,12
AR 187,13
AR 188,14
AR 189,15
U1 186,186,185
U1 187,187,185
U1 188,188,185
U1 189,189,185
AW 12,186
AW 13,187
AW 14,188
AW 15,189
AR 186,28
AR 187,29
AR 188,30
AR 189,31
U1 186,186,185
U1 187,187,185
U1 188,188,185
U1 189,189,185
AW 28,186
AW 29,187
AW 30,188
AW 31,189
AR 186,44
AR 187,45
AR 188,46
AR 189,47
U1 186,186,185
U1 187,187,185
U1 188,188,185
U1 189,189,185
AW 44,186
AW 45,187
AW 46,188
AW 47,189
AR 186,60
AR 187,61
AR 188,62
AR 189,63
U1 186,186,185
U1 187,187,185
U1 188,188,185
U1 189,189,185
AW 60,186
AW 61,187
AW 62,188
AW 63,189
AR 186,76
AR 187,77
AR 188,78
AR 189,79
U1 186,186,185
U1 187,187,185
U1 188,188,185
U1 189,189,185
AW 76,186
AW 77,187
AW 78,188
AW 79,189
AR 186,92
AR 187,93
AR 188,94
AR 189,95
U1 186,186,185
U1 187,187,185
U1 188,188,185
U1 189,189,185
AW 92,186
AW 93,187
AW 94,188
AW 95,189
AR 186,108
AR 187,109
AR 188,110
AR 189,111
U1 186,186,185
U1 187,187,185
U1 188,188,185
U1 189,189,185
AW 108,186
AW 109,187
AW 110,188
AW 111,189
AR 186,124
AR 187,125
AR 188,126
AR 189,127
U1 186,186,185
U1 187,187,185
U1 188,188,185
U1 189,189,185
AW 124,186
AW 125,187
AW 126,188
AW 127,189
E 8,104
E 9,105
E 10,106
E 11,107
s_nop 1
s_branch fbret_s0
fb_t0:
s_nop 7
s_nop 7
v_max3_f32 v184,v72,v73,v74
v_max3_f32 v184,v184,v75,v88
v_max3_f32 v184,v184,v89,v90
v_max_f32 v184,v184,v91
v_log_f32 v186,v56
s_nop 0
v_max3_f32 v184,v184,v186,0
V1 186,184
s_nop 1
v_permlane16_swap_b32 v186,v184
s_nop 1
v_max_f32 v184,v184,v186
V1 186,184
s_nop 1
v_permlane32_swap_b32 v186,v184
s_nop 1
v_max_f32 v184,v184,v186
E1 185,-v184
s_nop 0
V 178,0
B1 186,72,184
B1 187,73,184
E 186,186
E 187,187
s_nop 0
A 178,178,186
A 178,178,187
C 136,186,187
B1 186,74,184
B1 187,75,184
E 186,186
E 187,187
s_nop 0
A 178,178,186
A 178,178,187
C 137,186,187
B1 186,88,184
B1 187,89,184
E 186,186
E 187,187
s_nop 0
A 178,178,186
A 178,178,187
C 138,186,187
B1 186,90,184
B1 187,91,184
E 186,186
E 187,187
s_nop 0
A 178,178,186
A 178,178,187
C 139,186,187
V1 186,178
s_nop 1
v_permlane16_swap_b32 v186,v178
s_nop 1
A 178,178,186
V1 186,178
s_nop 1
v_permlane32_swap_b32 v186,v178
s_nop 1
A 178,178,186
F1 40,56,185,178
F1 41,56,185,178
F1 42,56,185,178
F1 43,56,185,178
V1 56,40
B1 168,168,184
B1 169,169,184
B1 170,170,184
B1 171,171,184
AR 186,8
AR 187,9
AR 188,10
AR 189,11
U1 186,186,185
U1 187,187,185
U1 188,188,185
U1 189,189,185
AW 8,186
AW 9,187
AW 10,188
AW 11,189
AR 186,24
AR 187,25
AR 188,26
AR 189,27
U1 186,186,185
U1 187,187,185
U1 188,188,185
U1 189,189,185
AW 24,186
AW 25,187
AW 26,188
AW 27,189
AR 186,40
AR 187,41
AR 188,42
AR 189,43
U1 186,186,185
U1 187,187,185
U1 188,188,185
U1 189,189,185
AW 40,186
AW 41,187
AW 42,188
AW 43,189
AR 186,56
AR 187,57
AR 188,58
AR 189,59
U1 186,186,185
U1 187,187,185
U1 188,188,185
U1 189,189,185
AW 56,186
AW 57,187
AW 58,188
AW 59,189
AR 186,72
AR 187,73
AR 188,74
AR 189,75
U1 186,186,185
U1 187,187,185
U1 188,188,185
U1 189,189,185
AW 72,186
AW 73,187
AW 74,188
AW 75,189
AR 186,88
AR 187,89
AR 188,90
AR 189,91
U1 186,186,185
U1 187,187,185
U1 188,188,185
U1 189,189,185
AW 88,186
AW 89,187
AW 90,188
AW 91,189
AR 186,104
AR 187,105
AR 188,106
AR 189,107
U1 186,186,185
U1 187,187,185
U1 188,188,185
U1 189,189,185
AW 104,186
AW 105,187
AW 106,188
AW 107,189
AR 186,120
AR 187,121
AR 188,122
AR 189,123
U1 186,186,185
U1 187,187,185
U1 188,188,185
U1 189,189,185
AW 120,186
AW 121,187
AW 122,188
AW 123,189
v_max3_f32 v184,v76,v77,v78
v_max3_f32 v184,v184,v79,v92
v_max3_f32 v184,v184,v93,v94
v_max_f32 v184,v184,v95
v_log_f32 v186,v60
s_nop 0
v_max3_f32 v184,v184,v186,0
V1 186,184
s_nop 1
v_permlane16_swap_b32 v186,v184
s_nop 1
v_max_f32 v184,v184,v186
V1 186,184
s_nop 1
v_permlane32_swap_b32 v186,v184
s_nop 1
v_max_f32 v184,v184,v186
E1 185,-v184
s_nop 0
V 179,0
B1 186,76,184
B1 187,77,184
E 186,186
E 187,187
s_nop 0
A 179,179,186
A 179,179,187
C 140,186,187
B1 186,78,184
B1 187,79,184
E 186,186
E 187,187
s_nop 0
A 179,179,186
A 179,179,187
C 141,186,187
B1 186,92,184
B1 187,93,184
E 186,186
E 187,187
s_nop 0
A 179,179,186
A 179,179,187
C 142,186,187
B1 186,94,184
B1 187,95,184
E 186,186
E 187,187
s_nop 0
A 179,179,186
A 179,179,187
C 143,186,187
V1 186,179
s_nop 1
v_permlane16_swap_b32 v186,v179
s_nop 1
A 179,179,186
V1 186,179
s_nop 1
v_permlane32_swap_b32 v186,v179
s_nop 1
A 179,179,186
F1 44,60,185,179
F1 45,60,185,179
F1 46,60,185,179
F1 47,60,185,179
V1 60,44
B1 172,172,184
B1 173,173,184
B1 174,174,184
B1 175,175,184
AR 186,12
AR 187,13
AR 188,14
AR 189,15
U1 186,186,185
U1 187,187,185
U1 188,188,185
U1 189,189,185
AW 12,186
AW 13,187
AW 14,188
AW 15,189
AR 186,28
AR 187,29
AR 188,30
AR 189,31
U1 186,186,185
U1 187,187,185
U1 188,188,185
U1 189,189,185
AW 28,186
AW 29,187
AW 30,188
AW 31,189
AR 186,44
AR 187,45
AR 188,46
AR 189,47
U1 186,186,185
U1 187,187,185
U1 188,188,185
U1 189,189,185
AW 44,186
AW 45,187
AW 46,188
AW 47,189
AR 186,60
AR 187,61
AR 188,62
AR 189,63
U1 186,186,185
U1 187,187,185
U1 188,188,185
U1 189,189,185
AW 60,186
AW 61,187
AW 62,188
AW 63,189
AR 186,76
AR 187,77
AR 188,78
AR 189,79
U1 186,186,185
U1 187,187,185
U1 188,188,185
U1 189,189,185
AW 76,186
AW 77,187
AW 78,188
AW 79,189
AR 186,92
AR 187,93
AR 188,94
AR 189,95
U1 186,186,185
U1 187,187,185
U1 188,188,185
U1 189,189,185
AW 92,186
AW 93,187
AW 94,188
AW 95,189
AR 186,108
AR 187,109
AR 188,110
AR 189,111
U1 186,186,185
U1 187,187,185
U1 188,188,185
U1 189,189,185
AW 108,186
AW 109,187
AW 110,188
AW 111,189
AR 186,124
AR 187,125
AR 188,126
AR 189,127
U1 186,186,185
U1 187,187,185
U1 188,188,185
U1 189,189,185
AW 124,186
AW 125,187
AW 126,188
AW 127,189
s_nop 1
s_branch fbret_t0
mask_b1:
V 21,0xff800000
s_cmp_eq_u32 s31,s32
s_cbranch_scc0 mask2_b1
K1 64,64,21,46
K1 65,65,21,48
K1 66,66,21,50
K1 67,67,21,52
K1 84,84,21,46
K1 85,85,21,48
K1 86,86,21,50
K1 87,87,21,52
V 80,0xff800000
V 81,0xff800000
V 82,0xff800000
V 83,0xff800000
s_branch maskret_b1
mask2_b1:
V 64,0xff800000
V 65,0xff800000
V 66,0xff800000
V 67,0xff800000
V 68,0xff800000
V 69,0xff800000
V 70,0xff800000
V 71,0xff800000
V 80,0xff800000
V 81,0xff800000
V 82,0xff800000
V 83,0xff800000
V 84,0xff800000
V 85,0xff800000
V 86,0xff800000
V 87,0xff800000
s_cmp_eq_u32 s30,3
s_cbranch_scc0 maskret_b1
K1 72,72,21,46
K1 73,73,21,48
K1 74,74,21,50
K1 75,75,21,52
K1 92,92,21,46
K1 93,93,21,48
K1 94,94,21,50
K1 95,95,21,52
V 88,0xff800000
V 89,0xff800000
V 90,0xff800000
V 91,0xff800000
s_branch maskret_b1
fb_b1:
s_nop 7
s_nop 7
v_max3_f32 v184,v96,v97,v98
v_max3_f32 v184,v184,v99,v112
v_max3_f32 v184,v184,v113,v114
v_max_f32 v184,v184,v115
v_log_f32 v186,v176
s_nop 0
v_max3_f32 v184,v184,v186,0
V1 186,184
s_nop 1
v_permlane16_swap_b32 v186,v184
s_nop 1
v_max_f32 v184,v184,v186
V1 186,184
s_nop 1
v_permlane32_swap_b32 v186,v184
s_nop 1
v_max_f32 v184,v184,v186
E1 185,-v184
s_nop 0
U1 180,176,185
B1 186,96,184
B1 187,97,184
E 186,186
E 187,187
s_nop 0
A 180,180,186
A 180,180,187
C 144,186,187
B1 186,98,184
B1 187,99,184
E 186,186
E 187,187
s_nop 0
A 180,180,186
A 180,180,187
C 145,186,187
B1 186,112,184
B1 187,113,184
E 186,186
E 187,187
s_nop 0
A 180,180,186
A 180,180,187
C 146,186,187
B1 186,114,184
B1 187,115,184
E 186,186
E 187,187
s_nop 0
A 180,180,186
A 180,180,187
C 147,186,187
V1 176,180
B1 64,64,184
B1 65,65,184
B1 66,66,184
B1 67,67,184
B1 80,80,184
B1 81,81,184
B1 82,82,184
B1 83,83,184
B1 160,160,184
B1 161,161,184
B1 162,162,184
B1 163,163,184
AR 186,0
AR 187,1
AR 188,2
AR 189,3
U1 186,186,185
U1 187,187,185
U1 188,188,185
U1 189,189,185
AW 0,186
AW 1,187
AW 2,188
AW 3,189
AR 186,16
AR 187,17
AR 188,18
AR 189,19
U1 186,186,185
U1 187,187,185
U1 188,188,185
U1 189,189,185
AW 16,186
AW 17,187
AW 18,188
AW 19,189
AR 186,32
AR 187,33
AR 188,34
AR 189,35
U1 186,186,185
U1 187,187,185
U1 188,188,185
U1 189,189,185
AW 32,186
AW 33,187
AW 34,188
AW 35,189
AR 186,48
AR 187,49
AR 188,50
AR 189,51
U1 186,186,185
U1 187,187,185
U1 188,188,185
U1 189,189,185
AW 48,186
AW 49,187
AW 50,188
AW 51,189
AR 186,64
AR 187,65
AR 188,66
AR 189,67
U1 186,186,185
U1 187,187,185
U1 188,188,185
U1 189,189,185
AW 64,186
AW 65,187
AW 66,188
AW 67,189
AR 186,80
AR 187,81
AR 188,82
AR 189,83
U1 186,186,185
U1 187,187,185
U1 188,188,185
U1 189,189,185
AW 80,186
AW 81,187
AW 82,188
AW 83,189
AR 186,96
AR 187,97
AR 188,98
AR 189,99
U1 186,186,185
U1 187,187,185
U1 188,188,185
U1 189,189,185
AW 96,186
AW 97,187
AW 98,188
AW 99,189
AR 186,112
AR 187,113
AR 188,114
AR 189,115
U1 186,186,185
U1 187,187,185
U1 188,188,185
U1 189,189,185
AW 112,186
AW 113,187
AW 114,188
AW 115,189
v_max3_f32 v184,v100,v101,v102
v_max3_f32 v184,v184,v103,v116
v_max3_f32 v184,v184,v117,v118
v_max_f32 v184,v184,v119
v_log_f32 v186,v177
s_nop 0
v_max3_f32 v184,v184,v186,0
V1 186,184
s_nop 1
v_permlane16_swap_b32 v186,v184
s_nop 1
v_max_f32 v184,v184,v186
V1 186,184
s_nop 1
v_permlane32_swap_b32 v186,v184
s_nop 1
v_max_f32 v184,v184,v186
E1 185,-v184
s_nop 0
U1 181,177,185
B1 186,100,184
B1 187,101,184
E 186,186
E 187,187
s_nop 0
A 181,181,186
A 181,181,187
C 148,186,187
B1 186,102,184
B1 187,103,184
E 186,186
E 187,187
s_nop 0
A 181,181,186
A 181,181,187
C 149,186,187
B1 186,116,184
B1 187,117,184
E 186,186
E 187,187
s_nop 0
A 181,181,186
A 181,181,187
C 150,186,187
B1 186,118,184
B1 187,119,184
E 186,186
E 187,187
s_nop 0
A 181,181,186
A 181,181,187
C 151,186,187
V1 177,181
B1 68,68,184
B1 69,69,184
B1 70,70,184
B1 71,71,184
B1 84,84,184
B1 85,85,184
B1 86,86,184
B1 87,87,184
B1 164,164,184
B1 165,165,184
B1 166,166,184
B1 167,167,184
AR 186,4
AR 187,5
AR 188,6
AR 189,7
U1 186,186,185
U1 187,187,185
U1 188,188,185
U1 189,189,185
AW 4,186
AW 5,187
AW 6,188
AW 7,189
AR 186,20
AR 187,21
AR 188,22
AR 189,23
U1 186,186,185
U1 187,187,185
U1 188,188,185
U1 189,189,185
AW 20,186
AW 21,187
AW 22,188
AW 23,189
AR 186,36
AR 187,37
AR 188,38
AR 189,39
U1 186,186,185
U1 187,187,185
U1 188,188,185
U1 189,189,185
AW 36,186
AW 37,187
AW 38,188
AW 39,189
AR 186,52
AR 187,53
AR 188,54
AR 189,55
U1 186,186,185
U1 187,187,185
U1 188,188,185
U1 189,189,185
AW 52,186
AW 53,187
AW 54,188
AW 55,189
AR 186,68
AR 187,69
AR 188,70
AR 189,71
U1 186,186,185
U1 187,187,185
U1 188,188,185
U1 189,189,185
AW 68,186
AW 69,187
AW 70,188
AW 71,189
AR 186,84
AR 187,85
AR 188,86
AR 189,87
U1 186,186,185
U1 187,187,185
U1 188,188,185
U1 189,189,185
AW 84,186
AW 85,187
AW 86,188
AW 87,189
AR 186,100
AR 187,101
AR 188,102
AR 189,103
U1 186,186,185
U1 187,187,185
U1 188,188,185
U1 189,189,185
AW 100,186
AW 101,187
AW 102,188
AW 103,189
AR 186,116
AR 187,117
AR 188,118
AR 189,119
U1 186,186,185
U1 187,187,185
U1 188,188,185
U1 189,189,185
AW 116,186
AW 117,187
AW 118,188
AW 119,189
v_max3_f32 v184,v104,v105,v106
v_max3_f32 v184,v184,v107,v120
v_max3_f32 v184,v184,v121,v122
v_max_f32 v184,v184,v123
v_log_f32 v186,v40
s_nop 0
v_max3_f32 v184,v184,v186,0
V1 186,184
s_nop 1
v_permlane16_swap_b32 v186,v184
s_nop 1
v_max_f32 v184,v184,v186
V1 186,184
s_nop 1
v_permlane32_swap_b32 v186,v184
s_nop 1
v_max_f32 v184,v184,v186
E1 185,-v184
s_nop 0
V 182,0
B1 186,104,184
B1 187,105,184
E 186,186
E 187,187
s_nop 0
A 182,182,186
A 182,182,187
C 152,186,187
B1 186,106,184
B1 187,107,184
E 186,186
E 187,187
s_nop 0
A 182,182,186
A 182,182,187
C 153,186,187
B1 186,120,184
B1 187,121,184
E 186,186
E 187,187
s_nop 0
A 182,182,186
A 182,182,187
C 154,186,187
B1 186,122,184
B1 187,123,184
E 186,186
E 187,187
s_nop 0
A 182,182,186
A 182,182,187
C 155,186,187
V1 186,182
s_nop 1
v_permlane16_swap_b32 v186,v182
s_nop 1
A 182,182,186
V1 186,182
s_nop 1
v_permlane32_swap_b32 v186,v182
s_nop 1
A 182,182,186
F1 56,40,185,182
F1 57,40,185,182
F1 58,40,185,182
F1 59,40,185,182
V1 40,56
B1 72,72,184
B1 73,73,184
B1 74,74,184
B1 75,75,184
B1 88,88,184
B1 89,89,184
B1 90,90,184
B1 91,91,184
B1 168,168,184
B1 169,169,184
B1 170,170,184
B1 171,171,184
AR 186,8
AR 187,9
AR 188,10
AR 189,11
U1 186,186,185
U1 187,187,185
U1 188,188,185
U1 189,189,185
AW 8,186
AW 9,187
AW 10,188
AW 11,189
AR 186,24
AR 187,25
AR 188,26
AR 189,27
U1 186,186,185
U1 187,187,185
U1 188,188,185
U1 189,189,185
AW 24,186
AW 25,187
AW 26,188
AW 27,189
AR 186,40
AR 187,41
AR 188,42
AR 189,43
U1 186,186,185
U1 187,187,185
U1 188,188,185
U1 189,189,185
AW 40,186
AW 41,187
AW 42,188
AW 43,189
AR 186,56
AR 187,57
AR 188,58
AR 189,59
U1 186,186,185
U1 187,187,185
U1 188,188,185
U1 189,189,185
AW 56,186
AW 57,187
AW 58,188
AW 59,189
AR 186,72
AR 187,73
AR 188,74
AR 189,75
U1 186,186,185
U1 187,187,185
U1 188,188,185
U1 189,189,185
AW 72,186
AW 73,187
AW 74,188
AW 75,189
AR 186,88
AR 187,89
AR 188,90
AR 189,91
U1 186,186,185
U1 187,187,185
U1 188,188,185
U1 189,189,185
AW 88,186
AW 89,187
AW 90,188
AW 91,189
AR 186,104
AR 187,105
AR 188,106
AR 189,107
U1 186,186,185
U1 187,187,185
U1 188,188,185
U1 189,189,185
AW 104,186
AW 105,187
AW 106,188
AW 107,189
AR 186,120
AR 187,121
AR 188,122
AR 189,123
U1 186,186,185
U1 187,187,185
U1 188,188,185
U1 189,189,185
AW 120,186
AW 121,187
AW 122,188
AW 123,189
v_max3_f32 v184,v108,v109,v110
v_max3_f32 v184,v184,v111,v124
v_max3_f32 v184,v184,v125,v126
v_max_f32 v184,v184,v127
v_log_f32 v186,v44
s_nop 0
v_max3_f32 v184,v184,v186,0
V1 186,184
s_nop 1
v_permlane16_swap_b32 v186,v184
s_nop 1
v_max_f32 v184,v184,v186
V1 186,184
s_nop 1
v_permlane32_swap_b32 v186,v184
s_nop 1
v_max_f32 v184,v184,v186
E1 185,-v184
s_nop 0
V 183,0
B1 186,108,184
B1 187,109,184
E 186,186
E 187,187
s_nop 0
A 183,183,186
A 183,183,187
C 156,186,187
B1 186,110,184
B1 187,111,184
E 186,186
E 187,187
s_nop 0
A 183,183,186
A 183,183,187
C 157,186,187
B1 186,124,184
B1 187,125,184
E 186,186
E 187,187
s_nop 0
A 183,183,186
A 183,183,187
C 158,186,187
B1 186,126,184
B1 187,127,184
E 186,186
E 187,187
s_nop 0
A 183,183,186
A 183,183,187
C 159,186,187
V1 186,183
s_nop 1
v_permlane16_swap_b32 v186,v183
s_nop 1
A 183,183,186
V1 186,183
s_nop 1
v_permlane32_swap_b32 v186,v183
s_nop 1
A 183,183,186
F1 60,44,185,183
F1 61,44,185,183
F1 62,44,185,183
F1 63,44,185,183
V1 44,60
B1 76,76,184
B1 77,77,184
B1 78,78,184
B1 79,79,184
B1 92,92,184
B1 93,93,184
B1 94,94,184
B1 95,95,184
B1 172,172,184
B1 173,173,184
B1 174,174,184
B1 175,175,184
AR 186,12
AR 187,13
AR 188,14
AR 189,15
U1 186,186,185
U1 187,187,185
U1 188,188,185
U1 189,189,185
AW 12,186
AW 13,187
AW 14,188
AW 15,189
AR 186,28
AR 187,29
AR 188,30
AR 189,31
U1 186,186,185
U1 187,187,185
U1 188,188,185
U1 189,189,185
AW 28,186
AW 29,187
AW 30,188
AW 31,189
AR 186,44
AR 187,45
AR 188,46
AR 189,47
U1 186,186,185
U1 187,187,185
U1 188,188,185
U1 189,189,185
AW 44,186
AW 45,187
AW 46,188
AW 47,189
AR 186,60
AR 187,61
AR 188,62
AR 189,63
U1 186,186,185
U1 187,187,185
U1 188,188,185
U1 189,189,185
AW 60,186
AW 61,187
AW 62,188
AW 63,189
AR 186,76
AR 187,77
AR 188,78
AR 189,79
U1 186,186,185
U1 187,187,185
U1 188,188,185
U1 189,189,185
AW 76,186
AW 77,187
AW 78,188
AW 79,189
AR 186,92
AR 187,93
AR 188,94
AR 189,95
U1 186,186,185
U1 187,187,185
U1 188,188,185
U1 189,189,185
AW 92,186
AW 93,187
AW 94,188
AW 95,189
AR 186,108
AR 187,109
AR 188,110
AR 189,111
U1 186,186,185
U1 187,187,185
U1 188,188,185
U1 189,189,185
AW 108,186
AW 109,187
AW 110,188
AW 111,189
AR 186,124
AR 187,125
AR 188,126
AR 189,127
U1 186,186,185
U1 187,187,185
U1 188,188,185
U1 189,189,185
AW 124,186
AW 125,187
AW 126,188
AW 127,189
E 8,72
E 9,73
E 10,74
E 11,75
s_nop 1
s_branch fbret_b1
mask_s1:
V 21,0xff800000
K1 72,72,21,46
K1 73,73,21,48
K1 74,74,21,50
K1 75,75,21,52
K1 92,92,21,46
K1 93,93,21,48
K1 94,94,21,50
K1 95,95,21,52
V 88,0xff800000
V 89,0xff800000
V 90,0xff800000
V 91,0xff800000
s_branch maskret_s1
fb_s1:
s_nop 7
s_nop 7
v_max3_f32 v184,v104,v105,v106
v_max3_f32 v184,v184,v107,v120
v_max3_f32 v184,v184,v121,v122
v_max_f32 v184,v184,v123
v_log_f32 v186,v40
s_nop 0
v_max3_f32 v184,v184,v186,0
V1 186,184
s_nop 1
v_permlane16_swap_b32 v186,v184
s_nop 1
v_max_f32 v184,v184,v186
V1 186,184
s_nop 1
v_permlane32_swap_b32 v186,v184
s_nop 1
v_max_f32 v184,v184,v186
E1 185,-v184
s_nop 0
V 182,0
B1 186,104,184
B1 187,105,184
E 186,186
E 187,187
s_nop 0
A 182,182,186
A 182,182,187
C 152,186,187
B1 186,106,184
B1 187,107,184
E 186,186
E 187,187
s_nop 0
A 182,182,186
A 182,182,187
C 153,186,187
B1 186,120,184
B1 187,121,184
E 186,186
E 187,187
s_nop 0
A 182,182,186
A 182,182,187
C 154,186,187
B1 186,122,184
B1 187,123,184
E 186,186
E 187,187
s_nop 0
A 182,182,186
A 182,182,187
C 155,186,187
V1 186,182
s_nop 1
v_permlane16_swap_b32 v186,v182
s_nop 1
A 182,182,186
V1 186,182
s_nop 1
v_permlane32_swap_b32 v186,v182
s_nop 1
A 182,182,186
F1 56,40,185,182
F1 57,40,185,182
F1 58,40,185,182
F1 59,40,185,182
V1 40,56
B1 72,72,184
B1 73,73,184
B1 74,74,184
B1 75,75,184
B1 88,88,184
B1 89,89,184
B1 90,90,184
B1 91,91,184
B1 168,168,184
B1 169,169,184
B1 170,170,184
B1 171,171,184
AR 186,8
AR 187,9
AR 188,10
AR 189,11
U1 186,186,185
U1 187,187,185
U1 188,188,185
U1 189,189,185
AW 8,186
AW 9,187
AW 10,188
AW 11,189
AR 186,24
AR 187,25
AR 188,26
AR 189,27
U1 186,186,185
U1 187,187,185
U1 188,188,185
U1 189,189,185
AW 24,186
AW 25,187
AW 26,188
AW 27,189
AR 186,40
AR 187,41
AR 188,42
AR 189,43
U1 186,186,185
U1 187,187,185
U1 188,188,185
U1 189,189,185
AW 40,186
AW 41,187
AW 42,188
AW 43,189
AR 186,56
AR 187,57
AR 188,58
AR 189,59
U1 186,186,185
U1 187,187,185
U1 188,188,185
U1 189,189,185
AW 56,186
AW 57,187
AW 58,188
AW 59,189
AR 186,72
AR 187,73
AR 188,74
AR 189,75
U1 186,186,185
U1 187,187,185
U1 188,188,185
U1 189,189,185
AW 72,186
AW 73,187
AW 74,188
AW 75,189
AR 186,88
AR 187,89
AR 188,90
AR 189,91
U1 186,186,185
U1 187,187,185
U1 188,188,185
U1 189,189,185
AW 88,186
AW 89,187
AW 90,188
AW 91,189
AR 186,104
AR 187,105
AR 188,106
AR 189,107
U1 186,186,185
U1 187,187,185
U1 188,188,185
U1 189,189,185
AW 104,186
AW 105,187
AW 106,188
AW 107,189
AR 186,120
AR 187,121
AR 188,122
AR 189,123
U1 186,186,185
U1 187,187,185
U1 188,188,185
U1 189,189,185
AW 120,186
AW 121,187
AW 122,188
AW 123,189
v_max3_f32 v184,v108,v109,v110
v_max3_f32 v184,v184,v111,v124
v_max3_f32 v184,v184,v125,v126
v_max_f32 v184,v184,v127
v_log_f32 v186,v44
s_nop 0
v_max3_f32 v184,v184,v186,0
V1 186,184
s_nop 1
v_permlane16_swap_b32 v186,v184
s_nop 1
v_max_f32 v184,v184,v186
V1 186,184
s_nop 1
v_permlane32_swap_b32 v186,v184
s_nop 1
v_max_f32 v184,v184,v186
E1 185,-v184
s_nop 0
V 183,0
B1 186,108,184
B1 187,109,184
E 186,186
E 187,187
s_nop 0
A 183,183,186
A 183,183,187
C 156,186,187
B1 186,110,184
B1 187,111,184
E 186,186
E 187,187
s_nop 0
A 183,183,186
A 183,183,187
C 157,186,187
B1 186,124,184
B1 187,125,184
E 186,186
E 187,187
s_nop 0
A 183,183,186
A 183,183,187
C 158,186,187
B1 186,126,184
B1 187,127,184
E 186,186
E 187,187
s_nop 0
A 183,183,186
A 183,183,187
C 159,186,187
V1 186,183
s_nop 1
v_permlane16_swap_b32 v186,v183
s_nop 1
A 183,183,186
V1 186,183
s_nop 1
v_permlane32_swap_b32 v186,v183
s_nop 1
A 183,183,186
F1 60,44,185,183
F1 61,44,185,183
F1 62,44,185,183
F1 63,44,185,183
V1 44,60
B1 76,76,184
B1 77,77,184
B1 78,78,184
B1 79,79,184
B1 92,92,184
B1 93,93,184
B1 94,94,184
B1 95,95,184
B1 172,172,184
B1 173,173,184
B1 174,174,184
B1 175,175,184
AR 186,12
AR 187,13
AR 188,14
AR 189,15
U1 186,186,185
U1 187,187,185
U1 188,188,185
U1 189,189,185
AW 12,186
AW 13,187
AW 14,188
AW 15,189
AR 186,28
AR 187,29
AR 188,30
AR 189,31
U1 186,186,185
U1 187,187,185
U1 188,188,185
U1 189,189,185
AW 28,186
AW 29,187
AW 30,188
AW 31,189
AR 186,44
AR 187,45
AR 188,46
AR 189,47
U1 186,186,185
U1 187,187,185
U1 188,188,185
U1 189,189,185
AW 44,186
AW 45,187
AW 46,188
AW 47,189
AR 186,60
AR 187,61
AR 188,62
AR 189,63
U1 186,186,185
U1 187,187,185
U1 188,188,185
U1 189,189,185
AW 60,186
AW 61,187
AW 62,188
AW 63,189
AR 186,76
AR 187,77
AR 188,78
AR 189,79
U1 186,186,185
U1 187,187,185
U1 188,188,185
U1 189,189,185
AW 76,186
AW 77,187
AW 78,188
AW 79,189
AR 186,92
AR 187,93
AR 188,94
AR 189,95
U1 186,186,185
U1 187,187,185
U1 188,188,185
U1 189,189,185
AW 92,186
AW 93,187
AW 94,188
AW 95,189
AR 186,108
AR 187,109
AR 188,110
AR 189,111
U1 186,186,185
U1 187,187,185
U1 188,188,185
U1 189,189,185
AW 108,186
AW 109,187
AW 110,188
AW 111,189
AR 186,124
AR 187,125
AR 188,126
AR 189,127
U1 186,186,185
U1 187,187,185
U1 188,188,185
U1 189,189,185
AW 124,186
AW 125,187
AW 126,188
AW 127,189
E 8,72
E 9,73
E 10,74
E 11,75
s_nop 1
s_branch fbret_s1
fb_t1:
s_nop 7
s_nop 7
v_max3_f32 v184,v104,v105,v106
v_max3_f32 v184,v184,v107,v120
v_max3_f32 v184,v184,v121,v122
v_max_f32 v184,v184,v123
v_log_f32 v186,v40
s_nop 0
v_max3_f32 v184,v184,v186,0
V1 186,184
s_nop 1
v_permlane16_swap_b32 v186,v184
s_nop 1
v_max_f32 v184,v184,v186
V1 186,184
s_nop 1
v_permlane32_swap_b32 v186,v184
s_nop 1
v_max_f32 v184,v184,v186
E1 185,-v184
s_nop 0
V 182,0
B1 186,104,184
B1 187,105,184
E 186,186
E 187,187
s_nop 0
A 182,182,186
A 182,182,187
C 152,186,187
B1 186,106,184
B1 187,107,184
E 186,186
E 187,187
s_nop 0
A 182,182,186
A 182,182,187
C 153,186,187
B1 186,120,184
B1 187,121,184
E 186,186
E 187,187
s_nop 0
A 182,182,186
A 182,182,187
C 154,186,187
B1 186,122,184
B1 187,123,184
E 186,186
E 187,187
s_nop 0
A 182,182,186
A 182,182,187
C 155,186,187
V1 186,182
s_nop 1
v_permlane16_swap_b32 v186,v182
s_nop 1
A 182,182,186
V1 186,182
s_nop 1
v_permlane32_swap_b32 v186,v182
s_nop 1
A 182,182,186
F1 56,40,185,182
F1 57,40,185,182
F1 58,40,185,182
F1 59,40,185,182
V1 40,56
B1 168,168,184
B1 169,169,184
B1 170,170,184
B1 171,171,184
AR 186,8
AR 187,9
AR 188,10
AR 189,11
U1 186,186,185
U1 187,187,185
U1 188,188,185
U1 189,189,185
AW 8,186
AW 9,187
AW 10,188
AW 11,189
AR 186,24
AR 187,25
AR 188,26
AR 189,27
U1 186,186,185
U1 187,187,185
U1 188,188,185
U1 189,189,185
AW 24,186
AW 25,187
AW 26,188
AW 27,189
AR 186,40
AR 187,41
AR 188,42
AR 189,43
U1 186,186,185
U1 187,187,185
U1 188,188,185
U1 189,189,185
AW 40,186
AW 41,187
AW 42,188
AW 43,189
AR 186,56
AR 187,57
AR 188,58
AR 189,59
U1 186,186,185
U1 187,187,185
U1 188,188,185
U1 189,189,185
AW 56,186
AW 57,187
AW 58,188
AW 59,189
AR 186,72
AR 187,73
AR 188,74
AR 189,75
U1 186,186,185
U1 187,187,185
U1 188,188,185
U1 189,189,185
AW 72,186
AW 73,187
AW 74,188
AW 75,189
AR 186,88
AR 187,89
AR 188,90
AR 189,91
U1 186,186,185
U1 187,187,185
U1 188,188,185
U1 189,189,185
AW 88,186
AW 89,187
AW 90,188
AW 91,189
AR 186,104
AR 187,105
AR 188,106
AR 189,107
U1 186,186,185
U1 187,187,185
U1 188,188,185
U1 189,189,185
AW 104,186
AW 105,187
AW 106,188
AW 107,189
AR 186,120
AR 187,121
AR 188,122
AR 189,123
U1 186,186,185
U1 187,187,185
U1 188,188,185
U1 189,189,185
AW 120,186
AW 121,187
AW 122,188
AW 123,189
v_max3_f32 v184,v108,v109,v110
v_max3_f32 v184,v184,v111,v124
v_max3_f32 v184,v184,v125,v126
v_max_f32 v184,v184,v127
v_log_f32 v186,v44
s_nop 0
v_max3_f32 v184,v184,v186,0
V1 186,184
s_nop 1
v_permlane16_swap_b32 v186,v184
s_nop 1
v_max_f32 v184,v184,v186
V1 186,184
s_nop 1
v_permlane32_swap_b32 v186,v184
s_nop 1
v_max_f32 v184,v184,v186
E1 185,-v184
s_nop 0
V 183,0
B1 186,108,184
B1 187,109,184
E 186,186
E 187,187
s_nop 0
A 183,183,186
A 183,183,187
C 156,186,187
B1 186,110,184
B1 187,111,184
E 186,186
E 187,187
s_nop 0
A 183,183,186
A 183,183,187
C 157,186,187
B1 186,124,184
B1 187,125,184
E 186,186
E 187,187
s_nop 0
A 183,183,186
A 183,183,187
C 158,186,187
B1 186,126,184
B1 187,127,184
E 186,186
E 187,187
s_nop 0
A 183,183,186
A 183,183,187
C 159,186,187
V1 186,183
s_nop 1
v_permlane16_swap_b32 v186,v183
s_nop 1
A 183,183,186
V1 186,183
s_nop 1
v_permlane32_swap_b32 v186,v183
s_nop 1
A 183,183,186
F1 60,44,185,183
F1 61,44,185,183
F1 62,44,185,183
F1 63,44,185,183
V1 44,60
B1 172,172,184
B1 173,173,184
B1 174,174,184
B1 175,175,184
AR 186,12
AR 187,13
AR 188,14
AR 189,15
U1 186,186,185
U1 187,187,185
U1 188,188,185
U1 189,189,185
AW 12,186
AW 13,187
AW 14,188
AW 15,189
AR 186,28
AR 187,29
AR 188,30
AR 189,31
U1 186,186,185
U1 187,187,185
U1 188,188,185
U1 189,189,185
AW 28,186
AW 29,187
AW 30,188
AW 31,189
AR 186,44
AR 187,45
AR 188,46
AR 189,47
U1 186,186,185
U1 187,187,185
U1 188,188,185
U1 189,189,185
AW 44,186
AW 45,187
AW 46,188
AW 47,189
AR 186,60
AR 187,61
AR 188,62
AR 189,63
U1 186,186,185
U1 187,187,185
U1 188,188,185
U1 189,189,185
AW 60,186
AW 61,187
AW 62,188
AW 63,189
AR 186,76
AR 187,77
AR 188,78
AR 189,79
U1 186,186,185
U1 187,187,185
U1 188,188,185
U1 189,189,185
AW 76,186
AW 77,187
AW 78,188
AW 79,189
AR 186,92
AR 187,93
AR 188,94
AR 189,95
U1 186,186,185
U1 187,187,185
U1 188,188,185
U1 189,189,185
AW 92,186
AW 93,187
AW 94,188
AW 95,189
AR 186,108
AR 187,109
AR 188,110
AR 189,111
U1 186,186,185
U1 187,187,185
U1 188,188,185
U1 189,189,185
AW 108,186
AW 109,187
AW 110,188
AW 111,189
AR 186,124
AR 187,125
AR 188,126
AR 189,127
U1 186,186,185
U1 187,187,185
U1 188,188,185
U1 189,189,185
AW 124,186
AW 125,187
AW 126,188
AW 127,189
s_nop 1
s_branch fbret_t1
spin_kv:
s_mov_b32 s100,0
spinl_kv:
s_sleep 4
buffer_load_dword v0,v26,s[92:95],s40 offen sc1
s_add_u32 s100,s100,1
s_cmp_ge_u32 s100,16384
s_cbranch_scc1 spinret_kv
s_waitcnt vmcnt(0)
v_readfirstlane_b32 s39,v0
s_nop 3
s_cmp_lt_u32 s39,10
s_cbranch_scc1 spinl_kv
s_branch spinret_kv
l12_gpost:
s_load_dwordx4 s[48:51],s[0:1],64
s_add_u32 s44,s8,100663296
s_addc_u32 s45,s9,0
s_and_b32 s45,s45,0xffff
s_mov_b32 s46,16777216
s_mov_b32 s47,0x00020000
s_add_u32 s56,s8,47185920
s_addc_u32 s57,s9,0
s_and_b32 s57,s57,0xffff
s_mov_b32 s58,393216
s_mov_b32 s59,0x00020000
s_lshr_b32 s31,s30,1
s_and_b32 s32,s30,1
s_lshl_b32 s33,s29,1
s_add_u32 s33,s33,s32
V 6,-2.302208198144325
V 7,-2.302208198144325
V 8,-0.1029432395800235
V 9,-0.1029432395800235
V 10,1.0
V 11,1.0
s_nop 0
PM 224,32,32
PM 226,34,34
PM 228,36,36
PM 230,38,38
PM 232,40,40
PM 234,42,42
PF 224,224,8,6
PF 226,226,8,6
PF 228,228,8,6
PF 230,230,8,6
PF 232,232,8,6
PF 234,234,8,6
PM 224,224,32
PM 226,226,34
PM 228,228,36
PM 230,230,38
PM 232,232,40
PM 234,234,42
E 224,224
E 225,225
E 226,226
E 227,227
E 228,228
E 229,229
E 230,230
E 231,231
E 232,232
E 233,233
E 234,234
E 235,235
PA 224,224,10
PA 226,226,10
PA 228,228,10
PA 230,230,10
PA 232,232,10
PA 234,234,10
RC 224,224
RC 225,225
RC 226,226
RC 227,227
RC 228,228
RC 229,229
RC 230,230
RC 231,231
RC 232,232
RC 233,233
RC 234,234
RC 235,235
PM 32,32,224
PM 34,34,226
PM 36,36,228
PM 38,38,230
PM 40,40,232
PM 42,42,234
PM 224,44,44
PM 226,46,46
PM 228,48,48
PM 230,50,50
PM 232,52,52
PM 234,54,54
PF 224,224,8,6
PF 226,226,8,6
PF 228,228,8,6
PF 230,230,8,6
PF 232,232,8,6
PF 234,234,8,6
PM 224,224,44
PM 226,226,46
PM 228,228,48
PM 230,230,50
PM 232,232,52
PM 234,234,54
E 224,224
E 225,225
E 226,226
E 227,227
E 228,228
E 229,229
E 230,230
E 231,231
E 232,232
E 233,233
E 234,234
E 235,235
PA 224,224,10
PA 226,226,10
PA 228,228,10
PA 230,230,10
PA 232,232,10
PA 234,234,10
RC 224,224
RC 225,225
RC 226,226
RC 227,227
RC 228,228
RC 229,229
RC 230,230
RC 231,231
RC 232,232
RC 233,233
RC 234,234
RC 235,235
PM 44,44,224
PM 46,46,226
PM 48,48,228
PM 50,50,230
PM 52,52,232
PM 54,54,234
PM 224,56,56
PM 226,58,58
PM 228,60,60
PM 230,62,62
PM 232,64,64
PM 234,66,66
PF 224,224,8,6
PF 226,226,8,6
PF 228,228,8,6
PF 230,230,8,6
PF 232,232,8,6
PF 234,234,8,6
PM 224,224,56
PM 226,226,58
PM 228,228,60
PM 230,230,62
PM 232,232,64
PM 234,234,66
E 224,224
E 225,225
E 226,226
E 227,227
E 228,228
E 229,229
E 230,230
E 231,231
E 232,232
E 233,233
E 234,234
E 235,235
PA 224,224,10
PA 226,226,10
PA 228,228,10
PA 230,230,10
PA 232,232,10
PA 234,234,10
RC 224,224
RC 225,225
RC 226,226
RC 227,227
RC 228,228
RC 229,229
RC 230,230
RC 231,231
RC 232,232
RC 233,233
RC 234,234
RC 235,235
PM 56,56,224
PM 58,58,226
PM 60,60,228
PM 62,62,230
PM 64,64,232
PM 66,66,234
PM 224,68,68
PM 226,70,70
PM 228,72,72
PM 230,74,74
PM 232,76,76
PM 234,78,78
PF 224,224,8,6
PF 226,226,8,6
PF 228,228,8,6
PF 230,230,8,6
PF 232,232,8,6
PF 234,234,8,6
PM 224,224,68
PM 226,226,70
PM 228,228,72
PM 230,230,74
PM 232,232,76
PM 234,234,78
E 224,224
E 225,225
E 226,226
E 227,227
E 228,228
E 229,229
E 230,230
E 231,231
E 232,232
E 233,233
E 234,234
E 235,235
PA 224,224,10
PA 226,226,10
PA 228,228,10
PA 230,230,10
PA 232,232,10
PA 234,234,10
RC 224,224
RC 225,225
RC 226,226
RC 227,227
RC 228,228
RC 229,229
RC 230,230
RC 231,231
RC 232,232
RC 233,233
RC 234,234
RC 235,235
PM 68,68,224
PM 70,70,226
PM 72,72,228
PM 74,74,230
PM 76,76,232
PM 78,78,234
PM 224,80,80
PM 226,82,82
PM 228,84,84
PM 230,86,86
PM 232,88,88
PM 234,90,90
PF 224,224,8,6
PF 226,226,8,6
PF 228,228,8,6
PF 230,230,8,6
PF 232,232,8,6
PF 234,234,8,6
PM 224,224,80
PM 226,226,82
PM 228,228,84
PM 230,230,86
PM 232,232,88
PM 234,234,90
E 224,224
E 225,225
E 226,226
E 227,227
E 228,228
E 229,229
E 230,230
E 231,231
E 232,232
E 233,233
E 234,234
E 235,235
PA 224,224,10
PA 226,226,10
PA 228,228,10
PA 230,230,10
PA 232,232,10
PA 234,234,10
RC 224,224
RC 225,225
RC 226,226
RC 227,227
RC 228,228
RC 229,229
RC 230,230
RC 231,231
RC 232,232
RC 233,233
RC 234,234
RC 235,235
PM 80,80,224
PM 82,82,226
PM 84,84,228
PM 86,86,230
PM 88,88,232
PM 90,90,234
PM 224,92,92
PM 226,94,94
PM 228,96,96
PM 230,98,98
PM 232,100,100
PM 234,102,102
PF 224,224,8,6
PF 226,226,8,6
PF 228,228,8,6
PF 230,230,8,6
PF 232,232,8,6
PF 234,234,8,6
PM 224,224,92
PM 226,226,94
PM 228,228,96
PM 230,230,98
PM 232,232,100
PM 234,234,102
E 224,224
E 225,225
E 226,226
E 227,227
E 228,228
E 229,229
E 230,230
E 231,231
E 232,232
E 233,233
E 234,234
E 235,235
PA 224,224,10
PA 226,226,10
PA 228,228,10
PA 230,230,10
PA 232,232,10
PA 234,234,10
RC 224,224
RC 225,225
RC 226,226
RC 227,227
RC 228,228
RC 229,229
RC 230,230
RC 231,231
RC 232,232
RC 233,233
RC 234,234
RC 235,235
PM 92,92,224
PM 94,94,226
PM 96,96,228
PM 98,98,230
PM 100,100,232
PM 102,102,234
PM 224,104,104
PM 226,106,106
PM 228,108,108
PM 230,110,110
PM 232,112,112
PM 234,114,114
PF 224,224,8,6
PF 226,226,8,6
PF 228,228,8,6
PF 230,230,8,6
PF 232,232,8,6
PF 234,234,8,6
PM 224,224,104
PM 226,226,106
PM 228,228,108
PM 230,230,110
PM 232,232,112
PM 234,234,114
E 224,224
E 225,225
E 226,226
E 227,227
E 228,228
E 229,229
E 230,230
E 231,231
E 232,232
E 233,233
E 234,234
E 235,235
PA 224,224,10
PA 226,226,10
PA 228,228,10
PA 230,230,10
PA 232,232,10
PA 234,234,10
RC 224,224
RC 225,225
RC 226,226
RC 227,227
RC 228,228
RC 229,229
RC 230,230
RC 231,231
RC 232,232
RC 233,233
RC 234,234
RC 235,235
PM 104,104,224
PM 106,106,226
PM 108,108,228
PM 110,110,230
PM 112,112,232
PM 114,114,234
PM 224,116,116
PM 226,118,118
PM 228,120,120
PM 230,122,122
PM 232,124,124
PM 234,126,126
PF 224,224,8,6
PF 226,226,8,6
PF 228,228,8,6
PF 230,230,8,6
PF 232,232,8,6
PF 234,234,8,6
PM 224,224,116
PM 226,226,118
PM 228,228,120
PM 230,230,122
PM 232,232,124
PM 234,234,126
E 224,224
E 225,225
E 226,226
E 227,227
E 228,228
E 229,229
E 230,230
E 231,231
E 232,232
E 233,233
E 234,234
E 235,235
PA 224,224,10
PA 226,226,10
PA 228,228,10
PA 230,230,10
PA 232,232,10
PA 234,234,10
RC 224,224
RC 225,225
RC 226,226
RC 227,227
RC 228,228
RC 229,229
RC 230,230
RC 231,231
RC 232,232
RC 233,233
RC 234,234
RC 235,235
PM 116,116,224
PM 118,118,226
PM 120,120,228
PM 122,122,230
PM 124,124,232
PM 126,126,234
AR 128,128
AR 129,129
AR 130,130
AR 131,131
AR 132,132
AR 133,133
AR 134,134
AR 135,135
AR 136,136
AR 137,137
AR 138,138
AR 139,139
AR 140,140
AR 141,141
AR 142,142
AR 143,143
AR 144,144
AR 145,145
AR 146,146
AR 147,147
AR 148,148
AR 149,149
AR 150,150
AR 151,151
AR 152,152
AR 153,153
AR 154,154
AR 155,155
AR 156,156
AR 157,157
AR 158,158
AR 159,159
AR 160,160
AR 161,161
AR 162,162
AR 163,163
AR 164,164
AR 165,165
AR 166,166
AR 167,167
AR 168,168
AR 169,169
AR 170,170
AR 171,171
AR 172,172
AR 173,173
AR 174,174
AR 175,175
AR 176,176
AR 177,177
AR 178,178
AR 179,179
AR 180,180
AR 181,181
AR 182,182
AR 183,183
AR 184,184
AR 185,185
AR 186,186
AR 187,187
AR 188,188
AR 189,189
AR 190,190
AR 191,191
AR 192,192
AR 193,193
AR 194,194
AR 195,195
AR 196,196
AR 197,197
AR 198,198
AR 199,199
AR 200,200
AR 201,201
AR 202,202
AR 203,203
AR 204,204
AR 205,205
AR 206,206
AR 207,207
AR 208,208
AR 209,209
AR 210,210
AR 211,211
AR 212,212
AR 213,213
AR 214,214
AR 215,215
AR 216,216
AR 217,217
AR 218,218
AR 219,219
AR 220,220
AR 221,221
AR 222,222
AR 223,223
PM 224,128,128
PM 226,130,130
PM 228,132,132
PM 230,134,134
PM 232,136,136
PM 234,138,138
PF 224,224,8,6
PF 226,226,8,6
PF 228,228,8,6
PF 230,230,8,6
PF 232,232,8,6
PF 234,234,8,6
PM 224,224,128
PM 226,226,130
PM 228,228,132
PM 230,230,134
PM 232,232,136
PM 234,234,138
E 224,224
E 225,225
E 226,226
E 227,227
E 228,228
E 229,229
E 230,230
E 231,231
E 232,232
E 233,233
E 234,234
E 235,235
PA 224,224,10
PA 226,226,10
PA 228,228,10
PA 230,230,10
PA 232,232,10
PA 234,234,10
RC 224,224
RC 225,225
RC 226,226
RC 227,227
RC 228,228
RC 229,229
RC 230,230
RC 231,231
RC 232,232
RC 233,233
RC 234,234
RC 235,235
PM 128,128,224
PM 130,130,226
PM 132,132,228
PM 134,134,230
PM 136,136,232
PM 138,138,234
PM 224,140,140
PM 226,142,142
PM 228,144,144
PM 230,146,146
PM 232,148,148
PM 234,150,150
PF 224,224,8,6
PF 226,226,8,6
PF 228,228,8,6
PF 230,230,8,6
PF 232,232,8,6
PF 234,234,8,6
PM 224,224,140
PM 226,226,142
PM 228,228,144
PM 230,230,146
PM 232,232,148
PM 234,234,150
E 224,224
E 225,225
E 226,226
E 227,227
E 228,228
E 229,229
E 230,230
E 231,231
E 232,232
E 233,233
E 234,234
E 235,235
PA 224,224,10
PA 226,226,10
PA 228,228,10
PA 230,230,10
PA 232,232,10
PA 234,234,10
RC 224,224
RC 225,225
RC 226,226
RC 227,227
RC 228,228
RC 229,229
RC 230,230
RC 231,231
RC 232,232
RC 233,233
RC 234,234
RC 235,235
PM 140,140,224
PM 142,142,226
PM 144,144,228
PM 146,146,230
PM 148,148,232
PM 150,150,234
PM 224,152,152
PM 226,154,154
PM 228,156,156
PM 230,158,158
PM 232,160,160
PM 234,162,162
PF 224,224,8,6
PF 226,226,8,6
PF 228,228,8,6
PF 230,230,8,6
PF 232,232,8,6
PF 234,234,8,6
PM 224,224,152
PM 226,226,154
PM 228,228,156
PM 230,230,158
PM 232,232,160
PM 234,234,162
E 224,224
E 225,225
E 226,226
E 227,227
E 228,228
E 229,229
E 230,230
E 231,231
E 232,232
E 233,233
E 234,234
E 235,235
PA 224,224,10
PA 226,226,10
PA 228,228,10
PA 230,230,10
PA 232,232,10
PA 234,234,10
RC 224,224
RC 225,225
RC 226,226
RC 227,227
RC 228,228
RC 229,229
RC 230,230
RC 231,231
RC 232,232
RC 233,233
RC 234,234
RC 235,235
PM 152,152,224
PM 154,154,226
PM 156,156,228
PM 158,158,230
PM 160,160,232
PM 162,162,234
PM 224,164,164
PM 226,166,166
PM 228,168,168
PM 230,170,170
PM 232,172,172
PM 234,174,174
PF 224,224,8,6
PF 226,226,8,6
PF 228,228,8,6
PF 230,230,8,6
PF 232,232,8,6
PF 234,234,8,6
PM 224,224,164
PM 226,226,166
PM 228,228,168
PM 230,230,170
PM 232,232,172
PM 234,234,174
E 224,224
E 225,225
E 226,226
E 227,227
E 228,228
E 229,229
E 230,230
E 231,231
E 232,232
E 233,233
E 234,234
E 235,235
PA 224,224,10
PA 226,226,10
PA 228,228,10
PA 230,230,10
PA 232,232,10
PA 234,234,10
RC 224,224
RC 225,225
RC 226,226
RC 227,227
RC 228,228
RC 229,229
RC 230,230
RC 231,231
RC 232,232
RC 233,233
RC 234,234
RC 235,235
PM 164,164,224
PM 166,166,226
PM 168,168,228
PM 170,170,230
PM 172,172,232
PM 174,174,234
PM 224,176,176
PM 226,178,178
PM 228,180,180
PM 230,182,182
PM 232,184,184
PM 234,186,186
PF 224,224,8,6
PF 226,226,8,6
PF 228,228,8,6
PF 230,230,8,6
PF 232,232,8,6
PF 234,234,8,6
PM 224,224,176
PM 226,226,178
PM 228,228,180
PM 230,230,182
PM 232,232,184
PM 234,234,186
E 224,224
E 225,225
E 226,226
E 227,227
E 228,228
E 229,229
E 230,230
E 231,231
E 232,232
E 233,233
E 234,234
E 235,235
PA 224,224,10
PA 226,226,10
PA 228,228,10
PA 230,230,10
PA 232,232,10
PA 234,234,10
RC 224,224
RC 225,225
RC 226,226
RC 227,227
RC 228,228
RC 229,229
RC 230,230
RC 231,231
RC 232,232
RC 233,233
RC 234,234
RC 235,235
PM 176,176,224
PM 178,178,226
PM 180,180,228
PM 182,182,230
PM 184,184,232
PM 186,186,234
PM 224,188,188
PM 226,190,190
PM 228,192,192
PM 230,194,194
PM 232,196,196
PM 234,198,198
PF 224,224,8,6
PF 226,226,8,6
PF 228,228,8,6
PF 230,230,8,6
PF 232,232,8,6
PF 234,234,8,6
PM 224,224,188
PM 226,226,190
PM 228,228,192
PM 230,230,194
PM 232,232,196
PM 234,234,198
E 224,224
E 225,225
E 226,226
E 227,227
E 228,228
E 229,229
E 230,230
E 231,231
E 232,232
E 233,233
E 234,234
E 235,235
PA 224,224,10
PA 226,226,10
PA 228,228,10
PA 230,230,10
PA 232,232,10
PA 234,234,10
RC 224,224
RC 225,225
RC 226,226
RC 227,227
RC 228,228
RC 229,229
RC 230,230
RC 231,231
RC 232,232
RC 233,233
RC 234,234
RC 235,235
PM 188,188,224
PM 190,190,226
PM 192,192,228
PM 194,194,230
PM 196,196,232
PM 198,198,234
PM 224,200,200
PM 226,202,202
PM 228,204,204
PM 230,206,206
PM 232,208,208
PM 234,210,210
PF 224,224,8,6
PF 226,226,8,6
PF 228,228,8,6
PF 230,230,8,6
PF 232,232,8,6
PF 234,234,8,6
PM 224,224,200
PM 226,226,202
PM 228,228,204
PM 230,230,206
PM 232,232,208
PM 234,234,210
E 224,224
E 225,225
E 226,226
E 227,227
E 228,228
E 229,229
E 230,230
E 231,231
E 232,232
E 233,233
E 234,234
E 235,235
PA 224,224,10
PA 226,226,10
PA 228,228,10
PA 230,230,10
PA 232,232,10
PA 234,234,10
RC 224,224
RC 225,225
RC 226,226
RC 227,227
RC 228,228
RC 229,229
RC 230,230
RC 231,231
RC 232,232
RC 233,233
RC 234,234
RC 235,235
PM 200,200,224
PM 202,202,226
PM 204,204,228
PM 206,206,230
PM 208,208,232
PM 210,210,234
PM 224,212,212
PM 226,214,214
PM 228,216,216
PM 230,218,218
PM 232,220,220
PM 234,222,222
PF 224,224,8,6
PF 226,226,8,6
PF 228,228,8,6
PF 230,230,8,6
PF 232,232,8,6
PF 234,234,8,6
PM 224,224,212
PM 226,226,214
PM 228,228,216
PM 230,230,218
PM 232,232,220
PM 234,234,222
E 224,224
E 225,225
E 226,226
E 227,227
E 228,228
E 229,229
E 230,230
E 231,231
E 232,232
E 233,233
E 234,234
E 235,235
PA 224,224,10
PA 226,226,10
PA 228,228,10
PA 230,230,10
PA 232,232,10
PA 234,234,10
RC 224,224
RC 225,225
RC 226,226
RC 227,227
RC 228,228
RC 229,229
RC 230,230
RC 231,231
RC 232,232
RC 233,233
RC 234,234
RC 235,235
PM 212,212,224
PM 214,214,226
PM 216,216,228
PM 218,218,230
PM 220,220,232
PM 222,222,234
v_bfe_u32 v12,v1,3,1
SL 12,8,12
v_lshrrev_b32 v13,4,v1
v_lshl_add_u32 v12,v13,6,v12
N 13,7,1
v_lshl_add_u32 v12,v13,3,v12
SL 12,1,12
s_lshl_b32 s40,s29,15
s_lshl_b32 s39,s28,12
s_add_u32 s40,s40,s39
s_lshl_b32 s39,s31,11
s_add_u32 s40,s40,s39
s_lshl_b32 s39,s32,3
s_add_u32 s40,s40,s39
N 13,8,1
v_cmp_ne_u32 s[60:61],0,v13
N 13,4,1
v_cmp_ne_u32 s[62:63],0,v13
N 13,2,1
v_cmp_ne_u32 s[34:35],0,v13
N 13,1,1
v_cmp_ne_u32 s[36:37],0,v13
PA 224,128,132
PM 240,128,128
PF 240,132,132,240
PA 224,224,136
PF 240,136,136,240
PA 224,224,140
PF 240,140,140,240
PA 224,224,144
PF 240,144,144,240
PA 224,224,148
PF 240,148,148,240
PA 226,130,134
PM 242,130,130
PF 242,134,134,242
PA 226,226,138
PF 242,138,138,242
PA 226,226,142
PF 242,142,142,242
PA 226,226,146
PF 242,146,146,242
PA 226,226,150
PF 242,150,150,242
PA 228,152,156
PM 244,152,152
PF 244,156,156,244
PA 228,228,160
PF 244,160,160,244
PA 228,228,164
PF 244,164,164,244
PA 228,228,168
PF 244,168,168,244
PA 228,228,172
PF 244,172,172,244
PA 230,154,158
PM 246,154,154
PF 246,158,158,246
PA 230,230,162
PF 246,162,162,246
PA 230,230,166
PF 246,166,166,246
PA 230,230,170
PF 246,170,170,246
PA 230,230,174
PF 246,174,174,246
PA 232,176,180
PM 248,176,176
PF 248,180,180,248
PA 232,232,184
PF 248,184,184,248
PA 232,232,188
PF 248,188,188,248
PA 232,232,192
PF 248,192,192,248
PA 232,232,196
PF 248,196,196,248
PA 234,178,182
PM 250,178,178
PF 250,182,182,250
PA 234,234,186
PF 250,186,186,250
PA 234,234,190
PF 250,190,190,250
PA 234,234,194
PF 250,194,194,250
PA 234,234,198
PF 250,198,198,250
PA 236,200,204
PM 252,200,200
PF 252,204,204,252
PA 236,236,208
PF 252,208,208,252
PA 236,236,212
PF 252,212,212,252
PA 236,236,216
PF 252,216,216,252
PA 236,236,220
PF 252,220,220,252
PA 238,202,206
PM 254,202,202
PF 254,206,206,254
PA 238,238,210
PF 254,210,210,254
PA 238,238,214
PF 254,214,214,254
PA 238,238,218
PF 254,218,218,254
PA 238,238,222
PF 254,222,222,254
K1 18,232,224,60
K1 224,224,232,60
K1 19,233,225,60
K1 225,225,233,60
K1 20,234,226,60
K1 226,226,234,60
K1 21,235,227,60
K1 227,227,235,60
s_nop 1
v_add_f32_dpp v224,v18,v224 row_mirror row_mask:0xf bank_mask:0xf
v_add_f32_dpp v225,v19,v225 row_mirror row_mask:0xf bank_mask:0xf
v_add_f32_dpp v226,v20,v226 row_mirror row_mask:0xf bank_mask:0xf
v_add_f32_dpp v227,v21,v227 row_mirror row_mask:0xf bank_mask:0xf
K1 18,236,228,60
K1 228,228,236,60
K1 19,237,229,60
K1 229,229,237,60
K1 20,238,230,60
K1 230,230,238,60
K1 21,239,231,60
K1 231,231,239,60
s_nop 1
v_add_f32_dpp v228,v18,v228 row_mirror row_mask:0xf bank_mask:0xf
v_add_f32_dpp v229,v19,v229 row_mirror row_mask:0xf bank_mask:0xf
v_add_f32_dpp v230,v20,v230 row_mirror row_mask:0xf bank_mask:0xf
v_add_f32_dpp v231,v21,v231 row_mirror row_mask:0xf bank_mask:0xf
K1 18,248,240,60
K1 240,240,248,60
K1 19,249,241,60
K1 241,241,249,60
K1 20,250,242,60
K1 242,242,250,60
K1 21,251,243,60
K1 243,243,251,60
s_nop 1
v_add_f32_dpp v240,v18,v240 row_mirror row_mask:0xf bank_mask:0xf
v_add_f32_dpp v241,v19,v241 row_mirror row_mask:0xf bank_mask:0xf
v_add_f32_dpp v242,v20,v242 row_mirror row_mask:0xf bank_mask:0xf
v_add_f32_dpp v243,v21,v243 row_mirror row_mask:0xf bank_mask:0xf
K1 18,252,244,60
K1 244,244,252,60
K1 19,253,245,60
K1 245,245,253,60
K1 20,254,246,60
K1 246,246,254,60
K1 21,255,247,60
K1 247,247,255,60
s_nop 1
v_add_f32_dpp v244,v18,v244 row_mirror row_mask:0xf bank_mask:0xf
v_add_f32_dpp v245,v19,v245 row_mirror row_mask:0xf bank_mask:0xf
v_add_f32_dpp v246,v20,v246 row_mirror row_mask:0xf bank_mask:0xf
v_add_f32_dpp v247,v21,v247 row_mirror row_mask:0xf bank_mask:0xf
K1 18,228,224,62
K1 224,224,228,62
K1 19,229,225,62
K1 225,225,229,62
K1 20,230,226,62
K1 226,226,230,62
K1 21,231,227,62
K1 227,227,231,62
s_nop 1
v_add_f32_dpp v224,v18,v224 row_half_mirror row_mask:0xf bank_mask:0xf
v_add_f32_dpp v225,v19,v225 row_half_mirror row_mask:0xf bank_mask:0xf
v_add_f32_dpp v226,v20,v226 row_half_mirror row_mask:0xf bank_mask:0xf
v_add_f32_dpp v227,v21,v227 row_half_mirror row_mask:0xf bank_mask:0xf
K1 18,244,240,62
K1 240,240,244,62
K1 19,245,241,62
K1 241,241,245,62
K1 20,246,242,62
K1 242,242,246,62
K1 21,247,243,62
K1 243,243,247,62
s_nop 1
v_add_f32_dpp v240,v18,v240 row_half_mirror row_mask:0xf bank_mask:0xf
v_add_f32_dpp v241,v19,v241 row_half_mirror row_mask:0xf bank_mask:0xf
v_add_f32_dpp v242,v20,v242 row_half_mirror row_mask:0xf bank_mask:0xf
v_add_f32_dpp v243,v21,v243 row_half_mirror row_mask:0xf bank_mask:0xf
K1 18,226,224,34
K1 224,224,226,34
K1 19,227,225,34
K1 225,225,227,34
s_nop 1
v_add_f32_dpp v224,v18,v224 quad_perm:[3,2,1,0] row_mask:0xf bank_mask:0xf
v_add_f32_dpp v225,v19,v225 quad_perm:[3,2,1,0] row_mask:0xf bank_mask:0xf
K1 18,242,240,34
K1 240,240,242,34
K1 19,243,241,34
K1 241,241,243,34
s_nop 1
v_add_f32_dpp v240,v18,v240 quad_perm:[3,2,1,0] row_mask:0xf bank_mask:0xf
v_add_f32_dpp v241,v19,v241 quad_perm:[3,2,1,0] row_mask:0xf bank_mask:0xf
K1 18,225,224,36
K1 224,224,225,36
s_nop 1
v_add_f32_dpp v224,v18,v224 quad_perm:[1,0,3,2] row_mask:0xf bank_mask:0xf
K1 18,241,240,36
K1 240,240,241,36
s_nop 1
v_add_f32_dpp v240,v18,v240 quad_perm:[1,0,3,2] row_mask:0xf bank_mask:0xf
V1 225,240
buffer_store_dwordx2 v[224:225],v12,s[56:59],s40 offen offset:0 sc1
s_nop 1
PA 224,32,36
PM 240,32,32
PF 240,36,36,240
PA 224,224,40
PF 240,40,40,240
PA 224,224,44
PF 240,44,44,240
PA 224,224,48
PF 240,48,48,240
PA 224,224,52
PF 240,52,52,240
PA 226,34,38
PM 242,34,34
PF 242,38,38,242
PA 226,226,42
PF 242,42,42,242
PA 226,226,46
PF 242,46,46,242
PA 226,226,50
PF 242,50,50,242
PA 226,226,54
PF 242,54,54,242
PA 228,56,60
PM 244,56,56
PF 244,60,60,244
PA 228,228,64
PF 244,64,64,244
PA 228,228,68
PF 244,68,68,244
PA 228,228,72
PF 244,72,72,244
PA 228,228,76
PF 244,76,76,244
PA 230,58,62
PM 246,58,58
PF 246,62,62,246
PA 230,230,66
PF 246,66,66,246
PA 230,230,70
PF 246,70,70,246
PA 230,230,74
PF 246,74,74,246
PA 230,230,78
PF 246,78,78,246
PA 232,80,84
PM 248,80,80
PF 248,84,84,248
PA 232,232,88
PF 248,88,88,248
PA 232,232,92
PF 248,92,92,248
PA 232,232,96
PF 248,96,96,248
PA 232,232,100
PF 248,100,100,248
PA 234,82,86
PM 250,82,82
PF 250,86,86,250
PA 234,234,90
PF 250,90,90,250
PA 234,234,94
PF 250,94,94,250
PA 234,234,98
PF 250,98,98,250
PA 234,234,102
PF 250,102,102,250
PA 236,104,108
PM 252,104,104
PF 252,108,108,252
PA 236,236,112
PF 252,112,112,252
PA 236,236,116
PF 252,116,116,252
PA 236,236,120
PF 252,120,120,252
PA 236,236,124
PF 252,124,124,252
PA 238,106,110
PM 254,106,106
PF 254,110,110,254
PA 238,238,114
PF 254,114,114,254
PA 238,238,118
PF 254,118,118,254
PA 238,238,122
PF 254,122,122,254
PA 238,238,126
PF 254,126,126,254
K1 18,232,224,60
K1 224,224,232,60
K1 19,233,225,60
K1 225,225,233,60
K1 20,234,226,60
K1 226,226,234,60
K1 21,235,227,60
K1 227,227,235,60
s_nop 1
v_add_f32_dpp v224,v18,v224 row_mirror row_mask:0xf bank_mask:0xf
v_add_f32_dpp v225,v19,v225 row_mirror row_mask:0xf bank_mask:0xf
v_add_f32_dpp v226,v20,v226 row_mirror row_mask:0xf bank_mask:0xf
v_add_f32_dpp v227,v21,v227 row_mirror row_mask:0xf bank_mask:0xf
K1 18,236,228,60
K1 228,228,236,60
K1 19,237,229,60
K1 229,229,237,60
K1 20,238,230,60
K1 230,230,238,60
K1 21,239,231,60
K1 231,231,239,60
s_nop 1
v_add_f32_dpp v228,v18,v228 row_mirror row_mask:0xf bank_mask:0xf
v_add_f32_dpp v229,v19,v229 row_mirror row_mask:0xf bank_mask:0xf
v_add_f32_dpp v230,v20,v230 row_mirror row_mask:0xf bank_mask:0xf
v_add_f32_dpp v231,v21,v231 row_mirror row_mask:0xf bank_mask:0xf
K1 18,248,240,60
K1 240,240,248,60
K1 19,249,241,60
K1 241,241,249,60
K1 20,250,242,60
K1 242,242,250,60
K1 21,251,243,60
K1 243,243,251,60
s_nop 1
v_add_f32_dpp v240,v18,v240 row_mirror row_mask:0xf bank_mask:0xf
v_add_f32_dpp v241,v19,v241 row_mirror row_mask:0xf bank_mask:0xf
v_add_f32_dpp v242,v20,v242 row_mirror row_mask:0xf bank_mask:0xf
v_add_f32_dpp v243,v21,v243 row_mirror row_mask:0xf bank_mask:0xf
K1 18,252,244,60
K1 244,244,252,60
K1 19,253,245,60
K1 245,245,253,60
K1 20,254,246,60
K1 246,246,254,60
K1 21,255,247,60
K1 247,247,255,60
s_nop 1
v_add_f32_dpp v244,v18,v244 row_mirror row_mask:0xf bank_mask:0xf
v_add_f32_dpp v245,v19,v245 row_mirror row_mask:0xf bank_mask:0xf
v_add_f32_dpp v246,v20,v246 row_mirror row_mask:0xf bank_mask:0xf
v_add_f32_dpp v247,v21,v247 row_mirror row_mask:0xf bank_mask:0xf
K1 18,228,224,62
K1 224,224,228,62
K1 19,229,225,62
K1 225,225,229,62
K1 20,230,226,62
K1 226,226,230,62
K1 21,231,227,62
K1 227,227,231,62
s_nop 1
v_add_f32_dpp v224,v18,v224 row_half_mirror row_mask:0xf bank_mask:0xf
v_add_f32_dpp v225,v19,v225 row_half_mirror row_mask:0xf bank_mask:0xf
v_add_f32_dpp v226,v20,v226 row_half_mirror row_mask:0xf bank_mask:0xf
v_add_f32_dpp v227,v21,v227 row_half_mirror row_mask:0xf bank_mask:0xf
K1 18,244,240,62
K1 240,240,244,62
K1 19,245,241,62
K1 241,241,245,62
K1 20,246,242,62
K1 242,242,246,62
K1 21,247,243,62
K1 243,243,247,62
s_nop 1
v_add_f32_dpp v240,v18,v240 row_half_mirror row_mask:0xf bank_mask:0xf
v_add_f32_dpp v241,v19,v241 row_half_mirror row_mask:0xf bank_mask:0xf
v_add_f32_dpp v242,v20,v242 row_half_mirror row_mask:0xf bank_mask:0xf
v_add_f32_dpp v243,v21,v243 row_half_mirror row_mask:0xf bank_mask:0xf
K1 18,226,224,34
K1 224,224,226,34
K1 19,227,225,34
K1 225,225,227,34
s_nop 1
v_add_f32_dpp v224,v18,v224 quad_perm:[3,2,1,0] row_mask:0xf bank_mask:0xf
v_add_f32_dpp v225,v19,v225 quad_perm:[3,2,1,0] row_mask:0xf bank_mask:0xf
K1 18,242,240,34
K1 240,240,242,34
K1 19,243,241,34
K1 241,241,243,34
s_nop 1
v_add_f32_dpp v240,v18,v240 quad_perm:[3,2,1,0] row_mask:0xf bank_mask:0xf
v_add_f32_dpp v241,v19,v241 quad_perm:[3,2,1,0] row_mask:0xf bank_mask:0xf
K1 18,225,224,36
K1 224,224,225,36
s_nop 1
v_add_f32_dpp v224,v18,v224 quad_perm:[1,0,3,2] row_mask:0xf bank_mask:0xf
K1 18,241,240,36
K1 240,240,241,36
s_nop 1
v_add_f32_dpp v240,v18,v240 quad_perm:[1,0,3,2] row_mask:0xf bank_mask:0xf
V1 225,240
buffer_store_dwordx2 v[224:225],v12,s[56:59],s40 offen offset:1024 sc1
s_nop 1
C 18,128,129
C 19,130,131
AW 112,18
AW 113,19
C 18,152,153
C 19,154,155
AW 114,18
AW 115,19
C 18,132,133
C 19,134,135
AW 116,18
AW 117,19
C 18,156,157
C 19,158,159
AW 118,18
AW 119,19
C 18,136,137
C 19,138,139
AW 120,18
AW 121,19
C 18,160,161
C 19,162,163
AW 122,18
AW 123,19
C 18,140,141
C 19,142,143
AW 124,18
AW 125,19
C 18,164,165
C 19,166,167
AW 126,18
AW 127,19
C 18,144,145
C 19,146,147
AW 128,18
AW 129,19
C 18,168,169
C 19,170,171
AW 130,18
AW 131,19
C 18,148,149
C 19,150,151
AW 132,18
AW 133,19
C 18,172,173
C 19,174,175
AW 134,18
AW 135,19
C 18,176,177
C 19,178,179
AW 136,18
AW 137,19
C 18,200,201
C 19,202,203
AW 138,18
AW 139,19
C 18,180,181
C 19,182,183
AW 140,18
AW 141,19
C 18,204,205
C 19,206,207
AW 142,18
AW 143,19
C 18,184,185
C 19,186,187
AW 144,18
AW 145,19
C 18,208,209
C 19,210,211
AW 146,18
AW 147,19
C 18,188,189
C 19,190,191
AW 148,18
AW 149,19
C 18,212,213
C 19,214,215
AW 150,18
AW 151,19
C 18,192,193
C 19,194,195
AW 152,18
AW 153,19
C 18,216,217
C 19,218,219
AW 154,18
AW 155,19
C 18,196,197
C 19,198,199
AW 156,18
AW 157,19
C 18,220,221
C 19,222,223
AW 158,18
AW 159,19
C 18,32,33
C 19,34,35
AW 160,18
AW 161,19
C 18,56,57
C 19,58,59
AW 162,18
AW 163,19
C 18,36,37
C 19,38,39
AW 164,18
AW 165,19
C 18,60,61
C 19,62,63
AW 166,18
AW 167,19
C 18,40,41
C 19,42,43
AW 168,18
AW 169,19
C 18,64,65
C 19,66,67
AW 170,18
AW 171,19
C 18,44,45
C 19,46,47
AW 172,18
AW 173,19
C 18,68,69
C 19,70,71
AW 174,18
AW 175,19
C 18,48,49
C 19,50,51
AW 176,18
AW 177,19
C 18,72,73
C 19,74,75
AW 178,18
AW 179,19
C 18,52,53
C 19,54,55
AW 180,18
AW 181,19
C 18,76,77
C 19,78,79
AW 182,18
AW 183,19
C 18,80,81
C 19,82,83
AW 184,18
AW 185,19
C 18,104,105
C 19,106,107
AW 186,18
AW 187,19
C 18,84,85
C 19,86,87
AW 188,18
AW 189,19
C 18,108,109
C 19,110,111
AW 190,18
AW 191,19
C 18,88,89
C 19,90,91
AW 192,18
AW 193,19
C 18,112,113
C 19,114,115
AW 194,18
AW 195,19
C 18,92,93
C 19,94,95
AW 196,18
AW 197,19
C 18,116,117
C 19,118,119
AW 198,18
AW 199,19
C 18,96,97
C 19,98,99
AW 200,18
AW 201,19
C 18,120,121
C 19,122,123
AW 202,18
AW 203,19
C 18,100,101
C 19,102,103
AW 204,18
AW 205,19
C 18,124,125
C 19,126,127
AW 206,18
AW 207,19
s_lshl_b32 s39,s31,13
s_add_u32 s39,s39,98304
v_add_u32 v17,s39,v27
s_waitcnt lgkmcnt(0)
s_mov_b32 s52,s50
s_and_b32 s53,s51,0xffff
s_mov_b32 s54,4096
s_mov_b32 s55,0x00020000
s_and_b32 s49,s49,0xffff
s_mov_b32 s50,8388608
s_mov_b32 s51,0x00020000
s_waitcnt vmcnt(0)
s_barrier
T 0,3,36864
R 48,17,0
T 2,3,38400
R 52,17,1024
T 4,4,36864
T 6,4,38400
R 56,17,2048
T 8,5,36864
R 60,17,3072
T 10,5,38400
T 12,14,36864
R 64,17,4096
T 14,14,38400
R 68,17,5120
T 16,15,36864
T 18,15,38400
R 72,17,6144
T 20,16,36864
R 76,17,7168
T 22,16,38400
s_lshl_b32 s40,s28,8
s_add_u32 s40,s40,4096
buffer_atomic_add v28,v29,s[92:95],s40 offen sc1
s_bfe_u32 s39,s38,0x40015
s_lshl_b32 s39,s39,8
s_add_u32 s39,s39,28672
buffer_atomic_add v28,v29,s[92:95],s39 offen sc1
s_mov_b32 s63,0xffff0000
s_lshl_b32 s39,s30,10
v_add_u32 v12,s39,v27
v_lshrrev_b32 v13,4,v1
SL 13,5,13
s_lshl_b32 s39,s31,9
v_add_u32 v13,s39,v13
s_lshl_b32 s60,s28,12
s_lshl_b32 s61,s28,1
s_add_u32 s61,s61,s31
s_lshl_b32 s61,s61,20
s_mul_i32 s39,s33,6144
s_add_u32 s61,s61,s39
s_waitcnt lgkmcnt(0)
s_barrier
M 64,0,48,0
s_add_u32 m0,s43,98304
T 24,3,49152
R 80,17,16384
M 68,0,52,0
s_mul_i32 s15,s29,12288
M 72,0,56,0
s_lshl_b32 s39,s28,21
T 26,3,50688
M 76,0,60,0
s_add_u32 s15,s15,s39
L6 22,20,41
R 84,17,17408
M 80,0,64,0
s_lshl_b32 s12,s28,20
M 84,0,68,0
s_lshl_b32 s39,s28,9
T 28,4,49152
M 88,0,72,0
s_add_u32 s12,s12,s39
M 92,0,76,0
L7 22,20,41,1024
T 30,4,50688
M 96,4,48,0
s_add_u32 s13,s12,131072
R 88,17,18432
M 100,4,52,0
M 104,4,56,0
s_lshl_b32 s14,s30,13
T 32,5,49152
M 108,4,60,0
L7 22,20,41,2048
M 112,4,64,0
s_mul_i32 s36,s32,6
R 92,17,19456
M 116,4,68,0
s_lshl_b32 s34,s31,3
T 34,5,50688
M 120,4,72,0
M 124,4,76,0
s_mov_b32 s96,s15
L7 22,20,41,3072
T 36,14,49152
M 128,8,48,0
M 132,8,52,0
s_add_u32 s97,s15,2097152
R 96,17,20480
M 136,8,56,0
T 38,14,50688
M 140,8,60,0
s_add_u32 s41,s41,131072
s_cmp_eq_u32 s41,s5
s_cselect_b32 s41,s4,s41
M 144,8,64,0
s_mov_b32 s98,s12
R 100,17,21504
M 148,8,68,0
s_add_u32 s99,s12,512
M 152,8,72,0
T 40,15,49152
v_lshrrev_b32_e64 v60,3,v1
M 156,8,76,0
s_add_u32 m0,s11,36864
T 42,15,50688
M 160,12,48,0
v_lshrrev_b32_e64 v61,4,v1
M 164,12,52,0
R 104,17,22528
M 168,12,56,0
v_and_b32_e64 v62,7,v1
M 172,12,60,0
L 23,16,42
T 44,16,49152
M 176,12,64,0
R 108,17,23552
v_xor_b32_e64 v61,v61,v62
M 180,12,68,0
s_mul_i32 s39,s30,262144
M 184,12,72,0
T 46,16,50688
M 188,12,76,0
L1 24,16,42,1024
v_lshl_add_u32 v61,v61,4,s39
M 192,16,48,0
M 196,16,52,0
v_mul_u32_u24 v60,4096,v60
M 200,16,56,0
v_add_u32_e64 v18,v60,v61
M 204,16,60,0
L1 25,16,42,2048
M 208,16,64,0
v_xor_b32_e64 v19,64,v18
M 212,16,68,0
M 216,16,72,0
v_add_u32 v20,63488,v18
M 220,16,76,0
s_add_u32 s42,s42,294912
s_cmp_eq_u32 s42,s7
s_cselect_b32 s42,s6,s42
M 224,20,48,0
v_add_u32 v19,31744,v19
M 228,20,52,0
M 232,20,56,0
M 236,20,60,0
M 240,20,64,0
M 244,20,68,0
M 248,20,72,0
s_waitcnt lgkmcnt(0)
M 252,20,76,0
s_barrier
M2 64,24,80,64
s_add_u32 m0,s43,114688
T 0,3,0
v_add_u32 v21,63488,v19
M2 68,24,84,68
R 48,17,32768
v_and_b32_e64 v60,15,v1
M2 72,24,88,72
T 2,3,1536
v_lshrrev_b32_e64 v61,1,v60
M2 76,24,92,76
L6 22,20,41
R 52,17,33792
M2 80,24,96,80
v_lshrrev_b32_e64 v62,4,v1
M2 84,24,100,84
T 4,4,0
v_xor_b32_e64 v61,v61,v62
M2 88,24,104,88
v_lshlrev_b32_e64 v61,4,v61
M2 92,24,108,92
L7 22,20,41,1024
T 6,4,1536
M2 96,28,80,96
R 56,17,34816
v_lshl_add_u32 v60,v60,7,v61
M2 100,28,84,100
M2 104,28,88,104
s_lshl_b32 s39,s34,11
T 8,5,0
M2 108,28,92,108
L7 22,20,41,2048
M2 112,28,96,112
s_add_u32 s39,s39,65536
R 60,17,35840
M2 116,28,100,116
T 10,5,1536
v_add_u32 v8,s39,v60
M2 120,28,104,120
M2 124,28,108,124
L7 22,20,41,3072
T 12,14,0
M2 128,32,80,128
v_xor_b32_e64 v60,64,v60
M2 132,32,84,132
R 64,17,36864
v_add_u32_e64 v9,s39,v60
M2 136,32,88,136
T 14,14,1536
M2 140,32,92,140
s_add_u32 s41,s41,131072
s_cmp_eq_u32 s41,s5
s_cselect_b32 s41,s4,s41
M2 144,32,96,144
R 68,17,37888
v_add_u32 v10,0x10000,v8
M2 148,32,100,148
v_add_u32 v11,0x10000,v9
M2 152,32,104,152
s_mul_i32 s39,s30,3072
T 16,15,0
M2 156,32,108,156
s_add_u32 m0,s11,49152
T 18,15,1536
M2 160,36,80,160
v_lshlrev_b32_e64 v60,4,v1
M2 164,36,84,164
R 72,17,38912
M2 168,36,88,168
v_add_u32_e64 v2,s39,v60
M2 172,36,92,172
s_lshl_b32 s39,s36,10
L 23,16,42
T 20,16,0
M2 176,36,96,176
R 76,17,39936
M2 180,36,100,180
s_add_u32 s39,s39,0
M2 184,36,104,184
T 22,16,1536
M2 188,36,108,188
L1 24,16,42,1024
v_add_u32_e64 v7,s39,v60
M2 192,40,80,192
M2 196,40,84,196
v_and_b32_e64 v30,15,v1
M2 200,40,88,200
v_lshlrev_b32_e64 v30,1,v30
M2 204,40,92,204
L1 25,16,42,2048
M2 208,40,96,208
s_lshl_b32 s37,s28,4
M2 212,40,100,212
M2 216,40,104,216
s_add_u32 s37,s37,s34
M2 220,40,108,220
s_add_u32 s42,s42,294912
s_cmp_eq_u32 s42,s7
s_cselect_b32 s42,s6,s42
M2 224,44,80,224
s_lshl_b32 s37,s37,5
M2 228,44,84,228
M2 232,44,88,232
M2 236,44,92,236
M2 240,44,96,240
M2 244,44,100,244
M2 248,44,104,248
s_waitcnt lgkmcnt(0)
M2 252,44,108,252
s_barrier
M2 64,0,48,64
s_add_u32 m0,s43,131072
T 24,3,12288
R 80,17,49152
M2 68,0,52,68
M2 72,0,56,72
T 26,3,13824
M2 76,0,60,76
L6 22,20,41
R 84,17,50176
M2 80,0,64,80
M2 84,0,68,84
T 28,4,12288
M2 88,0,72,88
M2 92,0,76,92
L7 22,20,41,1024
T 30,4,13824
M2 96,4,48,96
R 88,17,51200
M2 100,4,52,100
M2 104,4,56,104
T 32,5,12288
M2 108,4,60,108
L7 22,20,41,2048
M2 112,4,64,112
R 92,17,52224
M2 116,4,68,116
T 34,5,13824
M2 120,4,72,120
M2 124,4,76,124
L7 22,20,41,3072
T 36,14,12288
M2 128,8,48,128
M2 132,8,52,132
R 96,17,53248
M2 136,8,56,136
T 38,14,13824
M2 140,8,60,140
s_add_u32 s41,s41,131072
s_cmp_eq_u32 s41,s5
s_cselect_b32 s41,s4,s41
M2 144,8,64,144
R 100,17,54272
M2 148,8,68,148
M2 152,8,72,152
T 40,15,12288
M2 156,8,76,156
s_add_u32 m0,s11,0
T 42,15,13824
M2 160,12,48,160
M2 164,12,52,164
R 104,17,55296
M2 168,12,56,168
M2 172,12,60,172
L 23,16,42
T 44,16,12288
M2 176,12,64,176
R 108,17,56320
M2 180,12,68,180
M2 184,12,72,184
T 46,16,13824
M2 188,12,76,188
L1 24,16,42,1024
M2 192,16,48,192
M2 196,16,52,196
M2 200,16,56,200
M2 204,16,60,204
L1 25,16,42,2048
M2 208,16,64,208
M2 212,16,68,212
M2 216,16,72,216
M2 220,16,76,220
s_add_u32 s42,s42,294912
s_cmp_eq_u32 s42,s7
s_cselect_b32 s42,s6,s42
M2 224,20,48,224
M2 228,20,52,228
M2 232,20,56,232
M2 236,20,60,236
M2 240,20,64,240
M2 244,20,68,244
M2 248,20,72,248
s_waitcnt vmcnt(17) lgkmcnt(0)
M2 252,20,76,252
s_barrier
M2 64,24,80,64
s_add_u32 m0,s43,147456
T 0,3,24576
R 48,17,0
M2 68,24,84,68
M2 72,24,88,72
T 2,3,26112
L6 22,20,41
M2 76,24,92,76
R 52,17,1024
M2 80,24,96,80
M2 84,24,100,84
T 4,4,24576
M2 88,24,104,88
L7 22,20,41,1024
M2 92,24,108,92
T 6,4,26112
M2 96,28,80,96
R 56,17,2048
M2 100,28,84,100
M2 104,28,88,104
T 8,5,24576
L7 22,20,41,2048
M2 108,28,92,108
M2 112,28,96,112
R 60,17,3072
M2 116,28,100,116
T 10,5,26112
M2 120,28,104,120
L7 22,20,41,3072
M2 124,28,108,124
T 12,14,24576
M2 128,32,80,128
M2 132,32,84,132
R 64,17,4096
M2 136,32,88,136
s_add_u32 s41,s41,131072
s_cmp_eq_u32 s41,s5
s_cselect_b32 s41,s4,s41
M2 140,32,92,140
T 14,14,26112
M2 144,32,96,144
R 68,17,5120
M2 148,32,100,148
M2 152,32,104,152
s_add_u32 m0,s11,12288
T 16,15,24576
M2 156,32,108,156
T 18,15,26112
M2 160,36,80,160
M2 164,36,84,164
R 72,17,6144
M2 168,36,88,168
L 23,16,42
M2 172,36,92,172
T 20,16,24576
M2 176,36,96,176
R 76,17,7168
M2 180,36,100,180
M2 184,36,104,184
L1 24,16,42,1024
T 22,16,26112
M2 188,36,108,188
M2 192,40,80,192
M2 196,40,84,196
M2 200,40,88,200
L1 25,16,42,2048
M2 204,40,92,204
M2 208,40,96,208
M2 212,40,100,212
M2 216,40,104,216
s_add_u32 s42,s42,294912
s_cmp_eq_u32 s42,s7
s_cselect_b32 s42,s6,s42
M2 220,40,108,220
M2 224,44,80,224
M2 228,44,84,228
M2 232,44,88,232
buffer_load_dword v0,v26,s[92:95],s40 offen sc1
M2 236,44,92,236
M2 240,44,96,240
M2 244,44,100,244
M2 248,44,104,248
M2 252,44,108,252
s_waitcnt vmcnt(0)
s_cmp_lg_u32 s30,0
s_cbranch_scc1 spinret_st
v_readfirstlane_b32 s39,v0
s_nop 3
s_cmp_lt_u32 s39,12
s_cbranch_scc1 spin_st
spinret_st:
s_waitcnt lgkmcnt(0)
s_barrier
M2 64,0,48,64
s_add_u32 m0,s43,98304
T 24,3,36864
L4 208,12,56,60
M2 68,0,52,68
s_add_u32 s60,s60,32768
R 80,17,16384
M2 72,0,56,72
T 26,3,38400
M2 76,0,60,76
L6 22,20,41
R 84,17,17408
M2 80,0,64,80
M2 84,0,68,84
T 28,4,36864
L4 212,12,56,60
M2 88,0,72,88
M2 92,0,76,92
L7 22,20,41,1024
T 30,4,38400
M2 96,4,48,96
R 88,17,18432
M2 100,4,52,100
s_add_u32 s60,s60,32768
M2 104,4,56,104
T 32,5,36864
M2 108,4,60,108
L7 22,20,41,2048
M2 112,4,64,112
R 92,17,19456
L4 216,12,56,60
M2 116,4,68,116
T 34,5,38400
M2 120,4,72,120
M2 124,4,76,124
L7 22,20,41,3072
T 36,14,36864
M2 128,8,48,128
s_add_u32 s60,s60,32768
M2 132,8,52,132
R 96,17,20480
M2 136,8,56,136
T 38,14,38400
M2 140,8,60,140
s_add_u32 s41,s41,131072
s_cmp_eq_u32 s41,s5
s_cselect_b32 s41,s4,s41
M2 144,8,64,144
R 100,17,21504
L4 220,12,56,60
M2 148,8,68,148
M2 152,8,72,152
T 40,15,36864
M2 156,8,76,156
s_add_u32 m0,s11,24576
T 42,15,38400
M2 160,12,48,160
s_add_u32 s60,s60,32768
M2 164,12,52,164
R 104,17,22528
M2 168,12,56,168
M2 172,12,60,172
L 23,16,42
T 44,16,36864
M2 176,12,64,176
L4 224,12,56,60
R 108,17,23552
M2 180,12,68,180
M2 184,12,72,184
T 46,16,38400
M2 188,12,76,188
s_add_u32 s60,s60,32768
L1 24,16,42,1024
M2 192,16,48,192
M2 196,16,52,196
M2 200,16,56,200
L4 228,12,56,60
M2 204,16,60,204
L1 25,16,42,2048
M2 208,16,64,208
M2 212,16,68,212
M2 216,16,72,216
s_add_u32 s60,s60,32768
M2 220,16,76,220
s_add_u32 s42,s42,294912
s_cmp_eq_u32 s42,s7
s_cselect_b32 s42,s6,s42
M2 224,20,48,224
M2 228,20,52,228
M2 232,20,56,232
M2 236,20,60,236
M2 240,20,64,240
M2 244,20,68,244
M2 248,20,72,248
s_waitcnt lgkmcnt(0)
M2 252,20,76,252
s_barrier
M2 64,24,80,64
s_add_u32 m0,s43,114688
T 0,3,49152
L4 232,12,56,60
M2 68,24,84,68
s_add_u32 s60,s60,32768
R 48,17,32768
M2 72,24,88,72
T 2,3,50688
M2 76,24,92,76
L6 22,20,41
R 52,17,33792
M2 80,24,96,80
M2 84,24,100,84
T 4,4,49152
L4 236,12,56,60
M2 88,24,104,88
M2 92,24,108,92
L7 22,20,41,1024
T 6,4,50688
M2 96,28,80,96
R 56,17,34816
M2 100,28,84,100
s_add_u32 s60,s60,32768
M2 104,28,88,104
T 8,5,49152
M2 108,28,92,108
L7 22,20,41,2048
M2 112,28,96,112
R 60,17,35840
L4 240,12,56,60
M2 116,28,100,116
T 10,5,50688
M2 120,28,104,120
M2 124,28,108,124
L7 22,20,41,3072
T 12,14,49152
M2 128,32,80,128
s_add_u32 s60,s60,32768
M2 132,32,84,132
R 64,17,36864
M2 136,32,88,136
T 14,14,50688
M2 140,32,92,140
s_add_u32 s41,s41,131072
s_cmp_eq_u32 s41,s5
s_cselect_b32 s41,s4,s41
M2 144,32,96,144
R 68,17,37888
L4 244,12,56,60
M2 148,32,100,148
M2 152,32,104,152
T 16,15,49152
M2 156,32,108,156
s_add_u32 m0,s11,36864
T 18,15,50688
M2 160,36,80,160
s_add_u32 s60,s60,32768
M2 164,36,84,164
R 72,17,38912
M2 168,36,88,168
M2 172,36,92,172
L 23,16,42
T 20,16,49152
M2 176,36,96,176
L4 248,12,56,60
R 76,17,39936
M2 180,36,100,180
M2 184,36,104,184
T 22,16,50688
M2 188,36,108,188
s_add_u32 s60,s60,32768
L1 24,16,42,1024
M2 192,40,80,192
M2 196,40,84,196
M2 200,40,88,200
L4 252,12,56,60
M2 204,40,92,204
L1 25,16,42,2048
M2 208,40,96,208
M2 212,40,100,212
M2 216,40,104,216
s_add_u32 s60,s60,32768
M2 220,40,108,220
s_add_u32 s42,s42,294912
s_cmp_eq_u32 s42,s7
s_cselect_b32 s42,s6,s42
M2 224,44,80,224
M2 228,44,84,228
M2 232,44,88,232
M2 236,44,92,236
M2 240,44,96,240
M2 244,44,100,244
M2 248,44,104,248
s_waitcnt lgkmcnt(0)
M2 252,44,108,252
s_barrier
M2 64,0,48,64
s_add_u32 m0,s43,131072
T 24,3,0
R 80,17,49152
M2 68,0,52,68
M2 72,0,56,72
T 26,3,1536
M2 76,0,60,76
L6 22,20,41
R 84,17,50176
M2 80,0,64,80
M2 84,0,68,84
T 28,4,0
M2 88,0,72,88
M2 92,0,76,92
L7 22,20,41,1024
T 30,4,1536
M2 96,4,48,96
R 88,17,51200
M2 100,4,52,100
M2 104,4,56,104
T 32,5,0
M2 108,4,60,108
L7 22,20,41,2048
M2 112,4,64,112
R 92,17,52224
M2 116,4,68,116
T 34,5,1536
M2 120,4,72,120
M2 124,4,76,124
L7 22,20,41,3072
T 36,14,0
M2 128,8,48,128
M2 132,8,52,132
R 96,17,53248
M2 136,8,56,136
T 38,14,1536
M2 140,8,60,140
s_add_u32 s41,s41,131072
s_cmp_eq_u32 s41,s5
s_cselect_b32 s41,s4,s41
M2 144,8,64,144
R 100,17,54272
M2 148,8,68,148
M2 152,8,72,152
T 40,15,0
M2 156,8,76,156
s_add_u32 m0,s11,49152
T 42,15,1536
M2 160,12,48,160
M2 164,12,52,164
R 104,17,55296
M2 168,12,56,168
M2 172,12,60,172
L 23,16,42
T 44,16,0
M2 176,12,64,176
R 108,17,56320
M2 180,12,68,180
M2 184,12,72,184
T 46,16,1536
M2 188,12,76,188
L1 24,16,42,1024
M2 192,16,48,192
M2 196,16,52,196
M2 200,16,56,200
M2 204,16,60,204
L1 25,16,42,2048
M2 208,16,64,208
M2 212,16,68,212
M2 216,16,72,216
M2 220,16,76,220
s_add_u32 s42,s42,294912
s_cmp_eq_u32 s42,s7
s_cselect_b32 s42,s6,s42
M2 224,20,48,224
M2 228,20,52,228
M2 232,20,56,232
M2 236,20,60,236
M2 240,20,64,240
M2 244,20,68,244
M2 248,20,72,248
s_waitcnt vmcnt(8) lgkmcnt(0)
M2 252,20,76,252
s_barrier
M2 64,24,80,64
s_add_u32 m0,s43,147456
T 0,3,12288
AR 60,208
M2 68,24,84,68
AR 61,209
AR 62,210
M2 72,24,88,72
R 48,17,0
AR 63,211
M2 76,24,92,76
T 2,3,13824
A 60,60,62
M2 80,24,96,80
L6 22,20,41
v_add_f32_e64 v61,v61,v63
M2 84,24,100,84
R 52,17,1024
AR 62,212
M2 88,24,104,88
AR 63,213
v_add_f32_e64 v60,v60,v62
M2 92,24,108,92
T 4,4,12288
v_add_f32_e64 v61,v61,v63
M2 96,28,80,96
L7 22,20,41,1024
AR 62,214
M2 100,28,84,100
T 6,4,13824
AR 63,215
M2 104,28,88,104
A 60,60,62
A 61,61,63
M2 108,28,92,108
R 56,17,2048
AR 62,216
M2 112,28,96,112
T 8,5,12288
AR 63,217
M2 116,28,100,116
L7 22,20,41,2048
v_add_f32_e64 v60,v60,v62
M2 120,28,104,120
R 60,17,3072
v_add_f32_e64 v61,v61,v63
M2 124,28,108,124
AR 62,218
AR 63,219
M2 128,32,80,128
T 10,5,13824
v_add_f32_e64 v60,v60,v62
M2 132,32,84,132
L7 22,20,41,3072
v_add_f32_e64 v61,v61,v63
M2 136,32,88,136
T 12,14,12288
AR 62,220
M2 140,32,92,140
R 64,17,4096
AR 63,221
M2 144,32,96,144
A 60,60,62
A 61,61,63
M2 148,32,100,148
T 14,14,13824
AR 62,222
M2 152,32,104,152
s_add_u32 s41,s41,131072
s_cmp_eq_u32 s41,s5
s_cselect_b32 s41,s4,s41
M2 156,32,108,156
s_add_u32 m0,s11,0
AR 63,223
A 60,60,62
M2 160,36,80,160
R 68,17,5120
v_add_f32_e64 v61,v61,v63
M2 164,36,84,164
T 16,15,12288
AR 62,224
M2 168,36,88,168
AR 63,225
v_add_f32_e64 v60,v60,v62
M2 172,36,92,172
T 18,15,13824
v_add_f32_e64 v61,v61,v63
M2 176,36,96,176
R 72,17,6144
AR 62,226
M2 180,36,100,180
AR 63,227
v_add_f32_e64 v60,v60,v62
M2 184,36,104,184
L 23,16,42
T 20,16,12288
M2 188,36,108,188
v_add_f32_e64 v61,v61,v63
AR 62,228
M2 192,40,80,192
R 76,17,7168
AR 63,229
M2 196,40,84,196
A 60,60,62
A 61,61,63
M2 200,40,88,200
T 22,16,13824
AR 62,230
M2 204,40,92,204
L1 24,16,42,1024
AR 63,231
M2 208,40,96,208
A 60,60,62
A 61,61,63
M2 212,40,100,212
AR 62,232
AR 63,233
M2 216,40,104,216
L1 25,16,42,2048
v_add_f32_e64 v60,v60,v62
M2 220,40,108,220
v_add_f32_e64 v61,v61,v63
AR 62,234
M2 224,44,80,224
AR 63,235
v_add_f32_e64 v60,v60,v62
M2 228,44,84,228
s_add_u32 s42,s42,294912
s_cmp_eq_u32 s42,s7
s_cselect_b32 s42,s6,s42
M2 232,44,88,232
v_add_f32_e64 v61,v61,v63
AR 62,236
M2 236,44,92,236
AR 63,237
v_add_f32_e64 v60,v60,v62
M2 240,44,96,240
v_add_f32_e64 v61,v61,v63
M2 244,44,100,244
M2 248,44,104,248
s_waitcnt lgkmcnt(0)
M2 252,44,108,252
s_barrier
M2 64,0,48,64
s_add_u32 m0,s43,98304
T 24,3,24576
AR 62,238
M2 68,0,52,68
AR 63,239
v_add_f32_e64 v60,v60,v62
M2 72,0,56,72
R 80,17,16384
v_add_f32_e64 v61,v61,v63
M2 76,0,60,76
T 26,3,26112
AR 62,240
M2 80,0,64,80
L6 22,20,41
AR 63,241
M2 84,0,68,84
R 84,17,17408
v_add_f32_e64 v60,v60,v62
M2 88,0,72,88
v_add_f32_e64 v61,v61,v63
AR 62,242
M2 92,0,76,92
T 28,4,24576
AR 63,243
M2 96,4,48,96
L7 22,20,41,1024
v_add_f32_e64 v60,v60,v62
M2 100,4,52,100
T 30,4,26112
v_add_f32_e64 v61,v61,v63
M2 104,4,56,104
R 88,17,18432
AR 62,244
M2 108,4,60,108
AR 63,245
v_add_f32_e64 v60,v60,v62
M2 112,4,64,112
T 32,5,24576
v_add_f32_e64 v61,v61,v63
M2 116,4,68,116
L7 22,20,41,2048
AR 62,246
M2 120,4,72,120
R 92,17,19456
AR 63,247
M2 124,4,76,124
T 34,5,26112
v_add_f32_e64 v60,v60,v62
M2 128,8,48,128
v_add_f32_e64 v61,v61,v63
AR 62,248
M2 132,8,52,132
L7 22,20,41,3072
T 36,14,24576
M2 136,8,56,136
AR 63,249
v_add_f32_e64 v60,v60,v62
M2 140,8,60,140
R 96,17,20480
v_add_f32_e64 v61,v61,v63
M2 144,8,64,144
AR 62,250
AR 63,251
M2 148,8,68,148
T 38,14,26112
v_add_f32_e64 v60,v60,v62
M2 152,8,72,152
s_add_u32 s41,s41,131072
s_cmp_eq_u32 s41,s5
s_cselect_b32 s41,s4,s41
M2 156,8,76,156
s_add_u32 m0,s11,12288
R 100,17,21504
v_add_f32_e64 v61,v61,v63
M2 160,12,48,160
AR 62,252
AR 63,253
M2 164,12,52,164
T 40,15,24576
v_add_f32_e64 v60,v60,v62
M2 168,12,56,168
T 42,15,26112
v_add_f32_e64 v61,v61,v63
M2 172,12,60,172
AR 62,254
AR 63,255
M2 176,12,64,176
R 104,17,22528
v_add_f32_e64 v60,v60,v62
M2 180,12,68,180
L 23,16,42
v_add_f32_e64 v61,v61,v63
M2 184,12,72,184
T 44,16,24576
U 60,0.00043402777777777775,60
M2 188,12,76,188
R 108,17,23552
U 61,0.00043402777777777775,61
M2 192,16,48,192
F 61,-v60,60,61
v_max_f32_e64 v61,0,v61
M2 196,16,52,196
T 46,16,26112
C 61,61,61
M2 200,16,56,200
L1 24,16,42,1024
N 61,0xffff0000,61
M2 204,16,60,204
A1 61,0x3727c5ac,61
C 61,61,61
M2 208,16,64,208
L1 25,16,42,2048
N 61,0xffff0000,61
M2 212,16,68,212
v_sqrt_f32_e64 v61,v61
M2 216,16,72,216
C 61,61,61
N 61,0xffff0000,61
M2 220,16,76,220
v_rcp_f32_e64 v62,v61
M2 224,20,48,224
C 60,60,60
N 60,0xffff0000,60
M2 228,20,52,228
s_add_u32 s42,s42,294912
s_cmp_eq_u32 s42,s7
s_cselect_b32 s42,s6,s42
M2 232,20,56,232
U1 63,60,62
B 63,0,63
M2 236,20,60,236
v_lshrrev_b32_e64 v60,2,v12
M2 240,20,64,240
ds_write_b32 v60,v62 offset:61440
ds_write_b32 v60,v63 offset:62464
M2 244,20,68,244
M2 248,20,72,248
s_waitcnt vmcnt(17) lgkmcnt(0)
M2 252,20,76,252
s_barrier
M2 64,24,80,64
s_add_u32 m0,s43,114688
T 0,3,36864
R1 32,13,61440
M2 68,24,84,68
R 48,17,32768
R1 36,13,61456
M2 72,24,88,72
T 2,3,38400
M2 76,24,92,76
L6 22,20,41
R 52,17,33792
M2 80,24,96,80
M2 84,24,100,84
T 4,4,36864
R1 40,13,62464
M2 88,24,104,88
M2 92,24,108,92
L7 22,20,41,1024
T 6,4,38400
M2 96,28,80,96
R 56,17,34816
M2 100,28,84,100
R1 44,13,62480
M2 104,28,88,104
T 8,5,36864
M2 108,28,92,108
L7 22,20,41,2048
M2 112,28,96,112
R 60,17,35840
buffer_load_ushort a208,v30,s[52:55],s37 offen offset:0
M2 116,28,100,116
T 10,5,38400
M2 120,28,104,120
M2 124,28,108,124
L7 22,20,41,3072
T 12,14,36864
M2 128,32,80,128
buffer_load_ushort a209,v30,s[52:55],s37 offen offset:32
M2 132,32,84,132
R 64,17,36864
M2 136,32,88,136
T 14,14,38400
M2 140,32,92,140
s_add_u32 s41,s41,131072
s_cmp_eq_u32 s41,s5
s_cselect_b32 s41,s4,s41
M2 144,32,96,144
R 68,17,37888
buffer_load_ushort a210,v30,s[52:55],s37 offen offset:64
M2 148,32,100,148
M2 152,32,104,152
T 16,15,36864
M2 156,32,108,156
s_add_u32 m0,s11,24576
T 18,15,38400
buffer_load_ushort a211,v30,s[52:55],s37 offen offset:96
M2 160,36,80,160
M2 164,36,84,164
R 72,17,38912
M2 168,36,88,168
M2 172,36,92,172
L 23,16,42
T 20,16,36864
M2 176,36,96,176
buffer_load_ushort a212,v30,s[52:55],s37 offen offset:128
R 76,17,39936
M2 180,36,100,180
M2 184,36,104,184
T 22,16,38400
M2 188,36,108,188
L1 24,16,42,1024
buffer_load_ushort a213,v30,s[52:55],s37 offen offset:160
M2 192,40,80,192
M2 196,40,84,196
M2 200,40,88,200
buffer_load_ushort a214,v30,s[52:55],s37 offen offset:192
M2 204,40,92,204
L1 25,16,42,2048
M2 208,40,96,208
M2 212,40,100,212
M2 216,40,104,216
buffer_load_ushort a215,v30,s[52:55],s37 offen offset:224
M2 220,40,108,220
s_add_u32 s42,s42,294912
s_cmp_eq_u32 s42,s7
s_cselect_b32 s42,s6,s42
M2 224,44,80,224
M2 228,44,84,228
M2 232,44,88,232
M2 236,44,92,236
M2 240,44,96,240
M2 244,44,100,244
M2 248,44,104,248
s_waitcnt vmcnt(25) lgkmcnt(0)
M2 252,44,108,252
s_barrier
M2 64,0,48,64
s_add_u32 m0,s43,131072
T 24,3,49152
AR 56,112
v_lshlrev_b32_e64 v57,16,v56
M2 68,0,52,68
R 80,17,49152
v_and_b32_e64 v56,s63,v56
M2 72,0,56,72
F1 57,57,32,40
F1 56,56,33,41
M2 76,0,60,76
T 26,3,50688
C 48,57,56
M2 80,0,64,80
L6 22,20,41
AR 58,113
M2 84,0,68,84
SL 59,16,58
N1 58,63,58
M2 88,0,72,88
R 84,17,50176
F1 59,59,34,42
M2 92,0,76,92
F1 58,58,35,43
C 49,59,58
M2 96,4,48,96
T 28,4,49152
AR 56,114
v_lshlrev_b32_e64 v57,16,v56
M2 100,4,52,100
L7 22,20,41,1024
v_and_b32_e64 v56,s63,v56
M2 104,4,56,104
T 30,4,50688
F1 57,57,36,44
M2 108,4,60,108
F1 56,56,37,45
C 50,57,56
M2 112,4,64,112
R 88,17,51200
AR 58,115
M2 116,4,68,116
T 32,5,49152
v_lshlrev_b32_e64 v59,16,v58
M2 120,4,72,120
L7 22,20,41,2048
v_and_b32_e64 v58,s63,v58
M2 124,4,76,124
F1 59,59,38,46
F1 58,58,39,47
M2 128,8,48,128
R 92,17,52224
T 34,5,50688
C 51,59,58
M2 132,8,52,132
s_add_u32 s62,s61,0
S1 48,27,44,62,0
AR 56,116
M2 136,8,56,136
L7 22,20,41,3072
SL 57,16,56
M2 140,8,60,140
T 36,14,49152
v_and_b32_e64 v56,s63,v56
M2 144,8,64,144
F1 57,57,32,40
F1 56,56,33,41
M2 148,8,68,148
R 96,17,53248
C 52,57,56
M2 152,8,72,152
AR 58,117
v_lshlrev_b32_e64 v59,16,v58
M2 156,8,76,156
T 38,14,50688
v_and_b32_e64 v58,s63,v58
M2 160,12,48,160
s_add_u32 s41,s41,131072
s_cmp_eq_u32 s41,s5
s_cselect_b32 s41,s4,s41
F1 59,59,34,42
M2 164,12,52,164
s_add_u32 m0,s11,36864
R 100,17,54272
F1 58,58,35,43
C 53,59,58
M2 168,12,56,168
T 40,15,49152
AR 56,118
v_lshlrev_b32_e64 v57,16,v56
M2 172,12,60,172
v_and_b32_e64 v56,s63,v56
F1 57,57,36,44
F1 56,56,37,45
M2 176,12,64,176
T 42,15,50688
C 54,57,56
AR 58,119
M2 180,12,68,180
R 104,17,55296
v_lshlrev_b32_e64 v59,16,v58
M2 184,12,72,184
v_and_b32_e64 v58,s63,v58
F1 59,59,38,46
M2 188,12,76,188
L 23,16,42
F1 58,58,39,47
M2 192,16,48,192
T 44,16,49152
C 55,59,58
M2 196,16,52,196
S1 52,27,44,62,1024
AR 56,120
M2 200,16,56,200
R 108,17,56320
v_lshlrev_b32_e64 v57,16,v56
M2 204,16,60,204
v_and_b32_e64 v56,s63,v56
F1 57,57,32,40
M2 208,16,64,208
T 46,16,50688
F1 56,56,33,41
M2 212,16,68,212
L1 24,16,42,1024
C 48,57,56
M2 216,16,72,216
AR 58,121
v_lshlrev_b32_e64 v59,16,v58
M2 220,16,76,220
v_and_b32_e64 v58,s63,v58
F1 59,59,34,42
M2 224,20,48,224
F1 58,58,35,43
C 49,59,58
M2 228,20,52,228
L1 25,16,42,2048
AR 56,122
M2 232,20,56,232
SL 57,16,56
N1 56,63,56
M2 236,20,60,236
F1 57,57,36,44
F1 56,56,37,45
M2 240,20,64,240
C 50,57,56
AR 58,123
M2 244,20,68,244
s_add_u32 s42,s42,294912
s_cmp_eq_u32 s42,s7
s_cselect_b32 s42,s6,s42
M2 248,20,72,248
SL 59,16,58
N1 58,63,58
F1 59,59,38,46
M2 252,20,76,252
F1 58,58,39,47
C 51,59,58
S1 48,27,44,62,2048
s_waitcnt vmcnt(28) lgkmcnt(0)
s_barrier
M2 64,24,80,64
s_add_u32 m0,s43,147456
T 0,3,0
AR 56,124
v_lshlrev_b32_e64 v57,16,v56
M2 68,24,84,68
R 48,17,0
v_and_b32_e64 v56,s63,v56
M2 72,24,88,72
F1 57,57,32,40
F1 56,56,33,41
M2 76,24,92,76
T 2,3,1536
C 52,57,56
M2 80,24,96,80
L6 22,20,41
AR 58,125
v_lshlrev_b32_e64 v59,16,v58
M2 84,24,100,84
R 52,17,1024
v_and_b32_e64 v58,s63,v58
M2 88,24,104,88
F1 59,59,34,42
F1 58,58,35,43
M2 92,24,108,92
T 4,4,0
C 53,59,58
M2 96,28,80,96
AR 56,126
v_lshlrev_b32_e64 v57,16,v56
M2 100,28,84,100
L7 22,20,41,1024
T 6,4,1536
v_and_b32_e64 v56,s63,v56
M2 104,28,88,104
F1 57,57,36,44
F1 56,56,37,45
M2 108,28,92,108
R 56,17,2048
C 54,57,56
M2 112,28,96,112
AR 58,127
v_lshlrev_b32_e64 v59,16,v58
M2 116,28,100,116
T 8,5,0
v_and_b32_e64 v58,s63,v58
M2 120,28,104,120
L7 22,20,41,2048
F1 59,59,38,46
F1 58,58,39,47
M2 124,28,108,124
R 60,17,3072
C 55,59,58
M2 128,32,80,128
S1 52,27,44,62,3072
AR 56,128
M2 132,32,84,132
T 10,5,1536
v_lshlrev_b32_e64 v57,16,v56
M2 136,32,88,136
v_and_b32_e64 v56,s63,v56
F1 57,57,32,40
M2 140,32,92,140
L7 22,20,41,3072
T 12,14,0
F1 56,56,33,41
M2 144,32,96,144
C 48,57,56
AR 58,129
M2 148,32,100,148
R 64,17,4096
v_lshlrev_b32_e64 v59,16,v58
M2 152,32,104,152
v_and_b32_e64 v58,s63,v58
F1 59,59,34,42
M2 156,32,108,156
T 14,14,1536
F1 58,58,35,43
M2 160,36,80,160
s_add_u32 s41,s41,131072
s_cmp_eq_u32 s41,s5
s_cselect_b32 s41,s4,s41
C 49,59,58
M2 164,36,84,164
s_add_u32 m0,s11,49152
R 68,17,5120
AR 56,130
v_lshlrev_b32_e64 v57,16,v56
M2 168,36,88,168
v_and_b32_e64 v56,s63,v56
F1 57,57,36,44
F1 56,56,37,45
M2 172,36,92,172
T 16,15,0
C 50,57,56
AR 58,131
M2 176,36,96,176
T 18,15,1536
SL 59,16,58
N1 58,63,58
M2 180,36,100,180
R 72,17,6144
F1 59,59,38,46
F1 58,58,39,47
M2 184,36,104,184
L 23,16,42
T 20,16,0
C 51,59,58
M2 188,36,108,188
s_add_u32 s62,s61,4096
S1 48,27,44,62,0
AR 56,132
M2 192,40,80,192
SL 57,16,56
N1 56,63,56
M2 196,40,84,196
R 76,17,7168
F1 57,57,32,40
M2 200,40,88,200
F1 56,56,33,41
C 52,57,56
M2 204,40,92,204
T 22,16,1536
AR 58,133
M2 208,40,96,208
L1 24,16,42,1024
v_lshlrev_b32_e64 v59,16,v58
M2 212,40,100,212
v_and_b32_e64 v58,s63,v58
F1 59,59,34,42
M2 216,40,104,216
F1 58,58,35,43
C 53,59,58
M2 220,40,108,220
AR 56,134
v_lshlrev_b32_e64 v57,16,v56
M2 224,44,80,224
L1 25,16,42,2048
v_and_b32_e64 v56,s63,v56
M2 228,44,84,228
F1 57,57,36,44
F1 56,56,37,45
M2 232,44,88,232
C 54,57,56
AR 58,135
M2 236,44,92,236
SL 59,16,58
N1 58,63,58
M2 240,44,96,240
F1 59,59,38,46
F1 58,58,39,47
M2 244,44,100,244
s_add_u32 s42,s42,294912
s_cmp_eq_u32 s42,s7
s_cselect_b32 s42,s6,s42
M2 248,44,104,248
C 55,59,58
M2 252,44,108,252
S1 52,27,44,62,1024
R1 32,13,61568
R1 36,13,61584
R1 40,13,62592
R1 44,13,62608
s_waitcnt vmcnt(30) lgkmcnt(0)
s_barrier
M2 64,0,48,64
s_add_u32 m0,s43,98304
T 24,3,12288
AR 56,136
v_lshlrev_b32_e64 v57,16,v56
M2 68,0,52,68
R 80,17,16384
v_and_b32_e64 v56,s63,v56
M2 72,0,56,72
F1 57,57,32,40
F1 56,56,33,41
M2 76,0,60,76
T 26,3,13824
C 48,57,56
M2 80,0,64,80
L6 22,20,41
AR 58,137
M2 84,0,68,84
SL 59,16,58
N1 58,63,58
M2 88,0,72,88
R 84,17,17408
F1 59,59,34,42
M2 92,0,76,92
F1 58,58,35,43
C 49,59,58
M2 96,4,48,96
T 28,4,12288
AR 56,138
v_lshlrev_b32_e64 v57,16,v56
M2 100,4,52,100
L7 22,20,41,1024
v_and_b32_e64 v56,s63,v56
M2 104,4,56,104
T 30,4,13824
F1 57,57,36,44
M2 108,4,60,108
F1 56,56,37,45
C 50,57,56
M2 112,4,64,112
R 88,17,18432
AR 58,139
M2 116,4,68,116
T 32,5,12288
v_lshlrev_b32_e64 v59,16,v58
M2 120,4,72,120
L7 22,20,41,2048
v_and_b32_e64 v58,s63,v58
M2 124,4,76,124
F1 59,59,38,46
F1 58,58,39,47
M2 128,8,48,128
R 92,17,19456
T 34,5,13824
C 51,59,58
M2 132,8,52,132
s_add_u32 s62,s61,262144
S1 48,27,44,62,0
AR 56,140
M2 136,8,56,136
L7 22,20,41,3072
v_lshlrev_b32_e64 v57,16,v56
M2 140,8,60,140
T 36,14,12288
v_and_b32_e64 v56,s63,v56
M2 144,8,64,144
F1 57,57,32,40
F1 56,56,33,41
M2 148,8,68,148
R 96,17,20480
C 52,57,56
M2 152,8,72,152
AR 58,141
v_lshlrev_b32_e64 v59,16,v58
M2 156,8,76,156
T 38,14,13824
v_and_b32_e64 v58,s63,v58
M2 160,12,48,160
s_add_u32 s41,s41,131072
s_cmp_eq_u32 s41,s5
s_cselect_b32 s41,s4,s41
F1 59,59,34,42
M2 164,12,52,164
s_add_u32 m0,s11,0
R 100,17,21504
F1 58,58,35,43
C 53,59,58
M2 168,12,56,168
T 40,15,12288
AR 56,142
SL 57,16,56
M2 172,12,60,172
v_and_b32_e64 v56,s63,v56
F1 57,57,36,44
F1 56,56,37,45
M2 176,12,64,176
T 42,15,13824
C 54,57,56
AR 58,143
M2 180,12,68,180
R 104,17,22528
v_lshlrev_b32_e64 v59,16,v58
M2 184,12,72,184
v_and_b32_e64 v58,s63,v58
F1 59,59,38,46
M2 188,12,76,188
L 23,16,42
F1 58,58,39,47
M2 192,16,48,192
T 44,16,12288
C 55,59,58
M2 196,16,52,196
S1 52,27,44,62,1024
AR 56,144
M2 200,16,56,200
R 108,17,23552
v_lshlrev_b32_e64 v57,16,v56
M2 204,16,60,204
v_and_b32_e64 v56,s63,v56
F1 57,57,32,40
M2 208,16,64,208
T 46,16,13824
F1 56,56,33,41
M2 212,16,68,212
L1 24,16,42,1024
C 48,57,56
M2 216,16,72,216
AR 58,145
v_lshlrev_b32_e64 v59,16,v58
M2 220,16,76,220
v_and_b32_e64 v58,s63,v58
F1 59,59,34,42
M2 224,20,48,224
F1 58,58,35,43
C 49,59,58
M2 228,20,52,228
L1 25,16,42,2048
AR 56,146
M2 232,20,56,232
SL 57,16,56
N1 56,63,56
M2 236,20,60,236
F1 57,57,36,44
F1 56,56,37,45
M2 240,20,64,240
C 50,57,56
AR 58,147
M2 244,20,68,244
s_add_u32 s42,s42,294912
s_cmp_eq_u32 s42,s7
s_cselect_b32 s42,s6,s42
M2 248,20,72,248
SL 59,16,58
N1 58,63,58
F1 59,59,38,46
M2 252,20,76,252
F1 58,58,39,47
C 51,59,58
S1 48,27,44,62,2048
s_waitcnt vmcnt(25) lgkmcnt(0)
s_barrier
M2 64,24,80,64
s_add_u32 m0,s43,114688
T 0,3,24576
AR 56,148
v_lshlrev_b32_e64 v57,16,v56
M2 68,24,84,68
R 48,17,32768
v_and_b32_e64 v56,s63,v56
M2 72,24,88,72
F1 57,57,32,40
F1 56,56,33,41
M2 76,24,92,76
T 2,3,26112
C 52,57,56
M2 80,24,96,80
AR 58,149
v_lshlrev_b32_e64 v59,16,v58
M2 84,24,100,84
R 52,17,33792
v_and_b32_e64 v58,s63,v58
M2 88,24,104,88
F1 59,59,34,42
F1 58,58,35,43
C 53,59,58
M2 92,24,108,92
T 4,4,24576
AR 56,150
M2 96,28,80,96
L6 22,20,41
v_lshlrev_b32_e64 v57,16,v56
M2 100,28,84,100
T 6,4,26112
v_and_b32_e64 v56,s63,v56
M2 104,28,88,104
F1 57,57,36,44
F1 56,56,37,45
M2 108,28,92,108
R 56,17,34816
C 54,57,56
M2 112,28,96,112
AR 58,151
v_lshlrev_b32_e64 v59,16,v58
M2 116,28,100,116
T 8,5,24576
v_and_b32_e64 v58,s63,v58
F1 59,59,38,46
M2 120,28,104,120
F1 58,58,39,47
C 55,59,58
M2 124,28,108,124
R 60,17,35840
S1 52,27,44,62,3072
M2 128,32,80,128
AR 56,152
v_lshlrev_b32_e64 v57,16,v56
M2 132,32,84,132
L7 22,20,41,1024
T 10,5,26112
M2 136,32,88,136
v_and_b32_e64 v56,s63,v56
F1 57,57,32,40
M2 140,32,92,140
T 12,14,24576
F1 56,56,33,41
M2 144,32,96,144
C 48,57,56
AR 58,153
v_lshlrev_b32_e64 v59,16,v58
M2 148,32,100,148
R 64,17,36864
v_and_b32_e64 v58,s63,v58
M2 152,32,104,152
F1 59,59,34,42
F1 58,58,35,43
M2 156,32,108,156
T 14,14,26112
C 49,59,58
M2 160,36,80,160
AR 56,154
v_lshlrev_b32_e64 v57,16,v56
M2 164,36,84,164
R 68,17,37888
v_and_b32_e64 v56,s63,v56
M2 168,36,88,168
L7 22,20,41,2048
F1 57,57,36,44
M2 172,36,92,172
T 16,15,24576
F1 56,56,37,45
C 50,57,56
M2 176,36,96,176
AR 58,155
v_lshlrev_b32_e64 v59,16,v58
M2 180,36,100,180
T 18,15,26112
v_and_b32_e64 v58,s63,v58
M2 184,36,104,184
F1 59,59,38,46
F1 58,58,39,47
M2 188,36,108,188
R 72,17,38912
C 51,59,58
M2 192,40,80,192
s_add_u32 s62,s61,266240
S1 48,27,44,62,0
T 20,16,24576
M2 196,40,84,196
AR 56,156
v_lshlrev_b32_e64 v57,16,v56
M2 200,40,88,200
L7 22,20,41,3072
R 76,17,39936
v_and_b32_e64 v56,s63,v56
M2 204,40,92,204
F1 57,57,32,40
F1 56,56,33,41
M2 208,40,96,208
T 22,16,26112
C 52,57,56
M2 212,40,100,212
AR 58,157
v_lshlrev_b32_e64 v59,16,v58
M2 216,40,104,216
v_and_b32_e64 v58,s63,v58
F1 59,59,34,42
M2 220,40,108,220
F1 58,58,35,43
C 53,59,58
M2 224,44,80,224
AR 56,158
v_lshlrev_b32_e64 v57,16,v56
M2 228,44,84,228
v_and_b32_e64 v56,s63,v56
F1 57,57,36,44
F1 56,56,37,45
M2 232,44,88,232
s_add_u32 s41,s41,131072
s_cmp_eq_u32 s41,s5
s_cselect_b32 s41,s4,s41
M2 236,44,92,236
C 54,57,56
AR 58,159
v_lshlrev_b32_e64 v59,16,v58
M2 240,44,96,240
v_and_b32_e64 v58,s63,v58
F1 59,59,38,46
F1 58,58,39,47
M2 244,44,100,244
C 55,59,58
M2 248,44,104,248
S1 52,27,44,62,1024
R1 32,13,61696
R1 36,13,61712
M2 252,44,108,252
R1 40,13,62720
R1 44,13,62736
s_waitcnt vmcnt(22) lgkmcnt(0)
s_barrier
M2 64,0,48,64
T 24,3,36864
AR 56,160
M2 68,0,52,68
SL 57,16,56
N1 56,63,56
M2 72,0,56,72
R 80,17,49152
F1 57,57,32,40
M2 76,0,60,76
F1 56,56,33,41
C 48,57,56
M2 80,0,64,80
T 26,3,38400
AR 58,161
M2 84,0,68,84
SL 59,16,58
N1 58,63,58
M2 88,0,72,88
R 84,17,50176
F1 59,59,34,42
M2 92,0,76,92
F1 58,58,35,43
C 49,59,58
M2 96,4,48,96
T 28,4,36864
AR 56,162
M2 100,4,52,100
SL 57,16,56
N1 56,63,56
M2 104,4,56,104
T 30,4,38400
F1 57,57,36,44
M2 108,4,60,108
F1 56,56,37,45
C 50,57,56
M2 112,4,64,112
R 88,17,51200
AR 58,163
M2 116,4,68,116
T 32,5,36864
v_lshlrev_b32_e64 v59,16,v58
M2 120,4,72,120
v_and_b32_e64 v58,s63,v58
F1 59,59,38,46
M2 124,4,76,124
R 92,17,52224
F1 58,58,39,47
M2 128,8,48,128
T 34,5,38400
C 51,59,58
M2 132,8,52,132
s_add_u32 s62,s61,524288
S1 48,27,44,62,0
AR 56,164
M2 136,8,56,136
SL 57,16,56
N1 56,63,56
M2 140,8,60,140
T 36,14,36864
F1 57,57,32,40
M2 144,8,64,144
F1 56,56,33,41
C 52,57,56
M2 148,8,68,148
R 96,17,53248
AR 58,165
M2 152,8,72,152
SL 59,16,58
N1 58,63,58
M2 156,8,76,156
T 38,14,38400
F1 59,59,34,42
M2 160,12,48,160
F1 58,58,35,43
C 53,59,58
M2 164,12,52,164
R 100,17,54272
AR 56,166
M2 168,12,56,168
T 40,15,36864
v_lshlrev_b32_e64 v57,16,v56
M2 172,12,60,172
v_and_b32_e64 v56,s63,v56
F1 57,57,36,44
M2 176,12,64,176
T 42,15,38400
F1 56,56,37,45
M2 180,12,68,180
C 54,57,56
AR 58,167
M2 184,12,72,184
R 104,17,55296
v_lshlrev_b32_e64 v59,16,v58
M2 188,12,76,188
v_and_b32_e64 v58,s63,v58
F1 59,59,38,46
M2 192,16,48,192
T 44,16,36864
F1 58,58,39,47
M2 196,16,52,196
R 108,17,56320
C 55,59,58
M2 200,16,56,200
S1 52,27,44,62,1024
AR 56,168
M2 204,16,60,204
SL 57,16,56
N1 56,63,56
M2 208,16,64,208
T 46,16,38400
F1 57,57,32,40
M2 212,16,68,212
F1 56,56,33,41
C 48,57,56
M2 216,16,72,216
AR 58,169
v_lshlrev_b32_e64 v59,16,v58
M2 220,16,76,220
v_and_b32_e64 v58,s63,v58
F1 59,59,34,42
M2 224,20,48,224
F1 58,58,35,43
C 49,59,58
M2 228,20,52,228
AR 56,170
v_lshlrev_b32_e64 v57,16,v56
M2 232,20,56,232
v_and_b32_e64 v56,s63,v56
F1 57,57,36,44
M2 236,20,60,236
F1 56,56,37,45
C 50,57,56
M2 240,20,64,240
AR 58,171
v_lshlrev_b32_e64 v59,16,v58
M2 244,20,68,244
v_and_b32_e64 v58,s63,v58
F1 59,59,38,46
M2 248,20,72,248
F1 58,58,39,47
C 51,59,58
M2 252,20,76,252
S1 48,27,44,62,2048
s_waitcnt vmcnt(15) lgkmcnt(0)
s_barrier
M2 64,24,80,64
s_add_u32 m0,s14,65536
T 0,3,49152
AR 56,172
v_lshlrev_b32_e64 v57,16,v56
M2 68,24,84,68
R 48,17,0
v_and_b32_e64 v56,s63,v56
M2 72,24,88,72
F1 57,57,32,40
F1 56,56,33,41
M2 76,24,92,76
T 2,3,50688
C 52,57,56
M2 80,24,96,80
L 18,48,12
AR 58,173
v_lshlrev_b32_e64 v59,16,v58
M2 84,24,100,84
R 52,17,1024
v_and_b32_e64 v58,s63,v58
M2 88,24,104,88
F1 59,59,34,42
F1 58,58,35,43
M2 92,24,108,92
T 4,4,49152
C 53,59,58
M2 96,28,80,96
L1 19,48,12,1024
AR 56,174
v_lshlrev_b32_e64 v57,16,v56
M2 100,28,84,100
T 6,4,50688
v_and_b32_e64 v56,s63,v56
M2 104,28,88,104
F1 57,57,36,44
F1 56,56,37,45
M2 108,28,92,108
R 56,17,2048
C 54,57,56
M2 112,28,96,112
AR 58,175
v_lshlrev_b32_e64 v59,16,v58
M2 116,28,100,116
L1 20,48,12,2048
T 8,5,49152
v_and_b32_e64 v58,s63,v58
M2 120,28,104,120
F1 59,59,38,46
F1 58,58,39,47
M2 124,28,108,124
R 60,17,3072
C 55,59,58
M2 128,32,80,128
S1 52,27,44,62,3072
AR 56,176
M2 132,32,84,132
L1 21,48,12,3072
T 10,5,50688
v_lshlrev_b32_e64 v57,16,v56
M2 136,32,88,136
s_add_u32 s12,s12,128
v_and_b32_e64 v56,s63,v56
F1 57,57,32,40
M2 140,32,92,140
T 12,14,49152
F1 56,56,33,41
M2 144,32,96,144
C 48,57,56
AR 58,177
M2 148,32,100,148
s_add_u32 m0,s14,69632
R 64,17,4096
SL 59,16,58
N1 58,63,58
M2 152,32,104,152
F1 59,59,34,42
F1 58,58,35,43
M2 156,32,108,156
T 14,14,50688
C 49,59,58
M2 160,36,80,160
AR 56,178
v_lshlrev_b32_e64 v57,16,v56
M2 164,36,84,164
R 68,17,5120
v_and_b32_e64 v56,s63,v56
M2 168,36,88,168
T 16,15,49152
F1 57,57,36,44
F1 56,56,37,45
M2 172,36,92,172
C 50,57,56
AR 58,179
M2 176,36,96,176
T 18,15,50688
v_lshlrev_b32_e64 v59,16,v58
M2 180,36,100,180
v_and_b32_e64 v58,s63,v58
F1 59,59,38,46
M2 184,36,104,184
L 18,48,13
R 72,17,6144
F1 58,58,39,47
M2 188,36,108,188
T 20,16,49152
C 51,59,58
M2 192,40,80,192
s_add_u32 s62,s61,528384
S1 48,27,44,62,0
AR 56,180
M2 196,40,84,196
SL 57,16,56
N1 56,63,56
M2 200,40,88,200
L1 19,48,13,1024
R 76,17,7168
F1 57,57,32,40
M2 204,40,92,204
F1 56,56,33,41
C 52,57,56
M2 208,40,96,208
T 22,16,50688
AR 58,181
M2 212,40,100,212
SL 59,16,58
N1 58,63,58
M2 216,40,104,216
L1 20,48,13,2048
F1 59,59,34,42
M2 220,40,108,220
F1 58,58,35,43
C 53,59,58
AR 56,182
M2 224,44,80,224
SL 57,16,56
N1 56,63,56
M2 228,44,84,228
L1 21,48,13,3072
F1 57,57,36,44
M2 232,44,88,232
s_add_u32 s13,s12,131072
F1 56,56,37,45
C 54,57,56
M2 236,44,92,236
AR 58,183
SL 59,16,58
N1 58,63,58
M2 240,44,96,240
F1 59,59,38,46
F1 58,58,39,47
M2 244,44,100,244
C 55,59,58
M2 248,44,104,248
S1 52,27,44,62,1024
R1 32,13,61824
R1 36,13,61840
M2 252,44,108,252
R1 40,13,62848
R1 44,13,62864
s_waitcnt vmcnt(15) lgkmcnt(0)
s_barrier
M2 64,0,48,64
T 24,3,0
AR 56,184
M2 68,0,52,68
SL 57,16,56
N1 56,63,56
M2 72,0,56,72
R 80,17,16384
F1 57,57,32,40
M2 76,0,60,76
F1 56,56,33,41
C 48,57,56
M2 80,0,64,80
T 26,3,1536
AR 58,185
M2 84,0,68,84
SL 59,16,58
N1 58,63,58
M2 88,0,72,88
R 84,17,17408
F1 59,59,34,42
M2 92,0,76,92
F1 58,58,35,43
C 49,59,58
M2 96,4,48,96
T 28,4,0
AR 56,186
M2 100,4,52,100
SL 57,16,56
N1 56,63,56
M2 104,4,56,104
T 30,4,1536
F1 57,57,36,44
M2 108,4,60,108
F1 56,56,37,45
C 50,57,56
M2 112,4,64,112
R 88,17,18432
AR 58,187
M2 116,4,68,116
T 32,5,0
v_lshlrev_b32_e64 v59,16,v58
M2 120,4,72,120
v_and_b32_e64 v58,s63,v58
F1 59,59,38,46
M2 124,4,76,124
R 92,17,19456
F1 58,58,39,47
M2 128,8,48,128
T 34,5,1536
C 51,59,58
M2 132,8,52,132
s_add_u32 s62,s61,786432
S1 48,27,44,62,0
AR 56,188
M2 136,8,56,136
SL 57,16,56
N1 56,63,56
M2 140,8,60,140
T 36,14,0
F1 57,57,32,40
M2 144,8,64,144
F1 56,56,33,41
C 52,57,56
M2 148,8,68,148
R 96,17,20480
AR 58,189
M2 152,8,72,152
SL 59,16,58
N1 58,63,58
M2 156,8,76,156
T 38,14,1536
F1 59,59,34,42
M2 160,12,48,160
F1 58,58,35,43
C 53,59,58
M2 164,12,52,164
R 100,17,21504
AR 56,190
M2 168,12,56,168
T 40,15,0
v_lshlrev_b32_e64 v57,16,v56
M2 172,12,60,172
v_and_b32_e64 v56,s63,v56
F1 57,57,36,44
M2 176,12,64,176
T 42,15,1536
F1 56,56,37,45
M2 180,12,68,180
C 54,57,56
AR 58,191
M2 184,12,72,184
R 104,17,22528
v_lshlrev_b32_e64 v59,16,v58
M2 188,12,76,188
v_and_b32_e64 v58,s63,v58
F1 59,59,38,46
M2 192,16,48,192
T 44,16,0
F1 58,58,39,47
M2 196,16,52,196
R 108,17,23552
C 55,59,58
M2 200,16,56,200
S1 52,27,44,62,1024
AR 56,192
M2 204,16,60,204
SL 57,16,56
N1 56,63,56
M2 208,16,64,208
T 46,16,1536
F1 57,57,32,40
M2 212,16,68,212
F1 56,56,33,41
C 48,57,56
M2 216,16,72,216
AR 58,193
v_lshlrev_b32_e64 v59,16,v58
M2 220,16,76,220
v_and_b32_e64 v58,s63,v58
F1 59,59,34,42
M2 224,20,48,224
F1 58,58,35,43
C 49,59,58
M2 228,20,52,228
AR 56,194
v_lshlrev_b32_e64 v57,16,v56
M2 232,20,56,232
v_and_b32_e64 v56,s63,v56
F1 57,57,36,44
M2 236,20,60,236
F1 56,56,37,45
C 50,57,56
M2 240,20,64,240
AR 58,195
v_lshlrev_b32_e64 v59,16,v58
M2 244,20,68,244
v_and_b32_e64 v58,s63,v58
F1 59,59,38,46
M2 248,20,72,248
F1 58,58,39,47
C 51,59,58
M2 252,20,76,252
S1 48,27,44,62,2048
s_waitcnt vmcnt(3) lgkmcnt(0)
s_barrier
M2 64,24,80,64
s_add_u32 m0,s11,0
AR 56,196
SL 57,16,56
M2 68,24,84,68
v_and_b32_e64 v56,s63,v56
F1 57,57,32,40
M2 72,24,88,72
L6 2,44,15
F1 56,56,33,41
M2 76,24,92,76
C 52,57,56
AR 58,197
M2 80,24,96,80
L7 2,44,15,1024
v_lshlrev_b32_e64 v59,16,v58
M2 84,24,100,84
v_and_b32_e64 v58,s63,v58
F1 59,59,34,42
M2 88,24,104,88
L7 2,44,15,2048
F1 58,58,35,43
M2 92,24,108,92
s_add_u32 s15,s15,262144
C 53,59,58
AR 56,198
M2 96,28,80,96
s_add_u32 m0,s11,12288
SL 57,16,56
N1 56,63,56
M2 100,28,84,100
F1 57,57,36,44
F1 56,56,37,45
M2 104,28,88,104
C 54,57,56
AR 58,199
M2 108,28,92,108
L6 2,44,15
v_lshlrev_b32_e64 v59,16,v58
M2 112,28,96,112
v_and_b32_e64 v58,s63,v58
F1 59,59,38,46
M2 116,28,100,116
L7 2,44,15,1024
F1 58,58,39,47
M2 120,28,104,120
L7 2,44,15,2048
C 55,59,58
M2 124,28,108,124
s_add_u32 s15,s15,262144
S1 52,27,44,62,3072
AR 56,200
M2 128,32,80,128
s_add_u32 m0,s14,98304
SL 57,16,56
N1 56,63,56
M2 132,32,84,132
F1 57,57,32,40
F1 56,56,33,41
M2 136,32,88,136
C 48,57,56
AR 58,201
M2 140,32,92,140
SL 59,16,58
N1 58,63,58
M2 144,32,96,144
L 18,48,12
F1 59,59,34,42
M2 148,32,100,148
F1 58,58,35,43
C 49,59,58
M2 152,32,104,152
L1 19,48,12,1024
AR 56,202
M2 156,32,108,156
SL 57,16,56
N1 56,63,56
M2 160,36,80,160
L1 20,48,12,2048
F1 57,57,36,44
M2 164,36,84,164
F1 56,56,37,45
C 50,57,56
M2 168,36,88,168
L1 21,48,12,3072
AR 58,203
M2 172,36,92,172
s_add_u32 s12,s12,128
SL 59,16,58
N1 58,63,58
M2 176,36,96,176
s_add_u32 m0,s14,102400
F1 59,59,38,46
F1 58,58,39,47
M2 180,36,100,180
L 18,48,13
C 51,59,58
M2 184,36,104,184
s_add_u32 s62,s61,790528
S1 48,27,44,62,0
AR 56,204
M2 188,36,108,188
SL 57,16,56
N1 56,63,56
M2 192,40,80,192
L1 19,48,13,1024
F1 57,57,32,40
M2 196,40,84,196
F1 56,56,33,41
C 52,57,56
M2 200,40,88,200
L1 20,48,13,2048
AR 58,205
M2 204,40,92,204
SL 59,16,58
N1 58,63,58
M2 208,40,96,208
L1 21,48,13,3072
F1 59,59,34,42
M2 212,40,100,212
s_add_u32 s13,s12,131072
F1 58,58,35,43
C 53,59,58
M2 216,40,104,216
s_add_u32 m0,s11,24576
AR 56,206
v_lshlrev_b32_e64 v57,16,v56
M2 220,40,108,220
v_and_b32_e64 v56,s63,v56
F1 57,57,36,44
M2 224,44,80,224
F1 56,56,37,45
C 54,57,56
M2 228,44,84,228
L6 2,44,15
AR 58,207
M2 232,44,88,232
SL 59,16,58
N1 58,63,58
M2 236,44,92,236
L7 2,44,15,1024
F1 59,59,38,46
M2 240,44,96,240
F1 58,58,39,47
C 55,59,58
M2 244,44,100,244
S1 52,27,44,62,1024
L7 2,44,15,2048
M2 248,44,104,248
s_add_u32 s15,s15,262144
M2 252,44,108,252
s_lshl_b32 s40,s29,8
s_add_u32 s40,s40,6144
AR 35,208
SL 32,16,35
SL 33,16,35
SL 34,16,35
SL 35,16,35
AR 39,209
SL 36,16,39
SL 37,16,39
SL 38,16,39
SL 39,16,39
AR 43,210
SL 40,16,43
SL 41,16,43
SL 42,16,43
SL 43,16,43
AR 47,211
SL 44,16,47
SL 45,16,47
SL 46,16,47
SL 47,16,47
AR 51,212
SL 48,16,51
SL 49,16,51
SL 50,16,51
SL 51,16,51
AR 55,213
SL 52,16,55
SL 53,16,55
SL 54,16,55
SL 55,16,55
AR 59,214
SL 56,16,59
SL 57,16,59
SL 58,16,59
SL 59,16,59
AR 63,215
SL 60,16,63
SL 61,16,63
SL 62,16,63
v_lshlrev_b32_e64 v63,16,v63
C 64,64,65
C 66,66,67
AW 112,64
AW 113,66
C 68,68,69
C 70,70,71
AW 114,68
AW 115,70
C 72,72,73
C 74,74,75
AW 116,72
AW 117,74
C 76,76,77
C 78,78,79
AW 118,76
AW 119,78
C 80,80,81
C 82,82,83
AW 120,80
AW 121,82
C 84,84,85
C 86,86,87
AW 122,84
AW 123,86
C 88,88,89
C 90,90,91
AW 124,88
AW 125,90
C 92,92,93
C 94,94,95
AW 126,92
AW 127,94
C 96,96,97
C 98,98,99
AW 128,96
AW 129,98
C 100,100,101
C 102,102,103
AW 130,100
AW 131,102
C 104,104,105
C 106,106,107
AW 132,104
AW 133,106
C 108,108,109
C 110,110,111
AW 134,108
AW 135,110
C 112,112,113
C 114,114,115
AW 136,112
AW 137,114
C 116,116,117
C 118,118,119
AW 138,116
AW 139,118
C 120,120,121
C 122,122,123
AW 140,120
AW 141,122
C 124,124,125
C 126,126,127
AW 142,124
AW 143,126
C 128,128,129
C 130,130,131
AW 144,128
AW 145,130
C 132,132,133
C 134,134,135
AW 146,132
AW 147,134
C 136,136,137
C 138,138,139
AW 148,136
AW 149,138
C 140,140,141
C 142,142,143
AW 150,140
AW 151,142
C 144,144,145
C 146,146,147
AW 152,144
AW 153,146
C 148,148,149
C 150,150,151
AW 154,148
AW 155,150
C 152,152,153
C 154,154,155
AW 156,152
AW 157,154
C 156,156,157
C 158,158,159
AW 158,156
AW 159,158
C 160,160,161
C 162,162,163
AW 160,160
AW 161,162
C 164,164,165
C 166,166,167
AW 162,164
AW 163,166
C 168,168,169
C 170,170,171
AW 164,168
AW 165,170
C 172,172,173
C 174,174,175
AW 166,172
AW 167,174
C 176,176,177
C 178,178,179
AW 168,176
AW 169,178
C 180,180,181
C 182,182,183
AW 170,180
AW 171,182
C 184,184,185
C 186,186,187
AW 172,184
AW 173,186
C 188,188,189
C 190,190,191
AW 174,188
AW 175,190
C 192,192,193
C 194,194,195
AW 176,192
AW 177,194
C 196,196,197
C 198,198,199
AW 178,196
AW 179,198
C 200,200,201
C 202,202,203
AW 180,200
AW 181,202
C 204,204,205
C 206,206,207
AW 182,204
AW 183,206
C 208,208,209
C 210,210,211
AW 184,208
AW 185,210
C 212,212,213
C 214,214,215
AW 186,212
AW 187,214
C 216,216,217
C 218,218,219
AW 188,216
AW 189,218
C 220,220,221
C 222,222,223
AW 190,220
AW 191,222
C 224,224,225
C 226,226,227
AW 192,224
AW 193,226
C 228,228,229
C 230,230,231
AW 194,228
AW 195,230
C 232,232,233
C 234,234,235
AW 196,232
AW 197,234
C 236,236,237
C 238,238,239
AW 198,236
AW 199,238
C 240,240,241
C 242,242,243
AW 200,240
AW 201,242
C 244,244,245
C 246,246,247
AW 202,244
AW 203,246
C 248,248,249
C 250,250,251
AW 204,248
AW 205,250
C 252,252,253
C 254,254,255
AW 206,252
AW 207,254
s_mov_b32 s60,-0.1029432395800235
s_mov_b32 s61,0xffff0000
s_waitcnt vmcnt(1)
s_barrier
R 0,7,0
R 48,8,0
R 52,8,2048
R 4,7,1024
R 56,8,4096
R 8,7,2048
R 60,8,6144
R 12,7,3072
R 64,8,8192
R 68,8,10240
R 16,7,4096
R 72,8,12288
R 20,7,5120
R 76,8,14336
buffer_atomic_add v28,v29,s[92:95],s40 offen sc1
s_waitcnt lgkmcnt(0)
s_barrier
M2 64,0,48,32
s_add_u32 m0,s11,36864
R 24,7,12288
M2 68,0,52,36
R 80,9,0
L6 2,44,15
M2 72,0,56,40
M2 76,0,60,44
R 84,9,2048
M2 80,0,64,48
L7 2,44,15,1024
M2 84,0,68,52
M2 88,0,72,56
R 28,7,13312
L7 2,44,15,2048
M2 92,0,76,60
M2 96,4,48,32
R 88,9,4096
M2 100,4,52,36
s_add_u32 s15,s15,262144
M2 104,4,56,40
R 32,7,14336
M2 108,4,60,44
s_add_u32 m0,s14,131072
M2 112,4,64,48
M2 116,4,68,52
R 92,9,6144
M2 120,4,72,56
L 18,48,12
M2 124,4,76,60
R 36,7,15360
M2 128,8,48,32
M2 132,8,52,36
L1 19,48,12,1024
R 96,9,8192
M2 136,8,56,40
M2 140,8,60,44
L1 20,48,12,2048
M2 144,8,64,48
R 100,9,10240
M2 148,8,68,52
M2 152,8,72,56
L1 21,48,12,3072
R 40,7,16384
M2 156,8,76,60
M2 160,12,48,32
s_add_u32 s12,s12,128
R 104,9,12288
M2 164,12,52,36
M2 168,12,56,40
M2 172,12,60,44
s_add_u32 m0,s14,135168
R 44,7,17408
M2 176,12,64,48
M2 180,12,68,52
R 108,9,14336
M2 184,12,72,56
L 18,48,13
M2 188,12,76,60
M2 192,16,48,32
L1 19,48,13,1024
M2 196,16,52,36
M2 200,16,56,40
M2 204,16,60,44
L1 20,48,13,2048
M2 208,16,64,48
M2 212,16,68,52
L1 21,48,13,3072
M2 216,16,72,56
M2 220,16,76,60
M2 224,20,48,32
s_add_u32 s13,s12,131072
M2 228,20,52,36
M2 232,20,56,40
M2 236,20,60,44
M2 240,20,64,48
M2 244,20,68,52
M2 248,20,72,56
s_waitcnt vmcnt(12) lgkmcnt(0)
M2 252,20,76,60
s_barrier
M2 64,24,80,64
s_add_u32 m0,s11,0
R 0,7,24576
M2 68,24,84,68
R 48,8,32768
L6 2,44,15
M2 72,24,88,72
M2 76,24,92,76
R 52,8,34816
L7 2,44,15,1024
M2 80,24,96,80
M2 84,24,100,84
M2 88,24,104,88
R 4,7,25600
L7 2,44,15,2048
M2 92,24,108,92
M2 96,28,80,96
s_add_u32 s15,s15,262144
R 56,8,36864
M2 100,28,84,100
M2 104,28,88,104
R 8,7,26624
M2 108,28,92,108
s_add_u32 m0,s11,12288
M2 112,28,96,112
M2 116,28,100,116
R 60,8,38912
L6 2,44,15
M2 120,28,104,120
M2 124,28,108,124
R 12,7,27648
M2 128,32,80,128
L7 2,44,15,1024
M2 132,32,84,132
R 64,8,40960
M2 136,32,88,136
L7 2,44,15,2048
M2 140,32,92,140
M2 144,32,96,144
R 68,8,43008
M2 148,32,100,148
s_add_u32 s15,s15,262144
M2 152,32,104,152
R 16,7,28672
M2 156,32,108,156
s_add_u32 m0,s14,65536
M2 160,36,80,160
R 72,8,45056
M2 164,36,84,164
L 18,48,12
M2 168,36,88,168
M2 172,36,92,172
R 20,7,29696
M2 176,36,96,176
L1 19,48,12,1024
M2 180,36,100,180
R 76,8,47104
M2 184,36,104,184
L1 20,48,12,2048
M2 188,36,108,188
M2 192,40,80,192
M2 196,40,84,196
L1 21,48,12,3072
M2 200,40,88,200
M2 204,40,92,204
s_and_b32 s12,s12,0xfffff000
s_cmp_eq_u32 s12,s98
s_cselect_b32 s12,s99,s12
M2 208,40,96,208
M2 212,40,100,212
M2 216,40,104,216
s_add_u32 m0,s14,69632
M2 220,40,108,220
M2 224,44,80,224
L 18,48,13
M2 228,44,84,228
M2 232,44,88,232
M2 236,44,92,236
M2 240,44,96,240
M2 244,44,100,244
M2 248,44,104,248
s_waitcnt vmcnt(19) lgkmcnt(0)
M2 252,44,108,252
s_barrier
M2 64,0,48,64
R 24,7,36864
L1 19,48,13,1024
M2 68,0,52,68
R 80,9,32768
M2 72,0,56,72
M2 76,0,60,76
L1 20,48,13,2048
R 84,9,34816
M2 80,0,64,80
M2 84,0,68,84
M2 88,0,72,88
R 28,7,37888
M2 92,0,76,92
L1 21,48,13,3072
M2 96,4,48,96
R 88,9,36864
M2 100,4,52,100
M2 104,4,56,104
R 32,7,38912
M2 108,4,60,108
M2 112,4,64,112
s_add_u32 s13,s12,131072
M2 116,4,68,116
R 92,9,38912
M2 120,4,72,120
M2 124,4,76,124
R 36,7,39936
M2 128,8,48,128
s_add_u32 m0,s11,24576
M2 132,8,52,132
R 96,9,40960
M2 136,8,56,136
M2 140,8,60,140
M2 144,8,64,144
R 100,9,43008
M2 148,8,68,148
L6 2,44,15
M2 152,8,72,152
R 40,7,40960
M2 156,8,76,156
M2 160,12,48,160
R 104,9,45056
M2 164,12,52,164
L7 2,44,15,1024
M2 168,12,56,168
M2 172,12,60,172
R 44,7,41984
M2 176,12,64,176
M2 180,12,68,180
R 108,9,47104
L7 2,44,15,2048
M2 184,12,72,184
M2 188,12,76,188
M2 192,16,48,192
M2 196,16,52,196
M2 200,16,56,200
s_add_u32 s15,s15,262144
M2 204,16,60,204
M2 208,16,64,208
M2 212,16,68,212
M2 216,16,72,216
buffer_load_dword v0,v26,s[92:95],s40 offen sc1
M2 220,16,76,220
M2 224,20,48,224
M2 228,20,52,228
M2 232,20,56,232
M2 236,20,60,236
M2 240,20,64,240
M2 244,20,68,244
M2 248,20,72,248
s_waitcnt vmcnt(15) lgkmcnt(0)
M2 252,20,76,252
s_barrier
M2 64,24,80,64
s_add_u32 m0,s11,36864
R 0,7,0
M2 68,24,84,68
R 48,10,0
L6 2,44,15
M2 72,24,88,72
M2 76,24,92,76
R 52,10,2048
M2 80,24,96,80
L7 2,44,15,1024
M2 84,24,100,84
M2 88,24,104,88
R 4,7,1024
M2 92,24,108,92
L7 2,44,15,2048
M2 96,28,80,96
R 56,10,4096
M2 100,28,84,100
M2 104,28,88,104
s_and_b32 s15,s15,0x3ffff
s_cmp_eq_u32 s15,s96
s_cselect_b32 s15,s97,s15
M2 108,28,92,108
R 8,7,2048
M2 112,28,96,112
s_add_u32 m0,s14,98304
M2 116,28,100,116
R 60,10,6144
M2 120,28,104,120
M2 124,28,108,124
R 12,7,3072
L 18,48,12
M2 128,32,80,128
M2 132,32,84,132
R 64,10,8192
M2 136,32,88,136
L1 19,48,12,1024
M2 140,32,92,140
M2 144,32,96,144
R 68,10,10240
M2 148,32,100,148
L1 20,48,12,2048
M2 152,32,104,152
R 16,7,4096
M2 156,32,108,156
L1 21,48,12,3072
M2 160,36,80,160
R 72,10,12288
M2 164,36,84,164
M2 168,36,88,168
s_add_u32 s12,s12,128
s_cmp_eq_u32 s12,s98
s_cselect_b32 s12,s99,s12
M2 172,36,92,172
R 20,7,5120
M2 176,36,96,176
M2 180,36,100,180
s_add_u32 m0,s14,102400
R 76,10,14336
M2 184,36,104,184
M2 188,36,108,188
M2 192,40,80,192
L 18,48,13
M2 196,40,84,196
M2 200,40,88,200
L1 19,48,13,1024
M2 204,40,92,204
M2 208,40,96,208
M2 212,40,100,212
L1 20,48,13,2048
M2 216,40,104,216
M2 220,40,108,220
M2 224,44,80,224
L1 21,48,13,3072
M2 228,44,84,228
M2 232,44,88,232
M2 236,44,92,236
s_add_u32 s13,s12,131072
M2 240,44,96,240
M2 244,44,100,244
M2 248,44,104,248
M2 252,44,108,252
s_waitcnt vmcnt(11)
s_cmp_lg_u32 s30,0
s_cbranch_scc1 spinret_zn0
v_readfirstlane_b32 s39,v0
s_nop 3
s_cmp_lt_u32 s39,8
s_cbranch_scc1 spin_zn0
spinret_zn0:
s_waitcnt lgkmcnt(0)
s_barrier
M2 64,0,48,64
s_add_u32 m0,s11,0
R 24,7,12288
M2 68,0,52,68
R 80,11,0
M2 72,0,56,72
M2 76,0,60,76
R 84,11,2048
M2 80,0,64,80
M2 84,0,68,84
M2 88,0,72,88
R 28,7,13312
M2 92,0,76,92
L6 2,44,15
M2 96,4,48,96
R 88,11,4096
M2 100,4,52,100
M2 104,4,56,104
R 32,7,14336
M2 108,4,60,108
M2 112,4,64,112
M2 116,4,68,116
R 92,11,6144
M2 120,4,72,120
M2 124,4,76,124
R 36,7,15360
M2 128,8,48,128
L7 2,44,15,1024
M2 132,8,52,132
R 96,11,8192
M2 136,8,56,136
M2 140,8,60,140
M2 144,8,64,144
R 100,11,10240
M2 148,8,68,148
M2 152,8,72,152
R 40,7,16384
M2 156,8,76,156
M2 160,12,48,160
R 104,11,12288
M2 164,12,52,164
L7 2,44,15,2048
M2 168,12,56,168
M2 172,12,60,172
R 44,7,17408
M2 176,12,64,176
M2 180,12,68,180
R 108,11,14336
M2 184,12,72,184
M2 188,12,76,188
M2 192,16,48,192
M2 196,16,52,196
M2 200,16,56,200
s_add_u32 s15,s15,262144
s_cmp_eq_u32 s15,s96
s_cselect_b32 s15,s97,s15
M2 204,16,60,204
M2 208,16,64,208
M2 212,16,68,212
M2 216,16,72,216
M2 220,16,76,220
M2 224,20,48,224
M2 228,20,52,228
M2 232,20,56,232
M2 236,20,60,236
M2 240,20,64,240
M2 244,20,68,244
M2 248,20,72,248
s_waitcnt lgkmcnt(0)
M2 252,20,76,252
s_barrier
M2 64,24,80,64
s_add_u32 m0,s11,12288
R 0,7,24576
M2 68,24,84,68
R 48,8,0
M2 72,24,88,72
M2 76,24,92,76
L6 2,44,15
R 52,8,2048
M2 80,24,96,80
M2 84,24,100,84
M2 88,24,104,88
R 4,7,25600
M2 92,24,108,92
L7 2,44,15,1024
M2 96,28,80,96
R 56,8,4096
M2 100,28,84,100
M2 104,28,88,104
R 8,7,26624
M2 108,28,92,108
L7 2,44,15,2048
M2 112,28,96,112
M2 116,28,100,116
R 60,8,6144
M2 120,28,104,120
M2 124,28,108,124
s_add_u32 s15,s15,262144
s_cmp_eq_u32 s15,s96
s_cselect_b32 s15,s97,s15
M2 128,32,80,128
R 12,7,27648
M2 132,32,84,132
R 64,8,8192
M2 136,32,88,136
M2 140,32,92,140
s_add_u32 m0,s14,131072
M2 144,32,96,144
R 68,8,10240
M2 148,32,100,148
M2 152,32,104,152
R 16,7,28672
M2 156,32,108,156
L 18,48,12
M2 160,36,80,160
R 72,8,12288
M2 164,36,84,164
M2 168,36,88,168
M2 172,36,92,172
L1 19,48,12,1024
R 20,7,29696
M2 176,36,96,176
M2 180,36,100,180
R 76,8,14336
M2 184,36,104,184
M2 188,36,108,188
L1 20,48,12,2048
M2 192,40,80,192
M2 196,40,84,196
M2 200,40,88,200
M2 204,40,92,204
L1 21,48,12,3072
M2 208,40,96,208
M2 212,40,100,212
M2 216,40,104,216
M2 220,40,108,220
s_add_u32 s12,s12,128
s_cmp_eq_u32 s12,s98
s_cselect_b32 s12,s99,s12
M2 224,44,80,224
M2 228,44,84,228
M2 232,44,88,232
M2 236,44,92,236
M2 240,44,96,240
M2 244,44,100,244
M2 248,44,104,248
s_waitcnt vmcnt(18) lgkmcnt(0)
M2 252,44,108,252
s_barrier
M2 64,0,48,64
s_add_u32 m0,s14,135168
R 24,7,36864
M2 68,0,52,68
R 80,9,0
M2 72,0,56,72
M2 76,0,60,76
L 18,48,13
R 84,9,2048
M2 80,0,64,80
M2 84,0,68,84
M2 88,0,72,88
R 28,7,37888
M2 92,0,76,92
L1 19,48,13,1024
M2 96,4,48,96
R 88,9,4096
M2 100,4,52,100
M2 104,4,56,104
R 32,7,38912
M2 108,4,60,108
L1 20,48,13,2048
M2 112,4,64,112
M2 116,4,68,116
R 92,9,6144
M2 120,4,72,120
M2 124,4,76,124
L1 21,48,13,3072
R 36,7,39936
M2 128,8,48,128
M2 132,8,52,132
R 96,9,8192
M2 136,8,56,136
M2 140,8,60,140
s_add_u32 s13,s12,131072
M2 144,8,64,144
R 100,9,10240
M2 148,8,68,148
M2 152,8,72,152
R 40,7,40960
M2 156,8,76,156
s_add_u32 m0,s11,24576
M2 160,12,48,160
R 104,9,12288
M2 164,12,52,164
M2 168,12,56,168
M2 172,12,60,172
L6 2,44,15
R 44,7,41984
M2 176,12,64,176
M2 180,12,68,180
R 108,9,14336
M2 184,12,72,184
M2 188,12,76,188
L7 2,44,15,1024
M2 192,16,48,192
M2 196,16,52,196
M2 200,16,56,200
M2 204,16,60,204
L7 2,44,15,2048
M2 208,16,64,208
M2 212,16,68,212
M2 216,16,72,216
M2 220,16,76,220
s_add_u32 s15,s15,262144
s_cmp_eq_u32 s15,s96
s_cselect_b32 s15,s97,s15
M2 224,20,48,224
M2 228,20,52,228
M2 232,20,56,232
M2 236,20,60,236
M2 240,20,64,240
M2 244,20,68,244
M2 248,20,72,248
s_waitcnt vmcnt(14) lgkmcnt(0)
M2 252,20,76,252
s_barrier
s_mov_b32 s35,4
gl_2:
M2 64,24,80,64
s_add_u32 m0,s11,36864
R 0,7,0
AR 49,112
M2 68,24,84,68
AR 53,113
v_accvgpr_mov_b32 a112,a136
M2 72,24,88,72
R 48,8,32768
v_accvgpr_mov_b32 a113,a137
M2 76,24,92,76
L6 2,44,15
v_accvgpr_mov_b32 a136,a160
M2 80,24,96,80
R 52,8,34816
v_accvgpr_mov_b32 a137,a161
M2 84,24,100,84
v_accvgpr_mov_b32 a160,a184
v_accvgpr_mov_b32 a161,a185
M2 88,24,104,88
R 4,7,1024
v_lshlrev_b32_e64 v48,16,v49
M2 92,24,108,92
L7 2,44,15,1024
v_lshlrev_b32_e64 v52,16,v53
M2 96,28,80,96
R 56,8,36864
v_and_b32_e64 v49,s61,v49
M2 100,28,84,100
N1 53,61,53
U1 50,48,48
M2 104,28,88,104
R 8,7,2048
v_mul_f32_e64 v54,v52,v52
M2 108,28,92,108
L7 2,44,15,2048
v_mul_f32_e64 v51,v49,v49
M2 112,28,96,112
v_mul_f32_e64 v55,v53,v53
F2 50,50,60,6
M2 116,28,100,116
R 60,8,38912
F2 54,54,60,6
M2 120,28,104,120
F2 51,51,60,6
F2 55,55,60,6
M2 124,28,108,124
s_add_u32 s15,s15,262144
s_cmp_eq_u32 s15,s96
s_cselect_b32 s15,s97,s15
M2 128,32,80,128
R 12,7,3072
v_mul_f32_e64 v50,v50,v48
M2 132,32,84,132
R 64,8,40960
v_mul_f32_e64 v54,v54,v52
M2 136,32,88,136
U1 51,51,49
U1 55,55,53
M2 140,32,92,140
s_add_u32 m0,s14,65536
v_exp_f32_e64 v50,v50
M2 144,32,96,144
R 68,8,43008
M2 148,32,100,148
v_exp_f32_e64 v54,v54
M2 152,32,104,152
R 16,7,4096
M2 156,32,108,156
L 18,48,12
M2 160,36,80,160
R 72,8,45056
M2 164,36,84,164
v_exp_f32_e64 v51,v51
M2 168,36,88,168
v_exp_f32_e64 v55,v55
M2 172,36,92,172
L1 19,48,12,1024
v_add_f32_e64 v50,1.0,v50
M2 176,36,96,176
R 20,7,5120
v_add_f32_e64 v54,1.0,v54
M2 180,36,100,180
A1 51,1.0,51
A1 55,1.0,55
M2 184,36,104,184
R 76,8,47104
M2 188,36,108,188
L1 20,48,12,2048
M2 192,40,80,192
v_rcp_f32_e64 v50,v50
M2 196,40,84,196
v_rcp_f32_e64 v54,v54
M2 200,40,88,200
v_rcp_f32_e64 v51,v51
M2 204,40,92,204
v_rcp_f32_e64 v55,v55
M2 208,40,96,208
L1 21,48,12,3072
v_mul_f32_e64 v48,v48,v50
M2 212,40,100,212
U1 52,52,54
U1 49,49,51
M2 216,40,104,216
v_mul_f32_e64 v53,v53,v55
C 48,48,49
M2 220,40,108,220
s_add_u32 s12,s12,128
s_cmp_eq_u32 s12,s98
s_cselect_b32 s12,s99,s12
M2 224,44,80,224
C 52,52,53
AW 184,48
M2 228,44,84,228
AW 185,52
M2 232,44,88,232
M2 236,44,92,236
M2 240,44,96,240
M2 244,44,100,244
M2 248,44,104,248
s_waitcnt vmcnt(18) lgkmcnt(0)
M2 252,44,108,252
s_barrier
M2 64,0,48,64
s_add_u32 m0,s14,69632
R 24,7,12288
AR 49,114
M2 68,0,52,68
AR 53,115
v_accvgpr_mov_b32 a114,a138
M2 72,0,56,72
R 80,9,32768
v_accvgpr_mov_b32 a115,a139
M2 76,0,60,76
L 18,48,13
v_accvgpr_mov_b32 a138,a162
M2 80,0,64,80
R 84,9,34816
v_accvgpr_mov_b32 a139,a163
M2 84,0,68,84
v_accvgpr_mov_b32 a162,a186
v_accvgpr_mov_b32 a163,a187
M2 88,0,72,88
R 28,7,13312
v_lshlrev_b32_e64 v48,16,v49
M2 92,0,76,92
L1 19,48,13,1024
v_lshlrev_b32_e64 v52,16,v53
M2 96,4,48,96
R 88,9,36864
v_and_b32_e64 v49,s61,v49
M2 100,4,52,100
N1 53,61,53
U1 50,48,48
M2 104,4,56,104
R 32,7,14336
v_mul_f32_e64 v54,v52,v52
M2 108,4,60,108
L1 20,48,13,2048
v_mul_f32_e64 v51,v49,v49
M2 112,4,64,112
v_mul_f32_e64 v55,v53,v53
F2 50,50,60,6
M2 116,4,68,116
R 92,9,38912
F2 54,54,60,6
M2 120,4,72,120
F2 51,51,60,6
F2 55,55,60,6
M2 124,4,76,124
L1 21,48,13,3072
R 36,7,15360
M2 128,8,48,128
U1 50,50,48
U1 54,54,52
M2 132,8,52,132
R 96,9,40960
v_mul_f32_e64 v51,v51,v49
M2 136,8,56,136
v_mul_f32_e64 v55,v55,v53
M2 140,8,60,140
s_add_u32 s13,s12,131072
v_exp_f32_e64 v50,v50
M2 144,8,64,144
R 100,9,43008
M2 148,8,68,148
v_exp_f32_e64 v54,v54
M2 152,8,72,152
R 40,7,16384
M2 156,8,76,156
s_add_u32 m0,s11,0
E 51,51
M2 160,12,48,160
R 104,9,45056
v_add_f32_e64 v50,1.0,v50
M2 164,12,52,164
v_exp_f32_e64 v55,v55
M2 168,12,56,168
A1 54,1.0,54
A1 51,1.0,51
M2 172,12,60,172
L6 2,44,15
R 44,7,17408
M2 176,12,64,176
v_add_f32_e64 v55,1.0,v55
M2 180,12,68,180
R 108,9,47104
M2 184,12,72,184
v_rcp_f32_e64 v50,v50
M2 188,12,76,188
L7 2,44,15,1024
M2 192,16,48,192
v_rcp_f32_e64 v54,v54
M2 196,16,52,196
v_rcp_f32_e64 v51,v51
M2 200,16,56,200
v_rcp_f32_e64 v55,v55
M2 204,16,60,204
L7 2,44,15,2048
v_mul_f32_e64 v48,v48,v50
M2 208,16,64,208
U1 52,52,54
U1 49,49,51
M2 212,16,68,212
v_mul_f32_e64 v53,v53,v55
C 48,48,49
M2 216,16,72,216
C 52,52,53
AW 186,48
M2 220,16,76,220
s_add_u32 s15,s15,262144
s_cmp_eq_u32 s15,s96
s_cselect_b32 s15,s97,s15
M2 224,20,48,224
AW 187,52
M2 228,20,52,228
M2 232,20,56,232
M2 236,20,60,236
M2 240,20,64,240
M2 244,20,68,244
M2 248,20,72,248
s_waitcnt vmcnt(14) lgkmcnt(0)
M2 252,20,76,252
s_barrier
M2 64,24,80,64
s_add_u32 m0,s11,12288
R 0,7,24576
AR 49,116
M2 68,24,84,68
AR 53,117
v_accvgpr_mov_b32 a116,a140
M2 72,24,88,72
R 48,10,0
v_accvgpr_mov_b32 a117,a141
M2 76,24,92,76
L6 2,44,15
v_accvgpr_mov_b32 a140,a164
M2 80,24,96,80
R 52,10,2048
v_accvgpr_mov_b32 a141,a165
M2 84,24,100,84
v_accvgpr_mov_b32 a164,a188
v_accvgpr_mov_b32 a165,a189
M2 88,24,104,88
R 4,7,25600
v_lshlrev_b32_e64 v48,16,v49
M2 92,24,108,92
L7 2,44,15,1024
v_lshlrev_b32_e64 v52,16,v53
M2 96,28,80,96
R 56,10,4096
v_and_b32_e64 v49,s61,v49
M2 100,28,84,100
N1 53,61,53
U1 50,48,48
M2 104,28,88,104
R 8,7,26624
v_mul_f32_e64 v54,v52,v52
M2 108,28,92,108
L7 2,44,15,2048
v_mul_f32_e64 v51,v49,v49
M2 112,28,96,112
v_mul_f32_e64 v55,v53,v53
F2 50,50,60,6
M2 116,28,100,116
R 60,10,6144
F2 54,54,60,6
M2 120,28,104,120
F2 51,51,60,6
F2 55,55,60,6
M2 124,28,108,124
s_add_u32 s15,s15,262144
s_cmp_eq_u32 s15,s96
s_cselect_b32 s15,s97,s15
M2 128,32,80,128
R 12,7,27648
v_mul_f32_e64 v50,v50,v48
M2 132,32,84,132
R 64,10,8192
v_mul_f32_e64 v54,v54,v52
M2 136,32,88,136
U1 51,51,49
U1 55,55,53
M2 140,32,92,140
s_add_u32 m0,s14,98304
v_exp_f32_e64 v50,v50
M2 144,32,96,144
R 68,10,10240
M2 148,32,100,148
v_exp_f32_e64 v54,v54
M2 152,32,104,152
R 16,7,28672
M2 156,32,108,156
L 18,48,12
M2 160,36,80,160
R 72,10,12288
M2 164,36,84,164
v_exp_f32_e64 v51,v51
M2 168,36,88,168
v_exp_f32_e64 v55,v55
M2 172,36,92,172
L1 19,48,12,1024
v_add_f32_e64 v50,1.0,v50
M2 176,36,96,176
R 20,7,29696
v_add_f32_e64 v54,1.0,v54
M2 180,36,100,180
A1 51,1.0,51
A1 55,1.0,55
M2 184,36,104,184
R 76,10,14336
M2 188,36,108,188
L1 20,48,12,2048
M2 192,40,80,192
v_rcp_f32_e64 v50,v50
M2 196,40,84,196
v_rcp_f32_e64 v54,v54
M2 200,40,88,200
v_rcp_f32_e64 v51,v51
M2 204,40,92,204
v_rcp_f32_e64 v55,v55
M2 208,40,96,208
L1 21,48,12,3072
v_mul_f32_e64 v48,v48,v50
M2 212,40,100,212
U1 52,52,54
U1 49,49,51
M2 216,40,104,216
v_mul_f32_e64 v53,v53,v55
C 48,48,49
M2 220,40,108,220
s_add_u32 s12,s12,128
s_cmp_eq_u32 s12,s98
s_cselect_b32 s12,s99,s12
M2 224,44,80,224
C 52,52,53
AW 188,48
M2 228,44,84,228
AW 189,52
M2 232,44,88,232
M2 236,44,92,236
M2 240,44,96,240
M2 244,44,100,244
M2 248,44,104,248
s_waitcnt vmcnt(18) lgkmcnt(0)
M2 252,44,108,252
s_barrier
M2 64,0,48,64
s_add_u32 m0,s14,102400
R 24,7,36864
AR 49,118
M2 68,0,52,68
AR 53,119
v_accvgpr_mov_b32 a118,a142
M2 72,0,56,72
R 80,11,0
v_accvgpr_mov_b32 a119,a143
M2 76,0,60,76
L 18,48,13
v_accvgpr_mov_b32 a142,a166
M2 80,0,64,80
R 84,11,2048
v_accvgpr_mov_b32 a143,a167
M2 84,0,68,84
v_accvgpr_mov_b32 a166,a190
v_accvgpr_mov_b32 a167,a191
M2 88,0,72,88
R 28,7,37888
v_lshlrev_b32_e64 v48,16,v49
M2 92,0,76,92
L1 19,48,13,1024
v_lshlrev_b32_e64 v52,16,v53
M2 96,4,48,96
R 88,11,4096
v_and_b32_e64 v49,s61,v49
M2 100,4,52,100
N1 53,61,53
U1 50,48,48
M2 104,4,56,104
R 32,7,38912
v_mul_f32_e64 v54,v52,v52
M2 108,4,60,108
L1 20,48,13,2048
v_mul_f32_e64 v51,v49,v49
M2 112,4,64,112
v_mul_f32_e64 v55,v53,v53
F2 50,50,60,6
M2 116,4,68,116
R 92,11,6144
F2 54,54,60,6
M2 120,4,72,120
F2 51,51,60,6
F2 55,55,60,6
M2 124,4,76,124
L1 21,48,13,3072
R 36,7,39936
M2 128,8,48,128
U1 50,50,48
U1 54,54,52
M2 132,8,52,132
R 96,11,8192
v_mul_f32_e64 v51,v51,v49
M2 136,8,56,136
v_mul_f32_e64 v55,v55,v53
M2 140,8,60,140
s_add_u32 s13,s12,131072
v_exp_f32_e64 v50,v50
M2 144,8,64,144
R 100,11,10240
M2 148,8,68,148
v_exp_f32_e64 v54,v54
M2 152,8,72,152
R 40,7,40960
M2 156,8,76,156
s_add_u32 m0,s11,24576
v_exp_f32_e64 v51,v51
M2 160,12,48,160
R 104,11,12288
v_add_f32_e64 v50,1.0,v50
M2 164,12,52,164
v_exp_f32_e64 v55,v55
M2 168,12,56,168
A1 54,1.0,54
A1 51,1.0,51
M2 172,12,60,172
L6 2,44,15
R 44,7,41984
M2 176,12,64,176
v_add_f32_e64 v55,1.0,v55
M2 180,12,68,180
R 108,11,14336
M2 184,12,72,184
v_rcp_f32_e64 v50,v50
M2 188,12,76,188
L7 2,44,15,1024
M2 192,16,48,192
v_rcp_f32_e64 v54,v54
M2 196,16,52,196
v_rcp_f32_e64 v51,v51
M2 200,16,56,200
v_rcp_f32_e64 v55,v55
M2 204,16,60,204
L7 2,44,15,2048
v_mul_f32_e64 v48,v48,v50
M2 208,16,64,208
U1 52,52,54
U1 49,49,51
M2 212,16,68,212
v_mul_f32_e64 v53,v53,v55
C 48,48,49
M2 216,16,72,216
C 52,52,53
AW 190,48
M2 220,16,76,220
s_add_u32 s15,s15,262144
s_cmp_eq_u32 s15,s96
s_cselect_b32 s15,s97,s15
M2 224,20,48,224
AW 191,52
M2 228,20,52,228
M2 232,20,56,232
M2 236,20,60,236
M2 240,20,64,240
M2 244,20,68,244
M2 248,20,72,248
s_waitcnt vmcnt(14) lgkmcnt(0)
M2 252,20,76,252
s_barrier
M2 64,24,80,64
s_add_u32 m0,s11,36864
R 0,7,0
AR 49,120
M2 68,24,84,68
AR 53,121
v_accvgpr_mov_b32 a120,a144
M2 72,24,88,72
R 48,8,0
v_accvgpr_mov_b32 a121,a145
M2 76,24,92,76
L6 2,44,15
v_accvgpr_mov_b32 a144,a168
M2 80,24,96,80
R 52,8,2048
v_accvgpr_mov_b32 a145,a169
M2 84,24,100,84
v_accvgpr_mov_b32 a168,a192
v_accvgpr_mov_b32 a169,a193
M2 88,24,104,88
R 4,7,1024
v_lshlrev_b32_e64 v48,16,v49
M2 92,24,108,92
L7 2,44,15,1024
v_lshlrev_b32_e64 v52,16,v53
M2 96,28,80,96
R 56,8,4096
v_and_b32_e64 v49,s61,v49
M2 100,28,84,100
N1 53,61,53
U1 50,48,48
M2 104,28,88,104
R 8,7,2048
v_mul_f32_e64 v54,v52,v52
M2 108,28,92,108
L7 2,44,15,2048
v_mul_f32_e64 v51,v49,v49
M2 112,28,96,112
v_mul_f32_e64 v55,v53,v53
F2 50,50,60,6
M2 116,28,100,116
R 60,8,6144
F2 54,54,60,6
M2 120,28,104,120
F2 51,51,60,6
F2 55,55,60,6
M2 124,28,108,124
s_add_u32 s15,s15,262144
s_cmp_eq_u32 s15,s96
s_cselect_b32 s15,s97,s15
M2 128,32,80,128
R 12,7,3072
v_mul_f32_e64 v50,v50,v48
M2 132,32,84,132
R 64,8,8192
v_mul_f32_e64 v54,v54,v52
M2 136,32,88,136
U1 51,51,49
U1 55,55,53
M2 140,32,92,140
s_add_u32 m0,s14,131072
v_exp_f32_e64 v50,v50
M2 144,32,96,144
R 68,8,10240
M2 148,32,100,148
v_exp_f32_e64 v54,v54
M2 152,32,104,152
R 16,7,4096
M2 156,32,108,156
L 18,48,12
M2 160,36,80,160
R 72,8,12288
M2 164,36,84,164
v_exp_f32_e64 v51,v51
M2 168,36,88,168
v_exp_f32_e64 v55,v55
M2 172,36,92,172
L1 19,48,12,1024
v_add_f32_e64 v50,1.0,v50
M2 176,36,96,176
R 20,7,5120
v_add_f32_e64 v54,1.0,v54
M2 180,36,100,180
A1 51,1.0,51
A1 55,1.0,55
M2 184,36,104,184
R 76,8,14336
M2 188,36,108,188
L1 20,48,12,2048
M2 192,40,80,192
v_rcp_f32_e64 v50,v50
M2 196,40,84,196
v_rcp_f32_e64 v54,v54
M2 200,40,88,200
v_rcp_f32_e64 v51,v51
M2 204,40,92,204
v_rcp_f32_e64 v55,v55
M2 208,40,96,208
L1 21,48,12,3072
v_mul_f32_e64 v48,v48,v50
M2 212,40,100,212
U1 52,52,54
U1 49,49,51
M2 216,40,104,216
v_mul_f32_e64 v53,v53,v55
C 48,48,49
M2 220,40,108,220
s_add_u32 s12,s12,128
s_cmp_eq_u32 s12,s98
s_cselect_b32 s12,s99,s12
M2 224,44,80,224
C 52,52,53
AW 192,48
M2 228,44,84,228
AW 193,52
M2 232,44,88,232
M2 236,44,92,236
M2 240,44,96,240
M2 244,44,100,244
M2 248,44,104,248
s_waitcnt vmcnt(18) lgkmcnt(0)
M2 252,44,108,252
s_barrier
M2 64,0,48,64
s_add_u32 m0,s14,135168
R 24,7,12288
AR 49,122
M2 68,0,52,68
AR 53,123
v_accvgpr_mov_b32 a122,a146
M2 72,0,56,72
R 80,9,0
v_accvgpr_mov_b32 a123,a147
M2 76,0,60,76
L 18,48,13
v_accvgpr_mov_b32 a146,a170
M2 80,0,64,80
R 84,9,2048
v_accvgpr_mov_b32 a147,a171
M2 84,0,68,84
v_accvgpr_mov_b32 a170,a194
v_accvgpr_mov_b32 a171,a195
M2 88,0,72,88
R 28,7,13312
v_lshlrev_b32_e64 v48,16,v49
M2 92,0,76,92
L1 19,48,13,1024
v_lshlrev_b32_e64 v52,16,v53
M2 96,4,48,96
R 88,9,4096
v_and_b32_e64 v49,s61,v49
M2 100,4,52,100
N1 53,61,53
U1 50,48,48
M2 104,4,56,104
R 32,7,14336
v_mul_f32_e64 v54,v52,v52
M2 108,4,60,108
L1 20,48,13,2048
v_mul_f32_e64 v51,v49,v49
M2 112,4,64,112
v_mul_f32_e64 v55,v53,v53
F2 50,50,60,6
M2 116,4,68,116
R 92,9,6144
F2 54,54,60,6
M2 120,4,72,120
F2 51,51,60,6
F2 55,55,60,6
M2 124,4,76,124
L1 21,48,13,3072
R 36,7,15360
M2 128,8,48,128
U1 50,50,48
U1 54,54,52
M2 132,8,52,132
R 96,9,8192
v_mul_f32_e64 v51,v51,v49
M2 136,8,56,136
v_mul_f32_e64 v55,v55,v53
M2 140,8,60,140
s_add_u32 s13,s12,131072
v_exp_f32_e64 v50,v50
M2 144,8,64,144
R 100,9,10240
M2 148,8,68,148
v_exp_f32_e64 v54,v54
M2 152,8,72,152
R 40,7,16384
M2 156,8,76,156
s_add_u32 m0,s11,0
E 51,51
M2 160,12,48,160
R 104,9,12288
v_add_f32_e64 v50,1.0,v50
M2 164,12,52,164
v_exp_f32_e64 v55,v55
M2 168,12,56,168
A1 54,1.0,54
A1 51,1.0,51
M2 172,12,60,172
L6 2,44,15
R 44,7,17408
M2 176,12,64,176
v_add_f32_e64 v55,1.0,v55
M2 180,12,68,180
R 108,9,14336
M2 184,12,72,184
v_rcp_f32_e64 v50,v50
M2 188,12,76,188
L7 2,44,15,1024
M2 192,16,48,192
v_rcp_f32_e64 v54,v54
M2 196,16,52,196
v_rcp_f32_e64 v51,v51
M2 200,16,56,200
v_rcp_f32_e64 v55,v55
M2 204,16,60,204
L7 2,44,15,2048
v_mul_f32_e64 v48,v48,v50
M2 208,16,64,208
U1 52,52,54
U1 49,49,51
M2 212,16,68,212
v_mul_f32_e64 v53,v53,v55
C 48,48,49
M2 216,16,72,216
C 52,52,53
AW 194,48
M2 220,16,76,220
s_add_u32 s15,s15,262144
s_cmp_eq_u32 s15,s96
s_cselect_b32 s15,s97,s15
M2 224,20,48,224
AW 195,52
M2 228,20,52,228
M2 232,20,56,232
M2 236,20,60,236
M2 240,20,64,240
M2 244,20,68,244
M2 248,20,72,248
s_waitcnt vmcnt(14) lgkmcnt(0)
M2 252,20,76,252
s_barrier
M2 64,24,80,64
s_add_u32 m0,s11,12288
R 0,7,24576
AR 49,124
M2 68,24,84,68
AR 53,125
v_accvgpr_mov_b32 a124,a148
M2 72,24,88,72
R 48,8,32768
v_accvgpr_mov_b32 a125,a149
M2 76,24,92,76
L6 2,44,15
v_accvgpr_mov_b32 a148,a172
M2 80,24,96,80
R 52,8,34816
v_accvgpr_mov_b32 a149,a173
M2 84,24,100,84
v_accvgpr_mov_b32 a172,a196
v_accvgpr_mov_b32 a173,a197
M2 88,24,104,88
R 4,7,25600
v_lshlrev_b32_e64 v48,16,v49
M2 92,24,108,92
L7 2,44,15,1024
v_lshlrev_b32_e64 v52,16,v53
M2 96,28,80,96
R 56,8,36864
v_and_b32_e64 v49,s61,v49
M2 100,28,84,100
N1 53,61,53
U1 50,48,48
M2 104,28,88,104
R 8,7,26624
v_mul_f32_e64 v54,v52,v52
M2 108,28,92,108
L7 2,44,15,2048
v_mul_f32_e64 v51,v49,v49
M2 112,28,96,112
v_mul_f32_e64 v55,v53,v53
F2 50,50,60,6
M2 116,28,100,116
R 60,8,38912
F2 54,54,60,6
M2 120,28,104,120
F2 51,51,60,6
F2 55,55,60,6
M2 124,28,108,124
s_add_u32 s15,s15,262144
s_cmp_eq_u32 s15,s96
s_cselect_b32 s15,s97,s15
M2 128,32,80,128
R 12,7,27648
v_mul_f32_e64 v50,v50,v48
M2 132,32,84,132
R 64,8,40960
v_mul_f32_e64 v54,v54,v52
M2 136,32,88,136
U1 51,51,49
U1 55,55,53
M2 140,32,92,140
s_add_u32 m0,s14,65536
v_exp_f32_e64 v50,v50
M2 144,32,96,144
R 68,8,43008
M2 148,32,100,148
v_exp_f32_e64 v54,v54
M2 152,32,104,152
R 16,7,28672
M2 156,32,108,156
L 18,48,12
M2 160,36,80,160
R 72,8,45056
M2 164,36,84,164
v_exp_f32_e64 v51,v51
M2 168,36,88,168
v_exp_f32_e64 v55,v55
M2 172,36,92,172
L1 19,48,12,1024
v_add_f32_e64 v50,1.0,v50
M2 176,36,96,176
R 20,7,29696
v_add_f32_e64 v54,1.0,v54
M2 180,36,100,180
A1 51,1.0,51
A1 55,1.0,55
M2 184,36,104,184
R 76,8,47104
M2 188,36,108,188
L1 20,48,12,2048
M2 192,40,80,192
v_rcp_f32_e64 v50,v50
M2 196,40,84,196
v_rcp_f32_e64 v54,v54
M2 200,40,88,200
v_rcp_f32_e64 v51,v51
M2 204,40,92,204
v_rcp_f32_e64 v55,v55
M2 208,40,96,208
L1 21,48,12,3072
v_mul_f32_e64 v48,v48,v50
M2 212,40,100,212
U1 52,52,54
U1 49,49,51
M2 216,40,104,216
v_mul_f32_e64 v53,v53,v55
C 48,48,49
M2 220,40,108,220
s_add_u32 s12,s12,128
s_cmp_eq_u32 s12,s98
s_cselect_b32 s12,s99,s12
M2 224,44,80,224
C 52,52,53
AW 196,48
M2 228,44,84,228
AW 197,52
M2 232,44,88,232
M2 236,44,92,236
M2 240,44,96,240
M2 244,44,100,244
M2 248,44,104,248
s_waitcnt vmcnt(18) lgkmcnt(0)
M2 252,44,108,252
s_barrier
M2 64,0,48,64
s_add_u32 m0,s14,69632
R 24,7,36864
AR 49,126
M2 68,0,52,68
AR 53,127
v_accvgpr_mov_b32 a126,a150
M2 72,0,56,72
R 80,9,32768
v_accvgpr_mov_b32 a127,a151
M2 76,0,60,76
L 18,48,13
v_accvgpr_mov_b32 a150,a174
M2 80,0,64,80
R 84,9,34816
v_accvgpr_mov_b32 a151,a175
M2 84,0,68,84
v_accvgpr_mov_b32 a174,a198
v_accvgpr_mov_b32 a175,a199
M2 88,0,72,88
R 28,7,37888
v_lshlrev_b32_e64 v48,16,v49
M2 92,0,76,92
L1 19,48,13,1024
v_lshlrev_b32_e64 v52,16,v53
M2 96,4,48,96
R 88,9,36864
v_and_b32_e64 v49,s61,v49
M2 100,4,52,100
N1 53,61,53
U1 50,48,48
M2 104,4,56,104
R 32,7,38912
v_mul_f32_e64 v54,v52,v52
M2 108,4,60,108
L1 20,48,13,2048
v_mul_f32_e64 v51,v49,v49
M2 112,4,64,112
v_mul_f32_e64 v55,v53,v53
F2 50,50,60,6
M2 116,4,68,116
R 92,9,38912
F2 54,54,60,6
M2 120,4,72,120
F2 51,51,60,6
F2 55,55,60,6
M2 124,4,76,124
L1 21,48,13,3072
R 36,7,39936
M2 128,8,48,128
U1 50,50,48
U1 54,54,52
M2 132,8,52,132
R 96,9,40960
v_mul_f32_e64 v51,v51,v49
M2 136,8,56,136
v_mul_f32_e64 v55,v55,v53
M2 140,8,60,140
s_add_u32 s13,s12,131072
v_exp_f32_e64 v50,v50
M2 144,8,64,144
R 100,9,43008
M2 148,8,68,148
v_exp_f32_e64 v54,v54
M2 152,8,72,152
R 40,7,40960
M2 156,8,76,156
s_add_u32 m0,s11,24576
v_exp_f32_e64 v51,v51
M2 160,12,48,160
R 104,9,45056
v_add_f32_e64 v50,1.0,v50
M2 164,12,52,164
v_exp_f32_e64 v55,v55
M2 168,12,56,168
A1 54,1.0,54
A1 51,1.0,51
M2 172,12,60,172
L6 2,44,15
R 44,7,41984
M2 176,12,64,176
v_add_f32_e64 v55,1.0,v55
M2 180,12,68,180
R 108,9,47104
M2 184,12,72,184
v_rcp_f32_e64 v50,v50
M2 188,12,76,188
L7 2,44,15,1024
M2 192,16,48,192
v_rcp_f32_e64 v54,v54
M2 196,16,52,196
v_rcp_f32_e64 v51,v51
M2 200,16,56,200
v_rcp_f32_e64 v55,v55
M2 204,16,60,204
L7 2,44,15,2048
v_mul_f32_e64 v48,v48,v50
M2 208,16,64,208
U1 52,52,54
U1 49,49,51
M2 212,16,68,212
v_mul_f32_e64 v53,v53,v55
C 48,48,49
M2 216,16,72,216
C 52,52,53
AW 198,48
M2 220,16,76,220
s_add_u32 s15,s15,262144
s_cmp_eq_u32 s15,s96
s_cselect_b32 s15,s97,s15
M2 224,20,48,224
AW 199,52
M2 228,20,52,228
M2 232,20,56,232
M2 236,20,60,236
M2 240,20,64,240
M2 244,20,68,244
M2 248,20,72,248
s_waitcnt vmcnt(14) lgkmcnt(0)
M2 252,20,76,252
s_barrier
M2 64,24,80,64
s_add_u32 m0,s11,36864
R 0,7,0
AR 49,128
M2 68,24,84,68
AR 53,129
v_accvgpr_mov_b32 a128,a152
M2 72,24,88,72
R 48,10,0
v_accvgpr_mov_b32 a129,a153
M2 76,24,92,76
L6 2,44,15
v_accvgpr_mov_b32 a152,a176
M2 80,24,96,80
R 52,10,2048
v_accvgpr_mov_b32 a153,a177
M2 84,24,100,84
v_accvgpr_mov_b32 a176,a200
v_accvgpr_mov_b32 a177,a201
M2 88,24,104,88
R 4,7,1024
v_lshlrev_b32_e64 v48,16,v49
M2 92,24,108,92
L7 2,44,15,1024
v_lshlrev_b32_e64 v52,16,v53
M2 96,28,80,96
R 56,10,4096
v_and_b32_e64 v49,s61,v49
M2 100,28,84,100
N1 53,61,53
U1 50,48,48
M2 104,28,88,104
R 8,7,2048
v_mul_f32_e64 v54,v52,v52
M2 108,28,92,108
L7 2,44,15,2048
v_mul_f32_e64 v51,v49,v49
M2 112,28,96,112
v_mul_f32_e64 v55,v53,v53
F2 50,50,60,6
M2 116,28,100,116
R 60,10,6144
F2 54,54,60,6
M2 120,28,104,120
F2 51,51,60,6
F2 55,55,60,6
M2 124,28,108,124
s_add_u32 s15,s15,262144
s_cmp_eq_u32 s15,s96
s_cselect_b32 s15,s97,s15
M2 128,32,80,128
R 12,7,3072
v_mul_f32_e64 v50,v50,v48
M2 132,32,84,132
R 64,10,8192
v_mul_f32_e64 v54,v54,v52
M2 136,32,88,136
U1 51,51,49
U1 55,55,53
M2 140,32,92,140
s_add_u32 m0,s14,98304
v_exp_f32_e64 v50,v50
M2 144,32,96,144
R 68,10,10240
M2 148,32,100,148
v_exp_f32_e64 v54,v54
M2 152,32,104,152
R 16,7,4096
M2 156,32,108,156
L 18,48,12
M2 160,36,80,160
R 72,10,12288
M2 164,36,84,164
v_exp_f32_e64 v51,v51
M2 168,36,88,168
v_exp_f32_e64 v55,v55
M2 172,36,92,172
L1 19,48,12,1024
v_add_f32_e64 v50,1.0,v50
M2 176,36,96,176
R 20,7,5120
v_add_f32_e64 v54,1.0,v54
M2 180,36,100,180
A1 51,1.0,51
A1 55,1.0,55
M2 184,36,104,184
R 76,10,14336
M2 188,36,108,188
L1 20,48,12,2048
M2 192,40,80,192
v_rcp_f32_e64 v50,v50
M2 196,40,84,196
v_rcp_f32_e64 v54,v54
M2 200,40,88,200
v_rcp_f32_e64 v51,v51
M2 204,40,92,204
v_rcp_f32_e64 v55,v55
M2 208,40,96,208
L1 21,48,12,3072
v_mul_f32_e64 v48,v48,v50
M2 212,40,100,212
U1 52,52,54
U1 49,49,51
M2 216,40,104,216
v_mul_f32_e64 v53,v53,v55
C 48,48,49
M2 220,40,108,220
s_add_u32 s12,s12,128
s_cmp_eq_u32 s12,s98
s_cselect_b32 s12,s99,s12
M2 224,44,80,224
C 52,52,53
AW 200,48
M2 228,44,84,228
AW 201,52
M2 232,44,88,232
M2 236,44,92,236
M2 240,44,96,240
M2 244,44,100,244
M2 248,44,104,248
s_waitcnt vmcnt(18) lgkmcnt(0)
M2 252,44,108,252
s_barrier
M2 64,0,48,64
s_add_u32 m0,s14,102400
R 24,7,12288
AR 49,130
M2 68,0,52,68
AR 53,131
v_accvgpr_mov_b32 a130,a154
M2 72,0,56,72
R 80,11,0
v_accvgpr_mov_b32 a131,a155
M2 76,0,60,76
L 18,48,13
v_accvgpr_mov_b32 a154,a178
M2 80,0,64,80
R 84,11,2048
v_accvgpr_mov_b32 a155,a179
M2 84,0,68,84
v_accvgpr_mov_b32 a178,a202
v_accvgpr_mov_b32 a179,a203
M2 88,0,72,88
R 28,7,13312
v_lshlrev_b32_e64 v48,16,v49
M2 92,0,76,92
L1 19,48,13,1024
v_lshlrev_b32_e64 v52,16,v53
M2 96,4,48,96
R 88,11,4096
v_and_b32_e64 v49,s61,v49
M2 100,4,52,100
N1 53,61,53
U1 50,48,48
M2 104,4,56,104
R 32,7,14336
v_mul_f32_e64 v54,v52,v52
M2 108,4,60,108
L1 20,48,13,2048
v_mul_f32_e64 v51,v49,v49
M2 112,4,64,112
v_mul_f32_e64 v55,v53,v53
F2 50,50,60,6
M2 116,4,68,116
R 92,11,6144
F2 54,54,60,6
M2 120,4,72,120
F2 51,51,60,6
F2 55,55,60,6
M2 124,4,76,124
L1 21,48,13,3072
R 36,7,15360
M2 128,8,48,128
U1 50,50,48
U1 54,54,52
M2 132,8,52,132
R 96,11,8192
v_mul_f32_e64 v51,v51,v49
M2 136,8,56,136
v_mul_f32_e64 v55,v55,v53
M2 140,8,60,140
s_add_u32 s13,s12,131072
v_exp_f32_e64 v50,v50
M2 144,8,64,144
R 100,11,10240
M2 148,8,68,148
v_exp_f32_e64 v54,v54
M2 152,8,72,152
R 40,7,16384
M2 156,8,76,156
s_add_u32 m0,s11,0
E 51,51
M2 160,12,48,160
R 104,11,12288
v_add_f32_e64 v50,1.0,v50
M2 164,12,52,164
v_exp_f32_e64 v55,v55
M2 168,12,56,168
A1 54,1.0,54
A1 51,1.0,51
M2 172,12,60,172
L6 2,44,15
R 44,7,17408
M2 176,12,64,176
v_add_f32_e64 v55,1.0,v55
M2 180,12,68,180
R 108,11,14336
M2 184,12,72,184
v_rcp_f32_e64 v50,v50
M2 188,12,76,188
L7 2,44,15,1024
M2 192,16,48,192
v_rcp_f32_e64 v54,v54
M2 196,16,52,196
v_rcp_f32_e64 v51,v51
M2 200,16,56,200
v_rcp_f32_e64 v55,v55
M2 204,16,60,204
L7 2,44,15,2048
v_mul_f32_e64 v48,v48,v50
M2 208,16,64,208
U1 52,52,54
U1 49,49,51
M2 212,16,68,212
v_mul_f32_e64 v53,v53,v55
C 48,48,49
M2 216,16,72,216
C 52,52,53
AW 202,48
M2 220,16,76,220
s_add_u32 s15,s15,262144
s_cmp_eq_u32 s15,s96
s_cselect_b32 s15,s97,s15
M2 224,20,48,224
AW 203,52
M2 228,20,52,228
M2 232,20,56,232
M2 236,20,60,236
M2 240,20,64,240
M2 244,20,68,244
M2 248,20,72,248
s_waitcnt vmcnt(14) lgkmcnt(0)
M2 252,20,76,252
s_barrier
M2 64,24,80,64
s_add_u32 m0,s11,12288
R 0,7,24576
AR 49,132
M2 68,24,84,68
AR 53,133
v_accvgpr_mov_b32 a132,a156
M2 72,24,88,72
R 48,8,0
v_accvgpr_mov_b32 a133,a157
M2 76,24,92,76
L6 2,44,15
v_accvgpr_mov_b32 a156,a180
M2 80,24,96,80
R 52,8,2048
v_accvgpr_mov_b32 a157,a181
M2 84,24,100,84
v_accvgpr_mov_b32 a180,a204
v_accvgpr_mov_b32 a181,a205
M2 88,24,104,88
R 4,7,25600
v_lshlrev_b32_e64 v48,16,v49
M2 92,24,108,92
L7 2,44,15,1024
v_lshlrev_b32_e64 v52,16,v53
M2 96,28,80,96
R 56,8,4096
v_and_b32_e64 v49,s61,v49
M2 100,28,84,100
N1 53,61,53
U1 50,48,48
M2 104,28,88,104
R 8,7,26624
v_mul_f32_e64 v54,v52,v52
M2 108,28,92,108
L7 2,44,15,2048
v_mul_f32_e64 v51,v49,v49
M2 112,28,96,112
v_mul_f32_e64 v55,v53,v53
F2 50,50,60,6
M2 116,28,100,116
R 60,8,6144
F2 54,54,60,6
M2 120,28,104,120
F2 51,51,60,6
F2 55,55,60,6
M2 124,28,108,124
s_add_u32 s15,s15,262144
s_cmp_eq_u32 s15,s96
s_cselect_b32 s15,s97,s15
M2 128,32,80,128
R 12,7,27648
v_mul_f32_e64 v50,v50,v48
M2 132,32,84,132
R 64,8,8192
v_mul_f32_e64 v54,v54,v52
M2 136,32,88,136
U1 51,51,49
U1 55,55,53
M2 140,32,92,140
s_add_u32 m0,s14,131072
v_exp_f32_e64 v50,v50
M2 144,32,96,144
R 68,8,10240
M2 148,32,100,148
v_exp_f32_e64 v54,v54
M2 152,32,104,152
R 16,7,28672
M2 156,32,108,156
L 18,48,12
M2 160,36,80,160
R 72,8,12288
M2 164,36,84,164
v_exp_f32_e64 v51,v51
M2 168,36,88,168
v_exp_f32_e64 v55,v55
M2 172,36,92,172
L1 19,48,12,1024
v_add_f32_e64 v50,1.0,v50
M2 176,36,96,176
R 20,7,29696
v_add_f32_e64 v54,1.0,v54
M2 180,36,100,180
A1 51,1.0,51
A1 55,1.0,55
M2 184,36,104,184
R 76,8,14336
M2 188,36,108,188
L1 20,48,12,2048
M2 192,40,80,192
v_rcp_f32_e64 v50,v50
M2 196,40,84,196
v_rcp_f32_e64 v54,v54
M2 200,40,88,200
v_rcp_f32_e64 v51,v51
M2 204,40,92,204
v_rcp_f32_e64 v55,v55
M2 208,40,96,208
L1 21,48,12,3072
v_mul_f32_e64 v48,v48,v50
M2 212,40,100,212
U1 52,52,54
U1 49,49,51
M2 216,40,104,216
v_mul_f32_e64 v53,v53,v55
C 48,48,49
M2 220,40,108,220
s_add_u32 s12,s12,128
s_cmp_eq_u32 s12,s98
s_cselect_b32 s12,s99,s12
M2 224,44,80,224
C 52,52,53
AW 204,48
M2 228,44,84,228
AW 205,52
M2 232,44,88,232
M2 236,44,92,236
M2 240,44,96,240
M2 244,44,100,244
M2 248,44,104,248
s_waitcnt vmcnt(18) lgkmcnt(0)
M2 252,44,108,252
s_barrier
M2 64,0,48,64
s_add_u32 m0,s14,135168
R 24,7,36864
AR 49,134
M2 68,0,52,68
AR 53,135
v_accvgpr_mov_b32 a134,a158
M2 72,0,56,72
R 80,9,0
v_accvgpr_mov_b32 a135,a159
M2 76,0,60,76
L 18,48,13
v_accvgpr_mov_b32 a158,a182
M2 80,0,64,80
R 84,9,2048
v_accvgpr_mov_b32 a159,a183
M2 84,0,68,84
v_accvgpr_mov_b32 a182,a206
v_accvgpr_mov_b32 a183,a207
M2 88,0,72,88
R 28,7,37888
v_lshlrev_b32_e64 v48,16,v49
M2 92,0,76,92
L1 19,48,13,1024
v_lshlrev_b32_e64 v52,16,v53
M2 96,4,48,96
R 88,9,4096
v_and_b32_e64 v49,s61,v49
M2 100,4,52,100
N1 53,61,53
U1 50,48,48
M2 104,4,56,104
R 32,7,38912
v_mul_f32_e64 v54,v52,v52
M2 108,4,60,108
L1 20,48,13,2048
v_mul_f32_e64 v51,v49,v49
M2 112,4,64,112
v_mul_f32_e64 v55,v53,v53
F2 50,50,60,6
M2 116,4,68,116
R 92,9,6144
F2 54,54,60,6
M2 120,4,72,120
F2 51,51,60,6
F2 55,55,60,6
M2 124,4,76,124
L1 21,48,13,3072
R 36,7,39936
M2 128,8,48,128
U1 50,50,48
U1 54,54,52
M2 132,8,52,132
R 96,9,8192
v_mul_f32_e64 v51,v51,v49
M2 136,8,56,136
v_mul_f32_e64 v55,v55,v53
M2 140,8,60,140
s_add_u32 s13,s12,131072
v_exp_f32_e64 v50,v50
M2 144,8,64,144
R 100,9,10240
M2 148,8,68,148
v_exp_f32_e64 v54,v54
M2 152,8,72,152
R 40,7,40960
M2 156,8,76,156
s_add_u32 m0,s11,24576
v_exp_f32_e64 v51,v51
M2 160,12,48,160
R 104,9,12288
v_add_f32_e64 v50,1.0,v50
M2 164,12,52,164
v_exp_f32_e64 v55,v55
M2 168,12,56,168
A1 54,1.0,54
A1 51,1.0,51
M2 172,12,60,172
L6 2,44,15
R 44,7,41984
M2 176,12,64,176
v_add_f32_e64 v55,1.0,v55
M2 180,12,68,180
R 108,9,14336
M2 184,12,72,184
v_rcp_f32_e64 v50,v50
M2 188,12,76,188
L7 2,44,15,1024
M2 192,16,48,192
v_rcp_f32_e64 v54,v54
M2 196,16,52,196
v_rcp_f32_e64 v51,v51
M2 200,16,56,200
v_rcp_f32_e64 v55,v55
M2 204,16,60,204
L7 2,44,15,2048
v_mul_f32_e64 v48,v48,v50
M2 208,16,64,208
U1 52,52,54
U1 49,49,51
M2 212,16,68,212
v_mul_f32_e64 v53,v53,v55
C 48,48,49
M2 216,16,72,216
C 52,52,53
AW 206,48
M2 220,16,76,220
s_add_u32 s15,s15,262144
s_cmp_eq_u32 s15,s96
s_cselect_b32 s15,s97,s15
M2 224,20,48,224
AW 207,52
M2 228,20,52,228
M2 232,20,56,232
M2 236,20,60,236
M2 240,20,64,240
M2 244,20,68,244
M2 248,20,72,248
s_waitcnt vmcnt(14) lgkmcnt(0)
M2 252,20,76,252
s_barrier
s_sub_u32 s35,s35,1
s_cmp_lg_u32 s35,0
s_cbranch_scc1 gl_2
M2 64,24,80,64
s_add_u32 m0,s11,36864
R 0,7,0
M2 68,24,84,68
R 48,8,32768
M2 72,24,88,72
M2 76,24,92,76
L6 2,44,15
R 52,8,34816
M2 80,24,96,80
M2 84,24,100,84
M2 88,24,104,88
R 4,7,1024
M2 92,24,108,92
L7 2,44,15,1024
M2 96,28,80,96
R 56,8,36864
M2 100,28,84,100
M2 104,28,88,104
R 8,7,2048
M2 108,28,92,108
L7 2,44,15,2048
M2 112,28,96,112
M2 116,28,100,116
R 60,8,38912
M2 120,28,104,120
M2 124,28,108,124
s_add_u32 s15,s15,262144
s_cmp_eq_u32 s15,s96
s_cselect_b32 s15,s97,s15
M2 128,32,80,128
R 12,7,3072
M2 132,32,84,132
R 64,8,40960
M2 136,32,88,136
M2 140,32,92,140
s_add_u32 m0,s14,65536
M2 144,32,96,144
R 68,8,43008
M2 148,32,100,148
M2 152,32,104,152
R 16,7,4096
M2 156,32,108,156
L 18,48,12
M2 160,36,80,160
R 72,8,45056
M2 164,36,84,164
M2 168,36,88,168
M2 172,36,92,172
L1 19,48,12,1024
R 20,7,5120
M2 176,36,96,176
M2 180,36,100,180
R 76,8,47104
M2 184,36,104,184
M2 188,36,108,188
L1 20,48,12,2048
M2 192,40,80,192
M2 196,40,84,196
M2 200,40,88,200
M2 204,40,92,204
L1 21,48,12,3072
M2 208,40,96,208
M2 212,40,100,212
M2 216,40,104,216
M2 220,40,108,220
s_add_u32 s12,s12,128
s_cmp_eq_u32 s12,s98
s_cselect_b32 s12,s99,s12
M2 224,44,80,224
M2 228,44,84,228
M2 232,44,88,232
M2 236,44,92,236
M2 240,44,96,240
M2 244,44,100,244
M2 248,44,104,248
s_waitcnt vmcnt(18) lgkmcnt(0)
M2 252,44,108,252
s_barrier
M2 64,0,48,64
s_add_u32 m0,s14,69632
R 24,7,12288
M2 68,0,52,68
R 80,9,32768
M2 72,0,56,72
M2 76,0,60,76
L 18,48,13
R 84,9,34816
M2 80,0,64,80
M2 84,0,68,84
M2 88,0,72,88
R 28,7,13312
M2 92,0,76,92
L1 19,48,13,1024
M2 96,4,48,96
R 88,9,36864
M2 100,4,52,100
M2 104,4,56,104
R 32,7,14336
M2 108,4,60,108
L1 20,48,13,2048
M2 112,4,64,112
M2 116,4,68,116
R 92,9,38912
M2 120,4,72,120
M2 124,4,76,124
L1 21,48,13,3072
R 36,7,15360
M2 128,8,48,128
M2 132,8,52,132
R 96,9,40960
M2 136,8,56,136
M2 140,8,60,140
s_add_u32 s13,s12,131072
M2 144,8,64,144
R 100,9,43008
M2 148,8,68,148
M2 152,8,72,152
R 40,7,16384
M2 156,8,76,156
s_add_u32 m0,s11,0
M2 160,12,48,160
R 104,9,45056
M2 164,12,52,164
M2 168,12,56,168
M2 172,12,60,172
L6 2,44,15
R 44,7,17408
M2 176,12,64,176
M2 180,12,68,180
R 108,9,47104
M2 184,12,72,184
M2 188,12,76,188
L7 2,44,15,1024
M2 192,16,48,192
M2 196,16,52,196
M2 200,16,56,200
M2 204,16,60,204
L7 2,44,15,2048
M2 208,16,64,208
M2 212,16,68,212
M2 216,16,72,216
M2 220,16,76,220
s_add_u32 s15,s15,262144
s_cmp_eq_u32 s15,s96
s_cselect_b32 s15,s97,s15
M2 224,20,48,224
M2 228,20,52,228
M2 232,20,56,232
M2 236,20,60,236
M2 240,20,64,240
M2 244,20,68,244
M2 248,20,72,248
s_waitcnt vmcnt(14) lgkmcnt(0)
M2 252,20,76,252
s_barrier
M2 64,24,80,64
s_add_u32 m0,s11,12288
R 0,7,24576
M2 68,24,84,68
R 48,10,0
M2 72,24,88,72
M2 76,24,92,76
L6 2,44,15
R 52,10,2048
M2 80,24,96,80
M2 84,24,100,84
M2 88,24,104,88
R 4,7,25600
M2 92,24,108,92
L7 2,44,15,1024
M2 96,28,80,96
R 56,10,4096
M2 100,28,84,100
M2 104,28,88,104
R 8,7,26624
M2 108,28,92,108
L7 2,44,15,2048
M2 112,28,96,112
M2 116,28,100,116
R 60,10,6144
M2 120,28,104,120
M2 124,28,108,124
s_add_u32 s15,s15,262144
s_cmp_eq_u32 s15,s96
s_cselect_b32 s15,s97,s15
M2 128,32,80,128
R 12,7,27648
M2 132,32,84,132
R 64,10,8192
M2 136,32,88,136
M2 140,32,92,140
s_add_u32 m0,s14,98304
M2 144,32,96,144
R 68,10,10240
M2 148,32,100,148
M2 152,32,104,152
R 16,7,28672
M2 156,32,108,156
L 18,48,12
M2 160,36,80,160
R 72,10,12288
M2 164,36,84,164
M2 168,36,88,168
M2 172,36,92,172
L1 19,48,12,1024
R 20,7,29696
M2 176,36,96,176
M2 180,36,100,180
R 76,10,14336
M2 184,36,104,184
M2 188,36,108,188
L1 20,48,12,2048
M2 192,40,80,192
M2 196,40,84,196
M2 200,40,88,200
M2 204,40,92,204
L1 21,48,12,3072
M2 208,40,96,208
M2 212,40,100,212
M2 216,40,104,216
M2 220,40,108,220
s_add_u32 s12,s12,128
s_cmp_eq_u32 s12,s98
s_cselect_b32 s12,s99,s12
M2 224,44,80,224
M2 228,44,84,228
M2 232,44,88,232
M2 236,44,92,236
M2 240,44,96,240
M2 244,44,100,244
M2 248,44,104,248
s_waitcnt vmcnt(18) lgkmcnt(0)
M2 252,44,108,252
s_barrier
M2 64,0,48,64
s_add_u32 m0,s14,102400
R 24,7,36864
M2 68,0,52,68
R 80,11,0
M2 72,0,56,72
M2 76,0,60,76
L 18,48,13
R 84,11,2048
M2 80,0,64,80
M2 84,0,68,84
M2 88,0,72,88
R 28,7,37888
M2 92,0,76,92
L1 19,48,13,1024
M2 96,4,48,96
R 88,11,4096
M2 100,4,52,100
M2 104,4,56,104
R 32,7,38912
M2 108,4,60,108
L1 20,48,13,2048
M2 112,4,64,112
M2 116,4,68,116
R 92,11,6144
M2 120,4,72,120
M2 124,4,76,124
L1 21,48,13,3072
R 36,7,39936
M2 128,8,48,128
M2 132,8,52,132
R 96,11,8192
M2 136,8,56,136
M2 140,8,60,140
s_add_u32 s13,s12,131072
M2 144,8,64,144
R 100,11,10240
M2 148,8,68,148
M2 152,8,72,152
R 40,7,40960
M2 156,8,76,156
s_add_u32 m0,s11,24576
M2 160,12,48,160
R 104,11,12288
M2 164,12,52,164
M2 168,12,56,168
M2 172,12,60,172
L6 2,44,15
R 44,7,41984
M2 176,12,64,176
M2 180,12,68,180
R 108,11,14336
M2 184,12,72,184
M2 188,12,76,188
L7 2,44,15,1024
M2 192,16,48,192
M2 196,16,52,196
M2 200,16,56,200
M2 204,16,60,204
L7 2,44,15,2048
M2 208,16,64,208
M2 212,16,68,212
M2 216,16,72,216
M2 220,16,76,220
s_add_u32 s15,s15,262144
s_cmp_eq_u32 s15,s96
s_cselect_b32 s15,s97,s15
M2 224,20,48,224
M2 228,20,52,228
M2 232,20,56,232
M2 236,20,60,236
M2 240,20,64,240
M2 244,20,68,244
M2 248,20,72,248
s_waitcnt vmcnt(14) lgkmcnt(0)
M2 252,20,76,252
s_barrier
M2 64,24,80,64
s_add_u32 m0,s11,36864
R 0,7,0
M2 68,24,84,68
R 48,8,0
M2 72,24,88,72
M2 76,24,92,76
R 52,8,2048
M2 80,24,96,80
M2 84,24,100,84
M2 88,24,104,88
R 4,7,1024
M2 92,24,108,92
L6 2,44,15
M2 96,28,80,96
R 56,8,4096
M2 100,28,84,100
M2 104,28,88,104
R 8,7,2048
M2 108,28,92,108
M2 112,28,96,112
M2 116,28,100,116
R 60,8,6144
M2 120,28,104,120
M2 124,28,108,124
R 12,7,3072
M2 128,32,80,128
L7 2,44,15,1024
M2 132,32,84,132
R 64,8,8192
M2 136,32,88,136
M2 140,32,92,140
M2 144,32,96,144
R 68,8,10240
M2 148,32,100,148
M2 152,32,104,152
R 16,7,4096
M2 156,32,108,156
M2 160,36,80,160
R 72,8,12288
M2 164,36,84,164
L7 2,44,15,2048
M2 168,36,88,168
M2 172,36,92,172
R 20,7,5120
M2 176,36,96,176
M2 180,36,100,180
R 76,8,14336
M2 184,36,104,184
M2 188,36,108,188
M2 192,40,80,192
M2 196,40,84,196
M2 200,40,88,200
s_add_u32 s15,s15,262144
s_cmp_eq_u32 s15,s96
s_cselect_b32 s15,s97,s15
M2 204,40,92,204
M2 208,40,96,208
M2 212,40,100,212
M2 216,40,104,216
M2 220,40,108,220
M2 224,44,80,224
M2 228,44,84,228
M2 232,44,88,232
M2 236,44,92,236
M2 240,44,96,240
M2 244,44,100,244
M2 248,44,104,248
s_waitcnt vmcnt(14) lgkmcnt(0)
M2 252,44,108,252
s_barrier
M2 64,0,48,64
R 24,7,12288
M2 68,0,52,68
R 80,9,0
M2 72,0,56,72
M2 76,0,60,76
R 84,9,2048
M2 80,0,64,80
M2 84,0,68,84
M2 88,0,72,88
R 28,7,13312
M2 92,0,76,92
M2 96,4,48,96
R 88,9,4096
M2 100,4,52,100
M2 104,4,56,104
R 32,7,14336
M2 108,4,60,108
M2 112,4,64,112
M2 116,4,68,116
R 92,9,6144
M2 120,4,72,120
M2 124,4,76,124
R 36,7,15360
M2 128,8,48,128
M2 132,8,52,132
R 96,9,8192
M2 136,8,56,136
M2 140,8,60,140
M2 144,8,64,144
R 100,9,10240
M2 148,8,68,148
M2 152,8,72,152
R 40,7,16384
M2 156,8,76,156
M2 160,12,48,160
R 104,9,12288
M2 164,12,52,164
M2 168,12,56,168
M2 172,12,60,172
R 44,7,17408
M2 176,12,64,176
M2 180,12,68,180
R 108,9,14336
M2 184,12,72,184
M2 188,12,76,188
M2 192,16,48,192
M2 196,16,52,196
M2 200,16,56,200
M2 204,16,60,204
M2 208,16,64,208
M2 212,16,68,212
M2 216,16,72,216
M2 220,16,76,220
M2 224,20,48,224
M2 228,20,52,228
M2 232,20,56,232
M2 236,20,60,236
M2 240,20,64,240
M2 244,20,68,244
M2 248,20,72,248
s_waitcnt vmcnt(3) lgkmcnt(0)
M2 252,20,76,252
s_barrier
M2 64,24,80,64
R 0,7,24576
M2 68,24,84,68
R 48,8,32768
M2 72,24,88,72
M2 76,24,92,76
R 52,8,34816
M2 80,24,96,80
M2 84,24,100,84
M2 88,24,104,88
R 4,7,25600
M2 92,24,108,92
M2 96,28,80,96
R 56,8,36864
M2 100,28,84,100
M2 104,28,88,104
R 8,7,26624
M2 108,28,92,108
M2 112,28,96,112
M2 116,28,100,116
R 60,8,38912
M2 120,28,104,120
M2 124,28,108,124
R 12,7,27648
M2 128,32,80,128
M2 132,32,84,132
R 64,8,40960
M2 136,32,88,136
M2 140,32,92,140
M2 144,32,96,144
R 68,8,43008
M2 148,32,100,148
M2 152,32,104,152
R 16,7,28672
M2 156,32,108,156
M2 160,36,80,160
R 72,8,45056
M2 164,36,84,164
M2 168,36,88,168
M2 172,36,92,172
R 20,7,29696
M2 176,36,96,176
M2 180,36,100,180
R 76,8,47104
M2 184,36,104,184
M2 188,36,108,188
M2 192,40,80,192
M2 196,40,84,196
M2 200,40,88,200
M2 204,40,92,204
M2 208,40,96,208
M2 212,40,100,212
M2 216,40,104,216
M2 220,40,108,220
M2 224,44,80,224
M2 228,44,84,228
M2 232,44,88,232
M2 236,44,92,236
M2 240,44,96,240
M2 244,44,100,244
M2 248,44,104,248
s_waitcnt vmcnt(0) lgkmcnt(0)
M2 252,44,108,252
s_barrier
M2 64,0,48,64
R 24,7,36864
M2 68,0,52,68
R 80,9,32768
M2 72,0,56,72
M2 76,0,60,76
R 84,9,34816
M2 80,0,64,80
M2 84,0,68,84
M2 88,0,72,88
R 28,7,37888
M2 92,0,76,92
M2 96,4,48,96
R 88,9,36864
M2 100,4,52,100
M2 104,4,56,104
R 32,7,38912
M2 108,4,60,108
M2 112,4,64,112
M2 116,4,68,116
R 92,9,38912
M2 120,4,72,120
M2 124,4,76,124
R 36,7,39936
M2 128,8,48,128
M2 132,8,52,132
R 96,9,40960
M2 136,8,56,136
M2 140,8,60,140
M2 144,8,64,144
R 100,9,43008
M2 148,8,68,148
M2 152,8,72,152
R 40,7,40960
M2 156,8,76,156
M2 160,12,48,160
R 104,9,45056
M2 164,12,52,164
M2 168,12,56,168
M2 172,12,60,172
R 44,7,41984
M2 176,12,64,176
M2 180,12,68,180
R 108,9,47104
M2 184,12,72,184
M2 188,12,76,188
M2 192,16,48,192
M2 196,16,52,196
M2 200,16,56,200
M2 204,16,60,204
M2 208,16,64,208
M2 212,16,68,212
M2 216,16,72,216
M2 220,16,76,220
M2 224,20,48,224
M2 228,20,52,228
M2 232,20,56,232
M2 236,20,60,236
M2 240,20,64,240
M2 244,20,68,244
M2 248,20,72,248
M2 252,20,76,252
s_waitcnt lgkmcnt(0)
M2 64,24,80,64
M2 68,24,84,68
M2 72,24,88,72
M2 76,24,92,76
M2 80,24,96,80
M2 84,24,100,84
M2 88,24,104,88
M2 92,24,108,92
M2 96,28,80,96
M2 100,28,84,100
M2 104,28,88,104
M2 108,28,92,108
M2 112,28,96,112
M2 116,28,100,116
M2 120,28,104,120
M2 124,28,108,124
M2 128,32,80,128
M2 132,32,84,132
M2 136,32,88,136
M2 140,32,92,140
M2 144,32,96,144
M2 148,32,100,148
M2 152,32,104,152
M2 156,32,108,156
M2 160,36,80,160
M2 164,36,84,164
M2 168,36,88,168
M2 172,36,92,172
M2 176,36,96,176
M2 180,36,100,180
M2 184,36,104,184
M2 188,36,108,188
M2 192,40,80,192
M2 196,40,84,196
M2 200,40,88,200
M2 204,40,92,204
M2 208,40,96,208
M2 212,40,100,212
M2 216,40,104,216
M2 220,40,108,220
M2 224,44,80,224
M2 228,44,84,228
M2 232,44,88,232
M2 236,44,92,236
M2 240,44,96,240
M2 244,44,100,244
M2 248,44,104,248
M2 252,44,108,252
l12_gend:
s_and_b32 s4,s2,0xfc
s_add_u32 s4,s4,fin_tab-l12_pc
s_load_dword s5,s[88:89],s4
s_load_dwordx2 s[44:45],s[0:1],40
s_load_dwordx2 s[46:47],s[0:1],80
s_load_dwordx2 s[60:61],s[0:1],0
s_load_dwordx2 s[62:63],s[0:1],88
s_mul_i32 s40,s33,3
s_add_u32 s40,s40,128
s_lshl_b32 s40,s40,7
s_lshl_b32 s39,s28,4
s_add_u32 s40,s40,s39
s_add_u32 s40,s40,s34
s_lshl_b32 s40,s40,10
s_nop 2
AR 9,112
SL 8,16,9
N 9,0xffff0000,9
PM 64,64,8
C 40,64,65
AR 11,113
SL 10,16,11
N 11,0xffff0000,11
PM 66,66,10
C 41,66,67
AR 9,128
SL 8,16,9
N 9,0xffff0000,9
PM 96,96,8
C 42,96,97
AR 11,129
SL 10,16,11
N 11,0xffff0000,11
PM 98,98,10
C 43,98,99
s_add_u32 s39,s40,0
S1 40,27,24,39,0
AR 9,114
SL 8,16,9
N 9,0xffff0000,9
PM 68,68,8
C 44,68,69
AR 11,115
SL 10,16,11
N 11,0xffff0000,11
PM 70,70,10
C 45,70,71
AR 9,130
SL 8,16,9
N 9,0xffff0000,9
PM 100,100,8
C 46,100,101
AR 11,131
SL 10,16,11
N 11,0xffff0000,11
PM 102,102,10
C 47,102,103
S1 44,27,24,39,1024
AR 9,116
SL 8,16,9
N 9,0xffff0000,9
PM 72,72,8
C 48,72,73
AR 11,117
SL 10,16,11
N 11,0xffff0000,11
PM 74,74,10
C 49,74,75
AR 9,132
SL 8,16,9
N 9,0xffff0000,9
PM 104,104,8
C 50,104,105
AR 11,133
SL 10,16,11
N 11,0xffff0000,11
PM 106,106,10
C 51,106,107
S1 48,27,24,39,2048
AR 9,118
SL 8,16,9
N 9,0xffff0000,9
PM 76,76,8
C 52,76,77
AR 11,119
SL 10,16,11
N 11,0xffff0000,11
PM 78,78,10
C 53,78,79
AR 9,134
SL 8,16,9
N 9,0xffff0000,9
PM 108,108,8
C 54,108,109
AR 11,135
SL 10,16,11
N 11,0xffff0000,11
PM 110,110,10
C 55,110,111
S1 52,27,24,39,3072
AR 9,120
SL 8,16,9
N 9,0xffff0000,9
PM 80,80,8
C 40,80,81
AR 11,121
SL 10,16,11
N 11,0xffff0000,11
PM 82,82,10
C 41,82,83
AR 9,136
SL 8,16,9
N 9,0xffff0000,9
PM 112,112,8
C 42,112,113
AR 11,137
SL 10,16,11
N 11,0xffff0000,11
PM 114,114,10
C 43,114,115
s_add_u32 s39,s40,4096
S1 40,27,24,39,0
AR 9,122
SL 8,16,9
N 9,0xffff0000,9
PM 84,84,8
C 44,84,85
AR 11,123
SL 10,16,11
N 11,0xffff0000,11
PM 86,86,10
C 45,86,87
AR 9,138
SL 8,16,9
N 9,0xffff0000,9
PM 116,116,8
C 46,116,117
AR 11,139
SL 10,16,11
N 11,0xffff0000,11
PM 118,118,10
C 47,118,119
S1 44,27,24,39,1024
AR 9,124
SL 8,16,9
N 9,0xffff0000,9
PM 88,88,8
C 48,88,89
AR 11,125
SL 10,16,11
N 11,0xffff0000,11
PM 90,90,10
C 49,90,91
AR 9,140
SL 8,16,9
N 9,0xffff0000,9
PM 120,120,8
C 50,120,121
AR 11,141
SL 10,16,11
N 11,0xffff0000,11
PM 122,122,10
C 51,122,123
S1 48,27,24,39,2048
AR 9,126
SL 8,16,9
N 9,0xffff0000,9
PM 92,92,8
C 52,92,93
AR 11,127
SL 10,16,11
N 11,0xffff0000,11
PM 94,94,10
C 53,94,95
AR 9,142
SL 8,16,9
N 9,0xffff0000,9
PM 124,124,8
C 54,124,125
AR 11,143
SL 10,16,11
N 11,0xffff0000,11
PM 126,126,10
C 55,126,127
S1 52,27,24,39,3072
AR 9,144
SL 8,16,9
N 9,0xffff0000,9
PM 128,128,8
C 40,128,129
AR 11,145
SL 10,16,11
N 11,0xffff0000,11
PM 130,130,10
C 41,130,131
AR 9,160
SL 8,16,9
N 9,0xffff0000,9
PM 160,160,8
C 42,160,161
AR 11,161
SL 10,16,11
N 11,0xffff0000,11
PM 162,162,10
C 43,162,163
s_add_u32 s39,s40,131072
S1 40,27,24,39,0
AR 9,146
SL 8,16,9
N 9,0xffff0000,9
PM 132,132,8
C 44,132,133
AR 11,147
SL 10,16,11
N 11,0xffff0000,11
PM 134,134,10
C 45,134,135
AR 9,162
SL 8,16,9
N 9,0xffff0000,9
PM 164,164,8
C 46,164,165
AR 11,163
SL 10,16,11
N 11,0xffff0000,11
PM 166,166,10
C 47,166,167
S1 44,27,24,39,1024
AR 9,148
SL 8,16,9
N 9,0xffff0000,9
PM 136,136,8
C 48,136,137
AR 11,149
SL 10,16,11
N 11,0xffff0000,11
PM 138,138,10
C 49,138,139
AR 9,164
SL 8,16,9
N 9,0xffff0000,9
PM 168,168,8
C 50,168,169
AR 11,165
SL 10,16,11
N 11,0xffff0000,11
PM 170,170,10
C 51,170,171
S1 48,27,24,39,2048
AR 9,150
SL 8,16,9
N 9,0xffff0000,9
PM 140,140,8
C 52,140,141
AR 11,151
SL 10,16,11
N 11,0xffff0000,11
PM 142,142,10
C 53,142,143
AR 9,166
SL 8,16,9
N 9,0xffff0000,9
PM 172,172,8
C 54,172,173
AR 11,167
SL 10,16,11
N 11,0xffff0000,11
PM 174,174,10
C 55,174,175
S1 52,27,24,39,3072
AR 9,152
SL 8,16,9
N 9,0xffff0000,9
PM 144,144,8
C 40,144,145
AR 11,153
SL 10,16,11
N 11,0xffff0000,11
PM 146,146,10
C 41,146,147
AR 9,168
SL 8,16,9
N 9,0xffff0000,9
PM 176,176,8
C 42,176,177
AR 11,169
SL 10,16,11
N 11,0xffff0000,11
PM 178,178,10
C 43,178,179
s_add_u32 s39,s40,135168
S1 40,27,24,39,0
AR 9,154
SL 8,16,9
N 9,0xffff0000,9
PM 148,148,8
C 44,148,149
AR 11,155
SL 10,16,11
N 11,0xffff0000,11
PM 150,150,10
C 45,150,151
AR 9,170
SL 8,16,9
N 9,0xffff0000,9
PM 180,180,8
C 46,180,181
AR 11,171
SL 10,16,11
N 11,0xffff0000,11
PM 182,182,10
C 47,182,183
S1 44,27,24,39,1024
AR 9,156
SL 8,16,9
N 9,0xffff0000,9
PM 152,152,8
C 48,152,153
AR 11,157
SL 10,16,11
N 11,0xffff0000,11
PM 154,154,10
C 49,154,155
AR 9,172
SL 8,16,9
N 9,0xffff0000,9
PM 184,184,8
C 50,184,185
AR 11,173
SL 10,16,11
N 11,0xffff0000,11
PM 186,186,10
C 51,186,187
S1 48,27,24,39,2048
AR 9,158
SL 8,16,9
N 9,0xffff0000,9
PM 156,156,8
C 52,156,157
AR 11,159
SL 10,16,11
N 11,0xffff0000,11
PM 158,158,10
C 53,158,159
AR 9,174
SL 8,16,9
N 9,0xffff0000,9
PM 188,188,8
C 54,188,189
AR 11,175
SL 10,16,11
N 11,0xffff0000,11
PM 190,190,10
C 55,190,191
S1 52,27,24,39,3072
AR 9,176
SL 8,16,9
N 9,0xffff0000,9
PM 192,192,8
C 40,192,193
AR 11,177
SL 10,16,11
N 11,0xffff0000,11
PM 194,194,10
C 41,194,195
AR 9,192
SL 8,16,9
N 9,0xffff0000,9
PM 224,224,8
C 42,224,225
AR 11,193
SL 10,16,11
N 11,0xffff0000,11
PM 226,226,10
C 43,226,227
s_add_u32 s39,s40,262144
S1 40,27,24,39,0
AR 9,178
SL 8,16,9
N 9,0xffff0000,9
PM 196,196,8
C 44,196,197
AR 11,179
SL 10,16,11
N 11,0xffff0000,11
PM 198,198,10
C 45,198,199
AR 9,194
SL 8,16,9
N 9,0xffff0000,9
PM 228,228,8
C 46,228,229
AR 11,195
SL 10,16,11
N 11,0xffff0000,11
PM 230,230,10
C 47,230,231
S1 44,27,24,39,1024
AR 9,180
SL 8,16,9
N 9,0xffff0000,9
PM 200,200,8
C 48,200,201
AR 11,181
SL 10,16,11
N 11,0xffff0000,11
PM 202,202,10
C 49,202,203
AR 9,196
SL 8,16,9
N 9,0xffff0000,9
PM 232,232,8
C 50,232,233
AR 11,197
SL 10,16,11
N 11,0xffff0000,11
PM 234,234,10
C 51,234,235
S1 48,27,24,39,2048
AR 9,182
SL 8,16,9
N 9,0xffff0000,9
PM 204,204,8
C 52,204,205
AR 11,183
SL 10,16,11
N 11,0xffff0000,11
PM 206,206,10
C 53,206,207
AR 9,198
SL 8,16,9
N 9,0xffff0000,9
PM 236,236,8
C 54,236,237
AR 11,199
SL 10,16,11
N 11,0xffff0000,11
PM 238,238,10
C 55,238,239
S1 52,27,24,39,3072
AR 9,184
SL 8,16,9
N 9,0xffff0000,9
PM 208,208,8
C 40,208,209
AR 11,185
SL 10,16,11
N 11,0xffff0000,11
PM 210,210,10
C 41,210,211
AR 9,200
SL 8,16,9
N 9,0xffff0000,9
PM 240,240,8
C 42,240,241
AR 11,201
SL 10,16,11
N 11,0xffff0000,11
PM 242,242,10
C 43,242,243
s_add_u32 s39,s40,266240
S1 40,27,24,39,0
AR 9,186
SL 8,16,9
N 9,0xffff0000,9
PM 212,212,8
C 44,212,213
AR 11,187
SL 10,16,11
N 11,0xffff0000,11
PM 214,214,10
C 45,214,215
AR 9,202
SL 8,16,9
N 9,0xffff0000,9
PM 244,244,8
C 46,244,245
AR 11,203
SL 10,16,11
N 11,0xffff0000,11
PM 246,246,10
C 47,246,247
S1 44,27,24,39,1024
AR 9,188
SL 8,16,9
N 9,0xffff0000,9
PM 216,216,8
C 48,216,217
AR 11,189
SL 10,16,11
N 11,0xffff0000,11
PM 218,218,10
C 49,218,219
AR 9,204
SL 8,16,9
N 9,0xffff0000,9
PM 248,248,8
C 50,248,249
AR 11,205
SL 10,16,11
N 11,0xffff0000,11
PM 250,250,10
C 51,250,251
S1 48,27,24,39,2048
AR 9,190
SL 8,16,9
N 9,0xffff0000,9
PM 220,220,8
C 52,220,221
AR 11,191
SL 10,16,11
N 11,0xffff0000,11
PM 222,222,10
C 53,222,223
AR 9,206
SL 8,16,9
N 9,0xffff0000,9
PM 252,252,8
C 54,252,253
AR 11,207
SL 10,16,11
N 11,0xffff0000,11
PM 254,254,10
C 55,254,255
S1 52,27,24,39,3072
s_cmp_ge_u32 s29,6
s_cselect_b32 s39,8,0
s_cselect_b32 s11,6,0
s_add_u32 s40,s28,s39
s_lshl_b32 s40,s40,8
s_add_u32 s40,s40,11264
s_sub_u32 s11,s29,s11
s_mul_i32 s11,s11,6
l12_fin:
s_mov_b32 s10,s40
s_and_b32 s4,s2,3
s_lshl_b32 s4,s4,3
s_barrier
s_waitcnt lgkmcnt(0)
s_lshr_b32 s5,s5,s4
s_and_b32 s33,s5,0xff
s_cmp_lt_u32 s33,240
s_cbranch_scc1 l12_fingo
s_waitcnt vmcnt(0)
s_barrier
buffer_atomic_add v28,v26,s[92:95],s10 offen sc1
s_endpgm
l12_fingo:
s_mul_i32 s40,s33,21846
s_lshr_b32 s40,s40,16
s_mul_i32 s41,s40,3
s_sub_u32 s41,s33,s41
s_lshr_b32 s42,s40,4
s_and_b32 s40,s40,15
s_mov_b64 s[4:5],s[44:45]
s_mov_b64 s[6:7],s[46:47]
s_mov_b64 s[24:25],s[60:61]
s_mov_b64 s[48:49],s[62:63]
s_mul_i32 s33,s30,192
v_add_u32 v20,s33,v1
v_mul_u32_u24 v21,2731,v20
v_lshrrev_b32 v21,16,v21
v_mul_u32_u24 v22,24,v21
v_sub_u32 v22,v20,v22
v_bfe_u32 v23,v21,1,2
SL 23,1,23
v_xor_b32 v22,v22,v23
v_mul_u32_u24 v21,1152,v21
v_lshl_add_u32 v4,v22,4,v21
v_add_u32 v20,64,v20
v_mul_u32_u24 v21,2731,v20
v_lshrrev_b32 v21,16,v21
v_mul_u32_u24 v22,24,v21
v_sub_u32 v22,v20,v22
v_bfe_u32 v23,v21,1,2
SL 23,1,23
v_xor_b32 v22,v22,v23
v_mul_u32_u24 v21,1152,v21
v_lshl_add_u32 v5,v22,4,v21
v_subrev_u32 v5,1024,v5
v_add_u32 v20,64,v20
v_mul_u32_u24 v21,2731,v20
v_lshrrev_b32 v21,16,v21
v_mul_u32_u24 v22,24,v21
v_sub_u32 v22,v20,v22
v_bfe_u32 v23,v21,1,2
SL 23,1,23
v_xor_b32 v22,v22,v23
v_mul_u32_u24 v21,1152,v21
v_lshl_add_u32 v6,v22,4,v21
v_subrev_u32 v6,2048,v6
s_mov_b32 s63,0
s_mov_b32 s38,0
s_cmp_eq_u32 s42,1
s_cselect_b32 s63,44,s63
s_cselect_b32 s38,0,s38
s_cmp_eq_u32 s42,2
s_cselect_b32 s63,88,s63
s_cselect_b32 s38,1,s38
s_cmp_eq_u32 s42,3
s_cselect_b32 s63,128,s63
s_cselect_b32 s38,2,s38
s_cmp_eq_u32 s42,4
s_cselect_b32 s63,164,s63
s_cselect_b32 s38,2,s38
s_mul_i32 s29,s63,36864
s_mul_i32 s33,s41,384
s_add_u32 s29,s29,s33
s_mul_i32 s35,s30,3072
s_lshl_b32 s62,s38,2
s_sub_u32 s62,44,s62
s_mov_b32 s58,s29
s_mul_i32 s59,s62,36864
s_add_u32 s59,s59,s58
s_mul_i32 s33,s11,36864
s_add_u32 s29,s29,s33
s_mov_b32 s52,4718592
s_mov_b32 s53,7372800
s_mov_b32 s19,0x00020000
s_waitcnt lgkmcnt(0)
s_sub_u32 s6,s6,4718592
s_subb_u32 s7,s7,0
s_cmp_lt_u32 s42,3
s_cselect_b32 s16,s4,s6
s_cselect_b32 s17,s5,s7
s_cselect_b32 s18,s52,s53
s_and_b32 s17,s17,0xffff
s_add_u32 m0,s35,0
s_nop 0
L 4,16,29
L1 5,16,29,1024
L1 6,16,29,2048
s_add_u32 s29,s29,36864
s_cmp_eq_u32 s29,s59
s_cselect_b32 s29,s58,s29
s_add_u32 m0,s35,12288
s_nop 0
L 4,16,29
L1 5,16,29,1024
L1 6,16,29,2048
s_add_u32 s29,s29,36864
s_cmp_eq_u32 s29,s59
s_cselect_b32 s29,s58,s29
s_add_u32 m0,s35,24576
s_nop 0
L 4,16,29
L1 5,16,29,1024
L1 6,16,29,2048
s_add_u32 s29,s29,36864
s_cmp_eq_u32 s29,s59
s_cselect_b32 s29,s58,s29
s_waitcnt vmcnt(9)
s_barrier
buffer_atomic_add v28,v26,s[92:95],s10 offen sc1
s_add_u32 s12,s8,48234496
s_addc_u32 s13,s9,0
s_and_b32 s13,s13,0xffff
s_mov_b32 s14,26214400
s_mov_b32 s15,0x00020000
s_lshl_b32 s28,s63,7
s_lshl_b32 s33,s40,3
s_add_u32 s28,s28,s33
s_lshl_b32 s28,s28,10
s_mov_b32 s60,s28
s_lshl_b32 s61,s62,17
s_add_u32 s61,s61,s60
s_lshl_b32 s33,s11,17
s_add_u32 s28,s28,s33
s_lshl_b32 s34,s30,11
s_lshr_b32 s31,s30,1
s_and_b32 s32,s30,1
s_lshl_b32 s36,s31,2
s_mul_i32 s37,s32,6
s_mul_i32 s33,s30,2048
SL 20,4,1
v_add_u32 v2,s33,v20
s_lshl_b32 s33,s36,10
s_add_u32 s33,s33,49152
v_add_u32 v3,s33,v20
v_lshrrev_b32 v20,4,v1
v_bfe_u32 v21,v1,2,2
v_lshl_add_u32 v21,v20,2,v21
v_bfe_u32 v23,v21,1,2
v_mul_u32_u24 v21,384,v21
N 22,3,1
v_lshl_add_u32 v21,v22,3,v21
s_add_u32 s33,s37,0
v_xor_b32 v22,s33,v23
v_lshl_add_u32 v8,v22,5,v21
s_add_u32 s33,s37,1
v_xor_b32 v22,s33,v23
v_lshl_add_u32 v9,v22,5,v21
s_add_u32 s33,s37,2
v_xor_b32 v22,s33,v23
v_lshl_add_u32 v10,v22,5,v21
s_add_u32 s33,s37,3
v_xor_b32 v22,s33,v23
v_lshl_add_u32 v11,v22,5,v21
s_add_u32 s33,s37,4
v_xor_b32 v22,s33,v23
v_lshl_add_u32 v12,v22,5,v21
s_add_u32 s33,s37,5
v_xor_b32 v22,s33,v23
v_lshl_add_u32 v13,v22,5,v21
v_add_u32 v20,s30,v1
V 21,1
v_cmp_eq_u32 vcc,0,v20
v_mov_b32_e64 v20,1073741824
s_nop 0
K 20,20,0,vcc
s_cmp_ge_u32 s42,3
s_cbranch_scc1 l12_finrdya
s_lshr_b32 s4,s40,1
s_lshl_b32 s4,s4,8
s_add_u32 s4,s4,9216
s_cmp_lg_u32 s30,0
s_cbranch_scc1 l12_finrdya
s_mov_b32 s5,0
l12_finspina:
buffer_load_dword v26,v20,s[92:95],s4 offen sc1
s_add_u32 s5,s5,1
s_cmp_ge_u32 s5,16384
s_cbranch_scc1 l12_finrdya
s_waitcnt vmcnt(0)
v_readfirstlane_b32 s6,v26
s_nop 3
s_cmp_ge_u32 s6,32
s_cbranch_scc1 l12_finrdya
s_sleep 4
s_branch l12_finspina
l12_finrdya:
s_barrier
s_add_u32 m0,s34,49152
s_nop 0
L6 2,12,28
L7 2,12,28,1024
s_add_u32 s28,s28,131072
s_cmp_eq_u32 s28,s61
s_cselect_b32 s28,s60,s28
s_add_u32 m0,s34,57344
s_nop 0
L6 2,12,28
L7 2,12,28,1024
s_add_u32 s28,s28,131072
s_cmp_eq_u32 s28,s61
s_cselect_b32 s28,s60,s28
s_add_u32 m0,s34,65536
s_nop 0
L6 2,12,28
L7 2,12,28,1024
s_add_u32 s28,s28,131072
s_cmp_eq_u32 s28,s61
s_cselect_b32 s28,s60,s28
s_waitcnt vmcnt(4)
s_barrier
T 0,8,0
R 48,3,0
T 2,8,6144
T 4,9,0
T 6,9,6144
R 52,3,1024
T 8,10,0
T 10,10,6144
T 12,11,0
R 56,3,2048
T 14,11,6144
T 16,12,0
T 18,12,6144
R 60,3,3072
T 20,13,0
T 22,13,6144
s_waitcnt lgkmcnt(0)
s_waitcnt vmcnt(2)
s_barrier
M 64,0,48,0
s_add_u32 m0,s35,36864
T 24,8,12288
R 64,3,8192
M 68,0,52,0
L 4,16,29
T 26,8,18432
M 72,0,56,0
L1 5,16,29,1024
T 28,9,12288
M 76,0,60,0
T 30,9,18432
L1 6,16,29,2048
M 80,4,48,0
R 68,3,9216
M 84,4,52,0
s_add_u32 s29,s29,36864
s_cmp_eq_u32 s29,s59
s_cselect_b32 s29,s58,s29
M 88,4,56,0
s_add_u32 m0,s34,73728
T 32,10,12288
T 34,10,18432
M 92,4,60,0
T 36,11,12288
L6 2,12,28
M 96,8,48,0
R 72,3,10240
L7 2,12,28,1024
M 100,8,52,0
T 38,11,18432
M 104,8,56,0
s_add_u32 s28,s28,131072
s_cmp_eq_u32 s28,s61
s_cselect_b32 s28,s60,s28
M 108,8,60,0
s_add_u32 m0,s35,0
T 40,12,12288
T 42,12,18432
M 112,12,48,0
R 76,3,11264
L 4,16,29
M 116,12,52,0
T 44,13,12288
L1 5,16,29,1024
M 120,12,56,0
T 46,13,18432
M 124,12,60,0
L1 6,16,29,2048
M 128,16,48,0
s_add_u32 s29,s29,36864
s_cmp_eq_u32 s29,s59
s_cselect_b32 s29,s58,s29
M 132,16,52,0
buffer_load_dword v26,v20,s[92:95],s10 offen sc1
M 136,16,56,0
M 140,16,60,0
M 144,20,48,0
M 148,20,52,0
M 152,20,56,0
s_waitcnt vmcnt(9) lgkmcnt(0)
M 156,20,60,0
s_barrier
M2 64,24,64,64
s_add_u32 m0,s34,49152
T 0,8,24576
R 48,3,16384
M2 68,24,68,68
L6 2,12,28
T 2,8,30720
M2 72,24,72,72
T 4,9,24576
L7 2,12,28,1024
M2 76,24,76,76
T 6,9,30720
M2 80,28,64,80
R 52,3,17408
M2 84,28,68,84
s_add_u32 s28,s28,131072
s_cmp_eq_u32 s28,s61
s_cselect_b32 s28,s60,s28
M2 88,28,72,88
s_add_u32 m0,s35,12288
T 8,10,24576
T 10,10,30720
M2 92,28,76,92
T 12,11,24576
L 4,16,29
M2 96,32,64,96
R 56,3,18432
M2 100,32,68,100
T 14,11,30720
L1 5,16,29,1024
M2 104,32,72,104
T 16,12,24576
M2 108,32,76,108
T 18,12,30720
L1 6,16,29,2048
M2 112,36,64,112
R 60,3,19456
M2 116,36,68,116
T 20,13,24576
M2 120,36,72,120
s_add_u32 s29,s29,36864
s_cmp_eq_u32 s29,s59
s_cselect_b32 s29,s58,s29
M2 124,36,76,124
s_add_u32 m0,s34,57344
T 22,13,30720
M2 128,40,64,128
L6 2,12,28
M2 132,40,68,132
M2 136,40,72,136
L7 2,12,28,1024
M2 140,40,76,140
M2 144,44,64,144
s_add_u32 s28,s28,131072
s_cmp_eq_u32 s28,s61
s_cselect_b32 s28,s60,s28
M2 148,44,68,148
M2 152,44,72,152
M2 156,44,76,156
s_waitcnt vmcnt(7)
s_cmp_lt_u32 s42,3
s_cbranch_scc1 l12_finrdyb
s_cmp_lg_u32 s30,0
s_cbranch_scc1 l12_finrdyb
v_readfirstlane_b32 s6,v26
s_nop 3
s_cmp_ge_u32 s6,6
s_cbranch_scc1 l12_finrdyb
s_mov_b32 s5,0
l12_finspinb:
buffer_load_dword v26,v20,s[92:95],s10 offen sc1
s_add_u32 s5,s5,1
s_cmp_ge_u32 s5,16384
s_cbranch_scc1 l12_finrdyb
s_waitcnt vmcnt(0)
v_readfirstlane_b32 s6,v26
s_nop 3
s_cmp_ge_u32 s6,6
s_cbranch_scc1 l12_finrdyb
s_sleep 4
s_branch l12_finspinb
l12_finrdyb:
s_waitcnt lgkmcnt(0)
s_barrier
M2 64,0,48,64
s_add_u32 m0,s35,24576
T 24,8,36864
R 64,3,24576
M2 68,0,52,68
T 26,8,43008
L 4,16,29
M2 72,0,56,72
T 28,9,36864
M2 76,0,60,76
T 30,9,43008
L1 5,16,29,1024
M2 80,4,48,80
R 68,3,25600
M2 84,4,52,84
T 32,10,36864
L1 6,16,29,2048
M2 88,4,56,88
T 34,10,43008
M2 92,4,60,92
T 36,11,36864
M2 96,8,48,96
s_add_u32 s29,s29,36864
s_cmp_eq_u32 s29,s59
s_cselect_b32 s29,s58,s29
M2 100,8,52,100
R 72,3,26624
T 38,11,43008
M2 104,8,56,104
s_add_u32 m0,s34,65536
T 40,12,36864
M2 108,8,60,108
T 42,12,43008
M2 112,12,48,112
R 76,3,27648
L6 2,12,28
M2 116,12,52,116
T 44,13,36864
M2 120,12,56,120
T 46,13,43008
L7 2,12,28,1024
M2 124,12,60,124
M2 128,16,48,128
s_add_u32 s28,s28,131072
s_cmp_eq_u32 s28,s61
s_cselect_b32 s28,s60,s28
M2 132,16,52,132
M2 136,16,56,136
M2 140,16,60,140
M2 144,20,48,144
M2 148,20,52,148
M2 152,20,56,152
s_waitcnt vmcnt(10) lgkmcnt(0)
M2 156,20,60,156
s_barrier
s_sub_u32 s38,9,s38
finl_3:
M2 64,24,64,64
s_add_u32 m0,s35,36864
T 0,8,0
R 48,3,0
M2 68,24,68,68
T 2,8,6144
L 4,16,29
M2 72,24,72,72
T 4,9,0
M2 76,24,76,76
T 6,9,6144
L1 5,16,29,1024
M2 80,28,64,80
R 52,3,1024
M2 84,28,68,84
T 8,10,0
L1 6,16,29,2048
M2 88,28,72,88
T 10,10,6144
M2 92,28,76,92
T 12,11,0
M2 96,32,64,96
s_add_u32 s29,s29,36864
s_cmp_eq_u32 s29,s59
s_cselect_b32 s29,s58,s29
M2 100,32,68,100
R 56,3,2048
T 14,11,6144
M2 104,32,72,104
s_add_u32 m0,s34,73728
T 16,12,0
M2 108,32,76,108
T 18,12,6144
M2 112,36,64,112
R 60,3,3072
L6 2,12,28
M2 116,36,68,116
T 20,13,0
M2 120,36,72,120
T 22,13,6144
L7 2,12,28,1024
M2 124,36,76,124
M2 128,40,64,128
s_add_u32 s28,s28,131072
s_cmp_eq_u32 s28,s61
s_cselect_b32 s28,s60,s28
M2 132,40,68,132
M2 136,40,72,136
M2 140,40,76,140
M2 144,44,64,144
M2 148,44,68,148
M2 152,44,72,152
s_waitcnt vmcnt(10) lgkmcnt(0)
M2 156,44,76,156
s_barrier
M2 64,0,48,64
s_add_u32 m0,s35,0
T 24,8,12288
R 64,3,8192
M2 68,0,52,68
T 26,8,18432
L 4,16,29
M2 72,0,56,72
T 28,9,12288
M2 76,0,60,76
T 30,9,18432
L1 5,16,29,1024
M2 80,4,48,80
R 68,3,9216
M2 84,4,52,84
T 32,10,12288
L1 6,16,29,2048
M2 88,4,56,88
T 34,10,18432
M2 92,4,60,92
T 36,11,12288
M2 96,8,48,96
s_add_u32 s29,s29,36864
s_cmp_eq_u32 s29,s59
s_cselect_b32 s29,s58,s29
M2 100,8,52,100
R 72,3,10240
T 38,11,18432
M2 104,8,56,104
s_add_u32 m0,s34,49152
T 40,12,12288
M2 108,8,60,108
T 42,12,18432
M2 112,12,48,112
R 76,3,11264
L6 2,12,28
M2 116,12,52,116
T 44,13,12288
M2 120,12,56,120
T 46,13,18432
L7 2,12,28,1024
M2 124,12,60,124
M2 128,16,48,128
s_add_u32 s28,s28,131072
s_cmp_eq_u32 s28,s61
s_cselect_b32 s28,s60,s28
M2 132,16,52,132
M2 136,16,56,136
M2 140,16,60,140
M2 144,20,48,144
M2 148,20,52,148
M2 152,20,56,152
s_waitcnt vmcnt(10) lgkmcnt(0)
M2 156,20,60,156
s_barrier
M2 64,24,64,64
s_add_u32 m0,s35,12288
T 0,8,24576
R 48,3,16384
M2 68,24,68,68
T 2,8,30720
L 4,16,29
M2 72,24,72,72
T 4,9,24576
M2 76,24,76,76
T 6,9,30720
L1 5,16,29,1024
M2 80,28,64,80
R 52,3,17408
M2 84,28,68,84
T 8,10,24576
L1 6,16,29,2048
M2 88,28,72,88
T 10,10,30720
M2 92,28,76,92
T 12,11,24576
M2 96,32,64,96
s_add_u32 s29,s29,36864
s_cmp_eq_u32 s29,s59
s_cselect_b32 s29,s58,s29
M2 100,32,68,100
R 56,3,18432
T 14,11,30720
M2 104,32,72,104
s_add_u32 m0,s34,57344
T 16,12,24576
M2 108,32,76,108
T 18,12,30720
M2 112,36,64,112
R 60,3,19456
L6 2,12,28
M2 116,36,68,116
T 20,13,24576
M2 120,36,72,120
T 22,13,30720
L7 2,12,28,1024
M2 124,36,76,124
M2 128,40,64,128
s_add_u32 s28,s28,131072
s_cmp_eq_u32 s28,s61
s_cselect_b32 s28,s60,s28
M2 132,40,68,132
M2 136,40,72,136
M2 140,40,76,140
M2 144,44,64,144
M2 148,44,68,148
M2 152,44,72,152
s_waitcnt vmcnt(10) lgkmcnt(0)
M2 156,44,76,156
s_barrier
M2 64,0,48,64
s_add_u32 m0,s35,24576
T 24,8,36864
R 64,3,24576
M2 68,0,52,68
T 26,8,43008
L 4,16,29
M2 72,0,56,72
T 28,9,36864
M2 76,0,60,76
T 30,9,43008
L1 5,16,29,1024
M2 80,4,48,80
R 68,3,25600
M2 84,4,52,84
T 32,10,36864
L1 6,16,29,2048
M2 88,4,56,88
T 34,10,43008
M2 92,4,60,92
T 36,11,36864
M2 96,8,48,96
s_add_u32 s29,s29,36864
s_cmp_eq_u32 s29,s59
s_cselect_b32 s29,s58,s29
M2 100,8,52,100
R 72,3,26624
T 38,11,43008
M2 104,8,56,104
s_add_u32 m0,s34,65536
T 40,12,36864
M2 108,8,60,108
T 42,12,43008
M2 112,12,48,112
R 76,3,27648
L6 2,12,28
M2 116,12,52,116
T 44,13,36864
M2 120,12,56,120
T 46,13,43008
L7 2,12,28,1024
M2 124,12,60,124
M2 128,16,48,128
s_add_u32 s28,s28,131072
s_cmp_eq_u32 s28,s61
s_cselect_b32 s28,s60,s28
M2 132,16,52,132
M2 136,16,56,136
M2 140,16,60,140
M2 144,20,48,144
M2 148,20,52,148
M2 152,20,56,152
s_waitcnt vmcnt(10) lgkmcnt(0)
M2 156,20,60,156
s_barrier
s_sub_u32 s38,s38,1
s_cmp_lg_u32 s38,0
s_cbranch_scc1 finl_3
M2 64,24,64,64
s_add_u32 m0,s35,36864
T 0,8,0
R 48,3,0
M2 68,24,68,68
T 2,8,6144
L 4,16,29
M2 72,24,72,72
T 4,9,0
M2 76,24,76,76
T 6,9,6144
L1 5,16,29,1024
M2 80,28,64,80
R 52,3,1024
M2 84,28,68,84
T 8,10,0
L1 6,16,29,2048
M2 88,28,72,88
T 10,10,6144
M2 92,28,76,92
T 12,11,0
M2 96,32,64,96
s_add_u32 s29,s29,36864
s_cmp_eq_u32 s29,s59
s_cselect_b32 s29,s58,s29
M2 100,32,68,100
R 56,3,2048
T 14,11,6144
M2 104,32,72,104
s_add_u32 m0,s34,73728
T 16,12,0
M2 108,32,76,108
T 18,12,6144
M2 112,36,64,112
R 60,3,3072
L6 2,12,28
M2 116,36,68,116
T 20,13,0
M2 120,36,72,120
T 22,13,6144
L7 2,12,28,1024
M2 124,36,76,124
M2 128,40,64,128
s_add_u32 s28,s28,131072
s_cmp_eq_u32 s28,s61
s_cselect_b32 s28,s60,s28
M2 132,40,68,132
M2 136,40,72,136
M2 140,40,76,140
M2 144,44,64,144
M2 148,44,68,148
M2 152,44,72,152
s_waitcnt vmcnt(10) lgkmcnt(0)
M2 156,44,76,156
s_barrier
M2 64,0,48,64
s_add_u32 s20,s8,75497472
s_addc_u32 s21,s9,0
T 24,8,12288
M2 68,0,52,68
s_and_b32 s21,s21,0xffff
R 64,3,8192
T 26,8,18432
M2 72,0,56,72
s_mov_b32 s22,23592960
T 28,9,12288
M2 76,0,60,76
s_mov_b32 s23,0x00020000
T 30,9,18432
M2 80,4,48,80
s_and_b32 s25,s25,0xffff
R 68,3,9216
M2 84,4,52,84
s_mov_b32 s26,2359296
T 32,10,12288
M2 88,4,56,88
s_mov_b32 s27,0x00020000
T 34,10,18432
M2 92,4,60,92
s_and_b32 s49,s49,0xffff
T 36,11,12288
M2 96,8,48,96
s_mov_b32 s50,2359296
R 72,3,10240
M2 100,8,52,100
s_mov_b32 s51,0x00020000
T 38,11,18432
v_lshlrev_b32_e64 v23,4,v1
M2 104,8,56,104
s_mul_i32 s43,s40,3
T 40,12,12288
M2 108,8,60,108
s_add_u32 s43,s43,s41
T 42,12,18432
M2 112,12,48,112
s_add_u32 s39,s43,64
R 76,3,11264
M2 116,12,52,116
s_lshl_b32 s39,s39,8
T 44,13,12288
M2 120,12,56,120
s_mul_i32 s43,s43,245760
T 46,13,18432
M2 124,12,60,124
s_mul_i32 s33,s30,12288
M2 128,16,48,128
s_add_u32 s43,s43,s33
M2 132,16,52,132
s_lshl_b32 s4,s40,1
M2 136,16,56,136
s_add_u32 s4,s4,s31
M2 140,16,60,140
s_mul_i32 s4,s4,73728
M2 144,20,48,144
s_mul_i32 s33,s41,384
M2 148,20,52,148
M2 152,20,56,152
s_waitcnt vmcnt(5) lgkmcnt(0)
M2 156,20,60,156
s_barrier
M2 64,24,64,64
s_add_u32 s4,s4,s33
T 0,8,24576
R 48,3,16384
M2 68,24,68,68
s_mul_i32 s33,s32,192
T 2,8,30720
M2 72,24,72,72
s_add_u32 s4,s4,s33
T 4,9,24576
M2 76,24,76,76
s_add_u32 s5,s42,0
T 6,9,30720
M2 80,28,64,80
s_and_b32 s33,s5,3
R 52,3,17408
M2 84,28,68,84
s_mul_i32 s33,s33,18432
T 8,10,24576
M2 88,28,72,88
s_add_u32 s52,s4,s33
T 10,10,30720
M2 92,28,76,92
s_lshr_b32 s33,s5,2
T 12,11,24576
M2 96,32,64,96
s_lshl_b32 s33,s33,6
R 56,3,18432
M2 100,32,68,100
s_add_u32 s52,s52,s33
T 14,11,30720
M2 104,32,72,104
s_lshl_b32 s55,s5,10
T 16,12,24576
M2 108,32,76,108
s_add_u32 s55,s55,s43
T 18,12,30720
M2 112,36,64,112
s_add_u32 s5,s42,5
R 60,3,19456
M2 116,36,68,116
s_and_b32 s33,s5,3
T 20,13,24576
M2 120,36,72,120
s_mul_i32 s33,s33,18432
T 22,13,30720
M2 124,36,76,124
s_add_u32 s53,s4,s33
M2 128,40,64,128
s_lshr_b32 s33,s5,2
M2 132,40,68,132
s_lshl_b32 s33,s33,6
M2 136,40,72,136
s_add_u32 s53,s53,s33
M2 140,40,76,140
s_lshl_b32 s56,s5,10
M2 144,44,64,144
s_add_u32 s56,s56,s43
M2 148,44,68,148
s_add_u32 s5,s42,10
M2 152,44,72,152
s_waitcnt vmcnt(0) lgkmcnt(0)
M2 156,44,76,156
s_barrier
M2 64,0,48,64
s_and_b32 s33,s5,3
T 24,8,36864
R 64,3,24576
M2 68,0,52,68
s_mul_i32 s33,s33,18432
T 26,8,43008
M2 72,0,56,72
s_add_u32 s54,s4,s33
T 28,9,36864
M2 76,0,60,76
s_lshr_b32 s33,s5,2
T 30,9,43008
M2 80,4,48,80
s_lshl_b32 s33,s33,6
R 68,3,25600
M2 84,4,52,84
s_add_u32 s54,s54,s33
T 32,10,36864
M2 88,4,56,88
s_lshl_b32 s57,s5,10
T 34,10,43008
M2 92,4,60,92
s_add_u32 s57,s57,s43
T 36,11,36864
M2 96,8,48,96
s_cmp_ge_u32 s5,12
s_cselect_b32 s54,1073741824,s54
s_cselect_b32 s57,1073741824,s57
M2 100,8,52,100
s_mul_i32 s33,s42,49152
R 72,3,26624
T 38,11,43008
M2 104,8,56,104
s_add_u32 s43,s43,s33
T 40,12,36864
N 22,15,1
M2 108,8,60,108
T 42,12,43008
v_mul_u32_u24 v22,1152,v22
M2 112,12,48,112
R 76,3,27648
v_lshrrev_b32_e64 v24,4,v1
M2 116,12,52,116
T 44,13,36864
v_lshl_add_u32 v22,v24,3,v22
M2 120,12,56,120
buffer_load_dwordx2 v[48:49],v22,s[24:27],s52 offen offset:0
T 46,13,43008
M2 124,12,60,124
buffer_load_dwordx2 v[50:51],v22,s[24:27],s52 offen offset:32
buffer_load_dwordx2 v[52:53],v22,s[24:27],s53 offen offset:0
M2 128,16,48,128
buffer_load_dwordx2 v[54:55],v22,s[24:27],s53 offen offset:32
buffer_load_dwordx2 v[56:57],v22,s[24:27],s54 offen offset:0
M2 132,16,52,132
buffer_load_dwordx2 v[58:59],v22,s[24:27],s54 offen offset:32
M2 136,16,56,136
M2 140,16,60,140
M2 144,20,48,144
M2 148,20,52,148
M2 152,20,56,152
M2 156,20,60,156
s_waitcnt lgkmcnt(0)
M2 64,24,64,64
M2 80,28,64,80
M2 68,24,68,68
M2 84,28,68,84
M2 72,24,72,72
M2 88,28,72,88
M2 76,24,76,76
M2 92,28,76,92
M2 96,32,64,96
C 160,64,65
C 161,66,67
M2 112,36,64,112
C 162,80,81
C 163,82,83
M2 100,32,68,100
s_add_u32 s33,s43,0
s_cmp_eq_u32 s42,0
s_cselect_b32 s33,1073741824,s33
M2 116,36,68,116
S1 160,23,20,33,0
C 164,68,69
M2 104,32,72,104
C 165,70,71
C 166,84,85
M2 120,36,72,120
C 167,86,87
M2 108,32,76,108
s_add_u32 s33,s43,0
s_cmp_eq_u32 s42,1
s_cselect_b32 s33,1073741824,s33
M2 124,36,76,124
S1 164,23,20,33,1024
C 168,72,73
M2 128,40,64,128
C 169,74,75
C 170,88,89
M2 144,44,64,144
C 171,90,91
M2 132,40,68,132
s_add_u32 s33,s43,0
s_cmp_eq_u32 s42,2
s_cselect_b32 s33,1073741824,s33
M2 148,44,68,148
S1 168,23,20,33,2048
C 172,76,77
C 173,78,79
M2 136,40,72,136
C 174,92,93
C 175,94,95
M2 152,44,72,152
s_add_u32 s33,s43,0
s_cmp_eq_u32 s42,3
s_cselect_b32 s33,1073741824,s33
M2 140,40,76,140
S1 172,23,20,33,3072
C 176,96,97
C 177,98,99
M2 156,44,76,156
C 178,112,113
C 179,114,115
s_add_u32 s33,s43,4096
s_cmp_eq_u32 s42,4
s_cselect_b32 s33,1073741824,s33
S1 176,23,20,33,0
s_nop 1
C 180,100,101
C 181,102,103
C 182,116,117
C 183,118,119
s_add_u32 s33,s43,4096
s_cmp_eq_u32 s42,0
s_cselect_b32 s33,1073741824,s33
S1 180,23,20,33,1024
C 184,104,105
C 185,106,107
C 186,120,121
C 187,122,123
s_add_u32 s33,s43,4096
s_cmp_eq_u32 s42,1
s_cselect_b32 s33,1073741824,s33
S1 184,23,20,33,2048
C 188,108,109
C 189,110,111
C 190,124,125
C 191,126,127
s_add_u32 s33,s43,4096
s_cmp_eq_u32 s42,2
s_cselect_b32 s33,1073741824,s33
S1 188,23,20,33,3072
C 192,128,129
C 193,130,131
C 194,144,145
C 195,146,147
s_add_u32 s33,s43,8192
s_cmp_eq_u32 s42,3
s_cselect_b32 s33,1073741824,s33
S1 192,23,20,33,0
C 196,132,133
C 197,134,135
C 198,148,149
C 199,150,151
s_add_u32 s33,s43,8192
s_cmp_eq_u32 s42,4
s_cselect_b32 s33,1073741824,s33
S1 196,23,20,33,1024
C 200,136,137
C 201,138,139
C 202,152,153
C 203,154,155
s_add_u32 s33,s43,8192
s_cmp_eq_u32 s42,0
s_cselect_b32 s33,1073741824,s33
S1 200,23,20,33,2048
C 204,140,141
C 205,142,143
C 206,156,157
C 207,158,159
s_add_u32 s33,s43,8192
s_cmp_eq_u32 s42,1
s_cselect_b32 s33,1073741824,s33
S1 204,23,20,33,3072
s_cmp_eq_u32 s42,0
s_cbranch_scc0 fin_mv1
V1 24,64
V1 28,80
V1 25,65
V1 29,81
V1 26,66
V1 30,82
V1 27,67
V1 31,83
V1 32,100
V1 36,116
V1 33,101
V1 37,117
V1 34,102
V1 38,118
V1 35,103
V1 39,119
V1 40,136
V1 44,152
V1 41,137
V1 45,153
V1 42,138
V1 46,154
V1 43,139
V1 47,155
s_branch fin_mvd
fin_mv1:
s_cmp_eq_u32 s42,1
s_cbranch_scc0 fin_mv2
V1 24,68
V1 28,84
V1 25,69
V1 29,85
V1 26,70
V1 30,86
V1 27,71
V1 31,87
V1 32,104
V1 36,120
V1 33,105
V1 37,121
V1 34,106
V1 38,122
V1 35,107
V1 39,123
V1 40,140
V1 44,156
V1 41,141
V1 45,157
V1 42,142
V1 46,158
V1 43,143
V1 47,159
s_branch fin_mvd
fin_mv2:
s_cmp_eq_u32 s42,2
s_cbranch_scc0 fin_mv3
V1 24,72
V1 28,88
V1 25,73
V1 29,89
V1 26,74
V1 30,90
V1 27,75
V1 31,91
V1 32,108
V1 36,124
V1 33,109
V1 37,125
V1 34,110
V1 38,126
V1 35,111
V1 39,127
s_branch fin_mvd
fin_mv3:
s_cmp_eq_u32 s42,3
s_cbranch_scc0 fin_mv4
V1 24,76
V1 28,92
V1 25,77
V1 29,93
V1 26,78
V1 30,94
V1 27,79
V1 31,95
V1 32,128
V1 36,144
V1 33,129
V1 37,145
V1 34,130
V1 38,146
V1 35,131
V1 39,147
s_branch fin_mvd
fin_mv4:
V1 24,96
V1 28,112
V1 25,97
V1 29,113
V1 26,98
V1 30,114
V1 27,99
V1 31,115
V1 32,132
V1 36,148
V1 33,133
V1 37,149
V1 34,134
V1 38,150
V1 35,135
V1 39,151
fin_mvd:
s_waitcnt vmcnt(12)
SL 4,16,48
N 5,0xffff0000,48
PA 24,24,4
SL 4,16,49
N 5,0xffff0000,49
PA 26,26,4
SL 4,16,50
N 5,0xffff0000,50
PA 28,28,4
SL 4,16,51
N 5,0xffff0000,51
PA 30,30,4
SL 4,16,52
N 5,0xffff0000,52
PA 32,32,4
SL 4,16,53
N 5,0xffff0000,53
PA 34,34,4
SL 4,16,54
N 5,0xffff0000,54
PA 36,36,4
SL 4,16,55
N 5,0xffff0000,55
PA 38,38,4
SL 4,16,56
N 5,0xffff0000,56
PA 40,40,4
SL 4,16,57
N 5,0xffff0000,57
PA 42,42,4
SL 4,16,58
N 5,0xffff0000,58
PA 44,44,4
SL 4,16,59
N 5,0xffff0000,59
PA 46,46,4
s_add_u32 s5,s42,1
s_cmp_ge_u32 s5,5
s_cselect_b32 s33,5,0
s_sub_u32 s5,s5,s33
s_mul_i32 s58,s5,49152
s_add_u32 s5,s42,2
s_cmp_ge_u32 s5,5
s_cselect_b32 s33,5,0
s_sub_u32 s5,s5,s33
s_mul_i32 s59,s5,49152
s_add_u32 s5,s42,3
s_cmp_ge_u32 s5,5
s_cselect_b32 s33,5,0
s_sub_u32 s5,s5,s33
s_mul_i32 s60,s5,49152
s_add_u32 s5,s42,4
s_cmp_ge_u32 s5,5
s_cselect_b32 s33,5,0
s_sub_u32 s5,s5,s33
s_mul_i32 s61,s5,49152
s_waitcnt vmcnt(0)
s_barrier
buffer_atomic_add v21,v20,s[92:95],s39 offen sc1
s_cmp_lg_u32 s30,0
s_cbranch_scc1 fin_rdy
s_mov_b32 s5,0
fin_spin:
buffer_load_dword v6,v20,s[92:95],s39 offen sc1
s_add_u32 s5,s5,1
s_cmp_ge_u32 s5,32768
s_cbranch_scc1 fin_rdy
s_waitcnt vmcnt(0)
v_readfirstlane_b32 s33,v6
s_nop 3
s_cmp_ge_u32 s33,5
s_cbranch_scc1 fin_rdy
s_sleep 2
s_branch fin_spin
fin_rdy:
s_barrier
s_add_u32 s33,s55,s58
L8 64,23,20,33
s_add_u32 s33,s56,s58
L8 80,23,20,33
s_add_u32 s33,s57,s58
L8 96,23,20,33
s_add_u32 s33,s55,s59
L8 68,23,20,33
s_add_u32 s33,s56,s59
L8 84,23,20,33
s_add_u32 s33,s57,s59
L8 100,23,20,33
s_add_u32 s33,s55,s60
L8 72,23,20,33
s_add_u32 s33,s56,s60
L8 88,23,20,33
s_add_u32 s33,s57,s60
L8 104,23,20,33
s_add_u32 s33,s55,s61
L8 76,23,20,33
s_add_u32 s33,s56,s61
L8 92,23,20,33
s_add_u32 s33,s57,s61
L8 108,23,20,33
s_waitcnt vmcnt(9)
SL 4,16,64
N 5,0xffff0000,64
PA 24,24,4
SL 6,16,65
N 7,0xffff0000,65
PA 26,26,6
SL 4,16,66
N 5,0xffff0000,66
PA 28,28,4
SL 6,16,67
N 7,0xffff0000,67
PA 30,30,6
SL 4,16,80
N 5,0xffff0000,80
PA 32,32,4
SL 6,16,81
N 7,0xffff0000,81
PA 34,34,6
SL 4,16,82
N 5,0xffff0000,82
PA 36,36,4
SL 6,16,83
N 7,0xffff0000,83
PA 38,38,6
SL 4,16,96
N 5,0xffff0000,96
PA 40,40,4
SL 6,16,97
N 7,0xffff0000,97
PA 42,42,6
SL 4,16,98
N 5,0xffff0000,98
PA 44,44,4
SL 6,16,99
N 7,0xffff0000,99
PA 46,46,6
s_waitcnt vmcnt(6)
SL 4,16,68
N 5,0xffff0000,68
PA 24,24,4
SL 6,16,69
N 7,0xffff0000,69
PA 26,26,6
SL 4,16,70
N 5,0xffff0000,70
PA 28,28,4
SL 6,16,71
N 7,0xffff0000,71
PA 30,30,6
SL 4,16,84
N 5,0xffff0000,84
PA 32,32,4
SL 6,16,85
N 7,0xffff0000,85
PA 34,34,6
SL 4,16,86
N 5,0xffff0000,86
PA 36,36,4
SL 6,16,87
N 7,0xffff0000,87
PA 38,38,6
SL 4,16,100
N 5,0xffff0000,100
PA 40,40,4
SL 6,16,101
N 7,0xffff0000,101
PA 42,42,6
SL 4,16,102
N 5,0xffff0000,102
PA 44,44,4
SL 6,16,103
N 7,0xffff0000,103
PA 46,46,6
s_waitcnt vmcnt(3)
SL 4,16,72
N 5,0xffff0000,72
PA 24,24,4
SL 6,16,73
N 7,0xffff0000,73
PA 26,26,6
SL 4,16,74
N 5,0xffff0000,74
PA 28,28,4
SL 6,16,75
N 7,0xffff0000,75
PA 30,30,6
SL 4,16,88
N 5,0xffff0000,88
PA 32,32,4
SL 6,16,89
N 7,0xffff0000,89
PA 34,34,6
SL 4,16,90
N 5,0xffff0000,90
PA 36,36,4
SL 6,16,91
N 7,0xffff0000,91
PA 38,38,6
SL 4,16,104
N 5,0xffff0000,104
PA 40,40,4
SL 6,16,105
N 7,0xffff0000,105
PA 42,42,6
SL 4,16,106
N 5,0xffff0000,106
PA 44,44,4
SL 6,16,107
N 7,0xffff0000,107
PA 46,46,6
s_waitcnt vmcnt(0)
SL 4,16,76
N 5,0xffff0000,76
PA 24,24,4
SL 6,16,77
N 7,0xffff0000,77
PA 26,26,6
SL 4,16,78
N 5,0xffff0000,78
PA 28,28,4
SL 6,16,79
N 7,0xffff0000,79
PA 30,30,6
C 48,24,25
C 49,26,27
C 50,28,29
C 51,30,31
buffer_store_dwordx2 v[48:49],v22,s[48:51],s52 offen offset:0
buffer_store_dwordx2 v[50:51],v22,s[48:51],s52 offen offset:32
SL 4,16,92
N 5,0xffff0000,92
PA 32,32,4
SL 6,16,93
N 7,0xffff0000,93
PA 34,34,6
SL 4,16,94
N 5,0xffff0000,94
PA 36,36,4
SL 6,16,95
N 7,0xffff0000,95
PA 38,38,6
C 52,32,33
C 53,34,35
C 54,36,37
C 55,38,39
buffer_store_dwordx2 v[52:53],v22,s[48:51],s53 offen offset:0
buffer_store_dwordx2 v[54:55],v22,s[48:51],s53 offen offset:32
SL 4,16,108
N 5,0xffff0000,108
PA 40,40,4
SL 6,16,109
N 7,0xffff0000,109
PA 42,42,6
SL 4,16,110
N 5,0xffff0000,110
PA 44,44,4
SL 6,16,111
N 7,0xffff0000,111
PA 46,46,6
C 56,40,41
C 57,42,43
C 58,44,45
C 59,46,47
buffer_store_dwordx2 v[56:57],v22,s[48:51],s54 offen offset:0
buffer_store_dwordx2 v[58:59],v22,s[48:51],s54 offen offset:32
s_endpgm
spin_st:
s_mov_b32 s100,0
spinl_st:
s_sleep 4
buffer_load_dword v0,v26,s[92:95],s40 offen sc1
s_add_u32 s100,s100,1
s_cmp_ge_u32 s100,16384
s_cbranch_scc1 spinret_st
s_waitcnt vmcnt(0)
v_readfirstlane_b32 s39,v0
s_nop 3
s_cmp_lt_u32 s39,12
s_cbranch_scc1 spinl_st
s_branch spinret_st
spin_zn0:
s_mov_b32 s100,0
spinl_zn0:
s_sleep 4
buffer_load_dword v0,v26,s[92:95],s40 offen sc1
s_add_u32 s100,s100,1
s_cmp_ge_u32 s100,16384
s_cbranch_scc1 spinret_zn0
s_waitcnt vmcnt(0)
v_readfirstlane_b32 s39,v0
s_nop 3
s_cmp_lt_u32 s39,8
s_cbranch_scc1 spinl_zn0
s_branch spinret_zn0
.p2align 2
.type fin_tab,@object
fin_tab:
.byte 144,168,147,171,192,216,195,219,150,174,153,177,198,222,201,225,156,180,159,183,204,228,207,231,162,186,165,189,210,234,213,237
.byte 145,169,148,172,193,217,196,220,151,175,154,178,199,223,202,226,157,181,160,184,205,229,208,232,163,187,166,190,211,235,214,238
.byte 146,170,149,173,194,218,197,221,152,176,155,179,200,224,203,227,158,182,161,185,206,230,209,233,164,188,167,191,212,236,215,239
.byte 22,31,37,73,82,118,124,133,23,32,38,74,83,119,125,134,24,33,39,75,84,87,126,135,25,34,40,76,85,88,127,136
.byte 18,27,66,69,78,114,120,129,19,28,67,70,79,115,121,130,20,29,68,71,80,116,122,131,21,30,36,72,81,117,123,132
.byte 26,35,41,77,86,89,128,137,42,3,12,93,54,63,96,105,43,4,13,94,55,64,97,106,44,5,14,95,56,65,98,107
.byte 45,6,15,48,57,138,99,108,46,7,16,49,58,139,100,109,47,8,17,50,59,140,101,110,0,9,90,51,60,141,102,111
.byte 1,10,91,52,61,142,103,112,2,11,92,53,62,143,104,113,255,255,255,255,255,255,255,255,255,255,255,255,255,255,255,255
code_end:
.section .rodata,"a"
.p2align 6
.amdhsa_kernel parallel_sum__compressed_kv_cla__mixer_gmlp__prompt_kernel
.amdhsa_next_free_vgpr 512
.amdhsa_next_free_sgpr 102
.amdhsa_accum_offset 256
.amdhsa_group_segment_fixed_size 0
.amdhsa_kernarg_size 112
.amdhsa_user_sgpr_count 2
.amdhsa_user_sgpr_kernarg_segment_ptr 1
.amdhsa_system_sgpr_workgroup_id_x 1
.amdhsa_float_denorm_mode_32 3
.end_amdhsa_kernel
```
